```python
import torch

def _softmax(x, axis=-1):
    return torch.softmax(x, dim=axis)

def _gelu(x):
    return torch.nn.functional.gelu(x, approximate='tanh')

def _silu(x):
    return torch.nn.functional.silu(x)

def _sigmoid(x):
    return torch.sigmoid(x)

def _layernorm(x, axis=-1, eps=1e-05):
    m = x.mean(dim=axis, keepdim=True)
    v = x.var(dim=axis, keepdim=True, unbiased=False)
    return (x - m) / torch.sqrt(v + eps)

def _scatter_add(tgt, idx, src, axis=0):
    return tgt.clone().index_add_(axis, idx, src)

def _segment_sum(src, seg, n):
    out = torch.zeros((n,) + src.shape[1:], dtype=src.dtype)
    return out.index_add_(0, seg, src)

def _pad(x, pw):
    flat = tuple((v for pair in reversed(pw) for v in pair))
    return torch.nn.functional.pad(x, flat)
kernel_name = 'interleave_layers__memory_aug_recurrent_mem_tr__geglu_ffn__prompt'

def setup_inputs():

    _w = lambda a: (lambda t: t.to(torch.bfloat16) if t.is_floating_point() else t)(torch.as_tensor(a))

    def _A_setup():
        B, S, Dm = (1, 2048, 512)
        H, Dh = (32, 128)
        M, seg = (8, 32)
        seg = min(seg, S)
        S = S // seg * seg
        return {'x': _w((lambda *s: torch.randn(*s, dtype=torch.bfloat16) * 0.05)(B, S, Dm)), 'mem0': _w((lambda *s: torch.randn(*s, dtype=torch.bfloat16) * 0.8)(B, M, Dm)), 'Wq': _w((lambda *s: torch.randn(*s, dtype=torch.bfloat16) * 0.8)(Dm, H, Dh) * Dm ** (-0.5)), 'Wk': _w((lambda *s: torch.randn(*s, dtype=torch.bfloat16) * 0.8)(Dm, H, Dh) * Dm ** (-0.5)), 'Wv': _w((lambda *s: torch.randn(*s, dtype=torch.bfloat16) * 0.8)(Dm, H, Dh) * Dm ** (-0.5)), 'Wo': _w((lambda *s: torch.randn(*s, dtype=torch.bfloat16) * 0.8)(H, Dh, Dm) * (H * Dh) ** (-0.5)), 'seg_len': seg}
    _A_in = _A_setup()

    def _B_setup():
        B, S, D, F = (1, 2048, 512, 1792)
        return {'x': _w((lambda *s: torch.randn(*s, dtype=torch.bfloat16) * 0.05)(B, S, D)), 'w_gate': _w((lambda *s: torch.randn(*s, dtype=torch.bfloat16) * 0.05)(D, F)), 'w_up': _w((lambda *s: torch.randn(*s, dtype=torch.bfloat16) * 0.05)(D, F)), 'w_down': _w((lambda *s: torch.randn(*s, dtype=torch.bfloat16) * 0.05)(F, D))}
    _B_in = _B_setup()
    return {'A_x': _A_in['x'], 'A_mem0': _A_in['mem0'], 'A_Wq': _A_in['Wq'], 'A_Wk': _A_in['Wk'], 'A_Wv': _A_in['Wv'], 'A_Wo': _A_in['Wo'], 'A_seg_len': _A_in['seg_len'], 'B_x': _B_in['x'], 'B_w_gate': _B_in['w_gate'], 'B_w_up': _B_in['w_up'], 'B_w_down': _B_in['w_down']}

def reference(A_x, A_mem0, A_Wq, A_Wk, A_Wv, A_Wo, A_seg_len, B_x, B_w_gate, B_w_up, B_w_down):

    def _A_ref(x, mem0, Wq, Wk, Wv, Wo, seg_len):
        B, S, Dm = x.shape
        H, Dh = (Wq.shape[1], Wq.shape[2])
        M = mem0.shape[1]
        scale = Dh ** (-0.5)
        n_seg = S // seg_len
        L = M + seg_len
        idx = torch.arange(L)
        mask = (idx[:, None] < M) | (idx[:, None] >= idx[None, :])
        mem = mem0
        outs = []
        for s in range(n_seg):
            xs = x[:, s * seg_len:(s + 1) * seg_len, :].clone()
            h = torch.concatenate([mem, xs], axis=1)
            q = torch.einsum('btd,dhe->bhte', h, Wq)
            k = torch.einsum('btd,dhe->bhte', h, Wk)
            v = torch.einsum('btd,dhe->bhte', h, Wv)
            scores = torch.einsum('bhqe,bhke->bhqk', q, k) * scale
            scores = torch.where(mask[None, None], scores, -1000000000.0)
            p = _softmax(scores, axis=-1)
            o = torch.einsum('bhqk,bhke->bhqe', p, v)
            o = torch.einsum('bhte,hed->btd', o, Wo)
            mem = o[:, :M, :].clone()
            outs.append(o[:, M:, :])
        return torch.concatenate(outs, axis=1)

    def _B_ref(x, w_gate, w_up, w_down):
        return _gelu(x @ w_gate) * (x @ w_up) @ w_down
    x = A_x
    x = x + _A_ref(_layernorm(x, axis=-1), A_mem0, A_Wq, A_Wk, A_Wv, A_Wo, A_seg_len)
    x = x + _B_ref(_layernorm(x, axis=-1), B_w_gate, B_w_up, B_w_down)
    x = x + _A_ref(_layernorm(x, axis=-1), A_mem0, A_Wq, A_Wk, A_Wv, A_Wo, A_seg_len)
    x = x + _B_ref(_layernorm(x, axis=-1), B_w_gate, B_w_up, B_w_down)
    return x
```

```asm
; @launch kernel=prep_kernel grid=(485,1,1) block=(256,1,1) lds=0
; @launch kernel=mega_kernel grid=(256,1,1) block=(256,1,1) lds=157184
.amdgcn_target "amdgcn-amd-amdhsa--gfx950"
.text
.globl prep_kernel
.p2align 8
.type prep_kernel,@function
prep_kernel:
    s_load_dwordx2 s[20:21], s[0:1], 104
    s_waitcnt lgkmcnt(0)
    s_mov_b32 s4, s20
    s_and_b32 s5, s21, 0xffff
    s_mov_b32 s6, 268435456
    s_mov_b32 s7, 0x00020000
    s_mov_b32 s16, 0x05040100
    s_mov_b32 s17, 0x07060302
    s_cmp_lt_u32 s2, 64
    s_cbranch_scc1 L_prep_fill
    s_cmp_lt_u32 s2, 324
    s_cbranch_scc1 L_prep_memx
    s_cmp_lt_u32 s2, 356
    s_cbranch_scc1 L_prep_xcopy
    s_cmp_lt_u32 s2, 357
    s_cbranch_scc1 L_prep_cnt
    s_cmp_lt_u32 s2, 485
    s_cbranch_scc1 L_prep_ln
    s_endpgm
L_prep_fill:
    s_sub_u32 s3, s2, 0
    s_lshl_b32 s3, s3, 16
    s_add_u32 s3, s3, 44040192
    v_lshlrev_b32 v1, 4, v0
    v_mov_b32 v4, -1
    v_mov_b32 v5, -1
    v_mov_b32 v6, -1
    v_mov_b32 v7, -1
    buffer_store_dwordx4 v[4:7], v1, s[4:7], s3 offen
    s_add_u32 s3, s3, 4096
    buffer_store_dwordx4 v[4:7], v1, s[4:7], s3 offen
    s_add_u32 s3, s3, 4096
    buffer_store_dwordx4 v[4:7], v1, s[4:7], s3 offen
    s_add_u32 s3, s3, 4096
    buffer_store_dwordx4 v[4:7], v1, s[4:7], s3 offen
    s_add_u32 s3, s3, 4096
    buffer_store_dwordx4 v[4:7], v1, s[4:7], s3 offen
    s_add_u32 s3, s3, 4096
    buffer_store_dwordx4 v[4:7], v1, s[4:7], s3 offen
    s_add_u32 s3, s3, 4096
    buffer_store_dwordx4 v[4:7], v1, s[4:7], s3 offen
    s_add_u32 s3, s3, 4096
    buffer_store_dwordx4 v[4:7], v1, s[4:7], s3 offen
    s_add_u32 s3, s3, 4096
    buffer_store_dwordx4 v[4:7], v1, s[4:7], s3 offen
    s_add_u32 s3, s3, 4096
    buffer_store_dwordx4 v[4:7], v1, s[4:7], s3 offen
    s_add_u32 s3, s3, 4096
    buffer_store_dwordx4 v[4:7], v1, s[4:7], s3 offen
    s_add_u32 s3, s3, 4096
    buffer_store_dwordx4 v[4:7], v1, s[4:7], s3 offen
    s_add_u32 s3, s3, 4096
    buffer_store_dwordx4 v[4:7], v1, s[4:7], s3 offen
    s_add_u32 s3, s3, 4096
    buffer_store_dwordx4 v[4:7], v1, s[4:7], s3 offen
    s_add_u32 s3, s3, 4096
    buffer_store_dwordx4 v[4:7], v1, s[4:7], s3 offen
    s_add_u32 s3, s3, 4096
    buffer_store_dwordx4 v[4:7], v1, s[4:7], s3 offen
    s_endpgm
L_prep_cnt:
    s_mov_b32 s3, 48234496
    v_lshlrev_b32 v1, 4, v0
    v_mov_b32 v4, 0
    v_mov_b32 v5, 0
    v_mov_b32 v6, 0
    v_mov_b32 v7, 0
    buffer_store_dwordx4 v[4:7], v1, s[4:7], s3 offen
    s_add_u32 s3, s3, 4096
    buffer_store_dwordx4 v[4:7], v1, s[4:7], s3 offen
    s_add_u32 s3, s3, 4096
    buffer_store_dwordx4 v[4:7], v1, s[4:7], s3 offen
    s_add_u32 s3, s3, 4096
    buffer_store_dwordx4 v[4:7], v1, s[4:7], s3 offen
    s_add_u32 s3, s3, 4096
    buffer_store_dwordx4 v[4:7], v1, s[4:7], s3 offen
    s_add_u32 s3, s3, 4096
    buffer_store_dwordx4 v[4:7], v1, s[4:7], s3 offen
    s_add_u32 s3, s3, 4096
    buffer_store_dwordx4 v[4:7], v1, s[4:7], s3 offen
    s_add_u32 s3, s3, 4096
    buffer_store_dwordx4 v[4:7], v1, s[4:7], s3 offen
    s_add_u32 s3, s3, 4096
    buffer_store_dwordx4 v[4:7], v1, s[4:7], s3 offen
    s_add_u32 s3, s3, 4096
    buffer_store_dwordx4 v[4:7], v1, s[4:7], s3 offen
    s_add_u32 s3, s3, 4096
    buffer_store_dwordx4 v[4:7], v1, s[4:7], s3 offen
    s_add_u32 s3, s3, 4096
    buffer_store_dwordx4 v[4:7], v1, s[4:7], s3 offen
    s_add_u32 s3, s3, 4096
    buffer_store_dwordx4 v[4:7], v1, s[4:7], s3 offen
    s_add_u32 s3, s3, 4096
    buffer_store_dwordx4 v[4:7], v1, s[4:7], s3 offen
    s_add_u32 s3, s3, 4096
    buffer_store_dwordx4 v[4:7], v1, s[4:7], s3 offen
    s_add_u32 s3, s3, 4096
    buffer_store_dwordx4 v[4:7], v1, s[4:7], s3 offen
    s_endpgm
L_prep_ln:
    s_load_dwordx2 s[20:21], s[0:1], 0
    s_waitcnt lgkmcnt(0)
    s_mov_b32 s8, s20
    s_and_b32 s9, s21, 0xffff
    s_mov_b32 s10, 2097152
    s_mov_b32 s11, 0x00020000
    s_sub_u32 s3, s2, 357
    v_lshrrev_b32 v1, 4, v0
    s_lshl_b32 s3, s3, 4
    v_add_u32 v1, s3, v1
    v_and_b32 v2, 15, v0
    v_lshlrev_b32 v3, 10, v1
    v_lshl_add_u32 v3, v2, 4, v3
    s_mov_b32 s19, 0
    buffer_load_dwordx4 v[16:19], v3, s[8:11], s19 offen offset:0
    buffer_load_dwordx4 v[20:23], v3, s[8:11], s19 offen offset:256
    buffer_load_dwordx4 v[24:27], v3, s[8:11], s19 offen offset:512
    buffer_load_dwordx4 v[28:31], v3, s[8:11], s19 offen offset:768
    v_bfe_u32 v4, v1, 3, 2
    v_and_b32 v5, 3, v1
    v_lshl_add_u32 v4, v4, 2, v5
    v_and_b32 v5, 3, v2
    v_lshl_add_u32 v4, v5, 4, v4
    v_lshlrev_b32 v4, 4, v4
    v_bfe_u32 v5, v1, 2, 1
    v_bfe_u32 v6, v1, 5, 1
    v_lshl_add_u32 v5, v6, 1, v5
    v_lshl_add_u32 v4, v5, 10, v4
    v_lshrrev_b32 v5, 6, v1
    v_lshrrev_b32 v6, 2, v2
    v_lshl_add_u32 v5, v5, 4, v6
    v_lshl_add_u32 v4, v5, 12, v4
    s_waitcnt vmcnt(0)
    v_lshlrev_b32 v32, 16, v16
    v_and_b32 v33, 0xffff0000, v16
    v_lshlrev_b32 v34, 16, v17
    v_and_b32 v35, 0xffff0000, v17
    v_lshlrev_b32 v36, 16, v18
    v_and_b32 v37, 0xffff0000, v18
    v_lshlrev_b32 v38, 16, v19
    v_and_b32 v39, 0xffff0000, v19
    v_lshlrev_b32 v40, 16, v20
    v_and_b32 v41, 0xffff0000, v20
    v_lshlrev_b32 v42, 16, v21
    v_and_b32 v43, 0xffff0000, v21
    v_lshlrev_b32 v44, 16, v22
    v_and_b32 v45, 0xffff0000, v22
    v_lshlrev_b32 v46, 16, v23
    v_and_b32 v47, 0xffff0000, v23
    v_lshlrev_b32 v48, 16, v24
    v_and_b32 v49, 0xffff0000, v24
    v_lshlrev_b32 v50, 16, v25
    v_and_b32 v51, 0xffff0000, v25
    v_lshlrev_b32 v52, 16, v26
    v_and_b32 v53, 0xffff0000, v26
    v_lshlrev_b32 v54, 16, v27
    v_and_b32 v55, 0xffff0000, v27
    v_lshlrev_b32 v56, 16, v28
    v_and_b32 v57, 0xffff0000, v28
    v_lshlrev_b32 v58, 16, v29
    v_and_b32 v59, 0xffff0000, v29
    v_lshlrev_b32 v60, 16, v30
    v_and_b32 v61, 0xffff0000, v30
    v_lshlrev_b32 v62, 16, v31
    v_and_b32 v63, 0xffff0000, v31
    v_add_f32 v7, v32, v33
    v_add_f32 v7, v7, v34
    v_add_f32 v7, v7, v35
    v_add_f32 v7, v7, v36
    v_add_f32 v7, v7, v37
    v_add_f32 v7, v7, v38
    v_add_f32 v7, v7, v39
    v_add_f32 v7, v7, v40
    v_add_f32 v7, v7, v41
    v_add_f32 v7, v7, v42
    v_add_f32 v7, v7, v43
    v_add_f32 v7, v7, v44
    v_add_f32 v7, v7, v45
    v_add_f32 v7, v7, v46
    v_add_f32 v7, v7, v47
    v_add_f32 v7, v7, v48
    v_add_f32 v7, v7, v49
    v_add_f32 v7, v7, v50
    v_add_f32 v7, v7, v51
    v_add_f32 v7, v7, v52
    v_add_f32 v7, v7, v53
    v_add_f32 v7, v7, v54
    v_add_f32 v7, v7, v55
    v_add_f32 v7, v7, v56
    v_add_f32 v7, v7, v57
    v_add_f32 v7, v7, v58
    v_add_f32 v7, v7, v59
    v_add_f32 v7, v7, v60
    v_add_f32 v7, v7, v61
    v_add_f32 v7, v7, v62
    v_add_f32 v7, v7, v63
    s_nop 1
    v_add_f32_dpp v7, v7, v7 row_ror:8
    s_nop 1
    v_add_f32_dpp v7, v7, v7 row_ror:4
    s_nop 1
    v_add_f32_dpp v7, v7, v7 row_ror:2
    s_nop 1
    v_add_f32_dpp v7, v7, v7 row_ror:1
    v_mul_f32 v7, 0x3b000000, v7
    v_sub_f32 v8, v32, v7
    v_mul_f32 v9, v8, v8
    v_sub_f32 v8, v33, v7
    v_fmac_f32 v9, v8, v8
    v_sub_f32 v8, v34, v7
    v_fmac_f32 v9, v8, v8
    v_sub_f32 v8, v35, v7
    v_fmac_f32 v9, v8, v8
    v_sub_f32 v8, v36, v7
    v_fmac_f32 v9, v8, v8
    v_sub_f32 v8, v37, v7
    v_fmac_f32 v9, v8, v8
    v_sub_f32 v8, v38, v7
    v_fmac_f32 v9, v8, v8
    v_sub_f32 v8, v39, v7
    v_fmac_f32 v9, v8, v8
    v_sub_f32 v8, v40, v7
    v_fmac_f32 v9, v8, v8
    v_sub_f32 v8, v41, v7
    v_fmac_f32 v9, v8, v8
    v_sub_f32 v8, v42, v7
    v_fmac_f32 v9, v8, v8
    v_sub_f32 v8, v43, v7
    v_fmac_f32 v9, v8, v8
    v_sub_f32 v8, v44, v7
    v_fmac_f32 v9, v8, v8
    v_sub_f32 v8, v45, v7
    v_fmac_f32 v9, v8, v8
    v_sub_f32 v8, v46, v7
    v_fmac_f32 v9, v8, v8
    v_sub_f32 v8, v47, v7
    v_fmac_f32 v9, v8, v8
    v_sub_f32 v8, v48, v7
    v_fmac_f32 v9, v8, v8
    v_sub_f32 v8, v49, v7
    v_fmac_f32 v9, v8, v8
    v_sub_f32 v8, v50, v7
    v_fmac_f32 v9, v8, v8
    v_sub_f32 v8, v51, v7
    v_fmac_f32 v9, v8, v8
    v_sub_f32 v8, v52, v7
    v_fmac_f32 v9, v8, v8
    v_sub_f32 v8, v53, v7
    v_fmac_f32 v9, v8, v8
    v_sub_f32 v8, v54, v7
    v_fmac_f32 v9, v8, v8
    v_sub_f32 v8, v55, v7
    v_fmac_f32 v9, v8, v8
    v_sub_f32 v8, v56, v7
    v_fmac_f32 v9, v8, v8
    v_sub_f32 v8, v57, v7
    v_fmac_f32 v9, v8, v8
    v_sub_f32 v8, v58, v7
    v_fmac_f32 v9, v8, v8
    v_sub_f32 v8, v59, v7
    v_fmac_f32 v9, v8, v8
    v_sub_f32 v8, v60, v7
    v_fmac_f32 v9, v8, v8
    v_sub_f32 v8, v61, v7
    v_fmac_f32 v9, v8, v8
    v_sub_f32 v8, v62, v7
    v_fmac_f32 v9, v8, v8
    v_sub_f32 v8, v63, v7
    v_fmac_f32 v9, v8, v8
    s_nop 1
    v_add_f32_dpp v9, v9, v9 row_ror:8
    s_nop 1
    v_add_f32_dpp v9, v9, v9 row_ror:4
    s_nop 1
    v_add_f32_dpp v9, v9, v9 row_ror:2
    s_nop 1
    v_add_f32_dpp v9, v9, v9 row_ror:1
    v_mul_f32 v9, 0x3b000000, v9
    v_cvt_pk_bf16_f32 v10, v7, v7
    v_lshlrev_b32 v7, 16, v10
    v_cvt_pk_bf16_f32 v10, v9, v9
    v_lshlrev_b32 v9, 16, v10
    v_add_f32 v9, 0x3727c5ac, v9
    v_cvt_pk_bf16_f32 v10, v9, v9
    v_lshlrev_b32 v9, 16, v10
    v_sqrt_f32 v9, v9
    s_nop 0
    v_cvt_pk_bf16_f32 v10, v9, v9
    v_lshlrev_b32 v9, 16, v10
    v_rcp_f32 v9, v9
    v_sub_f32 v32, v32, v7
    v_sub_f32 v33, v33, v7
    v_cvt_pk_bf16_f32 v10, v32, v33
    v_lshlrev_b32 v32, 16, v10
    v_and_b32 v33, 0xffff0000, v10
    v_mul_f32 v32, v32, v9
    v_mul_f32 v33, v33, v9
    v_cvt_pk_bf16_f32 v16, v32, v33
    v_sub_f32 v34, v34, v7
    v_sub_f32 v35, v35, v7
    v_cvt_pk_bf16_f32 v10, v34, v35
    v_lshlrev_b32 v34, 16, v10
    v_and_b32 v35, 0xffff0000, v10
    v_mul_f32 v34, v34, v9
    v_mul_f32 v35, v35, v9
    v_cvt_pk_bf16_f32 v17, v34, v35
    v_sub_f32 v36, v36, v7
    v_sub_f32 v37, v37, v7
    v_cvt_pk_bf16_f32 v10, v36, v37
    v_lshlrev_b32 v36, 16, v10
    v_and_b32 v37, 0xffff0000, v10
    v_mul_f32 v36, v36, v9
    v_mul_f32 v37, v37, v9
    v_cvt_pk_bf16_f32 v18, v36, v37
    v_sub_f32 v38, v38, v7
    v_sub_f32 v39, v39, v7
    v_cvt_pk_bf16_f32 v10, v38, v39
    v_lshlrev_b32 v38, 16, v10
    v_and_b32 v39, 0xffff0000, v10
    v_mul_f32 v38, v38, v9
    v_mul_f32 v39, v39, v9
    v_cvt_pk_bf16_f32 v19, v38, v39
    v_sub_f32 v40, v40, v7
    v_sub_f32 v41, v41, v7
    v_cvt_pk_bf16_f32 v10, v40, v41
    v_lshlrev_b32 v40, 16, v10
    v_and_b32 v41, 0xffff0000, v10
    v_mul_f32 v40, v40, v9
    v_mul_f32 v41, v41, v9
    v_cvt_pk_bf16_f32 v20, v40, v41
    v_sub_f32 v42, v42, v7
    v_sub_f32 v43, v43, v7
    v_cvt_pk_bf16_f32 v10, v42, v43
    v_lshlrev_b32 v42, 16, v10
    v_and_b32 v43, 0xffff0000, v10
    v_mul_f32 v42, v42, v9
    v_mul_f32 v43, v43, v9
    v_cvt_pk_bf16_f32 v21, v42, v43
    v_sub_f32 v44, v44, v7
    v_sub_f32 v45, v45, v7
    v_cvt_pk_bf16_f32 v10, v44, v45
    v_lshlrev_b32 v44, 16, v10
    v_and_b32 v45, 0xffff0000, v10
    v_mul_f32 v44, v44, v9
    v_mul_f32 v45, v45, v9
    v_cvt_pk_bf16_f32 v22, v44, v45
    v_sub_f32 v46, v46, v7
    v_sub_f32 v47, v47, v7
    v_cvt_pk_bf16_f32 v10, v46, v47
    v_lshlrev_b32 v46, 16, v10
    v_and_b32 v47, 0xffff0000, v10
    v_mul_f32 v46, v46, v9
    v_mul_f32 v47, v47, v9
    v_cvt_pk_bf16_f32 v23, v46, v47
    v_sub_f32 v48, v48, v7
    v_sub_f32 v49, v49, v7
    v_cvt_pk_bf16_f32 v10, v48, v49
    v_lshlrev_b32 v48, 16, v10
    v_and_b32 v49, 0xffff0000, v10
    v_mul_f32 v48, v48, v9
    v_mul_f32 v49, v49, v9
    v_cvt_pk_bf16_f32 v24, v48, v49
    v_sub_f32 v50, v50, v7
    v_sub_f32 v51, v51, v7
    v_cvt_pk_bf16_f32 v10, v50, v51
    v_lshlrev_b32 v50, 16, v10
    v_and_b32 v51, 0xffff0000, v10
    v_mul_f32 v50, v50, v9
    v_mul_f32 v51, v51, v9
    v_cvt_pk_bf16_f32 v25, v50, v51
    v_sub_f32 v52, v52, v7
    v_sub_f32 v53, v53, v7
    v_cvt_pk_bf16_f32 v10, v52, v53
    v_lshlrev_b32 v52, 16, v10
    v_and_b32 v53, 0xffff0000, v10
    v_mul_f32 v52, v52, v9
    v_mul_f32 v53, v53, v9
    v_cvt_pk_bf16_f32 v26, v52, v53
    v_sub_f32 v54, v54, v7
    v_sub_f32 v55, v55, v7
    v_cvt_pk_bf16_f32 v10, v54, v55
    v_lshlrev_b32 v54, 16, v10
    v_and_b32 v55, 0xffff0000, v10
    v_mul_f32 v54, v54, v9
    v_mul_f32 v55, v55, v9
    v_cvt_pk_bf16_f32 v27, v54, v55
    v_sub_f32 v56, v56, v7
    v_sub_f32 v57, v57, v7
    v_cvt_pk_bf16_f32 v10, v56, v57
    v_lshlrev_b32 v56, 16, v10
    v_and_b32 v57, 0xffff0000, v10
    v_mul_f32 v56, v56, v9
    v_mul_f32 v57, v57, v9
    v_cvt_pk_bf16_f32 v28, v56, v57
    v_sub_f32 v58, v58, v7
    v_sub_f32 v59, v59, v7
    v_cvt_pk_bf16_f32 v10, v58, v59
    v_lshlrev_b32 v58, 16, v10
    v_and_b32 v59, 0xffff0000, v10
    v_mul_f32 v58, v58, v9
    v_mul_f32 v59, v59, v9
    v_cvt_pk_bf16_f32 v29, v58, v59
    v_sub_f32 v60, v60, v7
    v_sub_f32 v61, v61, v7
    v_cvt_pk_bf16_f32 v10, v60, v61
    v_lshlrev_b32 v60, 16, v10
    v_and_b32 v61, 0xffff0000, v10
    v_mul_f32 v60, v60, v9
    v_mul_f32 v61, v61, v9
    v_cvt_pk_bf16_f32 v30, v60, v61
    v_sub_f32 v62, v62, v7
    v_sub_f32 v63, v63, v7
    v_cvt_pk_bf16_f32 v10, v62, v63
    v_lshlrev_b32 v62, 16, v10
    v_and_b32 v63, 0xffff0000, v10
    v_mul_f32 v62, v62, v9
    v_mul_f32 v63, v63, v9
    v_cvt_pk_bf16_f32 v31, v62, v63
    s_mov_b32 s19, 25165824
    buffer_store_dwordx4 v[16:19], v4, s[4:7], s19 offen
    s_add_u32 s19, s19, 16384
    buffer_store_dwordx4 v[20:23], v4, s[4:7], s19 offen
    s_add_u32 s19, s19, 16384
    buffer_store_dwordx4 v[24:27], v4, s[4:7], s19 offen
    s_add_u32 s19, s19, 16384
    buffer_store_dwordx4 v[28:31], v4, s[4:7], s19 offen
    s_endpgm
L_prep_xcopy:
    s_load_dwordx2 s[20:21], s[0:1], 0
    s_waitcnt lgkmcnt(0)
    s_mov_b32 s8, s20
    s_and_b32 s9, s21, 0xffff
    s_mov_b32 s10, 2097152
    s_mov_b32 s11, 0x00020000
    s_sub_u32 s3, s2, 324
    s_lshl_b32 s3, s3, 16
    s_add_u32 s18, s3, 33554432
    v_lshlrev_b32 v1, 4, v0
    buffer_load_dwordx4 v[4:7], v1, s[8:11], s3 offen
    s_add_u32 s3, s3, 4096
    buffer_load_dwordx4 v[8:11], v1, s[8:11], s3 offen
    s_add_u32 s3, s3, 4096
    buffer_load_dwordx4 v[12:15], v1, s[8:11], s3 offen
    s_add_u32 s3, s3, 4096
    buffer_load_dwordx4 v[16:19], v1, s[8:11], s3 offen
    s_add_u32 s3, s3, 4096
    buffer_load_dwordx4 v[20:23], v1, s[8:11], s3 offen
    s_add_u32 s3, s3, 4096
    buffer_load_dwordx4 v[24:27], v1, s[8:11], s3 offen
    s_add_u32 s3, s3, 4096
    buffer_load_dwordx4 v[28:31], v1, s[8:11], s3 offen
    s_add_u32 s3, s3, 4096
    buffer_load_dwordx4 v[32:35], v1, s[8:11], s3 offen
    s_add_u32 s3, s3, 4096
    buffer_load_dwordx4 v[36:39], v1, s[8:11], s3 offen
    s_add_u32 s3, s3, 4096
    buffer_load_dwordx4 v[40:43], v1, s[8:11], s3 offen
    s_add_u32 s3, s3, 4096
    buffer_load_dwordx4 v[44:47], v1, s[8:11], s3 offen
    s_add_u32 s3, s3, 4096
    buffer_load_dwordx4 v[48:51], v1, s[8:11], s3 offen
    s_add_u32 s3, s3, 4096
    buffer_load_dwordx4 v[52:55], v1, s[8:11], s3 offen
    s_add_u32 s3, s3, 4096
    buffer_load_dwordx4 v[56:59], v1, s[8:11], s3 offen
    s_add_u32 s3, s3, 4096
    buffer_load_dwordx4 v[60:63], v1, s[8:11], s3 offen
    s_add_u32 s3, s3, 4096
    buffer_load_dwordx4 v[64:67], v1, s[8:11], s3 offen
    s_waitcnt vmcnt(15)
    s_waitcnt vmcnt(15)
    buffer_store_dwordx4 v[4:7], v1, s[4:7], s18 offen
    s_add_u32 s18, s18, 4096
    s_nop 0
    s_waitcnt vmcnt(15)
    buffer_store_dwordx4 v[8:11], v1, s[4:7], s18 offen
    s_add_u32 s18, s18, 4096
    s_nop 0
    s_waitcnt vmcnt(15)
    buffer_store_dwordx4 v[12:15], v1, s[4:7], s18 offen
    s_add_u32 s18, s18, 4096
    s_nop 0
    s_waitcnt vmcnt(15)
    buffer_store_dwordx4 v[16:19], v1, s[4:7], s18 offen
    s_add_u32 s18, s18, 4096
    s_nop 0
    s_waitcnt vmcnt(15)
    buffer_store_dwordx4 v[20:23], v1, s[4:7], s18 offen
    s_add_u32 s18, s18, 4096
    s_nop 0
    s_waitcnt vmcnt(15)
    buffer_store_dwordx4 v[24:27], v1, s[4:7], s18 offen
    s_add_u32 s18, s18, 4096
    s_nop 0
    s_waitcnt vmcnt(15)
    buffer_store_dwordx4 v[28:31], v1, s[4:7], s18 offen
    s_add_u32 s18, s18, 4096
    s_nop 0
    s_waitcnt vmcnt(15)
    buffer_store_dwordx4 v[32:35], v1, s[4:7], s18 offen
    s_add_u32 s18, s18, 4096
    s_nop 0
    s_waitcnt vmcnt(15)
    buffer_store_dwordx4 v[36:39], v1, s[4:7], s18 offen
    s_add_u32 s18, s18, 4096
    s_nop 0
    s_waitcnt vmcnt(15)
    buffer_store_dwordx4 v[40:43], v1, s[4:7], s18 offen
    s_add_u32 s18, s18, 4096
    s_nop 0
    s_waitcnt vmcnt(15)
    buffer_store_dwordx4 v[44:47], v1, s[4:7], s18 offen
    s_add_u32 s18, s18, 4096
    s_nop 0
    s_waitcnt vmcnt(15)
    buffer_store_dwordx4 v[48:51], v1, s[4:7], s18 offen
    s_add_u32 s18, s18, 4096
    s_nop 0
    s_waitcnt vmcnt(15)
    buffer_store_dwordx4 v[52:55], v1, s[4:7], s18 offen
    s_add_u32 s18, s18, 4096
    s_nop 0
    s_waitcnt vmcnt(15)
    buffer_store_dwordx4 v[56:59], v1, s[4:7], s18 offen
    s_add_u32 s18, s18, 4096
    s_nop 0
    s_waitcnt vmcnt(15)
    buffer_store_dwordx4 v[60:63], v1, s[4:7], s18 offen
    s_add_u32 s18, s18, 4096
    s_nop 0
    s_waitcnt vmcnt(15)
    buffer_store_dwordx4 v[64:67], v1, s[4:7], s18 offen
    s_endpgm
L_prep_memx:
    s_load_dwordx2 s[20:21], s[0:1], 8
    s_waitcnt lgkmcnt(0)
    s_mov_b32 s8, s20
    s_and_b32 s9, s21, 0xffff
    s_mov_b32 s10, 8192
    s_mov_b32 s11, 0x00020000
    s_sub_u32 s3, s2, 64
    s_lshl_b32 s3, s3, 12
    v_lshlrev_b32 v1, 4, v0
    v_add_u32 v1, s3, v1
    v_subrev_u32 v2, 532480, v1
    v_cmp_gt_u32 vcc, 532480, v1
    s_nop 1
    v_cndmask_b32 v2, v2, v1, vcc
    v_lshrrev_b32 v3, 6, v2
    v_bfe_u32 v4, v2, 3, 3
    v_lshlrev_b32 v5, 10, v4
    v_lshl_add_u32 v5, v3, 3, v5
    buffer_load_dwordx2 v[8:9], v5, s[8:11], 0 offen
    buffer_load_dwordx2 v[10:11], v5, s[8:11], 0 offen offset:1024
    s_waitcnt vmcnt(0)
    v_cmp_gt_u32 vcc, 8192, v2
    v_min_u32 v8, -2, v8
    s_nop 0
    v_cndmask_b32 v8, -1, v8, vcc
    v_min_u32 v9, -2, v9
    v_cndmask_b32 v9, -1, v9, vcc
    v_min_u32 v10, -2, v10
    v_cndmask_b32 v10, -1, v10, vcc
    v_min_u32 v11, -2, v11
    v_cndmask_b32 v11, -1, v11, vcc
    v_cmp_gt_u32 vcc, 1064960, v1
    s_nop 0
    s_and_saveexec_b64 s[22:23], vcc
    s_cbranch_execz L_prep_end
    s_mov_b32 s19, 41943040
    buffer_store_dwordx4 v[8:11], v1, s[4:7], s19 offen
L_prep_end:
    s_endpgm

.globl mega_kernel
.p2align 8
.type mega_kernel,@function
mega_kernel:
    s_cmp_ge_u32 s2, 256
    s_cbranch_scc1 L_mega_end
    s_load_dwordx2 s[20:21], s[0:1], 104
    s_waitcnt lgkmcnt(0)
    s_mov_b32 s4, s20
    s_and_b32 s5, s21, 0xffff
    s_mov_b32 s6, 268435456
    s_mov_b32 s7, 0x00020000
    s_load_dwordx2 s[20:21], s[0:1], 88
    s_waitcnt lgkmcnt(0)
    s_mov_b32 s64, s20
    s_and_b32 s65, s21, 0xffff
    s_mov_b32 s66, 2097152
    s_mov_b32 s67, 0x00020000
    s_load_dwordx2 s[84:85], s[0:1], 16
    s_load_dwordx2 s[86:87], s[0:1], 24
    s_load_dwordx2 s[88:89], s[0:1], 32
    s_load_dwordx2 s[90:91], s[0:1], 40
    s_load_dwordx2 s[92:93], s[0:1], 64
    s_load_dwordx2 s[94:95], s[0:1], 72
    s_load_dwordx2 s[96:97], s[0:1], 80
    s_waitcnt lgkmcnt(0)
    s_mov_b32 s17, 48283648
    s_getreg_b32 s14, hwreg(HW_REG_XCC_ID)
    s_and_b32 s14, s14, 7
    v_lshrrev_b32 v1, 6, v0
    s_nop 0
    v_readfirstlane_b32 s13, v1
    s_nop 0
    s_cmp_lg_u32 s13, 0
    s_cbranch_scc1 L_rv_wait
    s_lshl_b32 s15, s14, 8
    v_mov_b32 v1, s15
    v_mov_b32 v2, 1
    s_mov_b64 exec, 1
    buffer_atomic_add v2, v1, s[4:7], s17 offen sc0
    s_waitcnt vmcnt(0)
    v_mov_b32 v1, 0
    ds_write_b32 v1, v2
    s_mov_b64 exec, -1
    s_waitcnt lgkmcnt(0)
L_rv_wait:
    s_barrier
    v_mov_b32 v1, 0
    ds_read_b32 v3, v1
    v_and_b32 v4, 7, v0
    v_lshlrev_b32 v4, 8, v4
    s_mov_b32 s26, 0
L_rv_poll:
    buffer_load_dword v5, v4, s[4:7], s17 offen sc1
    s_add_u32 s26, s26, 1
    s_cmp_gt_u32 s26, 4194304
    s_cbranch_scc1 L_mega_end
    s_waitcnt vmcnt(0) lgkmcnt(0)
    v_readlane_b32 s32, v5, 0
    v_readlane_b32 s33, v5, 1
    v_readlane_b32 s34, v5, 2
    v_readlane_b32 s35, v5, 3
    v_readlane_b32 s36, v5, 4
    v_readlane_b32 s37, v5, 5
    v_readlane_b32 s38, v5, 6
    v_readlane_b32 s39, v5, 7
    s_add_u32 s15, s32, s33
    s_add_u32 s15, s15, s34
    s_add_u32 s15, s15, s35
    s_add_u32 s15, s15, s36
    s_add_u32 s15, s15, s37
    s_add_u32 s15, s15, s38
    s_add_u32 s15, s15, s39
    s_cmp_lg_u32 s15, 256
    s_cbranch_scc1 L_rv_poll
    v_readfirstlane_b32 s12, v3
    s_mov_b32 s30, 0
    s_mov_b32 s31, 0
    s_cmp_lt_u32 0, s14
    s_cselect_b32 s15, s32, 0
    s_add_u32 s12, s12, s15
    s_add_u32 s16, s31, s32
    s_cmp_le_u32 s31, 0
    s_cselect_b32 s15, 1, 0
    s_cmp_ge_u32 s16, 32
    s_cselect_b32 s15, s15, 0
    s_or_b32 s30, s30, s15
    s_cmp_le_u32 s31, 32
    s_cselect_b32 s15, 2, 0
    s_cmp_ge_u32 s16, 64
    s_cselect_b32 s15, s15, 0
    s_or_b32 s30, s30, s15
    s_mov_b32 s31, s16
    s_cmp_lt_u32 1, s14
    s_cselect_b32 s15, s33, 0
    s_add_u32 s12, s12, s15
    s_add_u32 s16, s31, s33
    s_cmp_le_u32 s31, 0
    s_cselect_b32 s15, 1, 0
    s_cmp_ge_u32 s16, 32
    s_cselect_b32 s15, s15, 0
    s_or_b32 s30, s30, s15
    s_cmp_le_u32 s31, 32
    s_cselect_b32 s15, 2, 0
    s_cmp_ge_u32 s16, 64
    s_cselect_b32 s15, s15, 0
    s_or_b32 s30, s30, s15
    s_mov_b32 s31, s16
    s_cmp_lt_u32 2, s14
    s_cselect_b32 s15, s34, 0
    s_add_u32 s12, s12, s15
    s_add_u32 s16, s31, s34
    s_cmp_le_u32 s31, 0
    s_cselect_b32 s15, 1, 0
    s_cmp_ge_u32 s16, 32
    s_cselect_b32 s15, s15, 0
    s_or_b32 s30, s30, s15
    s_cmp_le_u32 s31, 32
    s_cselect_b32 s15, 2, 0
    s_cmp_ge_u32 s16, 64
    s_cselect_b32 s15, s15, 0
    s_or_b32 s30, s30, s15
    s_mov_b32 s31, s16
    s_cmp_lt_u32 3, s14
    s_cselect_b32 s15, s35, 0
    s_add_u32 s12, s12, s15
    s_add_u32 s16, s31, s35
    s_cmp_le_u32 s31, 0
    s_cselect_b32 s15, 1, 0
    s_cmp_ge_u32 s16, 32
    s_cselect_b32 s15, s15, 0
    s_or_b32 s30, s30, s15
    s_cmp_le_u32 s31, 32
    s_cselect_b32 s15, 2, 0
    s_cmp_ge_u32 s16, 64
    s_cselect_b32 s15, s15, 0
    s_or_b32 s30, s30, s15
    s_mov_b32 s31, s16
    s_cmp_lt_u32 4, s14
    s_cselect_b32 s15, s36, 0
    s_add_u32 s12, s12, s15
    s_add_u32 s16, s31, s36
    s_cmp_le_u32 s31, 0
    s_cselect_b32 s15, 1, 0
    s_cmp_ge_u32 s16, 32
    s_cselect_b32 s15, s15, 0
    s_or_b32 s30, s30, s15
    s_cmp_le_u32 s31, 32
    s_cselect_b32 s15, 2, 0
    s_cmp_ge_u32 s16, 64
    s_cselect_b32 s15, s15, 0
    s_or_b32 s30, s30, s15
    s_mov_b32 s31, s16
    s_cmp_lt_u32 5, s14
    s_cselect_b32 s15, s37, 0
    s_add_u32 s12, s12, s15
    s_add_u32 s16, s31, s37
    s_cmp_le_u32 s31, 0
    s_cselect_b32 s15, 1, 0
    s_cmp_ge_u32 s16, 32
    s_cselect_b32 s15, s15, 0
    s_or_b32 s30, s30, s15
    s_cmp_le_u32 s31, 32
    s_cselect_b32 s15, 2, 0
    s_cmp_ge_u32 s16, 64
    s_cselect_b32 s15, s15, 0
    s_or_b32 s30, s30, s15
    s_mov_b32 s31, s16
    s_cmp_lt_u32 6, s14
    s_cselect_b32 s15, s38, 0
    s_add_u32 s12, s12, s15
    s_add_u32 s16, s31, s38
    s_cmp_le_u32 s31, 0
    s_cselect_b32 s15, 1, 0
    s_cmp_ge_u32 s16, 32
    s_cselect_b32 s15, s15, 0
    s_or_b32 s30, s30, s15
    s_cmp_le_u32 s31, 32
    s_cselect_b32 s15, 2, 0
    s_cmp_ge_u32 s16, 64
    s_cselect_b32 s15, s15, 0
    s_or_b32 s30, s30, s15
    s_mov_b32 s31, s16
    s_cmp_lt_u32 7, s14
    s_cselect_b32 s15, s39, 0
    s_add_u32 s12, s12, s15
    s_add_u32 s16, s31, s39
    s_cmp_le_u32 s31, 0
    s_cselect_b32 s15, 1, 0
    s_cmp_ge_u32 s16, 32
    s_cselect_b32 s15, s15, 0
    s_or_b32 s30, s30, s15
    s_cmp_le_u32 s31, 32
    s_cselect_b32 s15, 2, 0
    s_cmp_ge_u32 s16, 64
    s_cselect_b32 s15, s15, 0
    s_or_b32 s30, s30, s15
    s_mov_b32 s31, s16
    s_barrier
    s_cmp_ge_u32 s12, 64
    s_cbranch_scc1 L_worker
    s_lshr_b32 s42, s12, 5
    s_and_b32 s12, s12, 31
    s_mul_i32 s43, s42, 104857600
    v_and_b32 v14, 63, v0
    v_lshlrev_b32 v1, 4, v14
    v_lshlrev_b32 v13, 3, v14
    v_and_b32 v15, 15, v14
    s_mul_i32 s16, s13, 6144
    s_add_u32 s16, s16, 131072
    s_mov_b32 s8, s84
    s_and_b32 s9, s85, 0xffff
    s_mov_b32 s10, 4194304
    s_mov_b32 s11, 0x00020000
    s_lshl_b32 s15, s12, 8
    s_lshl_b32 s14, s13, 6
    s_add_u32 s15, s15, s14
    v_lshrrev_b32 v2, 2, v14
    s_mov_b32 s23, 8192
    v_mul_lo_u32 v2, s23, v2
    v_and_b32 v3, 3, v14
    v_lshl_add_u32 v2, v3, 4, v2
    v_lshlrev_b32 v3, 4, v14
    v_add_u32 v3, s16, v3
    v_lshrrev_b32 v5, 4, v14
    v_bfe_u32 v6, v14, 2, 2
    v_lshl_add_u32 v5, v5, 3, v6
    v_mul_u32_u24 v5, 64, v5
    v_and_b32 v6, 3, v14
    v_lshl_add_u32 v5, v6, 4, v5
    v_add_u32 v5, s16, v5
    buffer_load_dwordx4 v[16:19], v2, s[8:11], s15 offen
    s_add_u32 s15, s15, 131072
    buffer_load_dwordx4 v[20:23], v2, s[8:11], s15 offen
    s_add_u32 s15, s15, 131072
    buffer_load_dwordx4 v[24:27], v2, s[8:11], s15 offen
    s_add_u32 s15, s15, 131072
    buffer_load_dwordx4 v[28:31], v2, s[8:11], s15 offen
    s_add_u32 s15, s15, 131072
    buffer_load_dwordx4 v[32:35], v2, s[8:11], s15 offen
    s_add_u32 s15, s15, 131072
    buffer_load_dwordx4 v[36:39], v2, s[8:11], s15 offen
    s_add_u32 s15, s15, 131072
    buffer_load_dwordx4 v[40:43], v2, s[8:11], s15 offen
    s_add_u32 s15, s15, 131072
    buffer_load_dwordx4 v[44:47], v2, s[8:11], s15 offen
    s_add_u32 s15, s15, 131072
    buffer_load_dwordx4 v[48:51], v2, s[8:11], s15 offen
    s_add_u32 s15, s15, 131072
    buffer_load_dwordx4 v[52:55], v2, s[8:11], s15 offen
    s_add_u32 s15, s15, 131072
    buffer_load_dwordx4 v[56:59], v2, s[8:11], s15 offen
    s_add_u32 s15, s15, 131072
    buffer_load_dwordx4 v[60:63], v2, s[8:11], s15 offen
    s_add_u32 s15, s15, 131072
    s_waitcnt vmcnt(6)
    ds_write_b128 v3, v[16:19] offset:0
    ds_write_b128 v3, v[20:23] offset:1024
    ds_write_b128 v3, v[24:27] offset:2048
    ds_write_b128 v3, v[28:31] offset:3072
    ds_write_b128 v3, v[32:35] offset:4096
    ds_write_b128 v3, v[36:39] offset:5120
    s_waitcnt lgkmcnt(0)
    ds_read_b64_tr_b16 a[0:1], v5 offset:0
    ds_read_b64_tr_b16 a[2:3], v5 offset:256
    ds_read_b64_tr_b16 a[64:65], v5 offset:8
    ds_read_b64_tr_b16 a[66:67], v5 offset:264
    ds_read_b64_tr_b16 a[4:5], v5 offset:2048
    ds_read_b64_tr_b16 a[6:7], v5 offset:2304
    ds_read_b64_tr_b16 a[68:69], v5 offset:2056
    ds_read_b64_tr_b16 a[70:71], v5 offset:2312
    ds_read_b64_tr_b16 a[8:9], v5 offset:4096
    ds_read_b64_tr_b16 a[10:11], v5 offset:4352
    ds_read_b64_tr_b16 a[72:73], v5 offset:4104
    ds_read_b64_tr_b16 a[74:75], v5 offset:4360
    s_waitcnt lgkmcnt(0)
    buffer_load_dwordx4 v[16:19], v2, s[8:11], s15 offen
    s_add_u32 s15, s15, 131072
    buffer_load_dwordx4 v[20:23], v2, s[8:11], s15 offen
    s_add_u32 s15, s15, 131072
    buffer_load_dwordx4 v[24:27], v2, s[8:11], s15 offen
    s_add_u32 s15, s15, 131072
    buffer_load_dwordx4 v[28:31], v2, s[8:11], s15 offen
    s_add_u32 s15, s15, 131072
    buffer_load_dwordx4 v[32:35], v2, s[8:11], s15 offen
    s_add_u32 s15, s15, 131072
    buffer_load_dwordx4 v[36:39], v2, s[8:11], s15 offen
    s_add_u32 s15, s15, 131072
    s_waitcnt vmcnt(6)
    ds_write_b128 v3, v[40:43] offset:0
    ds_write_b128 v3, v[44:47] offset:1024
    ds_write_b128 v3, v[48:51] offset:2048
    ds_write_b128 v3, v[52:55] offset:3072
    ds_write_b128 v3, v[56:59] offset:4096
    ds_write_b128 v3, v[60:63] offset:5120
    s_waitcnt lgkmcnt(0)
    ds_read_b64_tr_b16 a[12:13], v5 offset:0
    ds_read_b64_tr_b16 a[14:15], v5 offset:256
    ds_read_b64_tr_b16 a[76:77], v5 offset:8
    ds_read_b64_tr_b16 a[78:79], v5 offset:264
    ds_read_b64_tr_b16 a[16:17], v5 offset:2048
    ds_read_b64_tr_b16 a[18:19], v5 offset:2304
    ds_read_b64_tr_b16 a[80:81], v5 offset:2056
    ds_read_b64_tr_b16 a[82:83], v5 offset:2312
    ds_read_b64_tr_b16 a[20:21], v5 offset:4096
    ds_read_b64_tr_b16 a[22:23], v5 offset:4352
    ds_read_b64_tr_b16 a[84:85], v5 offset:4104
    ds_read_b64_tr_b16 a[86:87], v5 offset:4360
    s_waitcnt lgkmcnt(0)
    buffer_load_dwordx4 v[40:43], v2, s[8:11], s15 offen
    s_add_u32 s15, s15, 131072
    buffer_load_dwordx4 v[44:47], v2, s[8:11], s15 offen
    s_add_u32 s15, s15, 131072
    buffer_load_dwordx4 v[48:51], v2, s[8:11], s15 offen
    s_add_u32 s15, s15, 131072
    buffer_load_dwordx4 v[52:55], v2, s[8:11], s15 offen
    s_add_u32 s15, s15, 131072
    buffer_load_dwordx4 v[56:59], v2, s[8:11], s15 offen
    s_add_u32 s15, s15, 131072
    buffer_load_dwordx4 v[60:63], v2, s[8:11], s15 offen
    s_add_u32 s15, s15, 131072
    s_waitcnt vmcnt(6)
    ds_write_b128 v3, v[16:19] offset:0
    ds_write_b128 v3, v[20:23] offset:1024
    ds_write_b128 v3, v[24:27] offset:2048
    ds_write_b128 v3, v[28:31] offset:3072
    ds_write_b128 v3, v[32:35] offset:4096
    ds_write_b128 v3, v[36:39] offset:5120
    s_waitcnt lgkmcnt(0)
    ds_read_b64_tr_b16 a[24:25], v5 offset:0
    ds_read_b64_tr_b16 a[26:27], v5 offset:256
    ds_read_b64_tr_b16 a[88:89], v5 offset:8
    ds_read_b64_tr_b16 a[90:91], v5 offset:264
    ds_read_b64_tr_b16 a[28:29], v5 offset:2048
    ds_read_b64_tr_b16 a[30:31], v5 offset:2304
    ds_read_b64_tr_b16 a[92:93], v5 offset:2056
    ds_read_b64_tr_b16 a[94:95], v5 offset:2312
    ds_read_b64_tr_b16 a[32:33], v5 offset:4096
    ds_read_b64_tr_b16 a[34:35], v5 offset:4352
    ds_read_b64_tr_b16 a[96:97], v5 offset:4104
    ds_read_b64_tr_b16 a[98:99], v5 offset:4360
    s_waitcnt lgkmcnt(0)
    buffer_load_dwordx4 v[16:19], v2, s[8:11], s15 offen
    s_add_u32 s15, s15, 131072
    buffer_load_dwordx4 v[20:23], v2, s[8:11], s15 offen
    s_add_u32 s15, s15, 131072
    buffer_load_dwordx4 v[24:27], v2, s[8:11], s15 offen
    s_add_u32 s15, s15, 131072
    buffer_load_dwordx4 v[28:31], v2, s[8:11], s15 offen
    s_add_u32 s15, s15, 131072
    buffer_load_dwordx4 v[32:35], v2, s[8:11], s15 offen
    s_add_u32 s15, s15, 131072
    buffer_load_dwordx4 v[36:39], v2, s[8:11], s15 offen
    s_add_u32 s15, s15, 131072
    s_waitcnt vmcnt(6)
    ds_write_b128 v3, v[40:43] offset:0
    ds_write_b128 v3, v[44:47] offset:1024
    ds_write_b128 v3, v[48:51] offset:2048
    ds_write_b128 v3, v[52:55] offset:3072
    ds_write_b128 v3, v[56:59] offset:4096
    ds_write_b128 v3, v[60:63] offset:5120
    s_waitcnt lgkmcnt(0)
    ds_read_b64_tr_b16 a[36:37], v5 offset:0
    ds_read_b64_tr_b16 a[38:39], v5 offset:256
    ds_read_b64_tr_b16 a[100:101], v5 offset:8
    ds_read_b64_tr_b16 a[102:103], v5 offset:264
    ds_read_b64_tr_b16 a[40:41], v5 offset:2048
    ds_read_b64_tr_b16 a[42:43], v5 offset:2304
    ds_read_b64_tr_b16 a[104:105], v5 offset:2056
    ds_read_b64_tr_b16 a[106:107], v5 offset:2312
    ds_read_b64_tr_b16 a[44:45], v5 offset:4096
    ds_read_b64_tr_b16 a[46:47], v5 offset:4352
    ds_read_b64_tr_b16 a[108:109], v5 offset:4104
    ds_read_b64_tr_b16 a[110:111], v5 offset:4360
    s_waitcnt lgkmcnt(0)
    buffer_load_dwordx4 v[40:43], v2, s[8:11], s15 offen
    s_add_u32 s15, s15, 131072
    buffer_load_dwordx4 v[44:47], v2, s[8:11], s15 offen
    s_add_u32 s15, s15, 131072
    s_waitcnt vmcnt(2)
    ds_write_b128 v3, v[16:19] offset:0
    ds_write_b128 v3, v[20:23] offset:1024
    ds_write_b128 v3, v[24:27] offset:2048
    ds_write_b128 v3, v[28:31] offset:3072
    ds_write_b128 v3, v[32:35] offset:4096
    ds_write_b128 v3, v[36:39] offset:5120
    s_waitcnt lgkmcnt(0)
    ds_read_b64_tr_b16 a[48:49], v5 offset:0
    ds_read_b64_tr_b16 a[50:51], v5 offset:256
    ds_read_b64_tr_b16 a[112:113], v5 offset:8
    ds_read_b64_tr_b16 a[114:115], v5 offset:264
    ds_read_b64_tr_b16 a[52:53], v5 offset:2048
    ds_read_b64_tr_b16 a[54:55], v5 offset:2304
    ds_read_b64_tr_b16 a[116:117], v5 offset:2056
    ds_read_b64_tr_b16 a[118:119], v5 offset:2312
    ds_read_b64_tr_b16 a[56:57], v5 offset:4096
    ds_read_b64_tr_b16 a[58:59], v5 offset:4352
    ds_read_b64_tr_b16 a[120:121], v5 offset:4104
    ds_read_b64_tr_b16 a[122:123], v5 offset:4360
    s_waitcnt lgkmcnt(0)
    s_waitcnt vmcnt(0)
    ds_write_b128 v3, v[40:43] offset:0
    ds_write_b128 v3, v[44:47] offset:1024
    s_waitcnt lgkmcnt(0)
    ds_read_b64_tr_b16 a[60:61], v5 offset:0
    ds_read_b64_tr_b16 a[62:63], v5 offset:256
    ds_read_b64_tr_b16 a[124:125], v5 offset:8
    ds_read_b64_tr_b16 a[126:127], v5 offset:264
    s_waitcnt lgkmcnt(0)
    s_mov_b32 s8, s86
    s_and_b32 s9, s87, 0xffff
    s_mov_b32 s10, 4194304
    s_mov_b32 s11, 0x00020000
    s_lshl_b32 s15, s12, 8
    s_lshl_b32 s14, s13, 6
    s_add_u32 s15, s15, s14
    v_lshrrev_b32 v2, 2, v14
    s_mov_b32 s23, 8192
    v_mul_lo_u32 v2, s23, v2
    v_and_b32 v3, 3, v14
    v_lshl_add_u32 v2, v3, 4, v2
    v_lshlrev_b32 v3, 4, v14
    v_add_u32 v3, s16, v3
    v_lshrrev_b32 v5, 4, v14
    v_bfe_u32 v6, v14, 2, 2
    v_lshl_add_u32 v5, v5, 3, v6
    v_mul_u32_u24 v5, 64, v5
    v_and_b32 v6, 3, v14
    v_lshl_add_u32 v5, v6, 4, v5
    v_add_u32 v5, s16, v5
    buffer_load_dwordx4 v[16:19], v2, s[8:11], s15 offen
    s_add_u32 s15, s15, 131072
    buffer_load_dwordx4 v[20:23], v2, s[8:11], s15 offen
    s_add_u32 s15, s15, 131072
    buffer_load_dwordx4 v[24:27], v2, s[8:11], s15 offen
    s_add_u32 s15, s15, 131072
    buffer_load_dwordx4 v[28:31], v2, s[8:11], s15 offen
    s_add_u32 s15, s15, 131072
    buffer_load_dwordx4 v[32:35], v2, s[8:11], s15 offen
    s_add_u32 s15, s15, 131072
    buffer_load_dwordx4 v[36:39], v2, s[8:11], s15 offen
    s_add_u32 s15, s15, 131072
    buffer_load_dwordx4 v[40:43], v2, s[8:11], s15 offen
    s_add_u32 s15, s15, 131072
    buffer_load_dwordx4 v[44:47], v2, s[8:11], s15 offen
    s_add_u32 s15, s15, 131072
    buffer_load_dwordx4 v[48:51], v2, s[8:11], s15 offen
    s_add_u32 s15, s15, 131072
    buffer_load_dwordx4 v[52:55], v2, s[8:11], s15 offen
    s_add_u32 s15, s15, 131072
    buffer_load_dwordx4 v[56:59], v2, s[8:11], s15 offen
    s_add_u32 s15, s15, 131072
    buffer_load_dwordx4 v[60:63], v2, s[8:11], s15 offen
    s_add_u32 s15, s15, 131072
    s_waitcnt vmcnt(6)
    ds_write_b128 v3, v[16:19] offset:0
    ds_write_b128 v3, v[20:23] offset:1024
    ds_write_b128 v3, v[24:27] offset:2048
    ds_write_b128 v3, v[28:31] offset:3072
    ds_write_b128 v3, v[32:35] offset:4096
    ds_write_b128 v3, v[36:39] offset:5120
    s_waitcnt lgkmcnt(0)
    ds_read_b64_tr_b16 a[128:129], v5 offset:0
    ds_read_b64_tr_b16 a[130:131], v5 offset:256
    ds_read_b64_tr_b16 a[192:193], v5 offset:8
    ds_read_b64_tr_b16 a[194:195], v5 offset:264
    ds_read_b64_tr_b16 a[132:133], v5 offset:2048
    ds_read_b64_tr_b16 a[134:135], v5 offset:2304
    ds_read_b64_tr_b16 a[196:197], v5 offset:2056
    ds_read_b64_tr_b16 a[198:199], v5 offset:2312
    ds_read_b64_tr_b16 a[136:137], v5 offset:4096
    ds_read_b64_tr_b16 a[138:139], v5 offset:4352
    ds_read_b64_tr_b16 a[200:201], v5 offset:4104
    ds_read_b64_tr_b16 a[202:203], v5 offset:4360
    s_waitcnt lgkmcnt(0)
    buffer_load_dwordx4 v[16:19], v2, s[8:11], s15 offen
    s_add_u32 s15, s15, 131072
    buffer_load_dwordx4 v[20:23], v2, s[8:11], s15 offen
    s_add_u32 s15, s15, 131072
    buffer_load_dwordx4 v[24:27], v2, s[8:11], s15 offen
    s_add_u32 s15, s15, 131072
    buffer_load_dwordx4 v[28:31], v2, s[8:11], s15 offen
    s_add_u32 s15, s15, 131072
    buffer_load_dwordx4 v[32:35], v2, s[8:11], s15 offen
    s_add_u32 s15, s15, 131072
    buffer_load_dwordx4 v[36:39], v2, s[8:11], s15 offen
    s_add_u32 s15, s15, 131072
    s_waitcnt vmcnt(6)
    ds_write_b128 v3, v[40:43] offset:0
    ds_write_b128 v3, v[44:47] offset:1024
    ds_write_b128 v3, v[48:51] offset:2048
    ds_write_b128 v3, v[52:55] offset:3072
    ds_write_b128 v3, v[56:59] offset:4096
    ds_write_b128 v3, v[60:63] offset:5120
    s_waitcnt lgkmcnt(0)
    ds_read_b64_tr_b16 a[140:141], v5 offset:0
    ds_read_b64_tr_b16 a[142:143], v5 offset:256
    ds_read_b64_tr_b16 a[204:205], v5 offset:8
    ds_read_b64_tr_b16 a[206:207], v5 offset:264
    ds_read_b64_tr_b16 a[144:145], v5 offset:2048
    ds_read_b64_tr_b16 a[146:147], v5 offset:2304
    ds_read_b64_tr_b16 a[208:209], v5 offset:2056
    ds_read_b64_tr_b16 a[210:211], v5 offset:2312
    ds_read_b64_tr_b16 a[148:149], v5 offset:4096
    ds_read_b64_tr_b16 a[150:151], v5 offset:4352
    ds_read_b64_tr_b16 a[212:213], v5 offset:4104
    ds_read_b64_tr_b16 a[214:215], v5 offset:4360
    s_waitcnt lgkmcnt(0)
    buffer_load_dwordx4 v[40:43], v2, s[8:11], s15 offen
    s_add_u32 s15, s15, 131072
    buffer_load_dwordx4 v[44:47], v2, s[8:11], s15 offen
    s_add_u32 s15, s15, 131072
    buffer_load_dwordx4 v[48:51], v2, s[8:11], s15 offen
    s_add_u32 s15, s15, 131072
    buffer_load_dwordx4 v[52:55], v2, s[8:11], s15 offen
    s_add_u32 s15, s15, 131072
    buffer_load_dwordx4 v[56:59], v2, s[8:11], s15 offen
    s_add_u32 s15, s15, 131072
    buffer_load_dwordx4 v[60:63], v2, s[8:11], s15 offen
    s_add_u32 s15, s15, 131072
    s_waitcnt vmcnt(6)
    ds_write_b128 v3, v[16:19] offset:0
    ds_write_b128 v3, v[20:23] offset:1024
    ds_write_b128 v3, v[24:27] offset:2048
    ds_write_b128 v3, v[28:31] offset:3072
    ds_write_b128 v3, v[32:35] offset:4096
    ds_write_b128 v3, v[36:39] offset:5120
    s_waitcnt lgkmcnt(0)
    ds_read_b64_tr_b16 a[152:153], v5 offset:0
    ds_read_b64_tr_b16 a[154:155], v5 offset:256
    ds_read_b64_tr_b16 a[216:217], v5 offset:8
    ds_read_b64_tr_b16 a[218:219], v5 offset:264
    ds_read_b64_tr_b16 a[156:157], v5 offset:2048
    ds_read_b64_tr_b16 a[158:159], v5 offset:2304
    ds_read_b64_tr_b16 a[220:221], v5 offset:2056
    ds_read_b64_tr_b16 a[222:223], v5 offset:2312
    ds_read_b64_tr_b16 a[160:161], v5 offset:4096
    ds_read_b64_tr_b16 a[162:163], v5 offset:4352
    ds_read_b64_tr_b16 a[224:225], v5 offset:4104
    ds_read_b64_tr_b16 a[226:227], v5 offset:4360
    s_waitcnt lgkmcnt(0)
    buffer_load_dwordx4 v[16:19], v2, s[8:11], s15 offen
    s_add_u32 s15, s15, 131072
    buffer_load_dwordx4 v[20:23], v2, s[8:11], s15 offen
    s_add_u32 s15, s15, 131072
    buffer_load_dwordx4 v[24:27], v2, s[8:11], s15 offen
    s_add_u32 s15, s15, 131072
    buffer_load_dwordx4 v[28:31], v2, s[8:11], s15 offen
    s_add_u32 s15, s15, 131072
    buffer_load_dwordx4 v[32:35], v2, s[8:11], s15 offen
    s_add_u32 s15, s15, 131072
    buffer_load_dwordx4 v[36:39], v2, s[8:11], s15 offen
    s_add_u32 s15, s15, 131072
    s_waitcnt vmcnt(6)
    ds_write_b128 v3, v[40:43] offset:0
    ds_write_b128 v3, v[44:47] offset:1024
    ds_write_b128 v3, v[48:51] offset:2048
    ds_write_b128 v3, v[52:55] offset:3072
    ds_write_b128 v3, v[56:59] offset:4096
    ds_write_b128 v3, v[60:63] offset:5120
    s_waitcnt lgkmcnt(0)
    ds_read_b64_tr_b16 a[164:165], v5 offset:0
    ds_read_b64_tr_b16 a[166:167], v5 offset:256
    ds_read_b64_tr_b16 a[228:229], v5 offset:8
    ds_read_b64_tr_b16 a[230:231], v5 offset:264
    ds_read_b64_tr_b16 a[168:169], v5 offset:2048
    ds_read_b64_tr_b16 a[170:171], v5 offset:2304
    ds_read_b64_tr_b16 a[232:233], v5 offset:2056
    ds_read_b64_tr_b16 a[234:235], v5 offset:2312
    ds_read_b64_tr_b16 a[172:173], v5 offset:4096
    ds_read_b64_tr_b16 a[174:175], v5 offset:4352
    ds_read_b64_tr_b16 a[236:237], v5 offset:4104
    ds_read_b64_tr_b16 a[238:239], v5 offset:4360
    s_waitcnt lgkmcnt(0)
    buffer_load_dwordx4 v[40:43], v2, s[8:11], s15 offen
    s_add_u32 s15, s15, 131072
    buffer_load_dwordx4 v[44:47], v2, s[8:11], s15 offen
    s_add_u32 s15, s15, 131072
    s_waitcnt vmcnt(2)
    ds_write_b128 v3, v[16:19] offset:0
    ds_write_b128 v3, v[20:23] offset:1024
    ds_write_b128 v3, v[24:27] offset:2048
    ds_write_b128 v3, v[28:31] offset:3072
    ds_write_b128 v3, v[32:35] offset:4096
    ds_write_b128 v3, v[36:39] offset:5120
    s_waitcnt lgkmcnt(0)
    ds_read_b64_tr_b16 a[176:177], v5 offset:0
    ds_read_b64_tr_b16 a[178:179], v5 offset:256
    ds_read_b64_tr_b16 a[240:241], v5 offset:8
    ds_read_b64_tr_b16 a[242:243], v5 offset:264
    ds_read_b64_tr_b16 a[180:181], v5 offset:2048
    ds_read_b64_tr_b16 a[182:183], v5 offset:2304
    ds_read_b64_tr_b16 a[244:245], v5 offset:2056
    ds_read_b64_tr_b16 a[246:247], v5 offset:2312
    ds_read_b64_tr_b16 a[184:185], v5 offset:4096
    ds_read_b64_tr_b16 a[186:187], v5 offset:4352
    ds_read_b64_tr_b16 a[248:249], v5 offset:4104
    ds_read_b64_tr_b16 a[250:251], v5 offset:4360
    s_waitcnt lgkmcnt(0)
    s_waitcnt vmcnt(0)
    ds_write_b128 v3, v[40:43] offset:0
    ds_write_b128 v3, v[44:47] offset:1024
    s_waitcnt lgkmcnt(0)
    ds_read_b64_tr_b16 a[188:189], v5 offset:0
    ds_read_b64_tr_b16 a[190:191], v5 offset:256
    ds_read_b64_tr_b16 a[252:253], v5 offset:8
    ds_read_b64_tr_b16 a[254:255], v5 offset:264
    s_waitcnt lgkmcnt(0)
    s_mov_b32 s8, s88
    s_and_b32 s9, s89, 0xffff
    s_mov_b32 s10, 4194304
    s_mov_b32 s11, 0x00020000
    s_lshl_b32 s15, s12, 8
    s_lshl_b32 s14, s13, 6
    s_add_u32 s15, s15, s14
    v_lshrrev_b32 v2, 2, v14
    s_mov_b32 s23, 8192
    v_mul_lo_u32 v2, s23, v2
    v_and_b32 v3, 3, v14
    v_lshl_add_u32 v2, v3, 4, v2
    v_lshlrev_b32 v3, 4, v14
    v_add_u32 v3, s16, v3
    v_lshrrev_b32 v5, 4, v14
    v_bfe_u32 v6, v14, 2, 2
    v_lshl_add_u32 v5, v5, 3, v6
    v_mul_u32_u24 v5, 64, v5
    v_and_b32 v6, 3, v14
    v_lshl_add_u32 v5, v6, 4, v5
    v_add_u32 v5, s16, v5
    buffer_load_dwordx4 v[16:19], v2, s[8:11], s15 offen
    s_add_u32 s15, s15, 131072
    buffer_load_dwordx4 v[20:23], v2, s[8:11], s15 offen
    s_add_u32 s15, s15, 131072
    buffer_load_dwordx4 v[24:27], v2, s[8:11], s15 offen
    s_add_u32 s15, s15, 131072
    buffer_load_dwordx4 v[28:31], v2, s[8:11], s15 offen
    s_add_u32 s15, s15, 131072
    buffer_load_dwordx4 v[32:35], v2, s[8:11], s15 offen
    s_add_u32 s15, s15, 131072
    buffer_load_dwordx4 v[36:39], v2, s[8:11], s15 offen
    s_add_u32 s15, s15, 131072
    buffer_load_dwordx4 v[40:43], v2, s[8:11], s15 offen
    s_add_u32 s15, s15, 131072
    buffer_load_dwordx4 v[44:47], v2, s[8:11], s15 offen
    s_add_u32 s15, s15, 131072
    buffer_load_dwordx4 v[48:51], v2, s[8:11], s15 offen
    s_add_u32 s15, s15, 131072
    buffer_load_dwordx4 v[52:55], v2, s[8:11], s15 offen
    s_add_u32 s15, s15, 131072
    buffer_load_dwordx4 v[56:59], v2, s[8:11], s15 offen
    s_add_u32 s15, s15, 131072
    buffer_load_dwordx4 v[60:63], v2, s[8:11], s15 offen
    s_add_u32 s15, s15, 131072
    s_waitcnt vmcnt(6)
    ds_write_b128 v3, v[16:19] offset:0
    ds_write_b128 v3, v[20:23] offset:1024
    ds_write_b128 v3, v[24:27] offset:2048
    ds_write_b128 v3, v[28:31] offset:3072
    ds_write_b128 v3, v[32:35] offset:4096
    ds_write_b128 v3, v[36:39] offset:5120
    s_waitcnt lgkmcnt(0)
    ds_read_b64_tr_b16 v[128:129], v5 offset:0
    ds_read_b64_tr_b16 v[130:131], v5 offset:256
    ds_read_b64_tr_b16 v[192:193], v5 offset:8
    ds_read_b64_tr_b16 v[194:195], v5 offset:264
    ds_read_b64_tr_b16 v[132:133], v5 offset:2048
    ds_read_b64_tr_b16 v[134:135], v5 offset:2304
    ds_read_b64_tr_b16 v[196:197], v5 offset:2056
    ds_read_b64_tr_b16 v[198:199], v5 offset:2312
    ds_read_b64_tr_b16 v[136:137], v5 offset:4096
    ds_read_b64_tr_b16 v[138:139], v5 offset:4352
    ds_read_b64_tr_b16 v[200:201], v5 offset:4104
    ds_read_b64_tr_b16 v[202:203], v5 offset:4360
    s_waitcnt lgkmcnt(0)
    buffer_load_dwordx4 v[16:19], v2, s[8:11], s15 offen
    s_add_u32 s15, s15, 131072
    buffer_load_dwordx4 v[20:23], v2, s[8:11], s15 offen
    s_add_u32 s15, s15, 131072
    buffer_load_dwordx4 v[24:27], v2, s[8:11], s15 offen
    s_add_u32 s15, s15, 131072
    buffer_load_dwordx4 v[28:31], v2, s[8:11], s15 offen
    s_add_u32 s15, s15, 131072
    buffer_load_dwordx4 v[32:35], v2, s[8:11], s15 offen
    s_add_u32 s15, s15, 131072
    buffer_load_dwordx4 v[36:39], v2, s[8:11], s15 offen
    s_add_u32 s15, s15, 131072
    s_waitcnt vmcnt(6)
    ds_write_b128 v3, v[40:43] offset:0
    ds_write_b128 v3, v[44:47] offset:1024
    ds_write_b128 v3, v[48:51] offset:2048
    ds_write_b128 v3, v[52:55] offset:3072
    ds_write_b128 v3, v[56:59] offset:4096
    ds_write_b128 v3, v[60:63] offset:5120
    s_waitcnt lgkmcnt(0)
    ds_read_b64_tr_b16 v[140:141], v5 offset:0
    ds_read_b64_tr_b16 v[142:143], v5 offset:256
    ds_read_b64_tr_b16 v[204:205], v5 offset:8
    ds_read_b64_tr_b16 v[206:207], v5 offset:264
    ds_read_b64_tr_b16 v[144:145], v5 offset:2048
    ds_read_b64_tr_b16 v[146:147], v5 offset:2304
    ds_read_b64_tr_b16 v[208:209], v5 offset:2056
    ds_read_b64_tr_b16 v[210:211], v5 offset:2312
    ds_read_b64_tr_b16 v[148:149], v5 offset:4096
    ds_read_b64_tr_b16 v[150:151], v5 offset:4352
    ds_read_b64_tr_b16 v[212:213], v5 offset:4104
    ds_read_b64_tr_b16 v[214:215], v5 offset:4360
    s_waitcnt lgkmcnt(0)
    buffer_load_dwordx4 v[40:43], v2, s[8:11], s15 offen
    s_add_u32 s15, s15, 131072
    buffer_load_dwordx4 v[44:47], v2, s[8:11], s15 offen
    s_add_u32 s15, s15, 131072
    buffer_load_dwordx4 v[48:51], v2, s[8:11], s15 offen
    s_add_u32 s15, s15, 131072
    buffer_load_dwordx4 v[52:55], v2, s[8:11], s15 offen
    s_add_u32 s15, s15, 131072
    buffer_load_dwordx4 v[56:59], v2, s[8:11], s15 offen
    s_add_u32 s15, s15, 131072
    buffer_load_dwordx4 v[60:63], v2, s[8:11], s15 offen
    s_add_u32 s15, s15, 131072
    s_waitcnt vmcnt(6)
    ds_write_b128 v3, v[16:19] offset:0
    ds_write_b128 v3, v[20:23] offset:1024
    ds_write_b128 v3, v[24:27] offset:2048
    ds_write_b128 v3, v[28:31] offset:3072
    ds_write_b128 v3, v[32:35] offset:4096
    ds_write_b128 v3, v[36:39] offset:5120
    s_waitcnt lgkmcnt(0)
    ds_read_b64_tr_b16 v[152:153], v5 offset:0
    ds_read_b64_tr_b16 v[154:155], v5 offset:256
    ds_read_b64_tr_b16 v[216:217], v5 offset:8
    ds_read_b64_tr_b16 v[218:219], v5 offset:264
    ds_read_b64_tr_b16 v[156:157], v5 offset:2048
    ds_read_b64_tr_b16 v[158:159], v5 offset:2304
    ds_read_b64_tr_b16 v[220:221], v5 offset:2056
    ds_read_b64_tr_b16 v[222:223], v5 offset:2312
    ds_read_b64_tr_b16 v[160:161], v5 offset:4096
    ds_read_b64_tr_b16 v[162:163], v5 offset:4352
    ds_read_b64_tr_b16 v[224:225], v5 offset:4104
    ds_read_b64_tr_b16 v[226:227], v5 offset:4360
    s_waitcnt lgkmcnt(0)
    buffer_load_dwordx4 v[16:19], v2, s[8:11], s15 offen
    s_add_u32 s15, s15, 131072
    buffer_load_dwordx4 v[20:23], v2, s[8:11], s15 offen
    s_add_u32 s15, s15, 131072
    buffer_load_dwordx4 v[24:27], v2, s[8:11], s15 offen
    s_add_u32 s15, s15, 131072
    buffer_load_dwordx4 v[28:31], v2, s[8:11], s15 offen
    s_add_u32 s15, s15, 131072
    buffer_load_dwordx4 v[32:35], v2, s[8:11], s15 offen
    s_add_u32 s15, s15, 131072
    buffer_load_dwordx4 v[36:39], v2, s[8:11], s15 offen
    s_add_u32 s15, s15, 131072
    s_waitcnt vmcnt(6)
    ds_write_b128 v3, v[40:43] offset:0
    ds_write_b128 v3, v[44:47] offset:1024
    ds_write_b128 v3, v[48:51] offset:2048
    ds_write_b128 v3, v[52:55] offset:3072
    ds_write_b128 v3, v[56:59] offset:4096
    ds_write_b128 v3, v[60:63] offset:5120
    s_waitcnt lgkmcnt(0)
    ds_read_b64_tr_b16 v[164:165], v5 offset:0
    ds_read_b64_tr_b16 v[166:167], v5 offset:256
    ds_read_b64_tr_b16 v[228:229], v5 offset:8
    ds_read_b64_tr_b16 v[230:231], v5 offset:264
    ds_read_b64_tr_b16 v[168:169], v5 offset:2048
    ds_read_b64_tr_b16 v[170:171], v5 offset:2304
    ds_read_b64_tr_b16 v[232:233], v5 offset:2056
    ds_read_b64_tr_b16 v[234:235], v5 offset:2312
    ds_read_b64_tr_b16 v[172:173], v5 offset:4096
    ds_read_b64_tr_b16 v[174:175], v5 offset:4352
    ds_read_b64_tr_b16 v[236:237], v5 offset:4104
    ds_read_b64_tr_b16 v[238:239], v5 offset:4360
    s_waitcnt lgkmcnt(0)
    buffer_load_dwordx4 v[40:43], v2, s[8:11], s15 offen
    s_add_u32 s15, s15, 131072
    buffer_load_dwordx4 v[44:47], v2, s[8:11], s15 offen
    s_add_u32 s15, s15, 131072
    s_waitcnt vmcnt(2)
    ds_write_b128 v3, v[16:19] offset:0
    ds_write_b128 v3, v[20:23] offset:1024
    ds_write_b128 v3, v[24:27] offset:2048
    ds_write_b128 v3, v[28:31] offset:3072
    ds_write_b128 v3, v[32:35] offset:4096
    ds_write_b128 v3, v[36:39] offset:5120
    s_waitcnt lgkmcnt(0)
    ds_read_b64_tr_b16 v[176:177], v5 offset:0
    ds_read_b64_tr_b16 v[178:179], v5 offset:256
    ds_read_b64_tr_b16 v[240:241], v5 offset:8
    ds_read_b64_tr_b16 v[242:243], v5 offset:264
    ds_read_b64_tr_b16 v[180:181], v5 offset:2048
    ds_read_b64_tr_b16 v[182:183], v5 offset:2304
    ds_read_b64_tr_b16 v[244:245], v5 offset:2056
    ds_read_b64_tr_b16 v[246:247], v5 offset:2312
    ds_read_b64_tr_b16 v[184:185], v5 offset:4096
    ds_read_b64_tr_b16 v[186:187], v5 offset:4352
    ds_read_b64_tr_b16 v[248:249], v5 offset:4104
    ds_read_b64_tr_b16 v[250:251], v5 offset:4360
    s_waitcnt lgkmcnt(0)
    s_waitcnt vmcnt(0)
    ds_write_b128 v3, v[40:43] offset:0
    ds_write_b128 v3, v[44:47] offset:1024
    s_waitcnt lgkmcnt(0)
    ds_read_b64_tr_b16 v[188:189], v5 offset:0
    ds_read_b64_tr_b16 v[190:191], v5 offset:256
    ds_read_b64_tr_b16 v[252:253], v5 offset:8
    ds_read_b64_tr_b16 v[254:255], v5 offset:264
    s_waitcnt lgkmcnt(0)
    s_lshl_b32 s15, s13, 15
    v_add_u32 v9, s15, v1
    s_mov_b32 s8, s90
    s_and_b32 s9, s91, 0xffff
    s_mov_b32 s10, 4194304
    s_mov_b32 s11, 0x00020000
    s_lshl_b32 s15, s12, 17
    s_lshl_b32 s14, s13, 8
    s_add_u32 s15, s15, s14
    s_add_u32 s15, s15, 0
    v_lshrrev_b32 v2, 3, v14
    s_mov_b32 s23, 1024
    v_mul_lo_u32 v2, s23, v2
    v_and_b32 v3, 7, v14
    v_lshl_add_u32 v2, v3, 4, v2
    v_lshlrev_b32 v3, 4, v14
    v_add_u32 v3, s16, v3
    v_lshrrev_b32 v5, 4, v14
    v_bfe_u32 v6, v14, 2, 2
    v_lshl_add_u32 v5, v5, 3, v6
    v_mul_u32_u24 v5, 128, v5
    v_and_b32 v6, 3, v14
    v_lshl_add_u32 v5, v6, 4, v5
    v_add_u32 v5, s16, v5
    buffer_load_dwordx4 v[16:19], v2, s[8:11], s15 offen
    s_add_u32 s15, s15, 8192
    buffer_load_dwordx4 v[20:23], v2, s[8:11], s15 offen
    s_add_u32 s15, s15, 8192
    buffer_load_dwordx4 v[24:27], v2, s[8:11], s15 offen
    s_add_u32 s15, s15, 8192
    buffer_load_dwordx4 v[28:31], v2, s[8:11], s15 offen
    s_add_u32 s15, s15, 8192
    buffer_load_dwordx4 v[40:43], v2, s[8:11], s15 offen
    s_add_u32 s15, s15, 8192
    buffer_load_dwordx4 v[44:47], v2, s[8:11], s15 offen
    s_add_u32 s15, s15, 8192
    buffer_load_dwordx4 v[48:51], v2, s[8:11], s15 offen
    s_add_u32 s15, s15, 8192
    buffer_load_dwordx4 v[52:55], v2, s[8:11], s15 offen
    s_add_u32 s15, s15, 8192
    s_waitcnt vmcnt(4)
    ds_write_b128 v3, v[16:19] offset:0
    ds_write_b128 v3, v[20:23] offset:1024
    ds_write_b128 v3, v[24:27] offset:2048
    ds_write_b128 v3, v[28:31] offset:3072
    s_waitcnt lgkmcnt(0)
    ds_read_b64_tr_b16 v[80:81], v5 offset:0
    ds_read_b64_tr_b16 v[82:83], v5 offset:512
    ds_read_b64_tr_b16 v[84:85], v5 offset:8
    ds_read_b64_tr_b16 v[86:87], v5 offset:520
    ds_read_b64_tr_b16 v[88:89], v5 offset:64
    ds_read_b64_tr_b16 v[90:91], v5 offset:576
    ds_read_b64_tr_b16 v[92:93], v5 offset:72
    ds_read_b64_tr_b16 v[94:95], v5 offset:584
    s_waitcnt lgkmcnt(0)
    ds_write_b128 v9, v[80:83] offset:0
    ds_write_b128 v9, v[84:87] offset:4096
    ds_write_b128 v9, v[88:91] offset:8192
    ds_write_b128 v9, v[92:95] offset:12288
    s_waitcnt lgkmcnt(0)
    buffer_load_dwordx4 v[16:19], v2, s[8:11], s15 offen
    s_add_u32 s15, s15, 8192
    buffer_load_dwordx4 v[20:23], v2, s[8:11], s15 offen
    s_add_u32 s15, s15, 8192
    buffer_load_dwordx4 v[24:27], v2, s[8:11], s15 offen
    s_add_u32 s15, s15, 8192
    buffer_load_dwordx4 v[28:31], v2, s[8:11], s15 offen
    s_add_u32 s15, s15, 8192
    s_waitcnt vmcnt(4)
    ds_write_b128 v3, v[40:43] offset:0
    ds_write_b128 v3, v[44:47] offset:1024
    ds_write_b128 v3, v[48:51] offset:2048
    ds_write_b128 v3, v[52:55] offset:3072
    s_waitcnt lgkmcnt(0)
    ds_read_b64_tr_b16 v[80:81], v5 offset:0
    ds_read_b64_tr_b16 v[82:83], v5 offset:512
    ds_read_b64_tr_b16 v[84:85], v5 offset:8
    ds_read_b64_tr_b16 v[86:87], v5 offset:520
    ds_read_b64_tr_b16 v[88:89], v5 offset:64
    ds_read_b64_tr_b16 v[90:91], v5 offset:576
    ds_read_b64_tr_b16 v[92:93], v5 offset:72
    ds_read_b64_tr_b16 v[94:95], v5 offset:584
    s_waitcnt lgkmcnt(0)
    ds_write_b128 v9, v[80:83] offset:1024
    ds_write_b128 v9, v[84:87] offset:5120
    ds_write_b128 v9, v[88:91] offset:9216
    ds_write_b128 v9, v[92:95] offset:13312
    s_waitcnt lgkmcnt(0)
    buffer_load_dwordx4 v[40:43], v2, s[8:11], s15 offen
    s_add_u32 s15, s15, 8192
    buffer_load_dwordx4 v[44:47], v2, s[8:11], s15 offen
    s_add_u32 s15, s15, 8192
    buffer_load_dwordx4 v[48:51], v2, s[8:11], s15 offen
    s_add_u32 s15, s15, 8192
    buffer_load_dwordx4 v[52:55], v2, s[8:11], s15 offen
    s_add_u32 s15, s15, 8192
    s_waitcnt vmcnt(4)
    ds_write_b128 v3, v[16:19] offset:0
    ds_write_b128 v3, v[20:23] offset:1024
    ds_write_b128 v3, v[24:27] offset:2048
    ds_write_b128 v3, v[28:31] offset:3072
    s_waitcnt lgkmcnt(0)
    ds_read_b64_tr_b16 v[80:81], v5 offset:0
    ds_read_b64_tr_b16 v[82:83], v5 offset:512
    ds_read_b64_tr_b16 v[84:85], v5 offset:8
    ds_read_b64_tr_b16 v[86:87], v5 offset:520
    ds_read_b64_tr_b16 v[88:89], v5 offset:64
    ds_read_b64_tr_b16 v[90:91], v5 offset:576
    ds_read_b64_tr_b16 v[92:93], v5 offset:72
    ds_read_b64_tr_b16 v[94:95], v5 offset:584
    s_waitcnt lgkmcnt(0)
    ds_write_b128 v9, v[80:83] offset:2048
    ds_write_b128 v9, v[84:87] offset:6144
    ds_write_b128 v9, v[88:91] offset:10240
    ds_write_b128 v9, v[92:95] offset:14336
    s_waitcnt lgkmcnt(0)
    s_waitcnt vmcnt(0)
    ds_write_b128 v3, v[40:43] offset:0
    ds_write_b128 v3, v[44:47] offset:1024
    ds_write_b128 v3, v[48:51] offset:2048
    ds_write_b128 v3, v[52:55] offset:3072
    s_waitcnt lgkmcnt(0)
    ds_read_b64_tr_b16 v[80:81], v5 offset:0
    ds_read_b64_tr_b16 v[82:83], v5 offset:512
    ds_read_b64_tr_b16 v[84:85], v5 offset:8
    ds_read_b64_tr_b16 v[86:87], v5 offset:520
    ds_read_b64_tr_b16 v[88:89], v5 offset:64
    ds_read_b64_tr_b16 v[90:91], v5 offset:576
    ds_read_b64_tr_b16 v[92:93], v5 offset:72
    ds_read_b64_tr_b16 v[94:95], v5 offset:584
    s_waitcnt lgkmcnt(0)
    ds_write_b128 v9, v[80:83] offset:3072
    ds_write_b128 v9, v[84:87] offset:7168
    ds_write_b128 v9, v[88:91] offset:11264
    ds_write_b128 v9, v[92:95] offset:15360
    s_waitcnt lgkmcnt(0)
    s_lshl_b32 s15, s12, 17
    s_lshl_b32 s14, s13, 8
    s_add_u32 s15, s15, s14
    s_add_u32 s15, s15, 128
    v_lshrrev_b32 v2, 3, v14
    s_mov_b32 s23, 1024
    v_mul_lo_u32 v2, s23, v2
    v_and_b32 v3, 7, v14
    v_lshl_add_u32 v2, v3, 4, v2
    v_lshlrev_b32 v3, 4, v14
    v_add_u32 v3, s16, v3
    v_lshrrev_b32 v5, 4, v14
    v_bfe_u32 v6, v14, 2, 2
    v_lshl_add_u32 v5, v5, 3, v6
    v_mul_u32_u24 v5, 128, v5
    v_and_b32 v6, 3, v14
    v_lshl_add_u32 v5, v6, 4, v5
    v_add_u32 v5, s16, v5
    buffer_load_dwordx4 v[16:19], v2, s[8:11], s15 offen
    s_add_u32 s15, s15, 8192
    buffer_load_dwordx4 v[20:23], v2, s[8:11], s15 offen
    s_add_u32 s15, s15, 8192
    buffer_load_dwordx4 v[24:27], v2, s[8:11], s15 offen
    s_add_u32 s15, s15, 8192
    buffer_load_dwordx4 v[28:31], v2, s[8:11], s15 offen
    s_add_u32 s15, s15, 8192
    buffer_load_dwordx4 v[40:43], v2, s[8:11], s15 offen
    s_add_u32 s15, s15, 8192
    buffer_load_dwordx4 v[44:47], v2, s[8:11], s15 offen
    s_add_u32 s15, s15, 8192
    buffer_load_dwordx4 v[48:51], v2, s[8:11], s15 offen
    s_add_u32 s15, s15, 8192
    buffer_load_dwordx4 v[52:55], v2, s[8:11], s15 offen
    s_add_u32 s15, s15, 8192
    s_waitcnt vmcnt(4)
    ds_write_b128 v3, v[16:19] offset:0
    ds_write_b128 v3, v[20:23] offset:1024
    ds_write_b128 v3, v[24:27] offset:2048
    ds_write_b128 v3, v[28:31] offset:3072
    s_waitcnt lgkmcnt(0)
    ds_read_b64_tr_b16 v[80:81], v5 offset:0
    ds_read_b64_tr_b16 v[82:83], v5 offset:512
    ds_read_b64_tr_b16 v[84:85], v5 offset:8
    ds_read_b64_tr_b16 v[86:87], v5 offset:520
    ds_read_b64_tr_b16 v[88:89], v5 offset:64
    ds_read_b64_tr_b16 v[90:91], v5 offset:576
    ds_read_b64_tr_b16 v[92:93], v5 offset:72
    ds_read_b64_tr_b16 v[94:95], v5 offset:584
    s_waitcnt lgkmcnt(0)
    ds_write_b128 v9, v[80:83] offset:16384
    ds_write_b128 v9, v[84:87] offset:20480
    ds_write_b128 v9, v[88:91] offset:24576
    ds_write_b128 v9, v[92:95] offset:28672
    s_waitcnt lgkmcnt(0)
    buffer_load_dwordx4 v[16:19], v2, s[8:11], s15 offen
    s_add_u32 s15, s15, 8192
    buffer_load_dwordx4 v[20:23], v2, s[8:11], s15 offen
    s_add_u32 s15, s15, 8192
    buffer_load_dwordx4 v[24:27], v2, s[8:11], s15 offen
    s_add_u32 s15, s15, 8192
    buffer_load_dwordx4 v[28:31], v2, s[8:11], s15 offen
    s_add_u32 s15, s15, 8192
    s_waitcnt vmcnt(4)
    ds_write_b128 v3, v[40:43] offset:0
    ds_write_b128 v3, v[44:47] offset:1024
    ds_write_b128 v3, v[48:51] offset:2048
    ds_write_b128 v3, v[52:55] offset:3072
    s_waitcnt lgkmcnt(0)
    ds_read_b64_tr_b16 v[80:81], v5 offset:0
    ds_read_b64_tr_b16 v[82:83], v5 offset:512
    ds_read_b64_tr_b16 v[84:85], v5 offset:8
    ds_read_b64_tr_b16 v[86:87], v5 offset:520
    ds_read_b64_tr_b16 v[88:89], v5 offset:64
    ds_read_b64_tr_b16 v[90:91], v5 offset:576
    ds_read_b64_tr_b16 v[92:93], v5 offset:72
    ds_read_b64_tr_b16 v[94:95], v5 offset:584
    s_waitcnt lgkmcnt(0)
    ds_write_b128 v9, v[80:83] offset:17408
    ds_write_b128 v9, v[84:87] offset:21504
    ds_write_b128 v9, v[88:91] offset:25600
    ds_write_b128 v9, v[92:95] offset:29696
    s_waitcnt lgkmcnt(0)
    buffer_load_dwordx4 v[40:43], v2, s[8:11], s15 offen
    s_add_u32 s15, s15, 8192
    buffer_load_dwordx4 v[44:47], v2, s[8:11], s15 offen
    s_add_u32 s15, s15, 8192
    buffer_load_dwordx4 v[48:51], v2, s[8:11], s15 offen
    s_add_u32 s15, s15, 8192
    buffer_load_dwordx4 v[52:55], v2, s[8:11], s15 offen
    s_add_u32 s15, s15, 8192
    s_waitcnt vmcnt(4)
    ds_write_b128 v3, v[16:19] offset:0
    ds_write_b128 v3, v[20:23] offset:1024
    ds_write_b128 v3, v[24:27] offset:2048
    ds_write_b128 v3, v[28:31] offset:3072
    s_waitcnt lgkmcnt(0)
    ds_read_b64_tr_b16 v[80:81], v5 offset:0
    ds_read_b64_tr_b16 v[82:83], v5 offset:512
    ds_read_b64_tr_b16 v[84:85], v5 offset:8
    ds_read_b64_tr_b16 v[86:87], v5 offset:520
    ds_read_b64_tr_b16 v[88:89], v5 offset:64
    ds_read_b64_tr_b16 v[90:91], v5 offset:576
    ds_read_b64_tr_b16 v[92:93], v5 offset:72
    ds_read_b64_tr_b16 v[94:95], v5 offset:584
    s_waitcnt lgkmcnt(0)
    ds_write_b128 v9, v[80:83] offset:18432
    ds_write_b128 v9, v[84:87] offset:22528
    ds_write_b128 v9, v[88:91] offset:26624
    ds_write_b128 v9, v[92:95] offset:30720
    s_waitcnt lgkmcnt(0)
    s_waitcnt vmcnt(0)
    ds_write_b128 v3, v[40:43] offset:0
    ds_write_b128 v3, v[44:47] offset:1024
    ds_write_b128 v3, v[48:51] offset:2048
    ds_write_b128 v3, v[52:55] offset:3072
    s_waitcnt lgkmcnt(0)
    ds_read_b64_tr_b16 v[80:81], v5 offset:0
    ds_read_b64_tr_b16 v[82:83], v5 offset:512
    ds_read_b64_tr_b16 v[84:85], v5 offset:8
    ds_read_b64_tr_b16 v[86:87], v5 offset:520
    ds_read_b64_tr_b16 v[88:89], v5 offset:64
    ds_read_b64_tr_b16 v[90:91], v5 offset:576
    ds_read_b64_tr_b16 v[92:93], v5 offset:72
    ds_read_b64_tr_b16 v[94:95], v5 offset:584
    s_waitcnt lgkmcnt(0)
    ds_write_b128 v9, v[80:83] offset:19456
    ds_write_b128 v9, v[84:87] offset:23552
    ds_write_b128 v9, v[88:91] offset:27648
    ds_write_b128 v9, v[92:95] offset:31744
    s_waitcnt lgkmcnt(0)
    s_barrier
    v_mov_b32 v120, 0
    v_mov_b32 v121, 0
    v_mov_b32 v122, 0
    v_mov_b32 v123, 0
    v_add_u32 v2, 139776, v1
    ds_write_b128 v2, v[120:123]
    v_lshrrev_b32 v120, 4, v14
    s_lshl_b32 s15, s13, 11
    v_add_u32 v2, s15, v1
    v_and_b32 v3, 3, v14
    v_mul_u32_u24 v3, 2176, v3
    v_lshrrev_b32 v4, 2, v14
    v_lshl_add_u32 v3, v4, 3, v3
    s_lshl_b32 s15, s13, 8
    s_add_u32 s15, s15, 131072
    v_add_u32 v3, s15, v3
    v_mul_u32_u24 v4, 1088, v15
    v_add_u32 v4, 131072, v4
    v_mov_b32 v5, 139776
    v_cmp_gt_u32 vcc, 8, v15
    s_nop 1
    v_cndmask_b32 v4, v5, v4, vcc
    v_lshl_add_u32 v4, v120, 4, v4
    s_mul_i32 s15, s13, 3072
    s_add_u32 s15, s15, 140800
    v_add_u32 v5, s15, v1
    s_xor_b32 s15, s13, 1
    s_mul_i32 s15, s15, 3072
    s_add_u32 s15, s15, 140800
    v_add_u32 v6, s15, v1
    s_xor_b32 s15, s13, 2
    s_mul_i32 s15, s15, 3072
    s_add_u32 s15, s15, 140800
    v_add_u32 v122, s15, v1
    s_xor_b32 s15, s13, 3
    s_mul_i32 s15, s15, 3072
    s_add_u32 s15, s15, 140800
    v_add_u32 v123, s15, v1
    s_lshl_b32 s15, s13, 10
    s_add_u32 s15, s15, 153088
    v_add_u32 v7, s15, v1
    v_add_u32 v8, 153088, v1
    s_lshl_b32 s15, s13, 17
    s_lshl_b32 s14, s12, 9
    s_add_u32 s15, s15, s14
    v_lshlrev_b32 v10, 7, v120
    v_lshl_add_u32 v10, v15, 4, v10
    v_add_u32 v10, s15, v10
    s_lshl_b32 s15, s12, 14
    s_lshl_b32 s14, s13, 7
    s_add_u32 s15, s15, s14
    v_lshrrev_b32 v11, 3, v14
    v_lshlrev_b32 v11, 9, v11
    v_and_b32 v12, 7, v14
    v_lshl_add_u32 v11, v12, 4, v11
    v_add_u32 v11, s15, v11
    s_lshr_b32 s14, s12, 1
    s_lshl_b32 s14, s14, 3
    s_lshl_b32 s15, s13, 1
    s_add_u32 s14, s14, s15
    s_and_b32 s15, s12, 1
    s_add_u32 s14, s14, s15
    s_lshl_b32 s15, s14, 6
    v_add_u32 v12, s15, v13
    s_mul_i32 s16, s42, 532480
    s_add_u32 s16, s16, 41943040
    s_lshl_b32 s38, s42, 21
    s_add_u32 s38, s38, 44040192
    s_mov_b32 s17, s38
    s_lshl_b32 s14, s12, 2
    s_add_u32 s14, s14, s13
    s_lshl_b32 s14, s14, 10
    s_add_u32 s14, s14, s43
    s_add_u32 s18, s14, 67108864
    s_add_u32 s20, s14, 125829120
    s_add_u32 s21, s14, 134217728
    s_sub_u32 s14, s14, s43
    s_lshl_b32 s15, s14, 1
    s_add_u32 s15, s15, s43
    s_add_u32 s19, s15, 83886080
    s_lshl_b32 s39, s42, 12
    s_add_u32 s39, s39, 48267264
    s_lshl_b32 s40, s42, 14
    s_add_u32 s40, s40, 48248832
    s_mov_b32 s24, 0x00ff00ff
    s_mov_b32 s25, 0x00ff00ff
    s_mov_b32 s28, 1035273459
    s_mov_b32 s29, 1035273459
    s_mov_b32 s33, 1069066811
    s_mov_b32 s31, 3216550459
    s_mov_b32 s36, -1
    s_mov_b32 s37, 0
    v_mov_b32 v14, v122
    v_mov_b32 v15, v123
    v_mov_b32 v0, 0xf149f2ca
    s_mov_b32 s14, 0
    s_mov_b32 s48, 0
    s_mov_b32 s41, s17
    s_waitcnt vmcnt(0) lgkmcnt(0)
    s_barrier
    s_cmp_lg_u32 s13, 0
    s_cbranch_scc1 L_ch_nosig
    s_mov_b32 s15, 48291840
    v_mov_b32 v120, 0
    v_mov_b32 v121, 1
    s_mov_b64 exec, 1
    buffer_atomic_add v121, v120, s[4:7], s15 offen
    s_mov_b64 exec, -1
L_ch_nosig:
    s_lshr_b32 s15, s30, s42
    s_and_b32 s15, s15, 1
    s_cmp_eq_u32 s15, 1
    s_cbranch_scc1 L_step_loc
L_step_glb:
    s_cmp_eq_u32 s48, 1
    s_cbranch_scc1 L_kvok_glb
    s_lshr_b32 s15, s14, 1
    s_lshl_b32 s15, s15, 6
    s_add_u32 s15, s15, s40
    s_mov_b32 s26, 0
    v_mov_b32 v126, 0
L_pc_kv_glb:
    buffer_load_dword v127, v126, s[4:7], s15 offen sc1
    s_add_u32 s26, s26, 1
    s_cmp_gt_u32 s26, 4194304
    s_cbranch_scc1 L_mega_end
    s_waitcnt vmcnt(0)
    v_readfirstlane_b32 s27, v127
    s_nop 0
    s_cmp_ge_u32 s27, 32
    s_cbranch_scc1 L_pc_done_kv_glb
    s_sleep 1
    s_branch L_pc_kv_glb
L_pc_done_kv_glb:
    buffer_load_dwordx4 v[104:107], v1, s[4:7], s18 offen sc1
    s_add_u32 s22, s18, 131072
    buffer_load_dwordx4 v[108:111], v1, s[4:7], s22 offen sc1
    buffer_load_dwordx4 v[112:115], v1, s[4:7], s19 offen sc1
    buffer_load_dwordx4 v[116:119], v1, s[4:7], s19 offen offset:1024 sc1
L_kvok_glb:
    s_add_u32 s15, s14, 1
    s_lshr_b32 s15, s15, 1
    s_min_u32 s15, s15, 31
    s_lshl_b32 s15, s15, 6
    s_add_u32 s15, s15, s40
    v_mov_b32 v81, 0
    buffer_load_dword v82, v81, s[4:7], s15 offen sc1
    s_mov_b32 s26, 0
L_poll_mem_glb:
    buffer_load_dwordx4 v[120:123], v2, s[4:7], s16 offen sc1
    buffer_load_dwordx4 v[124:127], v2, s[4:7], s16 offen offset:1024 sc1
    s_add_u32 s26, s26, 1
    s_cmp_gt_u32 s26, 4194304
    s_cbranch_scc1 L_mega_end
    s_waitcnt vmcnt(0)
    v_max3_u32 v80, v120, v121, v122
    v_max3_u32 v80, v80, v123, v124
    v_max3_u32 v80, v80, v125, v126
    v_max_u32 v80, v80, v127
    v_cmp_eq_u32 vcc, -1, v80
    s_nop 4
    s_cbranch_vccnz L_poll_mem_glb
    v_readfirstlane_b32 s49, v82
    ds_write_b64 v3, v[120:121]
    ds_write_b64 v3, v[122:123] offset:1088
    ds_write_b64 v3, v[124:125] offset:128
    ds_write_b64 v3, v[126:127] offset:1216
    s_waitcnt lgkmcnt(0)
    s_barrier
    ds_read_b128 v[16:19], v4 offset:0
    ds_read_b128 v[20:23], v4 offset:64
    ds_read_b128 v[24:27], v4 offset:128
    ds_read_b128 v[28:31], v4 offset:192
    ds_read_b128 v[32:35], v4 offset:256
    ds_read_b128 v[36:39], v4 offset:320
    ds_read_b128 v[40:43], v4 offset:384
    ds_read_b128 v[44:47], v4 offset:448
    ds_read_b128 v[48:51], v4 offset:512
    ds_read_b128 v[52:55], v4 offset:576
    ds_read_b128 v[56:59], v4 offset:640
    ds_read_b128 v[60:63], v4 offset:704
    ds_read_b128 v[64:67], v4 offset:768
    ds_read_b128 v[68:71], v4 offset:832
    ds_read_b128 v[72:75], v4 offset:896
    ds_read_b128 v[76:79], v4 offset:960
    s_waitcnt lgkmcnt(15)
    v_mfma_f32_16x16x32_bf16 v[80:83], a[0:3], v[16:19], 0
    v_mfma_f32_16x16x32_bf16 v[84:87], a[64:67], v[16:19], 0
    v_mfma_f32_16x16x32_bf16 v[88:91], a[128:131], v[16:19], 0
    v_mfma_f32_16x16x32_bf16 v[92:95], a[192:195], v[16:19], 0
    s_waitcnt lgkmcnt(14)
    v_mfma_f32_16x16x32_bf16 v[80:83], a[4:7], v[20:23], v[80:83]
    v_mfma_f32_16x16x32_bf16 v[84:87], a[68:71], v[20:23], v[84:87]
    v_mfma_f32_16x16x32_bf16 v[88:91], a[132:135], v[20:23], v[88:91]
    v_mfma_f32_16x16x32_bf16 v[92:95], a[196:199], v[20:23], v[92:95]
    s_waitcnt lgkmcnt(13)
    v_mfma_f32_16x16x32_bf16 v[80:83], a[8:11], v[24:27], v[80:83]
    v_mfma_f32_16x16x32_bf16 v[84:87], a[72:75], v[24:27], v[84:87]
    v_mfma_f32_16x16x32_bf16 v[88:91], a[136:139], v[24:27], v[88:91]
    v_mfma_f32_16x16x32_bf16 v[92:95], a[200:203], v[24:27], v[92:95]
    s_waitcnt lgkmcnt(12)
    v_mfma_f32_16x16x32_bf16 v[80:83], a[12:15], v[28:31], v[80:83]
    v_mfma_f32_16x16x32_bf16 v[84:87], a[76:79], v[28:31], v[84:87]
    v_mfma_f32_16x16x32_bf16 v[88:91], a[140:143], v[28:31], v[88:91]
    v_mfma_f32_16x16x32_bf16 v[92:95], a[204:207], v[28:31], v[92:95]
    s_cmp_eq_u32 s14, 0
    s_cbranch_scc1 L_nodefer_glb
    v_mov_b32 v120, -1
    v_mov_b32 v121, -1
    v_mov_b32 v122, -1
    v_mov_b32 v123, -1
    v_mov_b32 v124, 1
    v_mov_b32 v125, 0
    s_add_u32 s22, s41, 0
    buffer_store_dwordx4 v[120:123], v11, s[4:7], s22 offen sc1
    s_add_u32 s22, s41, 4096
    buffer_store_dwordx4 v[120:123], v11, s[4:7], s22 offen sc1
    s_add_u32 s22, s41, 8192
    buffer_store_dwordx4 v[120:123], v11, s[4:7], s22 offen sc1
    s_add_u32 s22, s41, 12288
    buffer_store_dwordx4 v[120:123], v11, s[4:7], s22 offen sc1
    s_mov_b64 exec, 1
    buffer_atomic_add v124, v125, s[4:7], s39 offen
    s_mov_b64 exec, -1
    s_add_u32 s39, s39, 64
L_nodefer_glb:
    s_waitcnt lgkmcnt(11)
    v_mfma_f32_16x16x32_bf16 v[80:83], a[16:19], v[32:35], v[80:83]
    v_mfma_f32_16x16x32_bf16 v[84:87], a[80:83], v[32:35], v[84:87]
    v_mfma_f32_16x16x32_bf16 v[88:91], a[144:147], v[32:35], v[88:91]
    v_mfma_f32_16x16x32_bf16 v[92:95], a[208:211], v[32:35], v[92:95]
    s_waitcnt lgkmcnt(10)
    v_mfma_f32_16x16x32_bf16 v[80:83], a[20:23], v[36:39], v[80:83]
    v_mfma_f32_16x16x32_bf16 v[84:87], a[84:87], v[36:39], v[84:87]
    v_mfma_f32_16x16x32_bf16 v[88:91], a[148:151], v[36:39], v[88:91]
    v_mfma_f32_16x16x32_bf16 v[92:95], a[212:215], v[36:39], v[92:95]
    s_waitcnt lgkmcnt(9)
    v_mfma_f32_16x16x32_bf16 v[80:83], a[24:27], v[40:43], v[80:83]
    v_mfma_f32_16x16x32_bf16 v[84:87], a[88:91], v[40:43], v[84:87]
    v_mfma_f32_16x16x32_bf16 v[88:91], a[152:155], v[40:43], v[88:91]
    v_mfma_f32_16x16x32_bf16 v[92:95], a[216:219], v[40:43], v[92:95]
    s_waitcnt lgkmcnt(8)
    v_mfma_f32_16x16x32_bf16 v[80:83], a[28:31], v[44:47], v[80:83]
    v_mfma_f32_16x16x32_bf16 v[84:87], a[92:95], v[44:47], v[84:87]
    v_mfma_f32_16x16x32_bf16 v[88:91], a[156:159], v[44:47], v[88:91]
    v_mfma_f32_16x16x32_bf16 v[92:95], a[220:223], v[44:47], v[92:95]
    s_waitcnt lgkmcnt(7)
    v_mfma_f32_16x16x32_bf16 v[80:83], a[32:35], v[48:51], v[80:83]
    v_mfma_f32_16x16x32_bf16 v[84:87], a[96:99], v[48:51], v[84:87]
    v_mfma_f32_16x16x32_bf16 v[88:91], a[160:163], v[48:51], v[88:91]
    v_mfma_f32_16x16x32_bf16 v[92:95], a[224:227], v[48:51], v[92:95]
    s_waitcnt lgkmcnt(6)
    v_mfma_f32_16x16x32_bf16 v[80:83], a[36:39], v[52:55], v[80:83]
    v_mfma_f32_16x16x32_bf16 v[84:87], a[100:103], v[52:55], v[84:87]
    v_mfma_f32_16x16x32_bf16 v[88:91], a[164:167], v[52:55], v[88:91]
    v_mfma_f32_16x16x32_bf16 v[92:95], a[228:231], v[52:55], v[92:95]
    s_waitcnt lgkmcnt(5)
    v_mfma_f32_16x16x32_bf16 v[80:83], a[40:43], v[56:59], v[80:83]
    v_mfma_f32_16x16x32_bf16 v[84:87], a[104:107], v[56:59], v[84:87]
    v_mfma_f32_16x16x32_bf16 v[88:91], a[168:171], v[56:59], v[88:91]
    v_mfma_f32_16x16x32_bf16 v[92:95], a[232:235], v[56:59], v[92:95]
    s_waitcnt lgkmcnt(4)
    v_mfma_f32_16x16x32_bf16 v[80:83], a[44:47], v[60:63], v[80:83]
    v_mfma_f32_16x16x32_bf16 v[84:87], a[108:111], v[60:63], v[84:87]
    v_mfma_f32_16x16x32_bf16 v[88:91], a[172:175], v[60:63], v[88:91]
    v_mfma_f32_16x16x32_bf16 v[92:95], a[236:239], v[60:63], v[92:95]
    s_waitcnt lgkmcnt(3)
    v_mfma_f32_16x16x32_bf16 v[80:83], a[48:51], v[64:67], v[80:83]
    v_mfma_f32_16x16x32_bf16 v[84:87], a[112:115], v[64:67], v[84:87]
    v_mfma_f32_16x16x32_bf16 v[88:91], a[176:179], v[64:67], v[88:91]
    v_mfma_f32_16x16x32_bf16 v[92:95], a[240:243], v[64:67], v[92:95]
    s_waitcnt lgkmcnt(2)
    v_mfma_f32_16x16x32_bf16 v[80:83], a[52:55], v[68:71], v[80:83]
    v_mfma_f32_16x16x32_bf16 v[84:87], a[116:119], v[68:71], v[84:87]
    v_mfma_f32_16x16x32_bf16 v[88:91], a[180:183], v[68:71], v[88:91]
    v_mfma_f32_16x16x32_bf16 v[92:95], a[244:247], v[68:71], v[92:95]
    s_waitcnt lgkmcnt(1)
    v_mfma_f32_16x16x32_bf16 v[80:83], a[56:59], v[72:75], v[80:83]
    v_mfma_f32_16x16x32_bf16 v[84:87], a[120:123], v[72:75], v[84:87]
    v_mfma_f32_16x16x32_bf16 v[88:91], a[184:187], v[72:75], v[88:91]
    v_mfma_f32_16x16x32_bf16 v[92:95], a[248:251], v[72:75], v[92:95]
    s_waitcnt lgkmcnt(0)
    v_mfma_f32_16x16x32_bf16 v[80:83], a[60:63], v[76:79], v[80:83]
    v_mfma_f32_16x16x32_bf16 v[84:87], a[124:127], v[76:79], v[84:87]
    v_mfma_f32_16x16x32_bf16 v[88:91], a[188:191], v[76:79], v[88:91]
    v_mfma_f32_16x16x32_bf16 v[92:95], a[252:255], v[76:79], v[92:95]
    v_mfma_f32_16x16x32_bf16 v[96:99], v[16:19], v[128:131], 0
    v_mfma_f32_16x16x32_bf16 v[100:103], v[16:19], v[192:195], 0
    v_mfma_f32_16x16x32_bf16 v[96:99], v[20:23], v[132:135], v[96:99]
    v_mfma_f32_16x16x32_bf16 v[100:103], v[20:23], v[196:199], v[100:103]
    s_nop 0
    v_cvt_pk_bf16_f32 v120, v80, v81
    v_cvt_pk_bf16_f32 v121, v82, v83
    v_cvt_pk_bf16_f32 v122, v84, v85
    v_cvt_pk_bf16_f32 v123, v86, v87
    v_cvt_pk_bf16_f32 v124, v88, v89
    v_cvt_pk_bf16_f32 v125, v90, v91
    v_cvt_pk_bf16_f32 v126, v92, v93
    v_cvt_pk_bf16_f32 v127, v94, v95
    s_nop 1
    v_mfma_f32_16x16x32_bf16 v[80:83], v[124:127], v[120:123], 0
    v_mfma_f32_16x16x32_bf16 v[84:87], v[104:107], v[120:123], 0
    v_mfma_f32_16x16x32_bf16 v[88:91], v[108:111], v[120:123], 0
    buffer_store_dwordx4 v[124:127], v1, s[4:7], s20 offen sc1
    v_mfma_f32_16x16x32_bf16 v[96:99], v[24:27], v[136:139], v[96:99]
    v_mfma_f32_16x16x32_bf16 v[100:103], v[24:27], v[200:203], v[100:103]
    v_mfma_f32_16x16x32_bf16 v[96:99], v[28:31], v[140:143], v[96:99]
    v_mfma_f32_16x16x32_bf16 v[100:103], v[28:31], v[204:207], v[100:103]
    s_nop 0
    ds_write_b128 v5, v[80:83] offset:0
    ds_write_b128 v5, v[84:87] offset:1024
    ds_write_b128 v5, v[88:91] offset:2048
    v_mfma_f32_16x16x32_bf16 v[96:99], v[32:35], v[144:147], v[96:99]
    v_mfma_f32_16x16x32_bf16 v[100:103], v[32:35], v[208:211], v[100:103]
    v_mfma_f32_16x16x32_bf16 v[96:99], v[36:39], v[148:151], v[96:99]
    v_mfma_f32_16x16x32_bf16 v[100:103], v[36:39], v[212:215], v[100:103]
    s_add_u32 s18, s18, 262144
    s_add_u32 s19, s19, 262144
    s_mov_b32 s48, 0
    s_cmp_lt_u32 s49, 32
    s_cbranch_scc1 L_noprefk_glb
    s_cmp_ge_u32 s14, 63
    s_cbranch_scc1 L_noprefk_glb
    s_mov_b32 s48, 1
    buffer_load_dwordx4 v[104:107], v1, s[4:7], s18 offen sc1
    s_add_u32 s22, s18, 131072
    buffer_load_dwordx4 v[108:111], v1, s[4:7], s22 offen sc1
L_noprefk_glb:
    v_mfma_f32_16x16x32_bf16 v[96:99], v[40:43], v[152:155], v[96:99]
    v_mfma_f32_16x16x32_bf16 v[100:103], v[40:43], v[216:219], v[100:103]
    v_mfma_f32_16x16x32_bf16 v[96:99], v[44:47], v[156:159], v[96:99]
    v_mfma_f32_16x16x32_bf16 v[100:103], v[44:47], v[220:223], v[100:103]
    s_waitcnt lgkmcnt(0)
    s_barrier
    ds_read_b128 v[16:19], v6 offset:0
    ds_read_b128 v[20:23], v6 offset:1024
    ds_read_b128 v[24:27], v6 offset:2048
    ds_read_b128 v[28:31], v14 offset:0
    ds_read_b128 v[32:35], v14 offset:1024
    ds_read_b128 v[36:39], v14 offset:2048
    ds_read_b128 v[40:43], v15 offset:0
    ds_read_b128 v[44:47], v15 offset:1024
    ds_read_b128 v[92:95], v15 offset:2048
    v_mfma_f32_16x16x32_bf16 v[96:99], v[48:51], v[160:163], v[96:99]
    v_mfma_f32_16x16x32_bf16 v[100:103], v[48:51], v[224:227], v[100:103]
    v_mfma_f32_16x16x32_bf16 v[96:99], v[52:55], v[164:167], v[96:99]
    v_mfma_f32_16x16x32_bf16 v[100:103], v[52:55], v[228:231], v[100:103]
    v_mfma_f32_16x16x32_bf16 v[96:99], v[56:59], v[168:171], v[96:99]
    v_mfma_f32_16x16x32_bf16 v[100:103], v[56:59], v[232:235], v[100:103]
    s_waitcnt lgkmcnt(6)
    v_pk_add_f32 v[80:81], v[80:81], v[16:17]
    v_pk_add_f32 v[82:83], v[82:83], v[18:19]
    v_mfma_f32_16x16x32_bf16 v[96:99], v[60:63], v[172:175], v[96:99]
    v_pk_add_f32 v[84:85], v[84:85], v[20:21]
    v_pk_add_f32 v[86:87], v[86:87], v[22:23]
    v_pk_add_f32 v[88:89], v[88:89], v[24:25]
    v_mfma_f32_16x16x32_bf16 v[100:103], v[60:63], v[236:239], v[100:103]
    v_pk_add_f32 v[90:91], v[90:91], v[26:27]
    s_waitcnt lgkmcnt(0)
    v_pk_add_f32 v[28:29], v[28:29], v[40:41]
    v_mfma_f32_16x16x32_bf16 v[96:99], v[64:67], v[176:179], v[96:99]
    v_pk_add_f32 v[30:31], v[30:31], v[42:43]
    v_pk_add_f32 v[32:33], v[32:33], v[44:45]
    v_pk_add_f32 v[34:35], v[34:35], v[46:47]
    v_mfma_f32_16x16x32_bf16 v[100:103], v[64:67], v[240:243], v[100:103]
    v_pk_add_f32 v[36:37], v[36:37], v[92:93]
    v_pk_add_f32 v[38:39], v[38:39], v[94:95]
    v_pk_add_f32 v[80:81], v[80:81], v[28:29]
    v_mfma_f32_16x16x32_bf16 v[96:99], v[68:71], v[180:183], v[96:99]
    v_pk_add_f32 v[82:83], v[82:83], v[30:31]
    v_pk_add_f32 v[84:85], v[84:85], v[32:33]
    v_pk_add_f32 v[86:87], v[86:87], v[34:35]
    v_mfma_f32_16x16x32_bf16 v[100:103], v[68:71], v[244:247], v[100:103]
    v_pk_add_f32 v[88:89], v[88:89], v[36:37]
    v_pk_add_f32 v[90:91], v[90:91], v[38:39]
    v_cvt_pk_bf16_f32 v16, v80, v81
    v_mfma_f32_16x16x32_bf16 v[96:99], v[72:75], v[184:187], v[96:99]
    v_cvt_pk_bf16_f32 v17, v82, v83
    v_cvt_pk_bf16_f32 v18, v84, v85
    v_cvt_pk_bf16_f32 v19, v86, v87
    v_mfma_f32_16x16x32_bf16 v[100:103], v[72:75], v[248:251], v[100:103]
    v_cvt_pk_bf16_f32 v20, v88, v89
    v_cvt_pk_bf16_f32 v21, v90, v91
    v_lshlrev_b32 v80, 16, v16
    v_mfma_f32_16x16x32_bf16 v[96:99], v[76:79], v[188:191], v[96:99]
    v_and_b32 v81, 0xffff0000, v16
    v_lshlrev_b32 v82, 16, v17
    v_and_b32 v83, 0xffff0000, v17
    v_mfma_f32_16x16x32_bf16 v[100:103], v[76:79], v[252:255], v[100:103]
    v_lshlrev_b32 v84, 16, v18
    v_and_b32 v85, 0xffff0000, v18
    v_lshlrev_b32 v86, 16, v19
    v_and_b32 v87, 0xffff0000, v19
    v_lshlrev_b32 v88, 16, v20
    v_and_b32 v89, 0xffff0000, v20
    v_lshlrev_b32 v90, 16, v21
    v_and_b32 v91, 0xffff0000, v21
    v_pk_mul_f32 v[80:81], v[80:81], s[28:29]
    v_pk_mul_f32 v[82:83], v[82:83], s[28:29]
    v_pk_mul_f32 v[84:85], v[84:85], s[28:29]
    v_pk_mul_f32 v[86:87], v[86:87], s[28:29]
    v_pk_mul_f32 v[88:89], v[88:89], s[28:29]
    v_pk_mul_f32 v[90:91], v[90:91], s[28:29]
    v_cvt_pk_bf16_f32 v16, v80, v81
    v_cvt_pk_bf16_f32 v17, v82, v83
    v_cvt_pk_bf16_f32 v18, v84, v85
    v_cvt_pk_bf16_f32 v19, v86, v87
    v_cvt_pk_bf16_f32 v20, v88, v89
    v_cvt_pk_bf16_f32 v21, v90, v91
    v_lshlrev_b32 v80, 16, v16
    v_and_b32 v81, 0xffff0000, v16
    v_lshlrev_b32 v82, 16, v17
    v_and_b32 v83, 0xffff0000, v17
    v_lshlrev_b32 v84, 16, v18
    v_and_b32 v85, 0xffff0000, v18
    v_lshlrev_b32 v86, 16, v19
    v_and_b32 v87, 0xffff0000, v19
    v_lshlrev_b32 v88, 16, v20
    v_and_b32 v89, 0xffff0000, v20
    v_lshlrev_b32 v90, 16, v21
    v_and_b32 v91, 0xffff0000, v21
    v_cndmask_b32 v80, v0, v80, s[36:37]
    v_cndmask_b32 v81, v0, v81, s[36:37]
    v_cndmask_b32 v82, v0, v82, s[36:37]
    v_cndmask_b32 v83, v0, v83, s[36:37]
    v_max3_f32 v22, v80, v81, v82
    v_max3_f32 v23, v83, v84, v85
    v_max3_f32 v22, v22, v86, v87
    v_max3_f32 v23, v23, v88, v89
    v_max3_f32 v22, v22, v90, v91
    v_max_f32 v22, v22, v23
    v_mov_b32 v23, v22
    s_nop 1
    v_permlane16_swap_b32 v22, v23
    v_max_f32 v22, v22, v23
    v_mov_b32 v23, v22
    s_nop 1
    v_permlane32_swap_b32 v22, v23
    v_max_f32 v22, v22, v23
    v_mul_f32 v22, s31, v22
    v_fma_f32 v80, v80, s33, v22
    v_fma_f32 v81, v81, s33, v22
    v_fma_f32 v82, v82, s33, v22
    v_fma_f32 v83, v83, s33, v22
    v_fma_f32 v84, v84, s33, v22
    v_fma_f32 v85, v85, s33, v22
    v_fma_f32 v86, v86, s33, v22
    v_fma_f32 v87, v87, s33, v22
    v_fma_f32 v88, v88, s33, v22
    v_fma_f32 v89, v89, s33, v22
    v_fma_f32 v90, v90, s33, v22
    v_fma_f32 v91, v91, s33, v22
    v_cvt_pk_bf16_f32 v24, v96, v97
    v_cvt_pk_bf16_f32 v25, v98, v99
    v_cvt_pk_bf16_f32 v26, v100, v101
    v_cvt_pk_bf16_f32 v27, v102, v103
    v_exp_f32 v80, v80
    v_exp_f32 v81, v81
    v_exp_f32 v82, v82
    v_exp_f32 v83, v83
    v_exp_f32 v84, v84
    v_exp_f32 v85, v85
    v_exp_f32 v86, v86
    v_exp_f32 v87, v87
    v_exp_f32 v88, v88
    v_exp_f32 v89, v89
    v_exp_f32 v90, v90
    v_exp_f32 v91, v91
    ds_read_b128 v[32:35], v9 offset:0
    ds_read_b128 v[36:39], v9 offset:1024
    ds_read_b128 v[40:43], v9 offset:2048
    ds_read_b128 v[44:47], v9 offset:3072
    ds_read_b128 v[48:51], v9 offset:4096
    ds_read_b128 v[52:55], v9 offset:5120
    ds_read_b128 v[56:59], v9 offset:6144
    ds_read_b128 v[60:63], v9 offset:7168
    ds_read_b128 v[64:67], v9 offset:8192
    ds_read_b128 v[68:71], v9 offset:9216
    ds_read_b128 v[72:75], v9 offset:10240
    ds_read_b128 v[76:79], v9 offset:11264
    buffer_store_dwordx2 v[24:25], v13, s[4:7], s21 offen sc1
    buffer_store_dwordx2 v[26:27], v13, s[4:7], s21 offen offset:512 sc1
    v_pk_add_f32 v[16:17], v[80:81], v[82:83]
    v_pk_add_f32 v[18:19], v[84:85], v[86:87]
    v_pk_add_f32 v[20:21], v[88:89], v[90:91]
    v_pk_add_f32 v[16:17], v[16:17], v[18:19]
    v_pk_add_f32 v[16:17], v[16:17], v[20:21]
    v_add_f32 v22, v16, v17
    v_mov_b32 v23, v22
    s_nop 1
    v_permlane16_swap_b32 v22, v23
    v_add_f32 v22, v22, v23
    v_mov_b32 v23, v22
    s_nop 1
    v_permlane32_swap_b32 v22, v23
    v_add_f32 v22, v22, v23
    v_rcp_f32 v22, v22
    s_nop 0
    v_mov_b32 v23, v22
    v_pk_mul_f32 v[80:81], v[80:81], v[22:23]
    v_pk_mul_f32 v[82:83], v[82:83], v[22:23]
    v_pk_mul_f32 v[84:85], v[84:85], v[22:23]
    v_pk_mul_f32 v[86:87], v[86:87], v[22:23]
    v_pk_mul_f32 v[88:89], v[88:89], v[22:23]
    v_pk_mul_f32 v[90:91], v[90:91], v[22:23]
    v_cvt_pk_bf16_f32 v16, v80, v81
    v_cvt_pk_bf16_f32 v17, v82, v83
    v_cvt_pk_bf16_f32 v18, v84, v85
    v_cvt_pk_bf16_f32 v19, v86, v87
    v_cvt_pk_bf16_f32 v20, v88, v89
    v_cvt_pk_bf16_f32 v21, v90, v91
    s_nop 1
    v_mfma_f32_16x16x32_bf16 v[96:99], v[112:115], v[18:21], 0
    v_mfma_f32_16x16x32_bf16 v[100:103], v[116:119], v[18:21], 0
    v_mfma_f32_16x16x16_bf16 v[96:99], v[24:25], v[16:17], v[96:99]
    v_mfma_f32_16x16x16_bf16 v[100:103], v[26:27], v[16:17], v[100:103]
    ds_read_b128 v[80:83], v9 offset:12288
    ds_read_b128 v[84:87], v9 offset:13312
    ds_read_b128 v[88:91], v9 offset:14336
    ds_read_b128 v[92:95], v9 offset:15360
    s_cmp_eq_u32 s48, 0
    s_cbranch_scc1 L_nopref_glb
    s_nop 4
    buffer_load_dwordx4 v[112:115], v1, s[4:7], s19 offen sc1
    buffer_load_dwordx4 v[116:119], v1, s[4:7], s19 offen offset:1024 sc1
L_nopref_glb:
    v_cvt_pk_bf16_f32 v120, v96, v97
    v_cvt_pk_bf16_f32 v121, v98, v99
    v_cvt_pk_bf16_f32 v122, v100, v101
    v_cvt_pk_bf16_f32 v123, v102, v103
    ds_write_b128 v7, v[120:123]
    s_waitcnt lgkmcnt(0)
    s_barrier
    ds_read_b128 v[16:19], v8 offset:0
    ds_read_b128 v[20:23], v8 offset:1024
    ds_read_b128 v[24:27], v8 offset:2048
    ds_read_b128 v[28:31], v8 offset:3072
    s_waitcnt lgkmcnt(3)
    v_mfma_f32_16x16x32_bf16 v[96:99], v[32:35], v[16:19], 0
    v_mfma_f32_16x16x32_bf16 v[100:103], v[48:51], v[16:19], 0
    v_mfma_f32_16x16x32_bf16 v[120:123], v[64:67], v[16:19], 0
    v_mfma_f32_16x16x32_bf16 v[124:127], v[80:83], v[16:19], 0
    ds_read_b128 v[32:35], v9 offset:16384
    ds_read_b128 v[48:51], v9 offset:20480
    ds_read_b128 v[64:67], v9 offset:24576
    ds_read_b128 v[80:83], v9 offset:28672
    s_waitcnt lgkmcnt(6)
    v_mfma_f32_16x16x32_bf16 v[96:99], v[36:39], v[20:23], v[96:99]
    v_mfma_f32_16x16x32_bf16 v[100:103], v[52:55], v[20:23], v[100:103]
    v_mfma_f32_16x16x32_bf16 v[120:123], v[68:71], v[20:23], v[120:123]
    v_mfma_f32_16x16x32_bf16 v[124:127], v[84:87], v[20:23], v[124:127]
    ds_read_b128 v[36:39], v9 offset:17408
    ds_read_b128 v[52:55], v9 offset:21504
    ds_read_b128 v[68:71], v9 offset:25600
    ds_read_b128 v[84:87], v9 offset:29696
    s_waitcnt lgkmcnt(9)
    v_mfma_f32_16x16x32_bf16 v[96:99], v[40:43], v[24:27], v[96:99]
    v_mfma_f32_16x16x32_bf16 v[100:103], v[56:59], v[24:27], v[100:103]
    v_mfma_f32_16x16x32_bf16 v[120:123], v[72:75], v[24:27], v[120:123]
    v_mfma_f32_16x16x32_bf16 v[124:127], v[88:91], v[24:27], v[124:127]
    ds_read_b128 v[40:43], v9 offset:18432
    ds_read_b128 v[56:59], v9 offset:22528
    ds_read_b128 v[72:75], v9 offset:26624
    ds_read_b128 v[88:91], v9 offset:30720
    s_waitcnt lgkmcnt(12)
    v_mfma_f32_16x16x32_bf16 v[96:99], v[44:47], v[28:31], v[96:99]
    v_mfma_f32_16x16x32_bf16 v[100:103], v[60:63], v[28:31], v[100:103]
    v_mfma_f32_16x16x32_bf16 v[120:123], v[76:79], v[28:31], v[120:123]
    v_mfma_f32_16x16x32_bf16 v[124:127], v[92:95], v[28:31], v[124:127]
    ds_read_b128 v[44:47], v9 offset:19456
    ds_read_b128 v[60:63], v9 offset:23552
    ds_read_b128 v[76:79], v9 offset:27648
    ds_read_b128 v[92:95], v9 offset:31744
    s_mov_b64 exec, s[24:25]
    s_add_u32 s22, s17, 0
    buffer_store_dwordx4 v[96:99], v10, s[4:7], s22 offen sc1
    s_add_u32 s22, s17, 16384
    buffer_store_dwordx4 v[100:103], v10, s[4:7], s22 offen sc1
    s_add_u32 s22, s17, 32768
    buffer_store_dwordx4 v[120:123], v10, s[4:7], s22 offen sc1
    s_add_u32 s22, s17, 49152
    buffer_store_dwordx4 v[124:127], v10, s[4:7], s22 offen sc1
    s_mov_b64 exec, -1
    s_waitcnt lgkmcnt(12)
    v_mfma_f32_16x16x32_bf16 v[96:99], v[32:35], v[16:19], 0
    v_mfma_f32_16x16x32_bf16 v[100:103], v[48:51], v[16:19], 0
    v_mfma_f32_16x16x32_bf16 v[120:123], v[64:67], v[16:19], 0
    v_mfma_f32_16x16x32_bf16 v[124:127], v[80:83], v[16:19], 0
    s_waitcnt lgkmcnt(8)
    v_mfma_f32_16x16x32_bf16 v[96:99], v[36:39], v[20:23], v[96:99]
    v_mfma_f32_16x16x32_bf16 v[100:103], v[52:55], v[20:23], v[100:103]
    v_mfma_f32_16x16x32_bf16 v[120:123], v[68:71], v[20:23], v[120:123]
    v_mfma_f32_16x16x32_bf16 v[124:127], v[84:87], v[20:23], v[124:127]
    s_waitcnt lgkmcnt(4)
    v_mfma_f32_16x16x32_bf16 v[96:99], v[40:43], v[24:27], v[96:99]
    v_mfma_f32_16x16x32_bf16 v[100:103], v[56:59], v[24:27], v[100:103]
    v_mfma_f32_16x16x32_bf16 v[120:123], v[72:75], v[24:27], v[120:123]
    v_mfma_f32_16x16x32_bf16 v[124:127], v[88:91], v[24:27], v[124:127]
    s_waitcnt lgkmcnt(0)
    v_mfma_f32_16x16x32_bf16 v[96:99], v[44:47], v[28:31], v[96:99]
    v_mfma_f32_16x16x32_bf16 v[100:103], v[60:63], v[28:31], v[100:103]
    v_mfma_f32_16x16x32_bf16 v[120:123], v[76:79], v[28:31], v[120:123]
    v_mfma_f32_16x16x32_bf16 v[124:127], v[92:95], v[28:31], v[124:127]
    s_mov_b64 exec, s[24:25]
    s_add_u32 s22, s17, 65536
    s_nop 2
    buffer_store_dwordx4 v[96:99], v10, s[4:7], s22 offen sc1
    s_add_u32 s22, s17, 81920
    buffer_store_dwordx4 v[100:103], v10, s[4:7], s22 offen sc1
    s_add_u32 s22, s17, 98304
    buffer_store_dwordx4 v[120:123], v10, s[4:7], s22 offen sc1
    s_add_u32 s22, s17, 114688
    buffer_store_dwordx4 v[124:127], v10, s[4:7], s22 offen sc1
    s_mov_b64 exec, -1
    s_mov_b32 s26, 0
L_poll_part_glb:
    s_add_u32 s22, s17, 0
    buffer_load_dwordx4 v[40:43], v11, s[4:7], s22 offen sc1
    s_add_u32 s22, s17, 4096
    buffer_load_dwordx4 v[44:47], v11, s[4:7], s22 offen sc1
    s_add_u32 s22, s17, 8192
    buffer_load_dwordx4 v[48:51], v11, s[4:7], s22 offen sc1
    s_add_u32 s22, s17, 12288
    buffer_load_dwordx4 v[52:55], v11, s[4:7], s22 offen sc1
    s_add_u32 s26, s26, 1
    s_cmp_gt_u32 s26, 4194304
    s_cbranch_scc1 L_mega_end
    s_waitcnt vmcnt(0)
    v_max3_u32 v56, v40, v41, v42
    v_max3_u32 v56, v56, v43, v44
    v_max3_u32 v56, v56, v45, v46
    v_max3_u32 v56, v56, v47, v48
    v_max3_u32 v56, v56, v49, v50
    v_max3_u32 v56, v56, v51, v52
    v_max3_u32 v56, v56, v53, v54
    v_max_u32 v56, v56, v55
    v_cmp_eq_u32 vcc, -1, v56
    s_nop 4
    s_cbranch_vccnz L_poll_part_glb
    v_add_f32 v40, v40, v44
    v_add_f32 v48, v48, v52
    v_add_f32 v41, v41, v45
    v_add_f32 v49, v49, v53
    v_add_f32 v42, v42, v46
    v_add_f32 v50, v50, v54
    v_add_f32 v43, v43, v47
    v_add_f32 v51, v51, v55
    v_add_f32 v40, v40, v48
    v_add_f32 v41, v41, v49
    v_add_f32 v42, v42, v50
    v_add_f32 v43, v43, v51
    v_add_f32_dpp v40, v40, v40 row_ror:8
    v_mov_b32 v56, v40
    s_nop 1
    v_permlane16_swap_b32 v40, v56
    v_add_f32 v40, v40, v56
    v_mov_b32 v56, v40
    s_nop 1
    v_permlane32_swap_b32 v40, v56
    v_add_f32 v40, v40, v56
    v_add_f32_dpp v41, v41, v41 row_ror:8
    v_mov_b32 v57, v41
    s_nop 1
    v_permlane16_swap_b32 v41, v57
    v_add_f32 v41, v41, v57
    v_mov_b32 v57, v41
    s_nop 1
    v_permlane32_swap_b32 v41, v57
    v_add_f32 v41, v41, v57
    v_add_f32_dpp v42, v42, v42 row_ror:8
    v_mov_b32 v58, v42
    s_nop 1
    v_permlane16_swap_b32 v42, v58
    v_add_f32 v42, v42, v58
    v_mov_b32 v58, v42
    s_nop 1
    v_permlane32_swap_b32 v42, v58
    v_add_f32 v42, v42, v58
    v_add_f32_dpp v43, v43, v43 row_ror:8
    v_mov_b32 v59, v43
    s_nop 1
    v_permlane16_swap_b32 v43, v59
    v_add_f32 v43, v43, v59
    v_mov_b32 v59, v43
    s_nop 1
    v_permlane32_swap_b32 v43, v59
    v_add_f32 v43, v43, v59
    v_cvt_pk_bf16_f32 v60, v40, v41
    v_cvt_pk_bf16_f32 v61, v42, v43
    v_min_u32 v60, -2, v60
    v_min_u32 v61, -2, v61
    s_add_u32 s16, s16, 8192
    s_mov_b64 exec, 0xff
    buffer_store_dwordx2 v[60:61], v12, s[4:7], s16 offen sc1
    s_mov_b64 exec, -1
    s_mov_b32 s41, s17
    s_add_u32 s14, s14, 1
    s_and_b32 s15, s14, 3
    s_lshl_b32 s15, s15, 19
    s_add_u32 s17, s38, s15
    s_add_u32 s20, s20, 131072
    s_add_u32 s21, s21, 131072
    s_cmp_lt_u32 s14, 64
    s_cbranch_scc1 L_step_glb
    v_mov_b32 v124, 1
    v_mov_b32 v125, 0
    s_mov_b64 exec, 1
    buffer_atomic_add v124, v125, s[4:7], s39 offen
    s_mov_b64 exec, -1
    s_endpgm
L_step_loc:
    s_cmp_eq_u32 s48, 1
    s_cbranch_scc1 L_kvok_loc
    s_lshr_b32 s15, s14, 1
    s_lshl_b32 s15, s15, 6
    s_add_u32 s15, s15, s40
    s_mov_b32 s26, 0
    v_mov_b32 v126, 0
L_pc_kv_loc:
    buffer_load_dword v127, v126, s[4:7], s15 offen sc1
    s_add_u32 s26, s26, 1
    s_cmp_gt_u32 s26, 4194304
    s_cbranch_scc1 L_mega_end
    s_waitcnt vmcnt(0)
    v_readfirstlane_b32 s27, v127
    s_nop 0
    s_cmp_ge_u32 s27, 32
    s_cbranch_scc1 L_pc_done_kv_loc
    s_sleep 1
    s_branch L_pc_kv_loc
L_pc_done_kv_loc:
    buffer_load_dwordx4 v[104:107], v1, s[4:7], s18 offen sc1
    s_add_u32 s22, s18, 131072
    buffer_load_dwordx4 v[108:111], v1, s[4:7], s22 offen sc1
    buffer_load_dwordx4 v[112:115], v1, s[4:7], s19 offen sc1
    buffer_load_dwordx4 v[116:119], v1, s[4:7], s19 offen offset:1024 sc1
L_kvok_loc:
    s_add_u32 s15, s14, 1
    s_lshr_b32 s15, s15, 1
    s_min_u32 s15, s15, 31
    s_lshl_b32 s15, s15, 6
    s_add_u32 s15, s15, s40
    v_mov_b32 v81, 0
    buffer_load_dword v82, v81, s[4:7], s15 offen sc1
    s_mov_b32 s26, 0
L_poll_mem_loc:
    buffer_load_dwordx4 v[120:123], v2, s[4:7], s16 offen sc1
    buffer_load_dwordx4 v[124:127], v2, s[4:7], s16 offen offset:1024 sc1
    s_add_u32 s26, s26, 1
    s_cmp_gt_u32 s26, 4194304
    s_cbranch_scc1 L_mega_end
    s_waitcnt vmcnt(0)
    v_max3_u32 v80, v120, v121, v122
    v_max3_u32 v80, v80, v123, v124
    v_max3_u32 v80, v80, v125, v126
    v_max_u32 v80, v80, v127
    v_cmp_eq_u32 vcc, -1, v80
    s_nop 4
    s_cbranch_vccnz L_poll_mem_loc
    v_readfirstlane_b32 s49, v82
    ds_write_b64 v3, v[120:121]
    ds_write_b64 v3, v[122:123] offset:1088
    ds_write_b64 v3, v[124:125] offset:128
    ds_write_b64 v3, v[126:127] offset:1216
    s_waitcnt lgkmcnt(0)
    s_barrier
    ds_read_b128 v[16:19], v4 offset:0
    ds_read_b128 v[20:23], v4 offset:64
    ds_read_b128 v[24:27], v4 offset:128
    ds_read_b128 v[28:31], v4 offset:192
    ds_read_b128 v[32:35], v4 offset:256
    ds_read_b128 v[36:39], v4 offset:320
    ds_read_b128 v[40:43], v4 offset:384
    ds_read_b128 v[44:47], v4 offset:448
    ds_read_b128 v[48:51], v4 offset:512
    ds_read_b128 v[52:55], v4 offset:576
    ds_read_b128 v[56:59], v4 offset:640
    ds_read_b128 v[60:63], v4 offset:704
    ds_read_b128 v[64:67], v4 offset:768
    ds_read_b128 v[68:71], v4 offset:832
    ds_read_b128 v[72:75], v4 offset:896
    ds_read_b128 v[76:79], v4 offset:960
    s_waitcnt lgkmcnt(15)
    v_mfma_f32_16x16x32_bf16 v[80:83], a[0:3], v[16:19], 0
    v_mfma_f32_16x16x32_bf16 v[84:87], a[64:67], v[16:19], 0
    v_mfma_f32_16x16x32_bf16 v[88:91], a[128:131], v[16:19], 0
    v_mfma_f32_16x16x32_bf16 v[92:95], a[192:195], v[16:19], 0
    s_waitcnt lgkmcnt(14)
    v_mfma_f32_16x16x32_bf16 v[80:83], a[4:7], v[20:23], v[80:83]
    v_mfma_f32_16x16x32_bf16 v[84:87], a[68:71], v[20:23], v[84:87]
    v_mfma_f32_16x16x32_bf16 v[88:91], a[132:135], v[20:23], v[88:91]
    v_mfma_f32_16x16x32_bf16 v[92:95], a[196:199], v[20:23], v[92:95]
    s_waitcnt lgkmcnt(13)
    v_mfma_f32_16x16x32_bf16 v[80:83], a[8:11], v[24:27], v[80:83]
    v_mfma_f32_16x16x32_bf16 v[84:87], a[72:75], v[24:27], v[84:87]
    v_mfma_f32_16x16x32_bf16 v[88:91], a[136:139], v[24:27], v[88:91]
    v_mfma_f32_16x16x32_bf16 v[92:95], a[200:203], v[24:27], v[92:95]
    s_waitcnt lgkmcnt(12)
    v_mfma_f32_16x16x32_bf16 v[80:83], a[12:15], v[28:31], v[80:83]
    v_mfma_f32_16x16x32_bf16 v[84:87], a[76:79], v[28:31], v[84:87]
    v_mfma_f32_16x16x32_bf16 v[88:91], a[140:143], v[28:31], v[88:91]
    v_mfma_f32_16x16x32_bf16 v[92:95], a[204:207], v[28:31], v[92:95]
    s_cmp_eq_u32 s14, 0
    s_cbranch_scc1 L_nodefer_loc
    v_mov_b32 v120, -1
    v_mov_b32 v121, -1
    v_mov_b32 v122, -1
    v_mov_b32 v123, -1
    v_mov_b32 v124, 1
    v_mov_b32 v125, 0
    s_add_u32 s22, s41, 0
    buffer_store_dwordx4 v[120:123], v11, s[4:7], s22 offen
    s_add_u32 s22, s41, 4096
    buffer_store_dwordx4 v[120:123], v11, s[4:7], s22 offen
    s_add_u32 s22, s41, 8192
    buffer_store_dwordx4 v[120:123], v11, s[4:7], s22 offen
    s_add_u32 s22, s41, 12288
    buffer_store_dwordx4 v[120:123], v11, s[4:7], s22 offen
    s_mov_b64 exec, 1
    buffer_atomic_add v124, v125, s[4:7], s39 offen
    s_mov_b64 exec, -1
    s_add_u32 s39, s39, 64
L_nodefer_loc:
    s_waitcnt lgkmcnt(11)
    v_mfma_f32_16x16x32_bf16 v[80:83], a[16:19], v[32:35], v[80:83]
    v_mfma_f32_16x16x32_bf16 v[84:87], a[80:83], v[32:35], v[84:87]
    v_mfma_f32_16x16x32_bf16 v[88:91], a[144:147], v[32:35], v[88:91]
    v_mfma_f32_16x16x32_bf16 v[92:95], a[208:211], v[32:35], v[92:95]
    s_waitcnt lgkmcnt(10)
    v_mfma_f32_16x16x32_bf16 v[80:83], a[20:23], v[36:39], v[80:83]
    v_mfma_f32_16x16x32_bf16 v[84:87], a[84:87], v[36:39], v[84:87]
    v_mfma_f32_16x16x32_bf16 v[88:91], a[148:151], v[36:39], v[88:91]
    v_mfma_f32_16x16x32_bf16 v[92:95], a[212:215], v[36:39], v[92:95]
    s_waitcnt lgkmcnt(9)
    v_mfma_f32_16x16x32_bf16 v[80:83], a[24:27], v[40:43], v[80:83]
    v_mfma_f32_16x16x32_bf16 v[84:87], a[88:91], v[40:43], v[84:87]
    v_mfma_f32_16x16x32_bf16 v[88:91], a[152:155], v[40:43], v[88:91]
    v_mfma_f32_16x16x32_bf16 v[92:95], a[216:219], v[40:43], v[92:95]
    s_waitcnt lgkmcnt(8)
    v_mfma_f32_16x16x32_bf16 v[80:83], a[28:31], v[44:47], v[80:83]
    v_mfma_f32_16x16x32_bf16 v[84:87], a[92:95], v[44:47], v[84:87]
    v_mfma_f32_16x16x32_bf16 v[88:91], a[156:159], v[44:47], v[88:91]
    v_mfma_f32_16x16x32_bf16 v[92:95], a[220:223], v[44:47], v[92:95]
    s_waitcnt lgkmcnt(7)
    v_mfma_f32_16x16x32_bf16 v[80:83], a[32:35], v[48:51], v[80:83]
    v_mfma_f32_16x16x32_bf16 v[84:87], a[96:99], v[48:51], v[84:87]
    v_mfma_f32_16x16x32_bf16 v[88:91], a[160:163], v[48:51], v[88:91]
    v_mfma_f32_16x16x32_bf16 v[92:95], a[224:227], v[48:51], v[92:95]
    s_waitcnt lgkmcnt(6)
    v_mfma_f32_16x16x32_bf16 v[80:83], a[36:39], v[52:55], v[80:83]
    v_mfma_f32_16x16x32_bf16 v[84:87], a[100:103], v[52:55], v[84:87]
    v_mfma_f32_16x16x32_bf16 v[88:91], a[164:167], v[52:55], v[88:91]
    v_mfma_f32_16x16x32_bf16 v[92:95], a[228:231], v[52:55], v[92:95]
    s_waitcnt lgkmcnt(5)
    v_mfma_f32_16x16x32_bf16 v[80:83], a[40:43], v[56:59], v[80:83]
    v_mfma_f32_16x16x32_bf16 v[84:87], a[104:107], v[56:59], v[84:87]
    v_mfma_f32_16x16x32_bf16 v[88:91], a[168:171], v[56:59], v[88:91]
    v_mfma_f32_16x16x32_bf16 v[92:95], a[232:235], v[56:59], v[92:95]
    s_waitcnt lgkmcnt(4)
    v_mfma_f32_16x16x32_bf16 v[80:83], a[44:47], v[60:63], v[80:83]
    v_mfma_f32_16x16x32_bf16 v[84:87], a[108:111], v[60:63], v[84:87]
    v_mfma_f32_16x16x32_bf16 v[88:91], a[172:175], v[60:63], v[88:91]
    v_mfma_f32_16x16x32_bf16 v[92:95], a[236:239], v[60:63], v[92:95]
    s_waitcnt lgkmcnt(3)
    v_mfma_f32_16x16x32_bf16 v[80:83], a[48:51], v[64:67], v[80:83]
    v_mfma_f32_16x16x32_bf16 v[84:87], a[112:115], v[64:67], v[84:87]
    v_mfma_f32_16x16x32_bf16 v[88:91], a[176:179], v[64:67], v[88:91]
    v_mfma_f32_16x16x32_bf16 v[92:95], a[240:243], v[64:67], v[92:95]
    s_waitcnt lgkmcnt(2)
    v_mfma_f32_16x16x32_bf16 v[80:83], a[52:55], v[68:71], v[80:83]
    v_mfma_f32_16x16x32_bf16 v[84:87], a[116:119], v[68:71], v[84:87]
    v_mfma_f32_16x16x32_bf16 v[88:91], a[180:183], v[68:71], v[88:91]
    v_mfma_f32_16x16x32_bf16 v[92:95], a[244:247], v[68:71], v[92:95]
    s_waitcnt lgkmcnt(1)
    v_mfma_f32_16x16x32_bf16 v[80:83], a[56:59], v[72:75], v[80:83]
    v_mfma_f32_16x16x32_bf16 v[84:87], a[120:123], v[72:75], v[84:87]
    v_mfma_f32_16x16x32_bf16 v[88:91], a[184:187], v[72:75], v[88:91]
    v_mfma_f32_16x16x32_bf16 v[92:95], a[248:251], v[72:75], v[92:95]
    s_waitcnt lgkmcnt(0)
    v_mfma_f32_16x16x32_bf16 v[80:83], a[60:63], v[76:79], v[80:83]
    v_mfma_f32_16x16x32_bf16 v[84:87], a[124:127], v[76:79], v[84:87]
    v_mfma_f32_16x16x32_bf16 v[88:91], a[188:191], v[76:79], v[88:91]
    v_mfma_f32_16x16x32_bf16 v[92:95], a[252:255], v[76:79], v[92:95]
    v_mfma_f32_16x16x32_bf16 v[96:99], v[16:19], v[128:131], 0
    v_mfma_f32_16x16x32_bf16 v[100:103], v[16:19], v[192:195], 0
    v_mfma_f32_16x16x32_bf16 v[96:99], v[20:23], v[132:135], v[96:99]
    v_mfma_f32_16x16x32_bf16 v[100:103], v[20:23], v[196:199], v[100:103]
    s_nop 0
    v_cvt_pk_bf16_f32 v120, v80, v81
    v_cvt_pk_bf16_f32 v121, v82, v83
    v_cvt_pk_bf16_f32 v122, v84, v85
    v_cvt_pk_bf16_f32 v123, v86, v87
    v_cvt_pk_bf16_f32 v124, v88, v89
    v_cvt_pk_bf16_f32 v125, v90, v91
    v_cvt_pk_bf16_f32 v126, v92, v93
    v_cvt_pk_bf16_f32 v127, v94, v95
    s_nop 1
    v_mfma_f32_16x16x32_bf16 v[80:83], v[124:127], v[120:123], 0
    v_mfma_f32_16x16x32_bf16 v[84:87], v[104:107], v[120:123], 0
    v_mfma_f32_16x16x32_bf16 v[88:91], v[108:111], v[120:123], 0
    buffer_store_dwordx4 v[124:127], v1, s[4:7], s20 offen sc1
    v_mfma_f32_16x16x32_bf16 v[96:99], v[24:27], v[136:139], v[96:99]
    v_mfma_f32_16x16x32_bf16 v[100:103], v[24:27], v[200:203], v[100:103]
    v_mfma_f32_16x16x32_bf16 v[96:99], v[28:31], v[140:143], v[96:99]
    v_mfma_f32_16x16x32_bf16 v[100:103], v[28:31], v[204:207], v[100:103]
    s_nop 0
    ds_write_b128 v5, v[80:83] offset:0
    ds_write_b128 v5, v[84:87] offset:1024
    ds_write_b128 v5, v[88:91] offset:2048
    v_mfma_f32_16x16x32_bf16 v[96:99], v[32:35], v[144:147], v[96:99]
    v_mfma_f32_16x16x32_bf16 v[100:103], v[32:35], v[208:211], v[100:103]
    v_mfma_f32_16x16x32_bf16 v[96:99], v[36:39], v[148:151], v[96:99]
    v_mfma_f32_16x16x32_bf16 v[100:103], v[36:39], v[212:215], v[100:103]
    s_add_u32 s18, s18, 262144
    s_add_u32 s19, s19, 262144
    s_mov_b32 s48, 0
    s_cmp_lt_u32 s49, 32
    s_cbranch_scc1 L_noprefk_loc
    s_cmp_ge_u32 s14, 63
    s_cbranch_scc1 L_noprefk_loc
    s_mov_b32 s48, 1
    buffer_load_dwordx4 v[104:107], v1, s[4:7], s18 offen sc1
    s_add_u32 s22, s18, 131072
    buffer_load_dwordx4 v[108:111], v1, s[4:7], s22 offen sc1
L_noprefk_loc:
    v_mfma_f32_16x16x32_bf16 v[96:99], v[40:43], v[152:155], v[96:99]
    v_mfma_f32_16x16x32_bf16 v[100:103], v[40:43], v[216:219], v[100:103]
    v_mfma_f32_16x16x32_bf16 v[96:99], v[44:47], v[156:159], v[96:99]
    v_mfma_f32_16x16x32_bf16 v[100:103], v[44:47], v[220:223], v[100:103]
    s_waitcnt lgkmcnt(0)
    s_barrier
    ds_read_b128 v[16:19], v6 offset:0
    ds_read_b128 v[20:23], v6 offset:1024
    ds_read_b128 v[24:27], v6 offset:2048
    ds_read_b128 v[28:31], v14 offset:0
    ds_read_b128 v[32:35], v14 offset:1024
    ds_read_b128 v[36:39], v14 offset:2048
    ds_read_b128 v[40:43], v15 offset:0
    ds_read_b128 v[44:47], v15 offset:1024
    ds_read_b128 v[92:95], v15 offset:2048
    v_mfma_f32_16x16x32_bf16 v[96:99], v[48:51], v[160:163], v[96:99]
    v_mfma_f32_16x16x32_bf16 v[100:103], v[48:51], v[224:227], v[100:103]
    v_mfma_f32_16x16x32_bf16 v[96:99], v[52:55], v[164:167], v[96:99]
    v_mfma_f32_16x16x32_bf16 v[100:103], v[52:55], v[228:231], v[100:103]
    v_mfma_f32_16x16x32_bf16 v[96:99], v[56:59], v[168:171], v[96:99]
    v_mfma_f32_16x16x32_bf16 v[100:103], v[56:59], v[232:235], v[100:103]
    s_waitcnt lgkmcnt(6)
    v_pk_add_f32 v[80:81], v[80:81], v[16:17]
    v_pk_add_f32 v[82:83], v[82:83], v[18:19]
    v_mfma_f32_16x16x32_bf16 v[96:99], v[60:63], v[172:175], v[96:99]
    v_pk_add_f32 v[84:85], v[84:85], v[20:21]
    v_pk_add_f32 v[86:87], v[86:87], v[22:23]
    v_pk_add_f32 v[88:89], v[88:89], v[24:25]
    v_mfma_f32_16x16x32_bf16 v[100:103], v[60:63], v[236:239], v[100:103]
    v_pk_add_f32 v[90:91], v[90:91], v[26:27]
    s_waitcnt lgkmcnt(0)
    v_pk_add_f32 v[28:29], v[28:29], v[40:41]
    v_mfma_f32_16x16x32_bf16 v[96:99], v[64:67], v[176:179], v[96:99]
    v_pk_add_f32 v[30:31], v[30:31], v[42:43]
    v_pk_add_f32 v[32:33], v[32:33], v[44:45]
    v_pk_add_f32 v[34:35], v[34:35], v[46:47]
    v_mfma_f32_16x16x32_bf16 v[100:103], v[64:67], v[240:243], v[100:103]
    v_pk_add_f32 v[36:37], v[36:37], v[92:93]
    v_pk_add_f32 v[38:39], v[38:39], v[94:95]
    v_pk_add_f32 v[80:81], v[80:81], v[28:29]
    v_mfma_f32_16x16x32_bf16 v[96:99], v[68:71], v[180:183], v[96:99]
    v_pk_add_f32 v[82:83], v[82:83], v[30:31]
    v_pk_add_f32 v[84:85], v[84:85], v[32:33]
    v_pk_add_f32 v[86:87], v[86:87], v[34:35]
    v_mfma_f32_16x16x32_bf16 v[100:103], v[68:71], v[244:247], v[100:103]
    v_pk_add_f32 v[88:89], v[88:89], v[36:37]
    v_pk_add_f32 v[90:91], v[90:91], v[38:39]
    v_cvt_pk_bf16_f32 v16, v80, v81
    v_mfma_f32_16x16x32_bf16 v[96:99], v[72:75], v[184:187], v[96:99]
    v_cvt_pk_bf16_f32 v17, v82, v83
    v_cvt_pk_bf16_f32 v18, v84, v85
    v_cvt_pk_bf16_f32 v19, v86, v87
    v_mfma_f32_16x16x32_bf16 v[100:103], v[72:75], v[248:251], v[100:103]
    v_cvt_pk_bf16_f32 v20, v88, v89
    v_cvt_pk_bf16_f32 v21, v90, v91
    v_lshlrev_b32 v80, 16, v16
    v_mfma_f32_16x16x32_bf16 v[96:99], v[76:79], v[188:191], v[96:99]
    v_and_b32 v81, 0xffff0000, v16
    v_lshlrev_b32 v82, 16, v17
    v_and_b32 v83, 0xffff0000, v17
    v_mfma_f32_16x16x32_bf16 v[100:103], v[76:79], v[252:255], v[100:103]
    v_lshlrev_b32 v84, 16, v18
    v_and_b32 v85, 0xffff0000, v18
    v_lshlrev_b32 v86, 16, v19
    v_and_b32 v87, 0xffff0000, v19
    v_lshlrev_b32 v88, 16, v20
    v_and_b32 v89, 0xffff0000, v20
    v_lshlrev_b32 v90, 16, v21
    v_and_b32 v91, 0xffff0000, v21
    v_pk_mul_f32 v[80:81], v[80:81], s[28:29]
    v_pk_mul_f32 v[82:83], v[82:83], s[28:29]
    v_pk_mul_f32 v[84:85], v[84:85], s[28:29]
    v_pk_mul_f32 v[86:87], v[86:87], s[28:29]
    v_pk_mul_f32 v[88:89], v[88:89], s[28:29]
    v_pk_mul_f32 v[90:91], v[90:91], s[28:29]
    v_cvt_pk_bf16_f32 v16, v80, v81
    v_cvt_pk_bf16_f32 v17, v82, v83
    v_cvt_pk_bf16_f32 v18, v84, v85
    v_cvt_pk_bf16_f32 v19, v86, v87
    v_cvt_pk_bf16_f32 v20, v88, v89
    v_cvt_pk_bf16_f32 v21, v90, v91
    v_lshlrev_b32 v80, 16, v16
    v_and_b32 v81, 0xffff0000, v16
    v_lshlrev_b32 v82, 16, v17
    v_and_b32 v83, 0xffff0000, v17
    v_lshlrev_b32 v84, 16, v18
    v_and_b32 v85, 0xffff0000, v18
    v_lshlrev_b32 v86, 16, v19
    v_and_b32 v87, 0xffff0000, v19
    v_lshlrev_b32 v88, 16, v20
    v_and_b32 v89, 0xffff0000, v20
    v_lshlrev_b32 v90, 16, v21
    v_and_b32 v91, 0xffff0000, v21
    v_cndmask_b32 v80, v0, v80, s[36:37]
    v_cndmask_b32 v81, v0, v81, s[36:37]
    v_cndmask_b32 v82, v0, v82, s[36:37]
    v_cndmask_b32 v83, v0, v83, s[36:37]
    v_max3_f32 v22, v80, v81, v82
    v_max3_f32 v23, v83, v84, v85
    v_max3_f32 v22, v22, v86, v87
    v_max3_f32 v23, v23, v88, v89
    v_max3_f32 v22, v22, v90, v91
    v_max_f32 v22, v22, v23
    v_mov_b32 v23, v22
    s_nop 1
    v_permlane16_swap_b32 v22, v23
    v_max_f32 v22, v22, v23
    v_mov_b32 v23, v22
    s_nop 1
    v_permlane32_swap_b32 v22, v23
    v_max_f32 v22, v22, v23
    v_mul_f32 v22, s31, v22
    v_fma_f32 v80, v80, s33, v22
    v_fma_f32 v81, v81, s33, v22
    v_fma_f32 v82, v82, s33, v22
    v_fma_f32 v83, v83, s33, v22
    v_fma_f32 v84, v84, s33, v22
    v_fma_f32 v85, v85, s33, v22
    v_fma_f32 v86, v86, s33, v22
    v_fma_f32 v87, v87, s33, v22
    v_fma_f32 v88, v88, s33, v22
    v_fma_f32 v89, v89, s33, v22
    v_fma_f32 v90, v90, s33, v22
    v_fma_f32 v91, v91, s33, v22
    v_cvt_pk_bf16_f32 v24, v96, v97
    v_cvt_pk_bf16_f32 v25, v98, v99
    v_cvt_pk_bf16_f32 v26, v100, v101
    v_cvt_pk_bf16_f32 v27, v102, v103
    v_exp_f32 v80, v80
    v_exp_f32 v81, v81
    v_exp_f32 v82, v82
    v_exp_f32 v83, v83
    v_exp_f32 v84, v84
    v_exp_f32 v85, v85
    v_exp_f32 v86, v86
    v_exp_f32 v87, v87
    v_exp_f32 v88, v88
    v_exp_f32 v89, v89
    v_exp_f32 v90, v90
    v_exp_f32 v91, v91
    ds_read_b128 v[32:35], v9 offset:0
    ds_read_b128 v[36:39], v9 offset:1024
    ds_read_b128 v[40:43], v9 offset:2048
    ds_read_b128 v[44:47], v9 offset:3072
    ds_read_b128 v[48:51], v9 offset:4096
    ds_read_b128 v[52:55], v9 offset:5120
    ds_read_b128 v[56:59], v9 offset:6144
    ds_read_b128 v[60:63], v9 offset:7168
    ds_read_b128 v[64:67], v9 offset:8192
    ds_read_b128 v[68:71], v9 offset:9216
    ds_read_b128 v[72:75], v9 offset:10240
    ds_read_b128 v[76:79], v9 offset:11264
    buffer_store_dwordx2 v[24:25], v13, s[4:7], s21 offen sc1
    buffer_store_dwordx2 v[26:27], v13, s[4:7], s21 offen offset:512 sc1
    v_pk_add_f32 v[16:17], v[80:81], v[82:83]
    v_pk_add_f32 v[18:19], v[84:85], v[86:87]
    v_pk_add_f32 v[20:21], v[88:89], v[90:91]
    v_pk_add_f32 v[16:17], v[16:17], v[18:19]
    v_pk_add_f32 v[16:17], v[16:17], v[20:21]
    v_add_f32 v22, v16, v17
    v_mov_b32 v23, v22
    s_nop 1
    v_permlane16_swap_b32 v22, v23
    v_add_f32 v22, v22, v23
    v_mov_b32 v23, v22
    s_nop 1
    v_permlane32_swap_b32 v22, v23
    v_add_f32 v22, v22, v23
    v_rcp_f32 v22, v22
    s_nop 0
    v_mov_b32 v23, v22
    v_pk_mul_f32 v[80:81], v[80:81], v[22:23]
    v_pk_mul_f32 v[82:83], v[82:83], v[22:23]
    v_pk_mul_f32 v[84:85], v[84:85], v[22:23]
    v_pk_mul_f32 v[86:87], v[86:87], v[22:23]
    v_pk_mul_f32 v[88:89], v[88:89], v[22:23]
    v_pk_mul_f32 v[90:91], v[90:91], v[22:23]
    v_cvt_pk_bf16_f32 v16, v80, v81
    v_cvt_pk_bf16_f32 v17, v82, v83
    v_cvt_pk_bf16_f32 v18, v84, v85
    v_cvt_pk_bf16_f32 v19, v86, v87
    v_cvt_pk_bf16_f32 v20, v88, v89
    v_cvt_pk_bf16_f32 v21, v90, v91
    s_nop 1
    v_mfma_f32_16x16x32_bf16 v[96:99], v[112:115], v[18:21], 0
    v_mfma_f32_16x16x32_bf16 v[100:103], v[116:119], v[18:21], 0
    v_mfma_f32_16x16x16_bf16 v[96:99], v[24:25], v[16:17], v[96:99]
    v_mfma_f32_16x16x16_bf16 v[100:103], v[26:27], v[16:17], v[100:103]
    ds_read_b128 v[80:83], v9 offset:12288
    ds_read_b128 v[84:87], v9 offset:13312
    ds_read_b128 v[88:91], v9 offset:14336
    ds_read_b128 v[92:95], v9 offset:15360
    s_cmp_eq_u32 s48, 0
    s_cbranch_scc1 L_nopref_loc
    s_nop 4
    buffer_load_dwordx4 v[112:115], v1, s[4:7], s19 offen sc1
    buffer_load_dwordx4 v[116:119], v1, s[4:7], s19 offen offset:1024 sc1
L_nopref_loc:
    v_cvt_pk_bf16_f32 v120, v96, v97
    v_cvt_pk_bf16_f32 v121, v98, v99
    v_cvt_pk_bf16_f32 v122, v100, v101
    v_cvt_pk_bf16_f32 v123, v102, v103
    ds_write_b128 v7, v[120:123]
    s_waitcnt lgkmcnt(0)
    s_barrier
    ds_read_b128 v[16:19], v8 offset:0
    ds_read_b128 v[20:23], v8 offset:1024
    ds_read_b128 v[24:27], v8 offset:2048
    ds_read_b128 v[28:31], v8 offset:3072
    s_waitcnt lgkmcnt(3)
    v_mfma_f32_16x16x32_bf16 v[96:99], v[32:35], v[16:19], 0
    v_mfma_f32_16x16x32_bf16 v[100:103], v[48:51], v[16:19], 0
    v_mfma_f32_16x16x32_bf16 v[120:123], v[64:67], v[16:19], 0
    v_mfma_f32_16x16x32_bf16 v[124:127], v[80:83], v[16:19], 0
    ds_read_b128 v[32:35], v9 offset:16384
    ds_read_b128 v[48:51], v9 offset:20480
    ds_read_b128 v[64:67], v9 offset:24576
    ds_read_b128 v[80:83], v9 offset:28672
    s_waitcnt lgkmcnt(6)
    v_mfma_f32_16x16x32_bf16 v[96:99], v[36:39], v[20:23], v[96:99]
    v_mfma_f32_16x16x32_bf16 v[100:103], v[52:55], v[20:23], v[100:103]
    v_mfma_f32_16x16x32_bf16 v[120:123], v[68:71], v[20:23], v[120:123]
    v_mfma_f32_16x16x32_bf16 v[124:127], v[84:87], v[20:23], v[124:127]
    ds_read_b128 v[36:39], v9 offset:17408
    ds_read_b128 v[52:55], v9 offset:21504
    ds_read_b128 v[68:71], v9 offset:25600
    ds_read_b128 v[84:87], v9 offset:29696
    s_waitcnt lgkmcnt(9)
    v_mfma_f32_16x16x32_bf16 v[96:99], v[40:43], v[24:27], v[96:99]
    v_mfma_f32_16x16x32_bf16 v[100:103], v[56:59], v[24:27], v[100:103]
    v_mfma_f32_16x16x32_bf16 v[120:123], v[72:75], v[24:27], v[120:123]
    v_mfma_f32_16x16x32_bf16 v[124:127], v[88:91], v[24:27], v[124:127]
    ds_read_b128 v[40:43], v9 offset:18432
    ds_read_b128 v[56:59], v9 offset:22528
    ds_read_b128 v[72:75], v9 offset:26624
    ds_read_b128 v[88:91], v9 offset:30720
    s_waitcnt lgkmcnt(12)
    v_mfma_f32_16x16x32_bf16 v[96:99], v[44:47], v[28:31], v[96:99]
    v_mfma_f32_16x16x32_bf16 v[100:103], v[60:63], v[28:31], v[100:103]
    v_mfma_f32_16x16x32_bf16 v[120:123], v[76:79], v[28:31], v[120:123]
    v_mfma_f32_16x16x32_bf16 v[124:127], v[92:95], v[28:31], v[124:127]
    ds_read_b128 v[44:47], v9 offset:19456
    ds_read_b128 v[60:63], v9 offset:23552
    ds_read_b128 v[76:79], v9 offset:27648
    ds_read_b128 v[92:95], v9 offset:31744
    s_mov_b64 exec, s[24:25]
    s_add_u32 s22, s17, 0
    buffer_store_dwordx4 v[96:99], v10, s[4:7], s22 offen
    s_add_u32 s22, s17, 16384
    buffer_store_dwordx4 v[100:103], v10, s[4:7], s22 offen
    s_add_u32 s22, s17, 32768
    buffer_store_dwordx4 v[120:123], v10, s[4:7], s22 offen
    s_add_u32 s22, s17, 49152
    buffer_store_dwordx4 v[124:127], v10, s[4:7], s22 offen
    s_mov_b64 exec, -1
    s_waitcnt lgkmcnt(12)
    v_mfma_f32_16x16x32_bf16 v[96:99], v[32:35], v[16:19], 0
    v_mfma_f32_16x16x32_bf16 v[100:103], v[48:51], v[16:19], 0
    v_mfma_f32_16x16x32_bf16 v[120:123], v[64:67], v[16:19], 0
    v_mfma_f32_16x16x32_bf16 v[124:127], v[80:83], v[16:19], 0
    s_waitcnt lgkmcnt(8)
    v_mfma_f32_16x16x32_bf16 v[96:99], v[36:39], v[20:23], v[96:99]
    v_mfma_f32_16x16x32_bf16 v[100:103], v[52:55], v[20:23], v[100:103]
    v_mfma_f32_16x16x32_bf16 v[120:123], v[68:71], v[20:23], v[120:123]
    v_mfma_f32_16x16x32_bf16 v[124:127], v[84:87], v[20:23], v[124:127]
    s_waitcnt lgkmcnt(4)
    v_mfma_f32_16x16x32_bf16 v[96:99], v[40:43], v[24:27], v[96:99]
    v_mfma_f32_16x16x32_bf16 v[100:103], v[56:59], v[24:27], v[100:103]
    v_mfma_f32_16x16x32_bf16 v[120:123], v[72:75], v[24:27], v[120:123]
    v_mfma_f32_16x16x32_bf16 v[124:127], v[88:91], v[24:27], v[124:127]
    s_waitcnt lgkmcnt(0)
    v_mfma_f32_16x16x32_bf16 v[96:99], v[44:47], v[28:31], v[96:99]
    v_mfma_f32_16x16x32_bf16 v[100:103], v[60:63], v[28:31], v[100:103]
    v_mfma_f32_16x16x32_bf16 v[120:123], v[76:79], v[28:31], v[120:123]
    v_mfma_f32_16x16x32_bf16 v[124:127], v[92:95], v[28:31], v[124:127]
    s_mov_b64 exec, s[24:25]
    s_add_u32 s22, s17, 65536
    s_nop 2
    buffer_store_dwordx4 v[96:99], v10, s[4:7], s22 offen
    s_add_u32 s22, s17, 81920
    buffer_store_dwordx4 v[100:103], v10, s[4:7], s22 offen
    s_add_u32 s22, s17, 98304
    buffer_store_dwordx4 v[120:123], v10, s[4:7], s22 offen
    s_add_u32 s22, s17, 114688
    buffer_store_dwordx4 v[124:127], v10, s[4:7], s22 offen
    s_mov_b64 exec, -1
    s_mov_b32 s26, 0
L_poll_part_loc:
    s_add_u32 s22, s17, 0
    buffer_load_dwordx4 v[40:43], v11, s[4:7], s22 offen sc1
    s_add_u32 s22, s17, 4096
    buffer_load_dwordx4 v[44:47], v11, s[4:7], s22 offen sc1
    s_add_u32 s22, s17, 8192
    buffer_load_dwordx4 v[48:51], v11, s[4:7], s22 offen sc1
    s_add_u32 s22, s17, 12288
    buffer_load_dwordx4 v[52:55], v11, s[4:7], s22 offen sc1
    s_add_u32 s26, s26, 1
    s_cmp_gt_u32 s26, 4194304
    s_cbranch_scc1 L_mega_end
    s_waitcnt vmcnt(0)
    v_max3_u32 v56, v40, v41, v42
    v_max3_u32 v56, v56, v43, v44
    v_max3_u32 v56, v56, v45, v46
    v_max3_u32 v56, v56, v47, v48
    v_max3_u32 v56, v56, v49, v50
    v_max3_u32 v56, v56, v51, v52
    v_max3_u32 v56, v56, v53, v54
    v_max_u32 v56, v56, v55
    v_cmp_eq_u32 vcc, -1, v56
    s_nop 4
    s_cbranch_vccnz L_poll_part_loc
    v_add_f32 v40, v40, v44
    v_add_f32 v48, v48, v52
    v_add_f32 v41, v41, v45
    v_add_f32 v49, v49, v53
    v_add_f32 v42, v42, v46
    v_add_f32 v50, v50, v54
    v_add_f32 v43, v43, v47
    v_add_f32 v51, v51, v55
    v_add_f32 v40, v40, v48
    v_add_f32 v41, v41, v49
    v_add_f32 v42, v42, v50
    v_add_f32 v43, v43, v51
    v_add_f32_dpp v40, v40, v40 row_ror:8
    v_mov_b32 v56, v40
    s_nop 1
    v_permlane16_swap_b32 v40, v56
    v_add_f32 v40, v40, v56
    v_mov_b32 v56, v40
    s_nop 1
    v_permlane32_swap_b32 v40, v56
    v_add_f32 v40, v40, v56
    v_add_f32_dpp v41, v41, v41 row_ror:8
    v_mov_b32 v57, v41
    s_nop 1
    v_permlane16_swap_b32 v41, v57
    v_add_f32 v41, v41, v57
    v_mov_b32 v57, v41
    s_nop 1
    v_permlane32_swap_b32 v41, v57
    v_add_f32 v41, v41, v57
    v_add_f32_dpp v42, v42, v42 row_ror:8
    v_mov_b32 v58, v42
    s_nop 1
    v_permlane16_swap_b32 v42, v58
    v_add_f32 v42, v42, v58
    v_mov_b32 v58, v42
    s_nop 1
    v_permlane32_swap_b32 v42, v58
    v_add_f32 v42, v42, v58
    v_add_f32_dpp v43, v43, v43 row_ror:8
    v_mov_b32 v59, v43
    s_nop 1
    v_permlane16_swap_b32 v43, v59
    v_add_f32 v43, v43, v59
    v_mov_b32 v59, v43
    s_nop 1
    v_permlane32_swap_b32 v43, v59
    v_add_f32 v43, v43, v59
    v_cvt_pk_bf16_f32 v60, v40, v41
    v_cvt_pk_bf16_f32 v61, v42, v43
    v_min_u32 v60, -2, v60
    v_min_u32 v61, -2, v61
    s_add_u32 s16, s16, 8192
    s_mov_b64 exec, 0xff
    buffer_store_dwordx2 v[60:61], v12, s[4:7], s16 offen
    s_mov_b64 exec, -1
    s_mov_b32 s41, s17
    s_add_u32 s14, s14, 1
    s_and_b32 s15, s14, 3
    s_lshl_b32 s15, s15, 19
    s_add_u32 s17, s38, s15
    s_add_u32 s20, s20, 131072
    s_add_u32 s21, s21, 131072
    s_cmp_lt_u32 s14, 64
    s_cbranch_scc1 L_step_loc
    v_mov_b32 v124, 1
    v_mov_b32 v125, 0
    s_mov_b64 exec, 1
    buffer_atomic_add v124, v125, s[4:7], s39 offen
    s_mov_b64 exec, -1
    s_endpgm
L_worker:
    s_sub_u32 s12, s12, 64
    s_mov_b32 s68, 0
    s_mul_i32 s69, s12, 1280
    s_add_u32 s69, s69, 263192576
    s_getpc_b64 s[70:71]
L_pcref:
    s_mul_i32 s15, s12, 320
    s_add_u32 s70, s70, s15
    s_addc_u32 s71, s71, 0
    s_add_u32 s70, s70, L_table-L_pcref
    s_addc_u32 s71, s71, 0
L_wloop:
    s_load_dword s72, s[70:71], 0
    s_add_u32 s70, s70, 4
    s_addc_u32 s71, s71, 0
    s_waitcnt lgkmcnt(0)
    s_cmp_eq_u32 s72, -1
    s_cbranch_scc1 L_wend
    s_and_b32 s73, s72, 15
    s_bfe_u32 s40, s72, 0x50004
    s_bfe_u32 s41, s72, 0x60009
    s_bfe_u32 s42, s72, 0x1000f
    s_mul_i32 s43, s42, 104857600
    s_cmp_eq_u32 s73, 0
    s_cbranch_scc1 L_st0
    s_cmp_eq_u32 s73, 1
    s_cbranch_scc1 L_st1
    s_cmp_eq_u32 s73, 2
    s_cbranch_scc1 L_st2
    s_cmp_eq_u32 s73, 3
    s_cbranch_scc1 L_st3
    s_cmp_eq_u32 s73, 4
    s_cbranch_scc1 L_st4
    s_cmp_eq_u32 s73, 5
    s_cbranch_scc1 L_st5
    s_cmp_eq_u32 s73, 6
    s_cbranch_scc1 L_st6
    s_cmp_eq_u32 s73, 8
    s_cbranch_scc1 L_st8
    s_branch L_mega_end
L_st0:
    s_cmp_eq_u32 s42, 0
    s_cbranch_scc1 L_ln0_nodep
    s_mov_b32 s23, 0
    s_lshl_b32 s22, s23, 8
    s_add_u32 s22, s22, s40
    s_lshl_b32 s22, s22, 6
    s_add_u32 s22, s22, 48246784
    s_cmp_lg_u32 s13, 0
    s_cbranch_scc1 L_pc_done_ln0
    s_mov_b32 s26, 0
    v_mov_b32 v126, 0
L_pc_ln0:
    buffer_load_dword v127, v126, s[4:7], s22 offen sc1
    s_add_u32 s26, s26, 1
    s_cmp_gt_u32 s26, 4194304
    s_cbranch_scc1 L_mega_end
    s_waitcnt vmcnt(0)
    v_readfirstlane_b32 s27, v127
    s_nop 0
    s_cmp_ge_u32 s27, 32
    s_cbranch_scc1 L_pc_done_ln0
    s_sleep 4
    s_branch L_pc_ln0
L_pc_done_ln0:
    s_barrier
L_ln0_nodep:
    s_lshl_b32 s23, s42, 1
    s_add_u32 s23, s23, 0
    s_lshl_b32 s23, s23, 21
    s_add_u32 s19, s23, 33554432
    s_add_u32 s18, s23, 25165824
    v_lshrrev_b32 v1, 4, v0
    s_lshl_b32 s3, s40, 6
    s_lshl_b32 s15, s41, 5
    s_add_u32 s3, s3, s15
    v_add_u32 v1, s3, v1
    v_and_b32 v2, 15, v0
    v_lshlrev_b32 v3, 10, v1
    v_lshl_add_u32 v3, v2, 4, v3
    buffer_load_dwordx4 v[16:19], v3, s[4:7], s19 offen offset:0 sc1
    buffer_load_dwordx4 v[20:23], v3, s[4:7], s19 offen offset:256 sc1
    buffer_load_dwordx4 v[24:27], v3, s[4:7], s19 offen offset:512 sc1
    buffer_load_dwordx4 v[28:31], v3, s[4:7], s19 offen offset:768 sc1
    s_add_u32 s19, s19, 16384
    buffer_load_dwordx4 v[64:67], v3, s[4:7], s19 offen offset:0 sc1
    buffer_load_dwordx4 v[68:71], v3, s[4:7], s19 offen offset:256 sc1
    buffer_load_dwordx4 v[72:75], v3, s[4:7], s19 offen offset:512 sc1
    buffer_load_dwordx4 v[76:79], v3, s[4:7], s19 offen offset:768 sc1
    v_bfe_u32 v4, v1, 3, 2
    v_and_b32 v5, 3, v1
    v_lshl_add_u32 v4, v4, 2, v5
    v_and_b32 v5, 3, v2
    v_lshl_add_u32 v4, v5, 4, v4
    v_lshlrev_b32 v4, 4, v4
    v_bfe_u32 v5, v1, 2, 1
    v_bfe_u32 v6, v1, 5, 1
    v_lshl_add_u32 v5, v6, 1, v5
    v_lshl_add_u32 v4, v5, 10, v4
    v_lshrrev_b32 v5, 6, v1
    v_lshrrev_b32 v6, 2, v2
    v_lshl_add_u32 v5, v5, 4, v6
    v_lshl_add_u32 v4, v5, 12, v4
    s_waitcnt vmcnt(4)
    v_lshlrev_b32 v32, 16, v16
    v_and_b32 v33, 0xffff0000, v16
    v_lshlrev_b32 v34, 16, v17
    v_and_b32 v35, 0xffff0000, v17
    v_lshlrev_b32 v36, 16, v18
    v_and_b32 v37, 0xffff0000, v18
    v_lshlrev_b32 v38, 16, v19
    v_and_b32 v39, 0xffff0000, v19
    v_lshlrev_b32 v40, 16, v20
    v_and_b32 v41, 0xffff0000, v20
    v_lshlrev_b32 v42, 16, v21
    v_and_b32 v43, 0xffff0000, v21
    v_lshlrev_b32 v44, 16, v22
    v_and_b32 v45, 0xffff0000, v22
    v_lshlrev_b32 v46, 16, v23
    v_and_b32 v47, 0xffff0000, v23
    v_lshlrev_b32 v48, 16, v24
    v_and_b32 v49, 0xffff0000, v24
    v_lshlrev_b32 v50, 16, v25
    v_and_b32 v51, 0xffff0000, v25
    v_lshlrev_b32 v52, 16, v26
    v_and_b32 v53, 0xffff0000, v26
    v_lshlrev_b32 v54, 16, v27
    v_and_b32 v55, 0xffff0000, v27
    v_lshlrev_b32 v56, 16, v28
    v_and_b32 v57, 0xffff0000, v28
    v_lshlrev_b32 v58, 16, v29
    v_and_b32 v59, 0xffff0000, v29
    v_lshlrev_b32 v60, 16, v30
    v_and_b32 v61, 0xffff0000, v30
    v_lshlrev_b32 v62, 16, v31
    v_and_b32 v63, 0xffff0000, v31
    v_add_f32 v7, v32, v33
    v_add_f32 v7, v7, v34
    v_add_f32 v7, v7, v35
    v_add_f32 v7, v7, v36
    v_add_f32 v7, v7, v37
    v_add_f32 v7, v7, v38
    v_add_f32 v7, v7, v39
    v_add_f32 v7, v7, v40
    v_add_f32 v7, v7, v41
    v_add_f32 v7, v7, v42
    v_add_f32 v7, v7, v43
    v_add_f32 v7, v7, v44
    v_add_f32 v7, v7, v45
    v_add_f32 v7, v7, v46
    v_add_f32 v7, v7, v47
    v_add_f32 v7, v7, v48
    v_add_f32 v7, v7, v49
    v_add_f32 v7, v7, v50
    v_add_f32 v7, v7, v51
    v_add_f32 v7, v7, v52
    v_add_f32 v7, v7, v53
    v_add_f32 v7, v7, v54
    v_add_f32 v7, v7, v55
    v_add_f32 v7, v7, v56
    v_add_f32 v7, v7, v57
    v_add_f32 v7, v7, v58
    v_add_f32 v7, v7, v59
    v_add_f32 v7, v7, v60
    v_add_f32 v7, v7, v61
    v_add_f32 v7, v7, v62
    v_add_f32 v7, v7, v63
    s_nop 1
    v_add_f32_dpp v7, v7, v7 row_ror:8
    s_nop 1
    v_add_f32_dpp v7, v7, v7 row_ror:4
    s_nop 1
    v_add_f32_dpp v7, v7, v7 row_ror:2
    s_nop 1
    v_add_f32_dpp v7, v7, v7 row_ror:1
    v_mul_f32 v7, 0x3b000000, v7
    v_sub_f32 v8, v32, v7
    v_mul_f32 v9, v8, v8
    v_sub_f32 v8, v33, v7
    v_fmac_f32 v9, v8, v8
    v_sub_f32 v8, v34, v7
    v_fmac_f32 v9, v8, v8
    v_sub_f32 v8, v35, v7
    v_fmac_f32 v9, v8, v8
    v_sub_f32 v8, v36, v7
    v_fmac_f32 v9, v8, v8
    v_sub_f32 v8, v37, v7
    v_fmac_f32 v9, v8, v8
    v_sub_f32 v8, v38, v7
    v_fmac_f32 v9, v8, v8
    v_sub_f32 v8, v39, v7
    v_fmac_f32 v9, v8, v8
    v_sub_f32 v8, v40, v7
    v_fmac_f32 v9, v8, v8
    v_sub_f32 v8, v41, v7
    v_fmac_f32 v9, v8, v8
    v_sub_f32 v8, v42, v7
    v_fmac_f32 v9, v8, v8
    v_sub_f32 v8, v43, v7
    v_fmac_f32 v9, v8, v8
    v_sub_f32 v8, v44, v7
    v_fmac_f32 v9, v8, v8
    v_sub_f32 v8, v45, v7
    v_fmac_f32 v9, v8, v8
    v_sub_f32 v8, v46, v7
    v_fmac_f32 v9, v8, v8
    v_sub_f32 v8, v47, v7
    v_fmac_f32 v9, v8, v8
    v_sub_f32 v8, v48, v7
    v_fmac_f32 v9, v8, v8
    v_sub_f32 v8, v49, v7
    v_fmac_f32 v9, v8, v8
    v_sub_f32 v8, v50, v7
    v_fmac_f32 v9, v8, v8
    v_sub_f32 v8, v51, v7
    v_fmac_f32 v9, v8, v8
    v_sub_f32 v8, v52, v7
    v_fmac_f32 v9, v8, v8
    v_sub_f32 v8, v53, v7
    v_fmac_f32 v9, v8, v8
    v_sub_f32 v8, v54, v7
    v_fmac_f32 v9, v8, v8
    v_sub_f32 v8, v55, v7
    v_fmac_f32 v9, v8, v8
    v_sub_f32 v8, v56, v7
    v_fmac_f32 v9, v8, v8
    v_sub_f32 v8, v57, v7
    v_fmac_f32 v9, v8, v8
    v_sub_f32 v8, v58, v7
    v_fmac_f32 v9, v8, v8
    v_sub_f32 v8, v59, v7
    v_fmac_f32 v9, v8, v8
    v_sub_f32 v8, v60, v7
    v_fmac_f32 v9, v8, v8
    v_sub_f32 v8, v61, v7
    v_fmac_f32 v9, v8, v8
    v_sub_f32 v8, v62, v7
    v_fmac_f32 v9, v8, v8
    v_sub_f32 v8, v63, v7
    v_fmac_f32 v9, v8, v8
    s_nop 1
    v_add_f32_dpp v9, v9, v9 row_ror:8
    s_nop 1
    v_add_f32_dpp v9, v9, v9 row_ror:4
    s_nop 1
    v_add_f32_dpp v9, v9, v9 row_ror:2
    s_nop 1
    v_add_f32_dpp v9, v9, v9 row_ror:1
    v_mul_f32 v9, 0x3b000000, v9
    v_cvt_pk_bf16_f32 v10, v7, v7
    v_lshlrev_b32 v7, 16, v10
    v_cvt_pk_bf16_f32 v10, v9, v9
    v_lshlrev_b32 v9, 16, v10
    v_add_f32 v9, 0x3727c5ac, v9
    v_cvt_pk_bf16_f32 v10, v9, v9
    v_lshlrev_b32 v9, 16, v10
    v_sqrt_f32 v9, v9
    s_nop 0
    v_cvt_pk_bf16_f32 v10, v9, v9
    v_lshlrev_b32 v9, 16, v10
    v_rcp_f32 v9, v9
    v_sub_f32 v32, v32, v7
    v_sub_f32 v33, v33, v7
    v_cvt_pk_bf16_f32 v10, v32, v33
    v_lshlrev_b32 v32, 16, v10
    v_and_b32 v33, 0xffff0000, v10
    v_mul_f32 v32, v32, v9
    v_mul_f32 v33, v33, v9
    v_cvt_pk_bf16_f32 v16, v32, v33
    v_sub_f32 v34, v34, v7
    v_sub_f32 v35, v35, v7
    v_cvt_pk_bf16_f32 v10, v34, v35
    v_lshlrev_b32 v34, 16, v10
    v_and_b32 v35, 0xffff0000, v10
    v_mul_f32 v34, v34, v9
    v_mul_f32 v35, v35, v9
    v_cvt_pk_bf16_f32 v17, v34, v35
    v_sub_f32 v36, v36, v7
    v_sub_f32 v37, v37, v7
    v_cvt_pk_bf16_f32 v10, v36, v37
    v_lshlrev_b32 v36, 16, v10
    v_and_b32 v37, 0xffff0000, v10
    v_mul_f32 v36, v36, v9
    v_mul_f32 v37, v37, v9
    v_cvt_pk_bf16_f32 v18, v36, v37
    v_sub_f32 v38, v38, v7
    v_sub_f32 v39, v39, v7
    v_cvt_pk_bf16_f32 v10, v38, v39
    v_lshlrev_b32 v38, 16, v10
    v_and_b32 v39, 0xffff0000, v10
    v_mul_f32 v38, v38, v9
    v_mul_f32 v39, v39, v9
    v_cvt_pk_bf16_f32 v19, v38, v39
    v_sub_f32 v40, v40, v7
    v_sub_f32 v41, v41, v7
    v_cvt_pk_bf16_f32 v10, v40, v41
    v_lshlrev_b32 v40, 16, v10
    v_and_b32 v41, 0xffff0000, v10
    v_mul_f32 v40, v40, v9
    v_mul_f32 v41, v41, v9
    v_cvt_pk_bf16_f32 v20, v40, v41
    v_sub_f32 v42, v42, v7
    v_sub_f32 v43, v43, v7
    v_cvt_pk_bf16_f32 v10, v42, v43
    v_lshlrev_b32 v42, 16, v10
    v_and_b32 v43, 0xffff0000, v10
    v_mul_f32 v42, v42, v9
    v_mul_f32 v43, v43, v9
    v_cvt_pk_bf16_f32 v21, v42, v43
    v_sub_f32 v44, v44, v7
    v_sub_f32 v45, v45, v7
    v_cvt_pk_bf16_f32 v10, v44, v45
    v_lshlrev_b32 v44, 16, v10
    v_and_b32 v45, 0xffff0000, v10
    v_mul_f32 v44, v44, v9
    v_mul_f32 v45, v45, v9
    v_cvt_pk_bf16_f32 v22, v44, v45
    v_sub_f32 v46, v46, v7
    v_sub_f32 v47, v47, v7
    v_cvt_pk_bf16_f32 v10, v46, v47
    v_lshlrev_b32 v46, 16, v10
    v_and_b32 v47, 0xffff0000, v10
    v_mul_f32 v46, v46, v9
    v_mul_f32 v47, v47, v9
    v_cvt_pk_bf16_f32 v23, v46, v47
    v_sub_f32 v48, v48, v7
    v_sub_f32 v49, v49, v7
    v_cvt_pk_bf16_f32 v10, v48, v49
    v_lshlrev_b32 v48, 16, v10
    v_and_b32 v49, 0xffff0000, v10
    v_mul_f32 v48, v48, v9
    v_mul_f32 v49, v49, v9
    v_cvt_pk_bf16_f32 v24, v48, v49
    v_sub_f32 v50, v50, v7
    v_sub_f32 v51, v51, v7
    v_cvt_pk_bf16_f32 v10, v50, v51
    v_lshlrev_b32 v50, 16, v10
    v_and_b32 v51, 0xffff0000, v10
    v_mul_f32 v50, v50, v9
    v_mul_f32 v51, v51, v9
    v_cvt_pk_bf16_f32 v25, v50, v51
    v_sub_f32 v52, v52, v7
    v_sub_f32 v53, v53, v7
    v_cvt_pk_bf16_f32 v10, v52, v53
    v_lshlrev_b32 v52, 16, v10
    v_and_b32 v53, 0xffff0000, v10
    v_mul_f32 v52, v52, v9
    v_mul_f32 v53, v53, v9
    v_cvt_pk_bf16_f32 v26, v52, v53
    v_sub_f32 v54, v54, v7
    v_sub_f32 v55, v55, v7
    v_cvt_pk_bf16_f32 v10, v54, v55
    v_lshlrev_b32 v54, 16, v10
    v_and_b32 v55, 0xffff0000, v10
    v_mul_f32 v54, v54, v9
    v_mul_f32 v55, v55, v9
    v_cvt_pk_bf16_f32 v27, v54, v55
    v_sub_f32 v56, v56, v7
    v_sub_f32 v57, v57, v7
    v_cvt_pk_bf16_f32 v10, v56, v57
    v_lshlrev_b32 v56, 16, v10
    v_and_b32 v57, 0xffff0000, v10
    v_mul_f32 v56, v56, v9
    v_mul_f32 v57, v57, v9
    v_cvt_pk_bf16_f32 v28, v56, v57
    v_sub_f32 v58, v58, v7
    v_sub_f32 v59, v59, v7
    v_cvt_pk_bf16_f32 v10, v58, v59
    v_lshlrev_b32 v58, 16, v10
    v_and_b32 v59, 0xffff0000, v10
    v_mul_f32 v58, v58, v9
    v_mul_f32 v59, v59, v9
    v_cvt_pk_bf16_f32 v29, v58, v59
    v_sub_f32 v60, v60, v7
    v_sub_f32 v61, v61, v7
    v_cvt_pk_bf16_f32 v10, v60, v61
    v_lshlrev_b32 v60, 16, v10
    v_and_b32 v61, 0xffff0000, v10
    v_mul_f32 v60, v60, v9
    v_mul_f32 v61, v61, v9
    v_cvt_pk_bf16_f32 v30, v60, v61
    v_sub_f32 v62, v62, v7
    v_sub_f32 v63, v63, v7
    v_cvt_pk_bf16_f32 v10, v62, v63
    v_lshlrev_b32 v62, 16, v10
    v_and_b32 v63, 0xffff0000, v10
    v_mul_f32 v62, v62, v9
    v_mul_f32 v63, v63, v9
    v_cvt_pk_bf16_f32 v31, v62, v63
    s_add_u32 s20, s18, 0
    buffer_store_dwordx4 v[16:19], v4, s[4:7], s20 offen sc1
    s_add_u32 s20, s18, 16384
    buffer_store_dwordx4 v[20:23], v4, s[4:7], s20 offen sc1
    s_add_u32 s20, s18, 32768
    buffer_store_dwordx4 v[24:27], v4, s[4:7], s20 offen sc1
    s_add_u32 s20, s18, 49152
    buffer_store_dwordx4 v[28:31], v4, s[4:7], s20 offen sc1
    s_waitcnt vmcnt(4)
    v_mov_b32 v16, v64
    v_mov_b32 v17, v65
    v_mov_b32 v18, v66
    v_mov_b32 v19, v67
    v_mov_b32 v20, v68
    v_mov_b32 v21, v69
    v_mov_b32 v22, v70
    v_mov_b32 v23, v71
    v_mov_b32 v24, v72
    v_mov_b32 v25, v73
    v_mov_b32 v26, v74
    v_mov_b32 v27, v75
    v_mov_b32 v28, v76
    v_mov_b32 v29, v77
    v_mov_b32 v30, v78
    v_mov_b32 v31, v79
    v_lshlrev_b32 v32, 16, v16
    v_and_b32 v33, 0xffff0000, v16
    v_lshlrev_b32 v34, 16, v17
    v_and_b32 v35, 0xffff0000, v17
    v_lshlrev_b32 v36, 16, v18
    v_and_b32 v37, 0xffff0000, v18
    v_lshlrev_b32 v38, 16, v19
    v_and_b32 v39, 0xffff0000, v19
    v_lshlrev_b32 v40, 16, v20
    v_and_b32 v41, 0xffff0000, v20
    v_lshlrev_b32 v42, 16, v21
    v_and_b32 v43, 0xffff0000, v21
    v_lshlrev_b32 v44, 16, v22
    v_and_b32 v45, 0xffff0000, v22
    v_lshlrev_b32 v46, 16, v23
    v_and_b32 v47, 0xffff0000, v23
    v_lshlrev_b32 v48, 16, v24
    v_and_b32 v49, 0xffff0000, v24
    v_lshlrev_b32 v50, 16, v25
    v_and_b32 v51, 0xffff0000, v25
    v_lshlrev_b32 v52, 16, v26
    v_and_b32 v53, 0xffff0000, v26
    v_lshlrev_b32 v54, 16, v27
    v_and_b32 v55, 0xffff0000, v27
    v_lshlrev_b32 v56, 16, v28
    v_and_b32 v57, 0xffff0000, v28
    v_lshlrev_b32 v58, 16, v29
    v_and_b32 v59, 0xffff0000, v29
    v_lshlrev_b32 v60, 16, v30
    v_and_b32 v61, 0xffff0000, v30
    v_lshlrev_b32 v62, 16, v31
    v_and_b32 v63, 0xffff0000, v31
    v_add_f32 v7, v32, v33
    v_add_f32 v7, v7, v34
    v_add_f32 v7, v7, v35
    v_add_f32 v7, v7, v36
    v_add_f32 v7, v7, v37
    v_add_f32 v7, v7, v38
    v_add_f32 v7, v7, v39
    v_add_f32 v7, v7, v40
    v_add_f32 v7, v7, v41
    v_add_f32 v7, v7, v42
    v_add_f32 v7, v7, v43
    v_add_f32 v7, v7, v44
    v_add_f32 v7, v7, v45
    v_add_f32 v7, v7, v46
    v_add_f32 v7, v7, v47
    v_add_f32 v7, v7, v48
    v_add_f32 v7, v7, v49
    v_add_f32 v7, v7, v50
    v_add_f32 v7, v7, v51
    v_add_f32 v7, v7, v52
    v_add_f32 v7, v7, v53
    v_add_f32 v7, v7, v54
    v_add_f32 v7, v7, v55
    v_add_f32 v7, v7, v56
    v_add_f32 v7, v7, v57
    v_add_f32 v7, v7, v58
    v_add_f32 v7, v7, v59
    v_add_f32 v7, v7, v60
    v_add_f32 v7, v7, v61
    v_add_f32 v7, v7, v62
    v_add_f32 v7, v7, v63
    s_nop 1
    v_add_f32_dpp v7, v7, v7 row_ror:8
    s_nop 1
    v_add_f32_dpp v7, v7, v7 row_ror:4
    s_nop 1
    v_add_f32_dpp v7, v7, v7 row_ror:2
    s_nop 1
    v_add_f32_dpp v7, v7, v7 row_ror:1
    v_mul_f32 v7, 0x3b000000, v7
    v_sub_f32 v8, v32, v7
    v_mul_f32 v9, v8, v8
    v_sub_f32 v8, v33, v7
    v_fmac_f32 v9, v8, v8
    v_sub_f32 v8, v34, v7
    v_fmac_f32 v9, v8, v8
    v_sub_f32 v8, v35, v7
    v_fmac_f32 v9, v8, v8
    v_sub_f32 v8, v36, v7
    v_fmac_f32 v9, v8, v8
    v_sub_f32 v8, v37, v7
    v_fmac_f32 v9, v8, v8
    v_sub_f32 v8, v38, v7
    v_fmac_f32 v9, v8, v8
    v_sub_f32 v8, v39, v7
    v_fmac_f32 v9, v8, v8
    v_sub_f32 v8, v40, v7
    v_fmac_f32 v9, v8, v8
    v_sub_f32 v8, v41, v7
    v_fmac_f32 v9, v8, v8
    v_sub_f32 v8, v42, v7
    v_fmac_f32 v9, v8, v8
    v_sub_f32 v8, v43, v7
    v_fmac_f32 v9, v8, v8
    v_sub_f32 v8, v44, v7
    v_fmac_f32 v9, v8, v8
    v_sub_f32 v8, v45, v7
    v_fmac_f32 v9, v8, v8
    v_sub_f32 v8, v46, v7
    v_fmac_f32 v9, v8, v8
    v_sub_f32 v8, v47, v7
    v_fmac_f32 v9, v8, v8
    v_sub_f32 v8, v48, v7
    v_fmac_f32 v9, v8, v8
    v_sub_f32 v8, v49, v7
    v_fmac_f32 v9, v8, v8
    v_sub_f32 v8, v50, v7
    v_fmac_f32 v9, v8, v8
    v_sub_f32 v8, v51, v7
    v_fmac_f32 v9, v8, v8
    v_sub_f32 v8, v52, v7
    v_fmac_f32 v9, v8, v8
    v_sub_f32 v8, v53, v7
    v_fmac_f32 v9, v8, v8
    v_sub_f32 v8, v54, v7
    v_fmac_f32 v9, v8, v8
    v_sub_f32 v8, v55, v7
    v_fmac_f32 v9, v8, v8
    v_sub_f32 v8, v56, v7
    v_fmac_f32 v9, v8, v8
    v_sub_f32 v8, v57, v7
    v_fmac_f32 v9, v8, v8
    v_sub_f32 v8, v58, v7
    v_fmac_f32 v9, v8, v8
    v_sub_f32 v8, v59, v7
    v_fmac_f32 v9, v8, v8
    v_sub_f32 v8, v60, v7
    v_fmac_f32 v9, v8, v8
    v_sub_f32 v8, v61, v7
    v_fmac_f32 v9, v8, v8
    v_sub_f32 v8, v62, v7
    v_fmac_f32 v9, v8, v8
    v_sub_f32 v8, v63, v7
    v_fmac_f32 v9, v8, v8
    s_nop 1
    v_add_f32_dpp v9, v9, v9 row_ror:8
    s_nop 1
    v_add_f32_dpp v9, v9, v9 row_ror:4
    s_nop 1
    v_add_f32_dpp v9, v9, v9 row_ror:2
    s_nop 1
    v_add_f32_dpp v9, v9, v9 row_ror:1
    v_mul_f32 v9, 0x3b000000, v9
    v_cvt_pk_bf16_f32 v10, v7, v7
    v_lshlrev_b32 v7, 16, v10
    v_cvt_pk_bf16_f32 v10, v9, v9
    v_lshlrev_b32 v9, 16, v10
    v_add_f32 v9, 0x3727c5ac, v9
    v_cvt_pk_bf16_f32 v10, v9, v9
    v_lshlrev_b32 v9, 16, v10
    v_sqrt_f32 v9, v9
    s_nop 0
    v_cvt_pk_bf16_f32 v10, v9, v9
    v_lshlrev_b32 v9, 16, v10
    v_rcp_f32 v9, v9
    v_sub_f32 v32, v32, v7
    v_sub_f32 v33, v33, v7
    v_cvt_pk_bf16_f32 v10, v32, v33
    v_lshlrev_b32 v32, 16, v10
    v_and_b32 v33, 0xffff0000, v10
    v_mul_f32 v32, v32, v9
    v_mul_f32 v33, v33, v9
    v_cvt_pk_bf16_f32 v16, v32, v33
    v_sub_f32 v34, v34, v7
    v_sub_f32 v35, v35, v7
    v_cvt_pk_bf16_f32 v10, v34, v35
    v_lshlrev_b32 v34, 16, v10
    v_and_b32 v35, 0xffff0000, v10
    v_mul_f32 v34, v34, v9
    v_mul_f32 v35, v35, v9
    v_cvt_pk_bf16_f32 v17, v34, v35
    v_sub_f32 v36, v36, v7
    v_sub_f32 v37, v37, v7
    v_cvt_pk_bf16_f32 v10, v36, v37
    v_lshlrev_b32 v36, 16, v10
    v_and_b32 v37, 0xffff0000, v10
    v_mul_f32 v36, v36, v9
    v_mul_f32 v37, v37, v9
    v_cvt_pk_bf16_f32 v18, v36, v37
    v_sub_f32 v38, v38, v7
    v_sub_f32 v39, v39, v7
    v_cvt_pk_bf16_f32 v10, v38, v39
    v_lshlrev_b32 v38, 16, v10
    v_and_b32 v39, 0xffff0000, v10
    v_mul_f32 v38, v38, v9
    v_mul_f32 v39, v39, v9
    v_cvt_pk_bf16_f32 v19, v38, v39
    v_sub_f32 v40, v40, v7
    v_sub_f32 v41, v41, v7
    v_cvt_pk_bf16_f32 v10, v40, v41
    v_lshlrev_b32 v40, 16, v10
    v_and_b32 v41, 0xffff0000, v10
    v_mul_f32 v40, v40, v9
    v_mul_f32 v41, v41, v9
    v_cvt_pk_bf16_f32 v20, v40, v41
    v_sub_f32 v42, v42, v7
    v_sub_f32 v43, v43, v7
    v_cvt_pk_bf16_f32 v10, v42, v43
    v_lshlrev_b32 v42, 16, v10
    v_and_b32 v43, 0xffff0000, v10
    v_mul_f32 v42, v42, v9
    v_mul_f32 v43, v43, v9
    v_cvt_pk_bf16_f32 v21, v42, v43
    v_sub_f32 v44, v44, v7
    v_sub_f32 v45, v45, v7
    v_cvt_pk_bf16_f32 v10, v44, v45
    v_lshlrev_b32 v44, 16, v10
    v_and_b32 v45, 0xffff0000, v10
    v_mul_f32 v44, v44, v9
    v_mul_f32 v45, v45, v9
    v_cvt_pk_bf16_f32 v22, v44, v45
    v_sub_f32 v46, v46, v7
    v_sub_f32 v47, v47, v7
    v_cvt_pk_bf16_f32 v10, v46, v47
    v_lshlrev_b32 v46, 16, v10
    v_and_b32 v47, 0xffff0000, v10
    v_mul_f32 v46, v46, v9
    v_mul_f32 v47, v47, v9
    v_cvt_pk_bf16_f32 v23, v46, v47
    v_sub_f32 v48, v48, v7
    v_sub_f32 v49, v49, v7
    v_cvt_pk_bf16_f32 v10, v48, v49
    v_lshlrev_b32 v48, 16, v10
    v_and_b32 v49, 0xffff0000, v10
    v_mul_f32 v48, v48, v9
    v_mul_f32 v49, v49, v9
    v_cvt_pk_bf16_f32 v24, v48, v49
    v_sub_f32 v50, v50, v7
    v_sub_f32 v51, v51, v7
    v_cvt_pk_bf16_f32 v10, v50, v51
    v_lshlrev_b32 v50, 16, v10
    v_and_b32 v51, 0xffff0000, v10
    v_mul_f32 v50, v50, v9
    v_mul_f32 v51, v51, v9
    v_cvt_pk_bf16_f32 v25, v50, v51
    v_sub_f32 v52, v52, v7
    v_sub_f32 v53, v53, v7
    v_cvt_pk_bf16_f32 v10, v52, v53
    v_lshlrev_b32 v52, 16, v10
    v_and_b32 v53, 0xffff0000, v10
    v_mul_f32 v52, v52, v9
    v_mul_f32 v53, v53, v9
    v_cvt_pk_bf16_f32 v26, v52, v53
    v_sub_f32 v54, v54, v7
    v_sub_f32 v55, v55, v7
    v_cvt_pk_bf16_f32 v10, v54, v55
    v_lshlrev_b32 v54, 16, v10
    v_and_b32 v55, 0xffff0000, v10
    v_mul_f32 v54, v54, v9
    v_mul_f32 v55, v55, v9
    v_cvt_pk_bf16_f32 v27, v54, v55
    v_sub_f32 v56, v56, v7
    v_sub_f32 v57, v57, v7
    v_cvt_pk_bf16_f32 v10, v56, v57
    v_lshlrev_b32 v56, 16, v10
    v_and_b32 v57, 0xffff0000, v10
    v_mul_f32 v56, v56, v9
    v_mul_f32 v57, v57, v9
    v_cvt_pk_bf16_f32 v28, v56, v57
    v_sub_f32 v58, v58, v7
    v_sub_f32 v59, v59, v7
    v_cvt_pk_bf16_f32 v10, v58, v59
    v_lshlrev_b32 v58, 16, v10
    v_and_b32 v59, 0xffff0000, v10
    v_mul_f32 v58, v58, v9
    v_mul_f32 v59, v59, v9
    v_cvt_pk_bf16_f32 v29, v58, v59
    v_sub_f32 v60, v60, v7
    v_sub_f32 v61, v61, v7
    v_cvt_pk_bf16_f32 v10, v60, v61
    v_lshlrev_b32 v60, 16, v10
    v_and_b32 v61, 0xffff0000, v10
    v_mul_f32 v60, v60, v9
    v_mul_f32 v61, v61, v9
    v_cvt_pk_bf16_f32 v30, v60, v61
    v_sub_f32 v62, v62, v7
    v_sub_f32 v63, v63, v7
    v_cvt_pk_bf16_f32 v10, v62, v63
    v_lshlrev_b32 v62, 16, v10
    v_and_b32 v63, 0xffff0000, v10
    v_mul_f32 v62, v62, v9
    v_mul_f32 v63, v63, v9
    v_cvt_pk_bf16_f32 v31, v62, v63
    s_add_u32 s20, s18, 128
    buffer_store_dwordx4 v[16:19], v4, s[4:7], s20 offen sc1
    s_add_u32 s20, s18, 16512
    buffer_store_dwordx4 v[20:23], v4, s[4:7], s20 offen sc1
    s_add_u32 s20, s18, 32896
    buffer_store_dwordx4 v[24:27], v4, s[4:7], s20 offen sc1
    s_add_u32 s20, s18, 49280
    buffer_store_dwordx4 v[28:31], v4, s[4:7], s20 offen sc1
    s_waitcnt vmcnt(0) lgkmcnt(0)
    s_barrier
    s_cmp_lg_u32 s13, 0
    s_cbranch_scc1 L_wloop
    s_lshl_b32 s22, s42, 8
    s_add_u32 s22, s22, s40
    s_lshl_b32 s22, s22, 6
    s_add_u32 s22, s22, 48234496
    v_mov_b32 v126, 0
    v_mov_b32 v127, 1
    s_mov_b64 exec, 1
    buffer_atomic_add v127, v126, s[4:7], s22 offen
    s_mov_b64 exec, -1
    s_branch L_wloop
L_st1:
    s_and_b32 s16, s41, 15
    s_lshl_b32 s16, s16, 2
    s_add_u32 s16, s16, s13
    s_lshr_b32 s17, s41, 4
    s_add_u32 s18, s17, 1
    s_cmp_eq_u32 s17, 2
    s_cselect_b32 s18, 0, s18
    s_mul_i32 s15, s16, 3
    s_add_u32 s15, s15, s18
    s_lshl_b32 s15, s15, 16
    s_add_u32 s15, s15, 0
    v_and_b32 v4, 63, v0
    v_lshlrev_b32 v4, 4, v4
    s_bitcmp0_b32 s72, 16
    s_cbranch_scc1 L_q_nopre
    s_mov_b32 s22, 48291840
    s_cmp_lg_u32 s13, 0
    s_cbranch_scc1 L_pc_done_q_su
    s_mov_b32 s26, 0
    v_mov_b32 v126, 0
L_pc_q_su:
    buffer_load_dword v127, v126, s[4:7], s22 offen sc1
    s_add_u32 s26, s26, 1
    s_cmp_gt_u32 s26, 4194304
    s_cbranch_scc1 L_mega_end
    s_waitcnt vmcnt(0)
    v_readfirstlane_b32 s27, v127
    s_nop 0
    s_cmp_ge_u32 s27, 64
    s_cbranch_scc1 L_pc_done_q_su
    s_sleep 4
    s_branch L_pc_q_su
L_pc_done_q_su:
    s_barrier
    v_and_b32 v14, 63, v0
    s_mov_b32 s8, s84
    s_mov_b32 s9, s85
    s_cmp_eq_u32 s18, 1
    s_cselect_b32 s8, s86, s8
    s_cselect_b32 s9, s87, s9
    s_cmp_eq_u32 s18, 2
    s_cselect_b32 s8, s88, s8
    s_cselect_b32 s9, s89, s9
    s_and_b32 s9, s9, 0xffff
    s_mov_b32 s10, 4194304
    s_mov_b32 s11, 0x00020000
    s_lshl_b32 s15, s16, 7
    s_lshl_b32 s24, s13, 14
    v_lshrrev_b32 v2, 3, v14
    s_mov_b32 s23, 8192
    v_mul_lo_u32 v2, s23, v2
    v_and_b32 v3, 7, v14
    v_lshl_add_u32 v2, v3, 4, v2
    v_lshlrev_b32 v3, 4, v14
    v_add_u32 v3, s24, v3
    v_lshrrev_b32 v5, 4, v14
    v_bfe_u32 v6, v14, 2, 2
    v_lshl_add_u32 v5, v5, 3, v6
    v_mul_u32_u24 v5, 128, v5
    v_and_b32 v6, 3, v14
    v_lshl_add_u32 v5, v6, 4, v5
    v_add_u32 v5, s24, v5
    buffer_load_dwordx4 v[16:19], v2, s[8:11], s15 offen
    s_add_u32 s15, s15, 65536
    buffer_load_dwordx4 v[20:23], v2, s[8:11], s15 offen
    s_add_u32 s15, s15, 65536
    buffer_load_dwordx4 v[24:27], v2, s[8:11], s15 offen
    s_add_u32 s15, s15, 65536
    buffer_load_dwordx4 v[28:31], v2, s[8:11], s15 offen
    s_add_u32 s15, s15, 65536
    buffer_load_dwordx4 v[32:35], v2, s[8:11], s15 offen
    s_add_u32 s15, s15, 65536
    buffer_load_dwordx4 v[36:39], v2, s[8:11], s15 offen
    s_add_u32 s15, s15, 65536
    buffer_load_dwordx4 v[40:43], v2, s[8:11], s15 offen
    s_add_u32 s15, s15, 65536
    buffer_load_dwordx4 v[44:47], v2, s[8:11], s15 offen
    s_add_u32 s15, s15, 65536
    buffer_load_dwordx4 v[48:51], v2, s[8:11], s15 offen
    s_add_u32 s15, s15, 65536
    buffer_load_dwordx4 v[52:55], v2, s[8:11], s15 offen
    s_add_u32 s15, s15, 65536
    buffer_load_dwordx4 v[56:59], v2, s[8:11], s15 offen
    s_add_u32 s15, s15, 65536
    buffer_load_dwordx4 v[60:63], v2, s[8:11], s15 offen
    s_add_u32 s15, s15, 65536
    buffer_load_dwordx4 v[64:67], v2, s[8:11], s15 offen
    s_add_u32 s15, s15, 65536
    buffer_load_dwordx4 v[68:71], v2, s[8:11], s15 offen
    s_add_u32 s15, s15, 65536
    buffer_load_dwordx4 v[72:75], v2, s[8:11], s15 offen
    s_add_u32 s15, s15, 65536
    buffer_load_dwordx4 v[76:79], v2, s[8:11], s15 offen
    s_add_u32 s15, s15, 65536
    buffer_load_dwordx4 v[80:83], v2, s[8:11], s15 offen
    s_add_u32 s15, s15, 65536
    buffer_load_dwordx4 v[84:87], v2, s[8:11], s15 offen
    s_add_u32 s15, s15, 65536
    buffer_load_dwordx4 v[88:91], v2, s[8:11], s15 offen
    s_add_u32 s15, s15, 65536
    buffer_load_dwordx4 v[92:95], v2, s[8:11], s15 offen
    s_add_u32 s15, s15, 65536
    buffer_load_dwordx4 v[96:99], v2, s[8:11], s15 offen
    s_add_u32 s15, s15, 65536
    buffer_load_dwordx4 v[100:103], v2, s[8:11], s15 offen
    s_add_u32 s15, s15, 65536
    buffer_load_dwordx4 v[104:107], v2, s[8:11], s15 offen
    s_add_u32 s15, s15, 65536
    buffer_load_dwordx4 v[108:111], v2, s[8:11], s15 offen
    s_add_u32 s15, s15, 65536
    buffer_load_dwordx4 v[112:115], v2, s[8:11], s15 offen
    s_add_u32 s15, s15, 65536
    buffer_load_dwordx4 v[116:119], v2, s[8:11], s15 offen
    s_add_u32 s15, s15, 65536
    buffer_load_dwordx4 v[120:123], v2, s[8:11], s15 offen
    s_add_u32 s15, s15, 65536
    buffer_load_dwordx4 v[124:127], v2, s[8:11], s15 offen
    s_add_u32 s15, s15, 65536
    buffer_load_dwordx4 v[128:131], v2, s[8:11], s15 offen
    s_add_u32 s15, s15, 65536
    buffer_load_dwordx4 v[132:135], v2, s[8:11], s15 offen
    s_add_u32 s15, s15, 65536
    buffer_load_dwordx4 v[136:139], v2, s[8:11], s15 offen
    s_add_u32 s15, s15, 65536
    buffer_load_dwordx4 v[140:143], v2, s[8:11], s15 offen
    s_add_u32 s15, s15, 65536
    s_waitcnt vmcnt(16)
    ds_write_b128 v3, v[16:19] offset:0
    ds_write_b128 v3, v[20:23] offset:1024
    ds_write_b128 v3, v[24:27] offset:2048
    ds_write_b128 v3, v[28:31] offset:3072
    ds_write_b128 v3, v[32:35] offset:4096
    ds_write_b128 v3, v[36:39] offset:5120
    ds_write_b128 v3, v[40:43] offset:6144
    ds_write_b128 v3, v[44:47] offset:7168
    ds_write_b128 v3, v[48:51] offset:8192
    ds_write_b128 v3, v[52:55] offset:9216
    ds_write_b128 v3, v[56:59] offset:10240
    ds_write_b128 v3, v[60:63] offset:11264
    ds_write_b128 v3, v[64:67] offset:12288
    ds_write_b128 v3, v[68:71] offset:13312
    ds_write_b128 v3, v[72:75] offset:14336
    ds_write_b128 v3, v[76:79] offset:15360
    s_waitcnt lgkmcnt(0)
    ds_read_b64_tr_b16 a[0:1], v5 offset:0
    ds_read_b64_tr_b16 a[2:3], v5 offset:512
    ds_read_b64_tr_b16 a[4:5], v5 offset:8
    ds_read_b64_tr_b16 a[6:7], v5 offset:520
    ds_read_b64_tr_b16 a[8:9], v5 offset:64
    ds_read_b64_tr_b16 a[10:11], v5 offset:576
    ds_read_b64_tr_b16 a[12:13], v5 offset:72
    ds_read_b64_tr_b16 a[14:15], v5 offset:584
    ds_read_b64_tr_b16 a[16:17], v5 offset:4096
    ds_read_b64_tr_b16 a[18:19], v5 offset:4608
    ds_read_b64_tr_b16 a[20:21], v5 offset:4104
    ds_read_b64_tr_b16 a[22:23], v5 offset:4616
    ds_read_b64_tr_b16 a[24:25], v5 offset:4160
    ds_read_b64_tr_b16 a[26:27], v5 offset:4672
    ds_read_b64_tr_b16 a[28:29], v5 offset:4168
    ds_read_b64_tr_b16 a[30:31], v5 offset:4680
    ds_read_b64_tr_b16 a[32:33], v5 offset:8192
    ds_read_b64_tr_b16 a[34:35], v5 offset:8704
    ds_read_b64_tr_b16 a[36:37], v5 offset:8200
    ds_read_b64_tr_b16 a[38:39], v5 offset:8712
    ds_read_b64_tr_b16 a[40:41], v5 offset:8256
    ds_read_b64_tr_b16 a[42:43], v5 offset:8768
    ds_read_b64_tr_b16 a[44:45], v5 offset:8264
    ds_read_b64_tr_b16 a[46:47], v5 offset:8776
    ds_read_b64_tr_b16 a[48:49], v5 offset:12288
    ds_read_b64_tr_b16 a[50:51], v5 offset:12800
    ds_read_b64_tr_b16 a[52:53], v5 offset:12296
    ds_read_b64_tr_b16 a[54:55], v5 offset:12808
    ds_read_b64_tr_b16 a[56:57], v5 offset:12352
    ds_read_b64_tr_b16 a[58:59], v5 offset:12864
    ds_read_b64_tr_b16 a[60:61], v5 offset:12360
    ds_read_b64_tr_b16 a[62:63], v5 offset:12872
    s_waitcnt lgkmcnt(0)
    buffer_load_dwordx4 v[16:19], v2, s[8:11], s15 offen
    s_add_u32 s15, s15, 65536
    buffer_load_dwordx4 v[20:23], v2, s[8:11], s15 offen
    s_add_u32 s15, s15, 65536
    buffer_load_dwordx4 v[24:27], v2, s[8:11], s15 offen
    s_add_u32 s15, s15, 65536
    buffer_load_dwordx4 v[28:31], v2, s[8:11], s15 offen
    s_add_u32 s15, s15, 65536
    buffer_load_dwordx4 v[32:35], v2, s[8:11], s15 offen
    s_add_u32 s15, s15, 65536
    buffer_load_dwordx4 v[36:39], v2, s[8:11], s15 offen
    s_add_u32 s15, s15, 65536
    buffer_load_dwordx4 v[40:43], v2, s[8:11], s15 offen
    s_add_u32 s15, s15, 65536
    buffer_load_dwordx4 v[44:47], v2, s[8:11], s15 offen
    s_add_u32 s15, s15, 65536
    buffer_load_dwordx4 v[48:51], v2, s[8:11], s15 offen
    s_add_u32 s15, s15, 65536
    buffer_load_dwordx4 v[52:55], v2, s[8:11], s15 offen
    s_add_u32 s15, s15, 65536
    buffer_load_dwordx4 v[56:59], v2, s[8:11], s15 offen
    s_add_u32 s15, s15, 65536
    buffer_load_dwordx4 v[60:63], v2, s[8:11], s15 offen
    s_add_u32 s15, s15, 65536
    buffer_load_dwordx4 v[64:67], v2, s[8:11], s15 offen
    s_add_u32 s15, s15, 65536
    buffer_load_dwordx4 v[68:71], v2, s[8:11], s15 offen
    s_add_u32 s15, s15, 65536
    buffer_load_dwordx4 v[72:75], v2, s[8:11], s15 offen
    s_add_u32 s15, s15, 65536
    buffer_load_dwordx4 v[76:79], v2, s[8:11], s15 offen
    s_add_u32 s15, s15, 65536
    s_waitcnt vmcnt(16)
    ds_write_b128 v3, v[80:83] offset:0
    ds_write_b128 v3, v[84:87] offset:1024
    ds_write_b128 v3, v[88:91] offset:2048
    ds_write_b128 v3, v[92:95] offset:3072
    ds_write_b128 v3, v[96:99] offset:4096
    ds_write_b128 v3, v[100:103] offset:5120
    ds_write_b128 v3, v[104:107] offset:6144
    ds_write_b128 v3, v[108:111] offset:7168
    ds_write_b128 v3, v[112:115] offset:8192
    ds_write_b128 v3, v[116:119] offset:9216
    ds_write_b128 v3, v[120:123] offset:10240
    ds_write_b128 v3, v[124:127] offset:11264
    ds_write_b128 v3, v[128:131] offset:12288
    ds_write_b128 v3, v[132:135] offset:13312
    ds_write_b128 v3, v[136:139] offset:14336
    ds_write_b128 v3, v[140:143] offset:15360
    s_waitcnt lgkmcnt(0)
    ds_read_b64_tr_b16 a[64:65], v5 offset:0
    ds_read_b64_tr_b16 a[66:67], v5 offset:512
    ds_read_b64_tr_b16 a[68:69], v5 offset:8
    ds_read_b64_tr_b16 a[70:71], v5 offset:520
    ds_read_b64_tr_b16 a[72:73], v5 offset:64
    ds_read_b64_tr_b16 a[74:75], v5 offset:576
    ds_read_b64_tr_b16 a[76:77], v5 offset:72
    ds_read_b64_tr_b16 a[78:79], v5 offset:584
    ds_read_b64_tr_b16 a[80:81], v5 offset:4096
    ds_read_b64_tr_b16 a[82:83], v5 offset:4608
    ds_read_b64_tr_b16 a[84:85], v5 offset:4104
    ds_read_b64_tr_b16 a[86:87], v5 offset:4616
    ds_read_b64_tr_b16 a[88:89], v5 offset:4160
    ds_read_b64_tr_b16 a[90:91], v5 offset:4672
    ds_read_b64_tr_b16 a[92:93], v5 offset:4168
    ds_read_b64_tr_b16 a[94:95], v5 offset:4680
    ds_read_b64_tr_b16 a[96:97], v5 offset:8192
    ds_read_b64_tr_b16 a[98:99], v5 offset:8704
    ds_read_b64_tr_b16 a[100:101], v5 offset:8200
    ds_read_b64_tr_b16 a[102:103], v5 offset:8712
    ds_read_b64_tr_b16 a[104:105], v5 offset:8256
    ds_read_b64_tr_b16 a[106:107], v5 offset:8768
    ds_read_b64_tr_b16 a[108:109], v5 offset:8264
    ds_read_b64_tr_b16 a[110:111], v5 offset:8776
    ds_read_b64_tr_b16 a[112:113], v5 offset:12288
    ds_read_b64_tr_b16 a[114:115], v5 offset:12800
    ds_read_b64_tr_b16 a[116:117], v5 offset:12296
    ds_read_b64_tr_b16 a[118:119], v5 offset:12808
    ds_read_b64_tr_b16 a[120:121], v5 offset:12352
    ds_read_b64_tr_b16 a[122:123], v5 offset:12864
    ds_read_b64_tr_b16 a[124:125], v5 offset:12360
    ds_read_b64_tr_b16 a[126:127], v5 offset:12872
    s_waitcnt lgkmcnt(0)
    buffer_load_dwordx4 v[80:83], v2, s[8:11], s15 offen
    s_add_u32 s15, s15, 65536
    buffer_load_dwordx4 v[84:87], v2, s[8:11], s15 offen
    s_add_u32 s15, s15, 65536
    buffer_load_dwordx4 v[88:91], v2, s[8:11], s15 offen
    s_add_u32 s15, s15, 65536
    buffer_load_dwordx4 v[92:95], v2, s[8:11], s15 offen
    s_add_u32 s15, s15, 65536
    buffer_load_dwordx4 v[96:99], v2, s[8:11], s15 offen
    s_add_u32 s15, s15, 65536
    buffer_load_dwordx4 v[100:103], v2, s[8:11], s15 offen
    s_add_u32 s15, s15, 65536
    buffer_load_dwordx4 v[104:107], v2, s[8:11], s15 offen
    s_add_u32 s15, s15, 65536
    buffer_load_dwordx4 v[108:111], v2, s[8:11], s15 offen
    s_add_u32 s15, s15, 65536
    buffer_load_dwordx4 v[112:115], v2, s[8:11], s15 offen
    s_add_u32 s15, s15, 65536
    buffer_load_dwordx4 v[116:119], v2, s[8:11], s15 offen
    s_add_u32 s15, s15, 65536
    buffer_load_dwordx4 v[120:123], v2, s[8:11], s15 offen
    s_add_u32 s15, s15, 65536
    buffer_load_dwordx4 v[124:127], v2, s[8:11], s15 offen
    s_add_u32 s15, s15, 65536
    buffer_load_dwordx4 v[128:131], v2, s[8:11], s15 offen
    s_add_u32 s15, s15, 65536
    buffer_load_dwordx4 v[132:135], v2, s[8:11], s15 offen
    s_add_u32 s15, s15, 65536
    buffer_load_dwordx4 v[136:139], v2, s[8:11], s15 offen
    s_add_u32 s15, s15, 65536
    buffer_load_dwordx4 v[140:143], v2, s[8:11], s15 offen
    s_add_u32 s15, s15, 65536
    s_waitcnt vmcnt(16)
    ds_write_b128 v3, v[16:19] offset:0
    ds_write_b128 v3, v[20:23] offset:1024
    ds_write_b128 v3, v[24:27] offset:2048
    ds_write_b128 v3, v[28:31] offset:3072
    ds_write_b128 v3, v[32:35] offset:4096
    ds_write_b128 v3, v[36:39] offset:5120
    ds_write_b128 v3, v[40:43] offset:6144
    ds_write_b128 v3, v[44:47] offset:7168
    ds_write_b128 v3, v[48:51] offset:8192
    ds_write_b128 v3, v[52:55] offset:9216
    ds_write_b128 v3, v[56:59] offset:10240
    ds_write_b128 v3, v[60:63] offset:11264
    ds_write_b128 v3, v[64:67] offset:12288
    ds_write_b128 v3, v[68:71] offset:13312
    ds_write_b128 v3, v[72:75] offset:14336
    ds_write_b128 v3, v[76:79] offset:15360
    s_waitcnt lgkmcnt(0)
    ds_read_b64_tr_b16 a[128:129], v5 offset:0
    ds_read_b64_tr_b16 a[130:131], v5 offset:512
    ds_read_b64_tr_b16 a[132:133], v5 offset:8
    ds_read_b64_tr_b16 a[134:135], v5 offset:520
    ds_read_b64_tr_b16 a[136:137], v5 offset:64
    ds_read_b64_tr_b16 a[138:139], v5 offset:576
    ds_read_b64_tr_b16 a[140:141], v5 offset:72
    ds_read_b64_tr_b16 a[142:143], v5 offset:584
    ds_read_b64_tr_b16 a[144:145], v5 offset:4096
    ds_read_b64_tr_b16 a[146:147], v5 offset:4608
    ds_read_b64_tr_b16 a[148:149], v5 offset:4104
    ds_read_b64_tr_b16 a[150:151], v5 offset:4616
    ds_read_b64_tr_b16 a[152:153], v5 offset:4160
    ds_read_b64_tr_b16 a[154:155], v5 offset:4672
    ds_read_b64_tr_b16 a[156:157], v5 offset:4168
    ds_read_b64_tr_b16 a[158:159], v5 offset:4680
    ds_read_b64_tr_b16 a[160:161], v5 offset:8192
    ds_read_b64_tr_b16 a[162:163], v5 offset:8704
    ds_read_b64_tr_b16 a[164:165], v5 offset:8200
    ds_read_b64_tr_b16 a[166:167], v5 offset:8712
    ds_read_b64_tr_b16 a[168:169], v5 offset:8256
    ds_read_b64_tr_b16 a[170:171], v5 offset:8768
    ds_read_b64_tr_b16 a[172:173], v5 offset:8264
    ds_read_b64_tr_b16 a[174:175], v5 offset:8776
    ds_read_b64_tr_b16 a[176:177], v5 offset:12288
    ds_read_b64_tr_b16 a[178:179], v5 offset:12800
    ds_read_b64_tr_b16 a[180:181], v5 offset:12296
    ds_read_b64_tr_b16 a[182:183], v5 offset:12808
    ds_read_b64_tr_b16 a[184:185], v5 offset:12352
    ds_read_b64_tr_b16 a[186:187], v5 offset:12864
    ds_read_b64_tr_b16 a[188:189], v5 offset:12360
    ds_read_b64_tr_b16 a[190:191], v5 offset:12872
    s_waitcnt lgkmcnt(0)
    s_waitcnt vmcnt(0)
    ds_write_b128 v3, v[80:83] offset:0
    ds_write_b128 v3, v[84:87] offset:1024
    ds_write_b128 v3, v[88:91] offset:2048
    ds_write_b128 v3, v[92:95] offset:3072
    ds_write_b128 v3, v[96:99] offset:4096
    ds_write_b128 v3, v[100:103] offset:5120
    ds_write_b128 v3, v[104:107] offset:6144
    ds_write_b128 v3, v[108:111] offset:7168
    ds_write_b128 v3, v[112:115] offset:8192
    ds_write_b128 v3, v[116:119] offset:9216
    ds_write_b128 v3, v[120:123] offset:10240
    ds_write_b128 v3, v[124:127] offset:11264
    ds_write_b128 v3, v[128:131] offset:12288
    ds_write_b128 v3, v[132:135] offset:13312
    ds_write_b128 v3, v[136:139] offset:14336
    ds_write_b128 v3, v[140:143] offset:15360
    s_waitcnt lgkmcnt(0)
    ds_read_b64_tr_b16 a[192:193], v5 offset:0
    ds_read_b64_tr_b16 a[194:195], v5 offset:512
    ds_read_b64_tr_b16 a[196:197], v5 offset:8
    ds_read_b64_tr_b16 a[198:199], v5 offset:520
    ds_read_b64_tr_b16 a[200:201], v5 offset:64
    ds_read_b64_tr_b16 a[202:203], v5 offset:576
    ds_read_b64_tr_b16 a[204:205], v5 offset:72
    ds_read_b64_tr_b16 a[206:207], v5 offset:584
    ds_read_b64_tr_b16 a[208:209], v5 offset:4096
    ds_read_b64_tr_b16 a[210:211], v5 offset:4608
    ds_read_b64_tr_b16 a[212:213], v5 offset:4104
    ds_read_b64_tr_b16 a[214:215], v5 offset:4616
    ds_read_b64_tr_b16 a[216:217], v5 offset:4160
    ds_read_b64_tr_b16 a[218:219], v5 offset:4672
    ds_read_b64_tr_b16 a[220:221], v5 offset:4168
    ds_read_b64_tr_b16 a[222:223], v5 offset:4680
    ds_read_b64_tr_b16 a[224:225], v5 offset:8192
    ds_read_b64_tr_b16 a[226:227], v5 offset:8704
    ds_read_b64_tr_b16 a[228:229], v5 offset:8200
    ds_read_b64_tr_b16 a[230:231], v5 offset:8712
    ds_read_b64_tr_b16 a[232:233], v5 offset:8256
    ds_read_b64_tr_b16 a[234:235], v5 offset:8768
    ds_read_b64_tr_b16 a[236:237], v5 offset:8264
    ds_read_b64_tr_b16 a[238:239], v5 offset:8776
    ds_read_b64_tr_b16 a[240:241], v5 offset:12288
    ds_read_b64_tr_b16 a[242:243], v5 offset:12800
    ds_read_b64_tr_b16 a[244:245], v5 offset:12296
    ds_read_b64_tr_b16 a[246:247], v5 offset:12808
    ds_read_b64_tr_b16 a[248:249], v5 offset:12352
    ds_read_b64_tr_b16 a[250:251], v5 offset:12864
    ds_read_b64_tr_b16 a[252:253], v5 offset:12360
    ds_read_b64_tr_b16 a[254:255], v5 offset:12872
    s_waitcnt lgkmcnt(0)
    s_barrier
L_q_nopre:
    s_lshl_b32 s22, s42, 8
    s_add_u32 s22, s22, s40
    s_lshl_b32 s22, s22, 6
    s_add_u32 s22, s22, 48234496
    s_cmp_lg_u32 s13, 0
    s_cbranch_scc1 L_pc_done_q
    s_mov_b32 s26, 0
    v_mov_b32 v126, 0
L_pc_q:
    buffer_load_dword v127, v126, s[4:7], s22 offen sc1
    s_add_u32 s26, s26, 1
    s_cmp_gt_u32 s26, 4194304
    s_cbranch_scc1 L_mega_end
    s_waitcnt vmcnt(0)
    v_readfirstlane_b32 s27, v127
    s_nop 0
    s_cmp_ge_u32 s27, 2
    s_cbranch_scc1 L_pc_done_q
    s_sleep 4
    s_branch L_pc_q
L_pc_done_q:
    s_barrier
    v_lshlrev_b32 v1, 4, v0
    s_lshl_b32 s23, s42, 1
    s_add_u32 s23, s23, 0
    s_lshl_b32 s23, s23, 21
    s_lshl_b32 s19, s40, 16
    s_add_u32 s19, s19, s23
    s_add_u32 s19, s19, 25165824
    buffer_load_dwordx4 v[104:107], v1, s[4:7], s19 offen sc1
    s_add_u32 s19, s19, 4096
    buffer_load_dwordx4 v[108:111], v1, s[4:7], s19 offen sc1
    s_add_u32 s19, s19, 4096
    buffer_load_dwordx4 v[112:115], v1, s[4:7], s19 offen sc1
    s_add_u32 s19, s19, 4096
    buffer_load_dwordx4 v[116:119], v1, s[4:7], s19 offen sc1
    s_add_u32 s19, s19, 4096
    buffer_load_dwordx4 v[120:123], v1, s[4:7], s19 offen sc1
    s_add_u32 s19, s19, 4096
    buffer_load_dwordx4 v[124:127], v1, s[4:7], s19 offen sc1
    s_add_u32 s19, s19, 4096
    buffer_load_dwordx4 v[128:131], v1, s[4:7], s19 offen sc1
    s_add_u32 s19, s19, 4096
    buffer_load_dwordx4 v[132:135], v1, s[4:7], s19 offen sc1
    s_add_u32 s19, s19, 4096
    buffer_load_dwordx4 v[136:139], v1, s[4:7], s19 offen sc1
    s_add_u32 s19, s19, 4096
    buffer_load_dwordx4 v[140:143], v1, s[4:7], s19 offen sc1
    s_add_u32 s19, s19, 4096
    buffer_load_dwordx4 v[144:147], v1, s[4:7], s19 offen sc1
    s_add_u32 s19, s19, 4096
    buffer_load_dwordx4 v[148:151], v1, s[4:7], s19 offen sc1
    s_add_u32 s19, s19, 4096
    buffer_load_dwordx4 v[152:155], v1, s[4:7], s19 offen sc1
    s_add_u32 s19, s19, 4096
    buffer_load_dwordx4 v[156:159], v1, s[4:7], s19 offen sc1
    s_add_u32 s19, s19, 4096
    buffer_load_dwordx4 v[160:163], v1, s[4:7], s19 offen sc1
    s_add_u32 s19, s19, 4096
    buffer_load_dwordx4 v[164:167], v1, s[4:7], s19 offen sc1
    s_waitcnt vmcnt(15)
    ds_write_b128 v1, v[104:107] offset:0
    s_waitcnt vmcnt(14)
    ds_write_b128 v1, v[108:111] offset:4096
    s_waitcnt vmcnt(13)
    ds_write_b128 v1, v[112:115] offset:8192
    s_waitcnt vmcnt(12)
    ds_write_b128 v1, v[116:119] offset:12288
    s_waitcnt vmcnt(11)
    ds_write_b128 v1, v[120:123] offset:16384
    s_waitcnt vmcnt(10)
    ds_write_b128 v1, v[124:127] offset:20480
    s_waitcnt vmcnt(9)
    ds_write_b128 v1, v[128:131] offset:24576
    s_waitcnt vmcnt(8)
    ds_write_b128 v1, v[132:135] offset:28672
    s_waitcnt vmcnt(7)
    ds_write_b128 v1, v[136:139] offset:32768
    s_waitcnt vmcnt(6)
    ds_write_b128 v1, v[140:143] offset:36864
    s_waitcnt vmcnt(5)
    ds_write_b128 v1, v[144:147] offset:40960
    s_waitcnt vmcnt(4)
    ds_write_b128 v1, v[148:151] offset:45056
    s_waitcnt vmcnt(3)
    ds_write_b128 v1, v[152:155] offset:49152
    s_waitcnt vmcnt(2)
    ds_write_b128 v1, v[156:159] offset:53248
    s_waitcnt vmcnt(1)
    ds_write_b128 v1, v[160:163] offset:57344
    s_waitcnt vmcnt(0)
    ds_write_b128 v1, v[164:167] offset:61440
    v_mov_b32 v5, v4
    s_waitcnt lgkmcnt(0)
    s_barrier
    s_cmp_eq_u32 s17, 1
    s_cbranch_scc1 L_q_v
    ds_read_b128 v[8:11], v5 offset:0
    ds_read_b128 v[12:15], v5 offset:1024
    ds_read_b128 v[16:19], v5 offset:2048
    ds_read_b128 v[20:23], v5 offset:3072
    ds_read_b128 v[24:27], v5 offset:4096
    ds_read_b128 v[28:31], v5 offset:5120
    ds_read_b128 v[32:35], v5 offset:6144
    ds_read_b128 v[36:39], v5 offset:7168
    ds_read_b128 v[40:43], v5 offset:8192
    ds_read_b128 v[44:47], v5 offset:9216
    ds_read_b128 v[48:51], v5 offset:10240
    ds_read_b128 v[52:55], v5 offset:11264
    s_waitcnt lgkmcnt(8)
    v_mfma_f32_16x16x32_bf16 v[168:171], a[0:3], v[8:11], 0
    v_mfma_f32_16x16x32_bf16 v[172:175], a[0:3], v[12:15], 0
    v_mfma_f32_16x16x32_bf16 v[176:179], a[0:3], v[16:19], 0
    v_mfma_f32_16x16x32_bf16 v[180:183], a[0:3], v[20:23], 0
    v_mfma_f32_16x16x32_bf16 v[184:187], a[4:7], v[8:11], 0
    v_mfma_f32_16x16x32_bf16 v[188:191], a[4:7], v[12:15], 0
    v_mfma_f32_16x16x32_bf16 v[192:195], a[4:7], v[16:19], 0
    v_mfma_f32_16x16x32_bf16 v[196:199], a[4:7], v[20:23], 0
    v_mfma_f32_16x16x32_bf16 v[200:203], a[8:11], v[8:11], 0
    v_mfma_f32_16x16x32_bf16 v[204:207], a[8:11], v[12:15], 0
    v_mfma_f32_16x16x32_bf16 v[208:211], a[8:11], v[16:19], 0
    v_mfma_f32_16x16x32_bf16 v[212:215], a[8:11], v[20:23], 0
    v_mfma_f32_16x16x32_bf16 v[216:219], a[12:15], v[8:11], 0
    v_mfma_f32_16x16x32_bf16 v[220:223], a[12:15], v[12:15], 0
    v_mfma_f32_16x16x32_bf16 v[224:227], a[12:15], v[16:19], 0
    v_mfma_f32_16x16x32_bf16 v[228:231], a[12:15], v[20:23], 0
    ds_read_b128 v[8:11], v5 offset:12288
    ds_read_b128 v[12:15], v5 offset:13312
    ds_read_b128 v[16:19], v5 offset:14336
    ds_read_b128 v[20:23], v5 offset:15360
    s_waitcnt lgkmcnt(8)
    v_mfma_f32_16x16x32_bf16 v[168:171], a[16:19], v[24:27], v[168:171]
    v_mfma_f32_16x16x32_bf16 v[172:175], a[16:19], v[28:31], v[172:175]
    v_mfma_f32_16x16x32_bf16 v[176:179], a[16:19], v[32:35], v[176:179]
    v_mfma_f32_16x16x32_bf16 v[180:183], a[16:19], v[36:39], v[180:183]
    v_mfma_f32_16x16x32_bf16 v[184:187], a[20:23], v[24:27], v[184:187]
    v_mfma_f32_16x16x32_bf16 v[188:191], a[20:23], v[28:31], v[188:191]
    v_mfma_f32_16x16x32_bf16 v[192:195], a[20:23], v[32:35], v[192:195]
    v_mfma_f32_16x16x32_bf16 v[196:199], a[20:23], v[36:39], v[196:199]
    v_mfma_f32_16x16x32_bf16 v[200:203], a[24:27], v[24:27], v[200:203]
    v_mfma_f32_16x16x32_bf16 v[204:207], a[24:27], v[28:31], v[204:207]
    v_mfma_f32_16x16x32_bf16 v[208:211], a[24:27], v[32:35], v[208:211]
    v_mfma_f32_16x16x32_bf16 v[212:215], a[24:27], v[36:39], v[212:215]
    v_mfma_f32_16x16x32_bf16 v[216:219], a[28:31], v[24:27], v[216:219]
    v_mfma_f32_16x16x32_bf16 v[220:223], a[28:31], v[28:31], v[220:223]
    v_mfma_f32_16x16x32_bf16 v[224:227], a[28:31], v[32:35], v[224:227]
    v_mfma_f32_16x16x32_bf16 v[228:231], a[28:31], v[36:39], v[228:231]
    ds_read_b128 v[24:27], v5 offset:16384
    ds_read_b128 v[28:31], v5 offset:17408
    ds_read_b128 v[32:35], v5 offset:18432
    ds_read_b128 v[36:39], v5 offset:19456
    s_waitcnt lgkmcnt(8)
    v_mfma_f32_16x16x32_bf16 v[168:171], a[32:35], v[40:43], v[168:171]
    v_mfma_f32_16x16x32_bf16 v[172:175], a[32:35], v[44:47], v[172:175]
    v_mfma_f32_16x16x32_bf16 v[176:179], a[32:35], v[48:51], v[176:179]
    v_mfma_f32_16x16x32_bf16 v[180:183], a[32:35], v[52:55], v[180:183]
    v_mfma_f32_16x16x32_bf16 v[184:187], a[36:39], v[40:43], v[184:187]
    v_mfma_f32_16x16x32_bf16 v[188:191], a[36:39], v[44:47], v[188:191]
    v_mfma_f32_16x16x32_bf16 v[192:195], a[36:39], v[48:51], v[192:195]
    v_mfma_f32_16x16x32_bf16 v[196:199], a[36:39], v[52:55], v[196:199]
    v_mfma_f32_16x16x32_bf16 v[200:203], a[40:43], v[40:43], v[200:203]
    v_mfma_f32_16x16x32_bf16 v[204:207], a[40:43], v[44:47], v[204:207]
    v_mfma_f32_16x16x32_bf16 v[208:211], a[40:43], v[48:51], v[208:211]
    v_mfma_f32_16x16x32_bf16 v[212:215], a[40:43], v[52:55], v[212:215]
    v_mfma_f32_16x16x32_bf16 v[216:219], a[44:47], v[40:43], v[216:219]
    v_mfma_f32_16x16x32_bf16 v[220:223], a[44:47], v[44:47], v[220:223]
    v_mfma_f32_16x16x32_bf16 v[224:227], a[44:47], v[48:51], v[224:227]
    v_mfma_f32_16x16x32_bf16 v[228:231], a[44:47], v[52:55], v[228:231]
    ds_read_b128 v[40:43], v5 offset:20480
    ds_read_b128 v[44:47], v5 offset:21504
    ds_read_b128 v[48:51], v5 offset:22528
    ds_read_b128 v[52:55], v5 offset:23552
    s_waitcnt lgkmcnt(8)
    v_mfma_f32_16x16x32_bf16 v[168:171], a[48:51], v[8:11], v[168:171]
    v_mfma_f32_16x16x32_bf16 v[172:175], a[48:51], v[12:15], v[172:175]
    v_mfma_f32_16x16x32_bf16 v[176:179], a[48:51], v[16:19], v[176:179]
    v_mfma_f32_16x16x32_bf16 v[180:183], a[48:51], v[20:23], v[180:183]
    v_mfma_f32_16x16x32_bf16 v[184:187], a[52:55], v[8:11], v[184:187]
    v_mfma_f32_16x16x32_bf16 v[188:191], a[52:55], v[12:15], v[188:191]
    v_mfma_f32_16x16x32_bf16 v[192:195], a[52:55], v[16:19], v[192:195]
    v_mfma_f32_16x16x32_bf16 v[196:199], a[52:55], v[20:23], v[196:199]
    v_mfma_f32_16x16x32_bf16 v[200:203], a[56:59], v[8:11], v[200:203]
    v_mfma_f32_16x16x32_bf16 v[204:207], a[56:59], v[12:15], v[204:207]
    v_mfma_f32_16x16x32_bf16 v[208:211], a[56:59], v[16:19], v[208:211]
    v_mfma_f32_16x16x32_bf16 v[212:215], a[56:59], v[20:23], v[212:215]
    v_mfma_f32_16x16x32_bf16 v[216:219], a[60:63], v[8:11], v[216:219]
    v_mfma_f32_16x16x32_bf16 v[220:223], a[60:63], v[12:15], v[220:223]
    v_mfma_f32_16x16x32_bf16 v[224:227], a[60:63], v[16:19], v[224:227]
    v_mfma_f32_16x16x32_bf16 v[228:231], a[60:63], v[20:23], v[228:231]
    ds_read_b128 v[8:11], v5 offset:24576
    ds_read_b128 v[12:15], v5 offset:25600
    ds_read_b128 v[16:19], v5 offset:26624
    ds_read_b128 v[20:23], v5 offset:27648
    s_waitcnt lgkmcnt(8)
    v_mfma_f32_16x16x32_bf16 v[168:171], a[64:67], v[24:27], v[168:171]
    v_mfma_f32_16x16x32_bf16 v[172:175], a[64:67], v[28:31], v[172:175]
    v_mfma_f32_16x16x32_bf16 v[176:179], a[64:67], v[32:35], v[176:179]
    v_mfma_f32_16x16x32_bf16 v[180:183], a[64:67], v[36:39], v[180:183]
    v_mfma_f32_16x16x32_bf16 v[184:187], a[68:71], v[24:27], v[184:187]
    v_mfma_f32_16x16x32_bf16 v[188:191], a[68:71], v[28:31], v[188:191]
    v_mfma_f32_16x16x32_bf16 v[192:195], a[68:71], v[32:35], v[192:195]
    v_mfma_f32_16x16x32_bf16 v[196:199], a[68:71], v[36:39], v[196:199]
    v_mfma_f32_16x16x32_bf16 v[200:203], a[72:75], v[24:27], v[200:203]
    v_mfma_f32_16x16x32_bf16 v[204:207], a[72:75], v[28:31], v[204:207]
    v_mfma_f32_16x16x32_bf16 v[208:211], a[72:75], v[32:35], v[208:211]
    v_mfma_f32_16x16x32_bf16 v[212:215], a[72:75], v[36:39], v[212:215]
    v_mfma_f32_16x16x32_bf16 v[216:219], a[76:79], v[24:27], v[216:219]
    v_mfma_f32_16x16x32_bf16 v[220:223], a[76:79], v[28:31], v[220:223]
    v_mfma_f32_16x16x32_bf16 v[224:227], a[76:79], v[32:35], v[224:227]
    v_mfma_f32_16x16x32_bf16 v[228:231], a[76:79], v[36:39], v[228:231]
    ds_read_b128 v[24:27], v5 offset:28672
    ds_read_b128 v[28:31], v5 offset:29696
    ds_read_b128 v[32:35], v5 offset:30720
    ds_read_b128 v[36:39], v5 offset:31744
    s_waitcnt lgkmcnt(8)
    v_mfma_f32_16x16x32_bf16 v[168:171], a[80:83], v[40:43], v[168:171]
    v_mfma_f32_16x16x32_bf16 v[172:175], a[80:83], v[44:47], v[172:175]
    v_mfma_f32_16x16x32_bf16 v[176:179], a[80:83], v[48:51], v[176:179]
    v_mfma_f32_16x16x32_bf16 v[180:183], a[80:83], v[52:55], v[180:183]
    v_mfma_f32_16x16x32_bf16 v[184:187], a[84:87], v[40:43], v[184:187]
    v_mfma_f32_16x16x32_bf16 v[188:191], a[84:87], v[44:47], v[188:191]
    v_mfma_f32_16x16x32_bf16 v[192:195], a[84:87], v[48:51], v[192:195]
    v_mfma_f32_16x16x32_bf16 v[196:199], a[84:87], v[52:55], v[196:199]
    v_mfma_f32_16x16x32_bf16 v[200:203], a[88:91], v[40:43], v[200:203]
    v_mfma_f32_16x16x32_bf16 v[204:207], a[88:91], v[44:47], v[204:207]
    v_mfma_f32_16x16x32_bf16 v[208:211], a[88:91], v[48:51], v[208:211]
    v_mfma_f32_16x16x32_bf16 v[212:215], a[88:91], v[52:55], v[212:215]
    v_mfma_f32_16x16x32_bf16 v[216:219], a[92:95], v[40:43], v[216:219]
    v_mfma_f32_16x16x32_bf16 v[220:223], a[92:95], v[44:47], v[220:223]
    v_mfma_f32_16x16x32_bf16 v[224:227], a[92:95], v[48:51], v[224:227]
    v_mfma_f32_16x16x32_bf16 v[228:231], a[92:95], v[52:55], v[228:231]
    ds_read_b128 v[40:43], v5 offset:32768
    ds_read_b128 v[44:47], v5 offset:33792
    ds_read_b128 v[48:51], v5 offset:34816
    ds_read_b128 v[52:55], v5 offset:35840
    s_waitcnt lgkmcnt(8)
    v_mfma_f32_16x16x32_bf16 v[168:171], a[96:99], v[8:11], v[168:171]
    v_mfma_f32_16x16x32_bf16 v[172:175], a[96:99], v[12:15], v[172:175]
    v_mfma_f32_16x16x32_bf16 v[176:179], a[96:99], v[16:19], v[176:179]
    v_mfma_f32_16x16x32_bf16 v[180:183], a[96:99], v[20:23], v[180:183]
    v_mfma_f32_16x16x32_bf16 v[184:187], a[100:103], v[8:11], v[184:187]
    v_mfma_f32_16x16x32_bf16 v[188:191], a[100:103], v[12:15], v[188:191]
    v_mfma_f32_16x16x32_bf16 v[192:195], a[100:103], v[16:19], v[192:195]
    v_mfma_f32_16x16x32_bf16 v[196:199], a[100:103], v[20:23], v[196:199]
    v_mfma_f32_16x16x32_bf16 v[200:203], a[104:107], v[8:11], v[200:203]
    v_mfma_f32_16x16x32_bf16 v[204:207], a[104:107], v[12:15], v[204:207]
    v_mfma_f32_16x16x32_bf16 v[208:211], a[104:107], v[16:19], v[208:211]
    v_mfma_f32_16x16x32_bf16 v[212:215], a[104:107], v[20:23], v[212:215]
    v_mfma_f32_16x16x32_bf16 v[216:219], a[108:111], v[8:11], v[216:219]
    v_mfma_f32_16x16x32_bf16 v[220:223], a[108:111], v[12:15], v[220:223]
    v_mfma_f32_16x16x32_bf16 v[224:227], a[108:111], v[16:19], v[224:227]
    v_mfma_f32_16x16x32_bf16 v[228:231], a[108:111], v[20:23], v[228:231]
    ds_read_b128 v[8:11], v5 offset:36864
    ds_read_b128 v[12:15], v5 offset:37888
    ds_read_b128 v[16:19], v5 offset:38912
    ds_read_b128 v[20:23], v5 offset:39936
    s_waitcnt lgkmcnt(8)
    v_mfma_f32_16x16x32_bf16 v[168:171], a[112:115], v[24:27], v[168:171]
    v_mfma_f32_16x16x32_bf16 v[172:175], a[112:115], v[28:31], v[172:175]
    v_mfma_f32_16x16x32_bf16 v[176:179], a[112:115], v[32:35], v[176:179]
    v_mfma_f32_16x16x32_bf16 v[180:183], a[112:115], v[36:39], v[180:183]
    v_mfma_f32_16x16x32_bf16 v[184:187], a[116:119], v[24:27], v[184:187]
    v_mfma_f32_16x16x32_bf16 v[188:191], a[116:119], v[28:31], v[188:191]
    v_mfma_f32_16x16x32_bf16 v[192:195], a[116:119], v[32:35], v[192:195]
    v_mfma_f32_16x16x32_bf16 v[196:199], a[116:119], v[36:39], v[196:199]
    v_mfma_f32_16x16x32_bf16 v[200:203], a[120:123], v[24:27], v[200:203]
    v_mfma_f32_16x16x32_bf16 v[204:207], a[120:123], v[28:31], v[204:207]
    v_mfma_f32_16x16x32_bf16 v[208:211], a[120:123], v[32:35], v[208:211]
    v_mfma_f32_16x16x32_bf16 v[212:215], a[120:123], v[36:39], v[212:215]
    v_mfma_f32_16x16x32_bf16 v[216:219], a[124:127], v[24:27], v[216:219]
    v_mfma_f32_16x16x32_bf16 v[220:223], a[124:127], v[28:31], v[220:223]
    v_mfma_f32_16x16x32_bf16 v[224:227], a[124:127], v[32:35], v[224:227]
    v_mfma_f32_16x16x32_bf16 v[228:231], a[124:127], v[36:39], v[228:231]
    ds_read_b128 v[24:27], v5 offset:40960
    ds_read_b128 v[28:31], v5 offset:41984
    ds_read_b128 v[32:35], v5 offset:43008
    ds_read_b128 v[36:39], v5 offset:44032
    s_waitcnt lgkmcnt(8)
    v_mfma_f32_16x16x32_bf16 v[168:171], a[128:131], v[40:43], v[168:171]
    v_mfma_f32_16x16x32_bf16 v[172:175], a[128:131], v[44:47], v[172:175]
    v_mfma_f32_16x16x32_bf16 v[176:179], a[128:131], v[48:51], v[176:179]
    v_mfma_f32_16x16x32_bf16 v[180:183], a[128:131], v[52:55], v[180:183]
    v_mfma_f32_16x16x32_bf16 v[184:187], a[132:135], v[40:43], v[184:187]
    v_mfma_f32_16x16x32_bf16 v[188:191], a[132:135], v[44:47], v[188:191]
    v_mfma_f32_16x16x32_bf16 v[192:195], a[132:135], v[48:51], v[192:195]
    v_mfma_f32_16x16x32_bf16 v[196:199], a[132:135], v[52:55], v[196:199]
    v_mfma_f32_16x16x32_bf16 v[200:203], a[136:139], v[40:43], v[200:203]
    v_mfma_f32_16x16x32_bf16 v[204:207], a[136:139], v[44:47], v[204:207]
    v_mfma_f32_16x16x32_bf16 v[208:211], a[136:139], v[48:51], v[208:211]
    v_mfma_f32_16x16x32_bf16 v[212:215], a[136:139], v[52:55], v[212:215]
    v_mfma_f32_16x16x32_bf16 v[216:219], a[140:143], v[40:43], v[216:219]
    v_mfma_f32_16x16x32_bf16 v[220:223], a[140:143], v[44:47], v[220:223]
    v_mfma_f32_16x16x32_bf16 v[224:227], a[140:143], v[48:51], v[224:227]
    v_mfma_f32_16x16x32_bf16 v[228:231], a[140:143], v[52:55], v[228:231]
    ds_read_b128 v[40:43], v5 offset:45056
    ds_read_b128 v[44:47], v5 offset:46080
    ds_read_b128 v[48:51], v5 offset:47104
    ds_read_b128 v[52:55], v5 offset:48128
    s_waitcnt lgkmcnt(8)
    v_mfma_f32_16x16x32_bf16 v[168:171], a[144:147], v[8:11], v[168:171]
    v_mfma_f32_16x16x32_bf16 v[172:175], a[144:147], v[12:15], v[172:175]
    v_mfma_f32_16x16x32_bf16 v[176:179], a[144:147], v[16:19], v[176:179]
    v_mfma_f32_16x16x32_bf16 v[180:183], a[144:147], v[20:23], v[180:183]
    v_mfma_f32_16x16x32_bf16 v[184:187], a[148:151], v[8:11], v[184:187]
    v_mfma_f32_16x16x32_bf16 v[188:191], a[148:151], v[12:15], v[188:191]
    v_mfma_f32_16x16x32_bf16 v[192:195], a[148:151], v[16:19], v[192:195]
    v_mfma_f32_16x16x32_bf16 v[196:199], a[148:151], v[20:23], v[196:199]
    v_mfma_f32_16x16x32_bf16 v[200:203], a[152:155], v[8:11], v[200:203]
    v_mfma_f32_16x16x32_bf16 v[204:207], a[152:155], v[12:15], v[204:207]
    v_mfma_f32_16x16x32_bf16 v[208:211], a[152:155], v[16:19], v[208:211]
    v_mfma_f32_16x16x32_bf16 v[212:215], a[152:155], v[20:23], v[212:215]
    v_mfma_f32_16x16x32_bf16 v[216:219], a[156:159], v[8:11], v[216:219]
    v_mfma_f32_16x16x32_bf16 v[220:223], a[156:159], v[12:15], v[220:223]
    v_mfma_f32_16x16x32_bf16 v[224:227], a[156:159], v[16:19], v[224:227]
    v_mfma_f32_16x16x32_bf16 v[228:231], a[156:159], v[20:23], v[228:231]
    ds_read_b128 v[8:11], v5 offset:49152
    ds_read_b128 v[12:15], v5 offset:50176
    ds_read_b128 v[16:19], v5 offset:51200
    ds_read_b128 v[20:23], v5 offset:52224
    s_waitcnt lgkmcnt(8)
    v_mfma_f32_16x16x32_bf16 v[168:171], a[160:163], v[24:27], v[168:171]
    v_mfma_f32_16x16x32_bf16 v[172:175], a[160:163], v[28:31], v[172:175]
    v_mfma_f32_16x16x32_bf16 v[176:179], a[160:163], v[32:35], v[176:179]
    v_mfma_f32_16x16x32_bf16 v[180:183], a[160:163], v[36:39], v[180:183]
    v_mfma_f32_16x16x32_bf16 v[184:187], a[164:167], v[24:27], v[184:187]
    v_mfma_f32_16x16x32_bf16 v[188:191], a[164:167], v[28:31], v[188:191]
    v_mfma_f32_16x16x32_bf16 v[192:195], a[164:167], v[32:35], v[192:195]
    v_mfma_f32_16x16x32_bf16 v[196:199], a[164:167], v[36:39], v[196:199]
    v_mfma_f32_16x16x32_bf16 v[200:203], a[168:171], v[24:27], v[200:203]
    v_mfma_f32_16x16x32_bf16 v[204:207], a[168:171], v[28:31], v[204:207]
    v_mfma_f32_16x16x32_bf16 v[208:211], a[168:171], v[32:35], v[208:211]
    v_mfma_f32_16x16x32_bf16 v[212:215], a[168:171], v[36:39], v[212:215]
    v_mfma_f32_16x16x32_bf16 v[216:219], a[172:175], v[24:27], v[216:219]
    v_mfma_f32_16x16x32_bf16 v[220:223], a[172:175], v[28:31], v[220:223]
    v_mfma_f32_16x16x32_bf16 v[224:227], a[172:175], v[32:35], v[224:227]
    v_mfma_f32_16x16x32_bf16 v[228:231], a[172:175], v[36:39], v[228:231]
    ds_read_b128 v[24:27], v5 offset:53248
    ds_read_b128 v[28:31], v5 offset:54272
    ds_read_b128 v[32:35], v5 offset:55296
    ds_read_b128 v[36:39], v5 offset:56320
    s_waitcnt lgkmcnt(8)
    v_mfma_f32_16x16x32_bf16 v[168:171], a[176:179], v[40:43], v[168:171]
    v_mfma_f32_16x16x32_bf16 v[172:175], a[176:179], v[44:47], v[172:175]
    v_mfma_f32_16x16x32_bf16 v[176:179], a[176:179], v[48:51], v[176:179]
    v_mfma_f32_16x16x32_bf16 v[180:183], a[176:179], v[52:55], v[180:183]
    v_mfma_f32_16x16x32_bf16 v[184:187], a[180:183], v[40:43], v[184:187]
    v_mfma_f32_16x16x32_bf16 v[188:191], a[180:183], v[44:47], v[188:191]
    v_mfma_f32_16x16x32_bf16 v[192:195], a[180:183], v[48:51], v[192:195]
    v_mfma_f32_16x16x32_bf16 v[196:199], a[180:183], v[52:55], v[196:199]
    v_mfma_f32_16x16x32_bf16 v[200:203], a[184:187], v[40:43], v[200:203]
    v_mfma_f32_16x16x32_bf16 v[204:207], a[184:187], v[44:47], v[204:207]
    v_mfma_f32_16x16x32_bf16 v[208:211], a[184:187], v[48:51], v[208:211]
    v_mfma_f32_16x16x32_bf16 v[212:215], a[184:187], v[52:55], v[212:215]
    v_mfma_f32_16x16x32_bf16 v[216:219], a[188:191], v[40:43], v[216:219]
    v_mfma_f32_16x16x32_bf16 v[220:223], a[188:191], v[44:47], v[220:223]
    v_mfma_f32_16x16x32_bf16 v[224:227], a[188:191], v[48:51], v[224:227]
    v_mfma_f32_16x16x32_bf16 v[228:231], a[188:191], v[52:55], v[228:231]
    ds_read_b128 v[40:43], v5 offset:57344
    ds_read_b128 v[44:47], v5 offset:58368
    ds_read_b128 v[48:51], v5 offset:59392
    ds_read_b128 v[52:55], v5 offset:60416
    s_waitcnt lgkmcnt(8)
    v_mfma_f32_16x16x32_bf16 v[168:171], a[192:195], v[8:11], v[168:171]
    v_mfma_f32_16x16x32_bf16 v[172:175], a[192:195], v[12:15], v[172:175]
    v_mfma_f32_16x16x32_bf16 v[176:179], a[192:195], v[16:19], v[176:179]
    v_mfma_f32_16x16x32_bf16 v[180:183], a[192:195], v[20:23], v[180:183]
    v_mfma_f32_16x16x32_bf16 v[184:187], a[196:199], v[8:11], v[184:187]
    v_mfma_f32_16x16x32_bf16 v[188:191], a[196:199], v[12:15], v[188:191]
    v_mfma_f32_16x16x32_bf16 v[192:195], a[196:199], v[16:19], v[192:195]
    v_mfma_f32_16x16x32_bf16 v[196:199], a[196:199], v[20:23], v[196:199]
    v_mfma_f32_16x16x32_bf16 v[200:203], a[200:203], v[8:11], v[200:203]
    v_mfma_f32_16x16x32_bf16 v[204:207], a[200:203], v[12:15], v[204:207]
    v_mfma_f32_16x16x32_bf16 v[208:211], a[200:203], v[16:19], v[208:211]
    v_mfma_f32_16x16x32_bf16 v[212:215], a[200:203], v[20:23], v[212:215]
    v_mfma_f32_16x16x32_bf16 v[216:219], a[204:207], v[8:11], v[216:219]
    v_mfma_f32_16x16x32_bf16 v[220:223], a[204:207], v[12:15], v[220:223]
    v_mfma_f32_16x16x32_bf16 v[224:227], a[204:207], v[16:19], v[224:227]
    v_mfma_f32_16x16x32_bf16 v[228:231], a[204:207], v[20:23], v[228:231]
    ds_read_b128 v[8:11], v5 offset:61440
    ds_read_b128 v[12:15], v5 offset:62464
    ds_read_b128 v[16:19], v5 offset:63488
    ds_read_b128 v[20:23], v5 offset:64512
    s_waitcnt lgkmcnt(8)
    v_mfma_f32_16x16x32_bf16 v[168:171], a[208:211], v[24:27], v[168:171]
    v_mfma_f32_16x16x32_bf16 v[172:175], a[208:211], v[28:31], v[172:175]
    v_mfma_f32_16x16x32_bf16 v[176:179], a[208:211], v[32:35], v[176:179]
    v_mfma_f32_16x16x32_bf16 v[180:183], a[208:211], v[36:39], v[180:183]
    v_mfma_f32_16x16x32_bf16 v[184:187], a[212:215], v[24:27], v[184:187]
    v_mfma_f32_16x16x32_bf16 v[188:191], a[212:215], v[28:31], v[188:191]
    v_mfma_f32_16x16x32_bf16 v[192:195], a[212:215], v[32:35], v[192:195]
    v_mfma_f32_16x16x32_bf16 v[196:199], a[212:215], v[36:39], v[196:199]
    v_mfma_f32_16x16x32_bf16 v[200:203], a[216:219], v[24:27], v[200:203]
    v_mfma_f32_16x16x32_bf16 v[204:207], a[216:219], v[28:31], v[204:207]
    v_mfma_f32_16x16x32_bf16 v[208:211], a[216:219], v[32:35], v[208:211]
    v_mfma_f32_16x16x32_bf16 v[212:215], a[216:219], v[36:39], v[212:215]
    v_mfma_f32_16x16x32_bf16 v[216:219], a[220:223], v[24:27], v[216:219]
    v_mfma_f32_16x16x32_bf16 v[220:223], a[220:223], v[28:31], v[220:223]
    v_mfma_f32_16x16x32_bf16 v[224:227], a[220:223], v[32:35], v[224:227]
    v_mfma_f32_16x16x32_bf16 v[228:231], a[220:223], v[36:39], v[228:231]
    s_waitcnt lgkmcnt(4)
    v_mfma_f32_16x16x32_bf16 v[168:171], a[224:227], v[40:43], v[168:171]
    v_mfma_f32_16x16x32_bf16 v[172:175], a[224:227], v[44:47], v[172:175]
    v_mfma_f32_16x16x32_bf16 v[176:179], a[224:227], v[48:51], v[176:179]
    v_mfma_f32_16x16x32_bf16 v[180:183], a[224:227], v[52:55], v[180:183]
    v_mfma_f32_16x16x32_bf16 v[184:187], a[228:231], v[40:43], v[184:187]
    v_mfma_f32_16x16x32_bf16 v[188:191], a[228:231], v[44:47], v[188:191]
    v_mfma_f32_16x16x32_bf16 v[192:195], a[228:231], v[48:51], v[192:195]
    v_mfma_f32_16x16x32_bf16 v[196:199], a[228:231], v[52:55], v[196:199]
    v_mfma_f32_16x16x32_bf16 v[200:203], a[232:235], v[40:43], v[200:203]
    v_mfma_f32_16x16x32_bf16 v[204:207], a[232:235], v[44:47], v[204:207]
    v_mfma_f32_16x16x32_bf16 v[208:211], a[232:235], v[48:51], v[208:211]
    v_mfma_f32_16x16x32_bf16 v[212:215], a[232:235], v[52:55], v[212:215]
    v_mfma_f32_16x16x32_bf16 v[216:219], a[236:239], v[40:43], v[216:219]
    v_mfma_f32_16x16x32_bf16 v[220:223], a[236:239], v[44:47], v[220:223]
    v_mfma_f32_16x16x32_bf16 v[224:227], a[236:239], v[48:51], v[224:227]
    v_mfma_f32_16x16x32_bf16 v[228:231], a[236:239], v[52:55], v[228:231]
    s_waitcnt lgkmcnt(0)
    v_mfma_f32_16x16x32_bf16 v[168:171], a[240:243], v[8:11], v[168:171]
    v_mfma_f32_16x16x32_bf16 v[172:175], a[240:243], v[12:15], v[172:175]
    v_mfma_f32_16x16x32_bf16 v[176:179], a[240:243], v[16:19], v[176:179]
    v_mfma_f32_16x16x32_bf16 v[180:183], a[240:243], v[20:23], v[180:183]
    v_mfma_f32_16x16x32_bf16 v[184:187], a[244:247], v[8:11], v[184:187]
    v_mfma_f32_16x16x32_bf16 v[188:191], a[244:247], v[12:15], v[188:191]
    v_mfma_f32_16x16x32_bf16 v[192:195], a[244:247], v[16:19], v[192:195]
    v_mfma_f32_16x16x32_bf16 v[196:199], a[244:247], v[20:23], v[196:199]
    v_mfma_f32_16x16x32_bf16 v[200:203], a[248:251], v[8:11], v[200:203]
    v_mfma_f32_16x16x32_bf16 v[204:207], a[248:251], v[12:15], v[204:207]
    v_mfma_f32_16x16x32_bf16 v[208:211], a[248:251], v[16:19], v[208:211]
    v_mfma_f32_16x16x32_bf16 v[212:215], a[248:251], v[20:23], v[212:215]
    v_mfma_f32_16x16x32_bf16 v[216:219], a[252:255], v[8:11], v[216:219]
    v_mfma_f32_16x16x32_bf16 v[220:223], a[252:255], v[12:15], v[220:223]
    v_mfma_f32_16x16x32_bf16 v[224:227], a[252:255], v[16:19], v[224:227]
    v_mfma_f32_16x16x32_bf16 v[228:231], a[252:255], v[20:23], v[228:231]
    s_lshl_b32 s19, s40, 7
    s_lshr_b32 s20, s16, 1
    s_add_u32 s19, s19, s20
    s_lshl_b32 s19, s19, 2
    s_and_b32 s20, s16, 1
    s_lshl_b32 s20, s20, 1
    s_add_u32 s19, s19, s20
    s_lshl_b32 s19, s19, 10
    s_add_u32 s19, s19, s43
    s_mov_b32 s20, 67108864
    s_cmp_eq_u32 s17, 2
    s_cselect_b32 s20, 50331648, s20
    s_add_u32 s19, s19, s20
    v_cvt_pk_bf16_f32 v104, v168, v169
    v_cvt_pk_bf16_f32 v105, v170, v171
    v_cvt_pk_bf16_f32 v106, v184, v185
    v_cvt_pk_bf16_f32 v107, v186, v187
    buffer_store_dwordx4 v[104:107], v4, s[4:7], s19 offen offset:0 sc1
    v_cvt_pk_bf16_f32 v108, v200, v201
    v_cvt_pk_bf16_f32 v109, v202, v203
    v_cvt_pk_bf16_f32 v110, v216, v217
    v_cvt_pk_bf16_f32 v111, v218, v219
    buffer_store_dwordx4 v[108:111], v4, s[4:7], s19 offen offset:1024 sc1
    s_add_u32 s19, s19, 131072
    v_cvt_pk_bf16_f32 v112, v172, v173
    v_cvt_pk_bf16_f32 v113, v174, v175
    v_cvt_pk_bf16_f32 v114, v188, v189
    v_cvt_pk_bf16_f32 v115, v190, v191
    buffer_store_dwordx4 v[112:115], v4, s[4:7], s19 offen offset:0 sc1
    v_cvt_pk_bf16_f32 v116, v204, v205
    v_cvt_pk_bf16_f32 v117, v206, v207
    v_cvt_pk_bf16_f32 v118, v220, v221
    v_cvt_pk_bf16_f32 v119, v222, v223
    buffer_store_dwordx4 v[116:119], v4, s[4:7], s19 offen offset:1024 sc1
    s_add_u32 s19, s19, 131072
    v_cvt_pk_bf16_f32 v120, v176, v177
    v_cvt_pk_bf16_f32 v121, v178, v179
    v_cvt_pk_bf16_f32 v122, v192, v193
    v_cvt_pk_bf16_f32 v123, v194, v195
    buffer_store_dwordx4 v[120:123], v4, s[4:7], s19 offen offset:0 sc1
    v_cvt_pk_bf16_f32 v124, v208, v209
    v_cvt_pk_bf16_f32 v125, v210, v211
    v_cvt_pk_bf16_f32 v126, v224, v225
    v_cvt_pk_bf16_f32 v127, v226, v227
    buffer_store_dwordx4 v[124:127], v4, s[4:7], s19 offen offset:1024 sc1
    s_add_u32 s19, s19, 131072
    v_cvt_pk_bf16_f32 v128, v180, v181
    v_cvt_pk_bf16_f32 v129, v182, v183
    v_cvt_pk_bf16_f32 v130, v196, v197
    v_cvt_pk_bf16_f32 v131, v198, v199
    buffer_store_dwordx4 v[128:131], v4, s[4:7], s19 offen offset:0 sc1
    v_cvt_pk_bf16_f32 v132, v212, v213
    v_cvt_pk_bf16_f32 v133, v214, v215
    v_cvt_pk_bf16_f32 v134, v228, v229
    v_cvt_pk_bf16_f32 v135, v230, v231
    buffer_store_dwordx4 v[132:135], v4, s[4:7], s19 offen offset:1024 sc1
    s_cmp_eq_u32 s17, 2
    s_cbranch_scc1 L_q_sigq
    s_waitcnt vmcnt(0) lgkmcnt(0)
    s_barrier
    s_cmp_lg_u32 s13, 0
    s_cbranch_scc1 L_wloop
    s_lshl_b32 s22, s42, 8
    s_add_u32 s22, s22, s40
    s_lshl_b32 s22, s22, 6
    s_add_u32 s22, s22, 48248832
    v_mov_b32 v126, 0
    v_mov_b32 v127, 1
    s_mov_b64 exec, 1
    buffer_atomic_add v127, v126, s[4:7], s22 offen
    s_mov_b64 exec, -1
    s_branch L_wloop
L_q_sigq:
    s_waitcnt vmcnt(0) lgkmcnt(0)
    s_barrier
    s_cmp_lg_u32 s13, 0
    s_cbranch_scc1 L_wloop
    s_lshl_b32 s22, s42, 8
    s_add_u32 s22, s22, s40
    s_lshl_b32 s22, s22, 6
    s_add_u32 s22, s22, 48236544
    v_mov_b32 v126, 0
    v_mov_b32 v127, 1
    s_mov_b64 exec, 1
    buffer_atomic_add v127, v126, s[4:7], s22 offen
    s_mov_b64 exec, -1
    s_branch L_wloop
L_q_v:
    ds_read_b128 v[8:11], v5 offset:0
    ds_read_b128 v[12:15], v5 offset:1024
    ds_read_b128 v[16:19], v5 offset:2048
    ds_read_b128 v[20:23], v5 offset:3072
    ds_read_b128 v[24:27], v5 offset:4096
    ds_read_b128 v[28:31], v5 offset:5120
    ds_read_b128 v[32:35], v5 offset:6144
    ds_read_b128 v[36:39], v5 offset:7168
    ds_read_b128 v[40:43], v5 offset:8192
    ds_read_b128 v[44:47], v5 offset:9216
    ds_read_b128 v[48:51], v5 offset:10240
    ds_read_b128 v[52:55], v5 offset:11264
    s_waitcnt lgkmcnt(8)
    v_mfma_f32_16x16x32_bf16 v[168:171], v[8:11], a[0:3], 0
    v_mfma_f32_16x16x32_bf16 v[172:175], v[12:15], a[0:3], 0
    v_mfma_f32_16x16x32_bf16 v[176:179], v[16:19], a[0:3], 0
    v_mfma_f32_16x16x32_bf16 v[180:183], v[20:23], a[0:3], 0
    v_mfma_f32_16x16x32_bf16 v[184:187], v[8:11], a[4:7], 0
    v_mfma_f32_16x16x32_bf16 v[188:191], v[12:15], a[4:7], 0
    v_mfma_f32_16x16x32_bf16 v[192:195], v[16:19], a[4:7], 0
    v_mfma_f32_16x16x32_bf16 v[196:199], v[20:23], a[4:7], 0
    v_mfma_f32_16x16x32_bf16 v[200:203], v[8:11], a[8:11], 0
    v_mfma_f32_16x16x32_bf16 v[204:207], v[12:15], a[8:11], 0
    v_mfma_f32_16x16x32_bf16 v[208:211], v[16:19], a[8:11], 0
    v_mfma_f32_16x16x32_bf16 v[212:215], v[20:23], a[8:11], 0
    v_mfma_f32_16x16x32_bf16 v[216:219], v[8:11], a[12:15], 0
    v_mfma_f32_16x16x32_bf16 v[220:223], v[12:15], a[12:15], 0
    v_mfma_f32_16x16x32_bf16 v[224:227], v[16:19], a[12:15], 0
    v_mfma_f32_16x16x32_bf16 v[228:231], v[20:23], a[12:15], 0
    ds_read_b128 v[8:11], v5 offset:12288
    ds_read_b128 v[12:15], v5 offset:13312
    ds_read_b128 v[16:19], v5 offset:14336
    ds_read_b128 v[20:23], v5 offset:15360
    s_waitcnt lgkmcnt(8)
    v_mfma_f32_16x16x32_bf16 v[168:171], v[24:27], a[16:19], v[168:171]
    v_mfma_f32_16x16x32_bf16 v[172:175], v[28:31], a[16:19], v[172:175]
    v_mfma_f32_16x16x32_bf16 v[176:179], v[32:35], a[16:19], v[176:179]
    v_mfma_f32_16x16x32_bf16 v[180:183], v[36:39], a[16:19], v[180:183]
    v_mfma_f32_16x16x32_bf16 v[184:187], v[24:27], a[20:23], v[184:187]
    v_mfma_f32_16x16x32_bf16 v[188:191], v[28:31], a[20:23], v[188:191]
    v_mfma_f32_16x16x32_bf16 v[192:195], v[32:35], a[20:23], v[192:195]
    v_mfma_f32_16x16x32_bf16 v[196:199], v[36:39], a[20:23], v[196:199]
    v_mfma_f32_16x16x32_bf16 v[200:203], v[24:27], a[24:27], v[200:203]
    v_mfma_f32_16x16x32_bf16 v[204:207], v[28:31], a[24:27], v[204:207]
    v_mfma_f32_16x16x32_bf16 v[208:211], v[32:35], a[24:27], v[208:211]
    v_mfma_f32_16x16x32_bf16 v[212:215], v[36:39], a[24:27], v[212:215]
    v_mfma_f32_16x16x32_bf16 v[216:219], v[24:27], a[28:31], v[216:219]
    v_mfma_f32_16x16x32_bf16 v[220:223], v[28:31], a[28:31], v[220:223]
    v_mfma_f32_16x16x32_bf16 v[224:227], v[32:35], a[28:31], v[224:227]
    v_mfma_f32_16x16x32_bf16 v[228:231], v[36:39], a[28:31], v[228:231]
    ds_read_b128 v[24:27], v5 offset:16384
    ds_read_b128 v[28:31], v5 offset:17408
    ds_read_b128 v[32:35], v5 offset:18432
    ds_read_b128 v[36:39], v5 offset:19456
    s_waitcnt lgkmcnt(8)
    v_mfma_f32_16x16x32_bf16 v[168:171], v[40:43], a[32:35], v[168:171]
    v_mfma_f32_16x16x32_bf16 v[172:175], v[44:47], a[32:35], v[172:175]
    v_mfma_f32_16x16x32_bf16 v[176:179], v[48:51], a[32:35], v[176:179]
    v_mfma_f32_16x16x32_bf16 v[180:183], v[52:55], a[32:35], v[180:183]
    v_mfma_f32_16x16x32_bf16 v[184:187], v[40:43], a[36:39], v[184:187]
    v_mfma_f32_16x16x32_bf16 v[188:191], v[44:47], a[36:39], v[188:191]
    v_mfma_f32_16x16x32_bf16 v[192:195], v[48:51], a[36:39], v[192:195]
    v_mfma_f32_16x16x32_bf16 v[196:199], v[52:55], a[36:39], v[196:199]
    v_mfma_f32_16x16x32_bf16 v[200:203], v[40:43], a[40:43], v[200:203]
    v_mfma_f32_16x16x32_bf16 v[204:207], v[44:47], a[40:43], v[204:207]
    v_mfma_f32_16x16x32_bf16 v[208:211], v[48:51], a[40:43], v[208:211]
    v_mfma_f32_16x16x32_bf16 v[212:215], v[52:55], a[40:43], v[212:215]
    v_mfma_f32_16x16x32_bf16 v[216:219], v[40:43], a[44:47], v[216:219]
    v_mfma_f32_16x16x32_bf16 v[220:223], v[44:47], a[44:47], v[220:223]
    v_mfma_f32_16x16x32_bf16 v[224:227], v[48:51], a[44:47], v[224:227]
    v_mfma_f32_16x16x32_bf16 v[228:231], v[52:55], a[44:47], v[228:231]
    ds_read_b128 v[40:43], v5 offset:20480
    ds_read_b128 v[44:47], v5 offset:21504
    ds_read_b128 v[48:51], v5 offset:22528
    ds_read_b128 v[52:55], v5 offset:23552
    s_waitcnt lgkmcnt(8)
    v_mfma_f32_16x16x32_bf16 v[168:171], v[8:11], a[48:51], v[168:171]
    v_mfma_f32_16x16x32_bf16 v[172:175], v[12:15], a[48:51], v[172:175]
    v_mfma_f32_16x16x32_bf16 v[176:179], v[16:19], a[48:51], v[176:179]
    v_mfma_f32_16x16x32_bf16 v[180:183], v[20:23], a[48:51], v[180:183]
    v_mfma_f32_16x16x32_bf16 v[184:187], v[8:11], a[52:55], v[184:187]
    v_mfma_f32_16x16x32_bf16 v[188:191], v[12:15], a[52:55], v[188:191]
    v_mfma_f32_16x16x32_bf16 v[192:195], v[16:19], a[52:55], v[192:195]
    v_mfma_f32_16x16x32_bf16 v[196:199], v[20:23], a[52:55], v[196:199]
    v_mfma_f32_16x16x32_bf16 v[200:203], v[8:11], a[56:59], v[200:203]
    v_mfma_f32_16x16x32_bf16 v[204:207], v[12:15], a[56:59], v[204:207]
    v_mfma_f32_16x16x32_bf16 v[208:211], v[16:19], a[56:59], v[208:211]
    v_mfma_f32_16x16x32_bf16 v[212:215], v[20:23], a[56:59], v[212:215]
    v_mfma_f32_16x16x32_bf16 v[216:219], v[8:11], a[60:63], v[216:219]
    v_mfma_f32_16x16x32_bf16 v[220:223], v[12:15], a[60:63], v[220:223]
    v_mfma_f32_16x16x32_bf16 v[224:227], v[16:19], a[60:63], v[224:227]
    v_mfma_f32_16x16x32_bf16 v[228:231], v[20:23], a[60:63], v[228:231]
    ds_read_b128 v[8:11], v5 offset:24576
    ds_read_b128 v[12:15], v5 offset:25600
    ds_read_b128 v[16:19], v5 offset:26624
    ds_read_b128 v[20:23], v5 offset:27648
    s_waitcnt lgkmcnt(8)
    v_mfma_f32_16x16x32_bf16 v[168:171], v[24:27], a[64:67], v[168:171]
    v_mfma_f32_16x16x32_bf16 v[172:175], v[28:31], a[64:67], v[172:175]
    v_mfma_f32_16x16x32_bf16 v[176:179], v[32:35], a[64:67], v[176:179]
    v_mfma_f32_16x16x32_bf16 v[180:183], v[36:39], a[64:67], v[180:183]
    v_mfma_f32_16x16x32_bf16 v[184:187], v[24:27], a[68:71], v[184:187]
    v_mfma_f32_16x16x32_bf16 v[188:191], v[28:31], a[68:71], v[188:191]
    v_mfma_f32_16x16x32_bf16 v[192:195], v[32:35], a[68:71], v[192:195]
    v_mfma_f32_16x16x32_bf16 v[196:199], v[36:39], a[68:71], v[196:199]
    v_mfma_f32_16x16x32_bf16 v[200:203], v[24:27], a[72:75], v[200:203]
    v_mfma_f32_16x16x32_bf16 v[204:207], v[28:31], a[72:75], v[204:207]
    v_mfma_f32_16x16x32_bf16 v[208:211], v[32:35], a[72:75], v[208:211]
    v_mfma_f32_16x16x32_bf16 v[212:215], v[36:39], a[72:75], v[212:215]
    v_mfma_f32_16x16x32_bf16 v[216:219], v[24:27], a[76:79], v[216:219]
    v_mfma_f32_16x16x32_bf16 v[220:223], v[28:31], a[76:79], v[220:223]
    v_mfma_f32_16x16x32_bf16 v[224:227], v[32:35], a[76:79], v[224:227]
    v_mfma_f32_16x16x32_bf16 v[228:231], v[36:39], a[76:79], v[228:231]
    ds_read_b128 v[24:27], v5 offset:28672
    ds_read_b128 v[28:31], v5 offset:29696
    ds_read_b128 v[32:35], v5 offset:30720
    ds_read_b128 v[36:39], v5 offset:31744
    s_waitcnt lgkmcnt(8)
    v_mfma_f32_16x16x32_bf16 v[168:171], v[40:43], a[80:83], v[168:171]
    v_mfma_f32_16x16x32_bf16 v[172:175], v[44:47], a[80:83], v[172:175]
    v_mfma_f32_16x16x32_bf16 v[176:179], v[48:51], a[80:83], v[176:179]
    v_mfma_f32_16x16x32_bf16 v[180:183], v[52:55], a[80:83], v[180:183]
    v_mfma_f32_16x16x32_bf16 v[184:187], v[40:43], a[84:87], v[184:187]
    v_mfma_f32_16x16x32_bf16 v[188:191], v[44:47], a[84:87], v[188:191]
    v_mfma_f32_16x16x32_bf16 v[192:195], v[48:51], a[84:87], v[192:195]
    v_mfma_f32_16x16x32_bf16 v[196:199], v[52:55], a[84:87], v[196:199]
    v_mfma_f32_16x16x32_bf16 v[200:203], v[40:43], a[88:91], v[200:203]
    v_mfma_f32_16x16x32_bf16 v[204:207], v[44:47], a[88:91], v[204:207]
    v_mfma_f32_16x16x32_bf16 v[208:211], v[48:51], a[88:91], v[208:211]
    v_mfma_f32_16x16x32_bf16 v[212:215], v[52:55], a[88:91], v[212:215]
    v_mfma_f32_16x16x32_bf16 v[216:219], v[40:43], a[92:95], v[216:219]
    v_mfma_f32_16x16x32_bf16 v[220:223], v[44:47], a[92:95], v[220:223]
    v_mfma_f32_16x16x32_bf16 v[224:227], v[48:51], a[92:95], v[224:227]
    v_mfma_f32_16x16x32_bf16 v[228:231], v[52:55], a[92:95], v[228:231]
    ds_read_b128 v[40:43], v5 offset:32768
    ds_read_b128 v[44:47], v5 offset:33792
    ds_read_b128 v[48:51], v5 offset:34816
    ds_read_b128 v[52:55], v5 offset:35840
    s_waitcnt lgkmcnt(8)
    v_mfma_f32_16x16x32_bf16 v[168:171], v[8:11], a[96:99], v[168:171]
    v_mfma_f32_16x16x32_bf16 v[172:175], v[12:15], a[96:99], v[172:175]
    v_mfma_f32_16x16x32_bf16 v[176:179], v[16:19], a[96:99], v[176:179]
    v_mfma_f32_16x16x32_bf16 v[180:183], v[20:23], a[96:99], v[180:183]
    v_mfma_f32_16x16x32_bf16 v[184:187], v[8:11], a[100:103], v[184:187]
    v_mfma_f32_16x16x32_bf16 v[188:191], v[12:15], a[100:103], v[188:191]
    v_mfma_f32_16x16x32_bf16 v[192:195], v[16:19], a[100:103], v[192:195]
    v_mfma_f32_16x16x32_bf16 v[196:199], v[20:23], a[100:103], v[196:199]
    v_mfma_f32_16x16x32_bf16 v[200:203], v[8:11], a[104:107], v[200:203]
    v_mfma_f32_16x16x32_bf16 v[204:207], v[12:15], a[104:107], v[204:207]
    v_mfma_f32_16x16x32_bf16 v[208:211], v[16:19], a[104:107], v[208:211]
    v_mfma_f32_16x16x32_bf16 v[212:215], v[20:23], a[104:107], v[212:215]
    v_mfma_f32_16x16x32_bf16 v[216:219], v[8:11], a[108:111], v[216:219]
    v_mfma_f32_16x16x32_bf16 v[220:223], v[12:15], a[108:111], v[220:223]
    v_mfma_f32_16x16x32_bf16 v[224:227], v[16:19], a[108:111], v[224:227]
    v_mfma_f32_16x16x32_bf16 v[228:231], v[20:23], a[108:111], v[228:231]
    ds_read_b128 v[8:11], v5 offset:36864
    ds_read_b128 v[12:15], v5 offset:37888
    ds_read_b128 v[16:19], v5 offset:38912
    ds_read_b128 v[20:23], v5 offset:39936
    s_waitcnt lgkmcnt(8)
    v_mfma_f32_16x16x32_bf16 v[168:171], v[24:27], a[112:115], v[168:171]
    v_mfma_f32_16x16x32_bf16 v[172:175], v[28:31], a[112:115], v[172:175]
    v_mfma_f32_16x16x32_bf16 v[176:179], v[32:35], a[112:115], v[176:179]
    v_mfma_f32_16x16x32_bf16 v[180:183], v[36:39], a[112:115], v[180:183]
    v_mfma_f32_16x16x32_bf16 v[184:187], v[24:27], a[116:119], v[184:187]
    v_mfma_f32_16x16x32_bf16 v[188:191], v[28:31], a[116:119], v[188:191]
    v_mfma_f32_16x16x32_bf16 v[192:195], v[32:35], a[116:119], v[192:195]
    v_mfma_f32_16x16x32_bf16 v[196:199], v[36:39], a[116:119], v[196:199]
    v_mfma_f32_16x16x32_bf16 v[200:203], v[24:27], a[120:123], v[200:203]
    v_mfma_f32_16x16x32_bf16 v[204:207], v[28:31], a[120:123], v[204:207]
    v_mfma_f32_16x16x32_bf16 v[208:211], v[32:35], a[120:123], v[208:211]
    v_mfma_f32_16x16x32_bf16 v[212:215], v[36:39], a[120:123], v[212:215]
    v_mfma_f32_16x16x32_bf16 v[216:219], v[24:27], a[124:127], v[216:219]
    v_mfma_f32_16x16x32_bf16 v[220:223], v[28:31], a[124:127], v[220:223]
    v_mfma_f32_16x16x32_bf16 v[224:227], v[32:35], a[124:127], v[224:227]
    v_mfma_f32_16x16x32_bf16 v[228:231], v[36:39], a[124:127], v[228:231]
    ds_read_b128 v[24:27], v5 offset:40960
    ds_read_b128 v[28:31], v5 offset:41984
    ds_read_b128 v[32:35], v5 offset:43008
    ds_read_b128 v[36:39], v5 offset:44032
    s_waitcnt lgkmcnt(8)
    v_mfma_f32_16x16x32_bf16 v[168:171], v[40:43], a[128:131], v[168:171]
    v_mfma_f32_16x16x32_bf16 v[172:175], v[44:47], a[128:131], v[172:175]
    v_mfma_f32_16x16x32_bf16 v[176:179], v[48:51], a[128:131], v[176:179]
    v_mfma_f32_16x16x32_bf16 v[180:183], v[52:55], a[128:131], v[180:183]
    v_mfma_f32_16x16x32_bf16 v[184:187], v[40:43], a[132:135], v[184:187]
    v_mfma_f32_16x16x32_bf16 v[188:191], v[44:47], a[132:135], v[188:191]
    v_mfma_f32_16x16x32_bf16 v[192:195], v[48:51], a[132:135], v[192:195]
    v_mfma_f32_16x16x32_bf16 v[196:199], v[52:55], a[132:135], v[196:199]
    v_mfma_f32_16x16x32_bf16 v[200:203], v[40:43], a[136:139], v[200:203]
    v_mfma_f32_16x16x32_bf16 v[204:207], v[44:47], a[136:139], v[204:207]
    v_mfma_f32_16x16x32_bf16 v[208:211], v[48:51], a[136:139], v[208:211]
    v_mfma_f32_16x16x32_bf16 v[212:215], v[52:55], a[136:139], v[212:215]
    v_mfma_f32_16x16x32_bf16 v[216:219], v[40:43], a[140:143], v[216:219]
    v_mfma_f32_16x16x32_bf16 v[220:223], v[44:47], a[140:143], v[220:223]
    v_mfma_f32_16x16x32_bf16 v[224:227], v[48:51], a[140:143], v[224:227]
    v_mfma_f32_16x16x32_bf16 v[228:231], v[52:55], a[140:143], v[228:231]
    ds_read_b128 v[40:43], v5 offset:45056
    ds_read_b128 v[44:47], v5 offset:46080
    ds_read_b128 v[48:51], v5 offset:47104
    ds_read_b128 v[52:55], v5 offset:48128
    s_waitcnt lgkmcnt(8)
    v_mfma_f32_16x16x32_bf16 v[168:171], v[8:11], a[144:147], v[168:171]
    v_mfma_f32_16x16x32_bf16 v[172:175], v[12:15], a[144:147], v[172:175]
    v_mfma_f32_16x16x32_bf16 v[176:179], v[16:19], a[144:147], v[176:179]
    v_mfma_f32_16x16x32_bf16 v[180:183], v[20:23], a[144:147], v[180:183]
    v_mfma_f32_16x16x32_bf16 v[184:187], v[8:11], a[148:151], v[184:187]
    v_mfma_f32_16x16x32_bf16 v[188:191], v[12:15], a[148:151], v[188:191]
    v_mfma_f32_16x16x32_bf16 v[192:195], v[16:19], a[148:151], v[192:195]
    v_mfma_f32_16x16x32_bf16 v[196:199], v[20:23], a[148:151], v[196:199]
    v_mfma_f32_16x16x32_bf16 v[200:203], v[8:11], a[152:155], v[200:203]
    v_mfma_f32_16x16x32_bf16 v[204:207], v[12:15], a[152:155], v[204:207]
    v_mfma_f32_16x16x32_bf16 v[208:211], v[16:19], a[152:155], v[208:211]
    v_mfma_f32_16x16x32_bf16 v[212:215], v[20:23], a[152:155], v[212:215]
    v_mfma_f32_16x16x32_bf16 v[216:219], v[8:11], a[156:159], v[216:219]
    v_mfma_f32_16x16x32_bf16 v[220:223], v[12:15], a[156:159], v[220:223]
    v_mfma_f32_16x16x32_bf16 v[224:227], v[16:19], a[156:159], v[224:227]
    v_mfma_f32_16x16x32_bf16 v[228:231], v[20:23], a[156:159], v[228:231]
    ds_read_b128 v[8:11], v5 offset:49152
    ds_read_b128 v[12:15], v5 offset:50176
    ds_read_b128 v[16:19], v5 offset:51200
    ds_read_b128 v[20:23], v5 offset:52224
    s_waitcnt lgkmcnt(8)
    v_mfma_f32_16x16x32_bf16 v[168:171], v[24:27], a[160:163], v[168:171]
    v_mfma_f32_16x16x32_bf16 v[172:175], v[28:31], a[160:163], v[172:175]
    v_mfma_f32_16x16x32_bf16 v[176:179], v[32:35], a[160:163], v[176:179]
    v_mfma_f32_16x16x32_bf16 v[180:183], v[36:39], a[160:163], v[180:183]
    v_mfma_f32_16x16x32_bf16 v[184:187], v[24:27], a[164:167], v[184:187]
    v_mfma_f32_16x16x32_bf16 v[188:191], v[28:31], a[164:167], v[188:191]
    v_mfma_f32_16x16x32_bf16 v[192:195], v[32:35], a[164:167], v[192:195]
    v_mfma_f32_16x16x32_bf16 v[196:199], v[36:39], a[164:167], v[196:199]
    v_mfma_f32_16x16x32_bf16 v[200:203], v[24:27], a[168:171], v[200:203]
    v_mfma_f32_16x16x32_bf16 v[204:207], v[28:31], a[168:171], v[204:207]
    v_mfma_f32_16x16x32_bf16 v[208:211], v[32:35], a[168:171], v[208:211]
    v_mfma_f32_16x16x32_bf16 v[212:215], v[36:39], a[168:171], v[212:215]
    v_mfma_f32_16x16x32_bf16 v[216:219], v[24:27], a[172:175], v[216:219]
    v_mfma_f32_16x16x32_bf16 v[220:223], v[28:31], a[172:175], v[220:223]
    v_mfma_f32_16x16x32_bf16 v[224:227], v[32:35], a[172:175], v[224:227]
    v_mfma_f32_16x16x32_bf16 v[228:231], v[36:39], a[172:175], v[228:231]
    ds_read_b128 v[24:27], v5 offset:53248
    ds_read_b128 v[28:31], v5 offset:54272
    ds_read_b128 v[32:35], v5 offset:55296
    ds_read_b128 v[36:39], v5 offset:56320
    s_waitcnt lgkmcnt(8)
    v_mfma_f32_16x16x32_bf16 v[168:171], v[40:43], a[176:179], v[168:171]
    v_mfma_f32_16x16x32_bf16 v[172:175], v[44:47], a[176:179], v[172:175]
    v_mfma_f32_16x16x32_bf16 v[176:179], v[48:51], a[176:179], v[176:179]
    v_mfma_f32_16x16x32_bf16 v[180:183], v[52:55], a[176:179], v[180:183]
    v_mfma_f32_16x16x32_bf16 v[184:187], v[40:43], a[180:183], v[184:187]
    v_mfma_f32_16x16x32_bf16 v[188:191], v[44:47], a[180:183], v[188:191]
    v_mfma_f32_16x16x32_bf16 v[192:195], v[48:51], a[180:183], v[192:195]
    v_mfma_f32_16x16x32_bf16 v[196:199], v[52:55], a[180:183], v[196:199]
    v_mfma_f32_16x16x32_bf16 v[200:203], v[40:43], a[184:187], v[200:203]
    v_mfma_f32_16x16x32_bf16 v[204:207], v[44:47], a[184:187], v[204:207]
    v_mfma_f32_16x16x32_bf16 v[208:211], v[48:51], a[184:187], v[208:211]
    v_mfma_f32_16x16x32_bf16 v[212:215], v[52:55], a[184:187], v[212:215]
    v_mfma_f32_16x16x32_bf16 v[216:219], v[40:43], a[188:191], v[216:219]
    v_mfma_f32_16x16x32_bf16 v[220:223], v[44:47], a[188:191], v[220:223]
    v_mfma_f32_16x16x32_bf16 v[224:227], v[48:51], a[188:191], v[224:227]
    v_mfma_f32_16x16x32_bf16 v[228:231], v[52:55], a[188:191], v[228:231]
    ds_read_b128 v[40:43], v5 offset:57344
    ds_read_b128 v[44:47], v5 offset:58368
    ds_read_b128 v[48:51], v5 offset:59392
    ds_read_b128 v[52:55], v5 offset:60416
    s_waitcnt lgkmcnt(8)
    v_mfma_f32_16x16x32_bf16 v[168:171], v[8:11], a[192:195], v[168:171]
    v_mfma_f32_16x16x32_bf16 v[172:175], v[12:15], a[192:195], v[172:175]
    v_mfma_f32_16x16x32_bf16 v[176:179], v[16:19], a[192:195], v[176:179]
    v_mfma_f32_16x16x32_bf16 v[180:183], v[20:23], a[192:195], v[180:183]
    v_mfma_f32_16x16x32_bf16 v[184:187], v[8:11], a[196:199], v[184:187]
    v_mfma_f32_16x16x32_bf16 v[188:191], v[12:15], a[196:199], v[188:191]
    v_mfma_f32_16x16x32_bf16 v[192:195], v[16:19], a[196:199], v[192:195]
    v_mfma_f32_16x16x32_bf16 v[196:199], v[20:23], a[196:199], v[196:199]
    v_mfma_f32_16x16x32_bf16 v[200:203], v[8:11], a[200:203], v[200:203]
    v_mfma_f32_16x16x32_bf16 v[204:207], v[12:15], a[200:203], v[204:207]
    v_mfma_f32_16x16x32_bf16 v[208:211], v[16:19], a[200:203], v[208:211]
    v_mfma_f32_16x16x32_bf16 v[212:215], v[20:23], a[200:203], v[212:215]
    v_mfma_f32_16x16x32_bf16 v[216:219], v[8:11], a[204:207], v[216:219]
    v_mfma_f32_16x16x32_bf16 v[220:223], v[12:15], a[204:207], v[220:223]
    v_mfma_f32_16x16x32_bf16 v[224:227], v[16:19], a[204:207], v[224:227]
    v_mfma_f32_16x16x32_bf16 v[228:231], v[20:23], a[204:207], v[228:231]
    ds_read_b128 v[8:11], v5 offset:61440
    ds_read_b128 v[12:15], v5 offset:62464
    ds_read_b128 v[16:19], v5 offset:63488
    ds_read_b128 v[20:23], v5 offset:64512
    s_waitcnt lgkmcnt(8)
    v_mfma_f32_16x16x32_bf16 v[168:171], v[24:27], a[208:211], v[168:171]
    v_mfma_f32_16x16x32_bf16 v[172:175], v[28:31], a[208:211], v[172:175]
    v_mfma_f32_16x16x32_bf16 v[176:179], v[32:35], a[208:211], v[176:179]
    v_mfma_f32_16x16x32_bf16 v[180:183], v[36:39], a[208:211], v[180:183]
    v_mfma_f32_16x16x32_bf16 v[184:187], v[24:27], a[212:215], v[184:187]
    v_mfma_f32_16x16x32_bf16 v[188:191], v[28:31], a[212:215], v[188:191]
    v_mfma_f32_16x16x32_bf16 v[192:195], v[32:35], a[212:215], v[192:195]
    v_mfma_f32_16x16x32_bf16 v[196:199], v[36:39], a[212:215], v[196:199]
    v_mfma_f32_16x16x32_bf16 v[200:203], v[24:27], a[216:219], v[200:203]
    v_mfma_f32_16x16x32_bf16 v[204:207], v[28:31], a[216:219], v[204:207]
    v_mfma_f32_16x16x32_bf16 v[208:211], v[32:35], a[216:219], v[208:211]
    v_mfma_f32_16x16x32_bf16 v[212:215], v[36:39], a[216:219], v[212:215]
    v_mfma_f32_16x16x32_bf16 v[216:219], v[24:27], a[220:223], v[216:219]
    v_mfma_f32_16x16x32_bf16 v[220:223], v[28:31], a[220:223], v[220:223]
    v_mfma_f32_16x16x32_bf16 v[224:227], v[32:35], a[220:223], v[224:227]
    v_mfma_f32_16x16x32_bf16 v[228:231], v[36:39], a[220:223], v[228:231]
    s_waitcnt lgkmcnt(4)
    v_mfma_f32_16x16x32_bf16 v[168:171], v[40:43], a[224:227], v[168:171]
    v_mfma_f32_16x16x32_bf16 v[172:175], v[44:47], a[224:227], v[172:175]
    v_mfma_f32_16x16x32_bf16 v[176:179], v[48:51], a[224:227], v[176:179]
    v_mfma_f32_16x16x32_bf16 v[180:183], v[52:55], a[224:227], v[180:183]
    v_mfma_f32_16x16x32_bf16 v[184:187], v[40:43], a[228:231], v[184:187]
    v_mfma_f32_16x16x32_bf16 v[188:191], v[44:47], a[228:231], v[188:191]
    v_mfma_f32_16x16x32_bf16 v[192:195], v[48:51], a[228:231], v[192:195]
    v_mfma_f32_16x16x32_bf16 v[196:199], v[52:55], a[228:231], v[196:199]
    v_mfma_f32_16x16x32_bf16 v[200:203], v[40:43], a[232:235], v[200:203]
    v_mfma_f32_16x16x32_bf16 v[204:207], v[44:47], a[232:235], v[204:207]
    v_mfma_f32_16x16x32_bf16 v[208:211], v[48:51], a[232:235], v[208:211]
    v_mfma_f32_16x16x32_bf16 v[212:215], v[52:55], a[232:235], v[212:215]
    v_mfma_f32_16x16x32_bf16 v[216:219], v[40:43], a[236:239], v[216:219]
    v_mfma_f32_16x16x32_bf16 v[220:223], v[44:47], a[236:239], v[220:223]
    v_mfma_f32_16x16x32_bf16 v[224:227], v[48:51], a[236:239], v[224:227]
    v_mfma_f32_16x16x32_bf16 v[228:231], v[52:55], a[236:239], v[228:231]
    s_waitcnt lgkmcnt(0)
    v_mfma_f32_16x16x32_bf16 v[168:171], v[8:11], a[240:243], v[168:171]
    v_mfma_f32_16x16x32_bf16 v[172:175], v[12:15], a[240:243], v[172:175]
    v_mfma_f32_16x16x32_bf16 v[176:179], v[16:19], a[240:243], v[176:179]
    v_mfma_f32_16x16x32_bf16 v[180:183], v[20:23], a[240:243], v[180:183]
    v_mfma_f32_16x16x32_bf16 v[184:187], v[8:11], a[244:247], v[184:187]
    v_mfma_f32_16x16x32_bf16 v[188:191], v[12:15], a[244:247], v[188:191]
    v_mfma_f32_16x16x32_bf16 v[192:195], v[16:19], a[244:247], v[192:195]
    v_mfma_f32_16x16x32_bf16 v[196:199], v[20:23], a[244:247], v[196:199]
    v_mfma_f32_16x16x32_bf16 v[200:203], v[8:11], a[248:251], v[200:203]
    v_mfma_f32_16x16x32_bf16 v[204:207], v[12:15], a[248:251], v[204:207]
    v_mfma_f32_16x16x32_bf16 v[208:211], v[16:19], a[248:251], v[208:211]
    v_mfma_f32_16x16x32_bf16 v[212:215], v[20:23], a[248:251], v[212:215]
    v_mfma_f32_16x16x32_bf16 v[216:219], v[8:11], a[252:255], v[216:219]
    v_mfma_f32_16x16x32_bf16 v[220:223], v[12:15], a[252:255], v[220:223]
    v_mfma_f32_16x16x32_bf16 v[224:227], v[16:19], a[252:255], v[224:227]
    v_mfma_f32_16x16x32_bf16 v[228:231], v[20:23], a[252:255], v[228:231]
    s_lshl_b32 s19, s40, 6
    s_lshr_b32 s20, s16, 1
    s_add_u32 s19, s19, s20
    s_lshl_b32 s19, s19, 3
    s_and_b32 s20, s16, 1
    s_lshl_b32 s20, s20, 2
    s_add_u32 s19, s19, s20
    s_lshl_b32 s19, s19, 10
    s_add_u32 s19, s19, s43
    s_add_u32 s19, s19, 83886080
    v_cvt_pk_bf16_f32 v104, v168, v169
    v_cvt_pk_bf16_f32 v105, v170, v171
    v_cvt_pk_bf16_f32 v106, v172, v173
    v_cvt_pk_bf16_f32 v107, v174, v175
    buffer_store_dwordx4 v[104:107], v4, s[4:7], s19 offen offset:0 sc1
    v_cvt_pk_bf16_f32 v108, v184, v185
    v_cvt_pk_bf16_f32 v109, v186, v187
    v_cvt_pk_bf16_f32 v110, v188, v189
    v_cvt_pk_bf16_f32 v111, v190, v191
    buffer_store_dwordx4 v[108:111], v4, s[4:7], s19 offen offset:1024 sc1
    v_cvt_pk_bf16_f32 v112, v200, v201
    v_cvt_pk_bf16_f32 v113, v202, v203
    v_cvt_pk_bf16_f32 v114, v204, v205
    v_cvt_pk_bf16_f32 v115, v206, v207
    buffer_store_dwordx4 v[112:115], v4, s[4:7], s19 offen offset:2048 sc1
    v_cvt_pk_bf16_f32 v116, v216, v217
    v_cvt_pk_bf16_f32 v117, v218, v219
    v_cvt_pk_bf16_f32 v118, v220, v221
    v_cvt_pk_bf16_f32 v119, v222, v223
    buffer_store_dwordx4 v[116:119], v4, s[4:7], s19 offen offset:3072 sc1
    s_add_u32 s19, s19, 262144
    v_cvt_pk_bf16_f32 v120, v176, v177
    v_cvt_pk_bf16_f32 v121, v178, v179
    v_cvt_pk_bf16_f32 v122, v180, v181
    v_cvt_pk_bf16_f32 v123, v182, v183
    buffer_store_dwordx4 v[120:123], v4, s[4:7], s19 offen offset:0 sc1
    v_cvt_pk_bf16_f32 v124, v192, v193
    v_cvt_pk_bf16_f32 v125, v194, v195
    v_cvt_pk_bf16_f32 v126, v196, v197
    v_cvt_pk_bf16_f32 v127, v198, v199
    buffer_store_dwordx4 v[124:127], v4, s[4:7], s19 offen offset:1024 sc1
    v_cvt_pk_bf16_f32 v128, v208, v209
    v_cvt_pk_bf16_f32 v129, v210, v211
    v_cvt_pk_bf16_f32 v130, v212, v213
    v_cvt_pk_bf16_f32 v131, v214, v215
    buffer_store_dwordx4 v[128:131], v4, s[4:7], s19 offen offset:2048 sc1
    v_cvt_pk_bf16_f32 v132, v224, v225
    v_cvt_pk_bf16_f32 v133, v226, v227
    v_cvt_pk_bf16_f32 v134, v228, v229
    v_cvt_pk_bf16_f32 v135, v230, v231
    buffer_store_dwordx4 v[132:135], v4, s[4:7], s19 offen offset:3072 sc1
    s_waitcnt vmcnt(0) lgkmcnt(0)
    s_barrier
    s_cmp_lg_u32 s13, 0
    s_cbranch_scc1 L_wloop
    s_lshl_b32 s22, s42, 8
    s_add_u32 s22, s22, s40
    s_lshl_b32 s22, s22, 6
    s_add_u32 s22, s22, 48248832
    v_mov_b32 v126, 0
    v_mov_b32 v127, 1
    s_mov_b64 exec, 1
    buffer_atomic_add v127, v126, s[4:7], s22 offen
    s_mov_b64 exec, -1
    s_branch L_wloop
L_st2:
    s_lshl_b32 s12, s40, 1
    s_lshr_b32 s14, s41, 2
    s_add_u32 s12, s12, s14
    s_and_b32 s14, s41, 3
    s_lshl_b32 s14, s14, 3
    s_lshl_b32 s15, s13, 1
    s_add_u32 s14, s14, s15
    s_lshl_b32 s22, s42, 8
    s_add_u32 s22, s22, s40
    s_lshl_b32 s22, s22, 6
    s_add_u32 s22, s22, 48236544
    s_lshl_b32 s21, s42, 8
    s_add_u32 s21, s21, s40
    s_lshl_b32 s21, s21, 6
    s_add_u32 s21, s21, 48248832
    s_lshl_b32 s20, s42, 6
    s_add_u32 s20, s20, s12
    s_lshl_b32 s20, s20, 6
    s_add_u32 s20, s20, 48267264
    v_and_b32 v14, 63, v0
    v_lshlrev_b32 v1, 4, v14
    v_lshlrev_b32 v13, 3, v14
    s_sub_u32 s23, s21, s22
    v_mov_b32 v126, 0
    v_writelane_b32 v126, s23, 1
    s_sub_u32 s23, s20, s22
    v_writelane_b32 v126, s23, 2
    s_mov_b32 s26, 0
    buffer_load_dword v127, v126, s[4:7], s22 offen sc1
    s_waitcnt vmcnt(0)
    s_cmp_eq_u32 s68, 0
    s_cbranch_scc1 L_fp_done_a
    s_barrier
    s_cmp_lg_u32 s13, 0
    s_cbranch_scc1 L_fp_skip_a
    v_mov_b32 v124, 0
    v_mov_b32 v125, 1
    s_mov_b64 exec, 1
    buffer_atomic_add v125, v124, s[4:7], s68 offen
    s_mov_b64 exec, -1
L_fp_skip_a:
    s_mov_b32 s68, 0
L_fp_done_a:
    s_branch L_a_chk
L_a_poll:
    buffer_load_dword v127, v126, s[4:7], s22 offen sc1
    s_add_u32 s26, s26, 1
    s_cmp_gt_u32 s26, 4194304
    s_cbranch_scc1 L_mega_end
    s_waitcnt vmcnt(0)
L_a_chk:
    v_readlane_b32 s27, v127, 0
    v_readlane_b32 s23, v127, 1
    v_readlane_b32 s19, v127, 2
    s_cmp_ge_u32 s27, 16
    s_cselect_b32 s27, 1, 0
    s_cmp_ge_u32 s23, 32
    s_cselect_b32 s23, 1, 0
    s_and_b32 s27, s27, s23
    s_cmp_eq_u32 s27, 1
    s_cbranch_scc1 L_a_polled
    s_sleep 4
    s_branch L_a_poll
L_a_polled:
    s_lshl_b32 s15, s12, 6
    s_add_u32 s15, s15, s14
    s_add_u32 s15, s15, 0
    s_lshl_b32 s15, s15, 12
    s_add_u32 s15, s15, s43
    s_add_u32 s16, s15, 50331648
    s_add_u32 s17, s15, 67108864
    buffer_load_dwordx4 v[16:19], v1, s[4:7], s16 offen offset:0 sc1
    buffer_load_dwordx4 v[48:51], v1, s[4:7], s17 offen offset:0 sc1
    buffer_load_dwordx4 v[20:23], v1, s[4:7], s16 offen offset:1024 sc1
    buffer_load_dwordx4 v[52:55], v1, s[4:7], s17 offen offset:1024 sc1
    buffer_load_dwordx4 v[24:27], v1, s[4:7], s16 offen offset:2048 sc1
    buffer_load_dwordx4 v[56:59], v1, s[4:7], s17 offen offset:2048 sc1
    buffer_load_dwordx4 v[28:31], v1, s[4:7], s16 offen offset:3072 sc1
    buffer_load_dwordx4 v[60:63], v1, s[4:7], s17 offen offset:3072 sc1
    s_add_u32 s16, s16, 131072
    s_add_u32 s17, s17, 131072
    buffer_load_dwordx4 v[32:35], v1, s[4:7], s16 offen offset:0 sc1
    buffer_load_dwordx4 v[64:67], v1, s[4:7], s17 offen offset:0 sc1
    buffer_load_dwordx4 v[36:39], v1, s[4:7], s16 offen offset:1024 sc1
    buffer_load_dwordx4 v[68:71], v1, s[4:7], s17 offen offset:1024 sc1
    buffer_load_dwordx4 v[40:43], v1, s[4:7], s16 offen offset:2048 sc1
    buffer_load_dwordx4 v[72:75], v1, s[4:7], s17 offen offset:2048 sc1
    buffer_load_dwordx4 v[44:47], v1, s[4:7], s16 offen offset:3072 sc1
    buffer_load_dwordx4 v[76:79], v1, s[4:7], s17 offen offset:3072 sc1
    s_lshl_b32 s15, s12, 5
    s_add_u32 s15, s15, s14
    s_add_u32 s15, s15, 0
    s_lshl_b32 s16, s15, 13
    s_add_u32 s16, s16, s43
    s_add_u32 s16, s16, 83886080
    buffer_load_dwordx4 v[96:99], v1, s[4:7], s16 offen offset:0 sc1
    buffer_load_dwordx4 v[100:103], v1, s[4:7], s16 offen offset:1024 sc1
    buffer_load_dwordx4 v[104:107], v1, s[4:7], s16 offen offset:2048 sc1
    buffer_load_dwordx4 v[108:111], v1, s[4:7], s16 offen offset:3072 sc1
    s_add_u32 s16, s16, 4096
    buffer_load_dwordx4 v[112:115], v1, s[4:7], s16 offen offset:0 sc1
    buffer_load_dwordx4 v[116:119], v1, s[4:7], s16 offen offset:1024 sc1
    buffer_load_dwordx4 v[120:123], v1, s[4:7], s16 offen offset:2048 sc1
    buffer_load_dwordx4 v[240:243], v1, s[4:7], s16 offen offset:3072 sc1
    s_lshl_b32 s15, s12, 6
    s_add_u32 s15, s15, s14
    s_add_u32 s15, s15, 1
    s_lshl_b32 s15, s15, 12
    s_add_u32 s15, s15, s43
    s_add_u32 s16, s15, 50331648
    s_add_u32 s17, s15, 67108864
    buffer_load_dwordx4 a[0:3], v1, s[4:7], s16 offen offset:0 sc1
    buffer_load_dwordx4 a[32:35], v1, s[4:7], s17 offen offset:0 sc1
    buffer_load_dwordx4 a[4:7], v1, s[4:7], s16 offen offset:1024 sc1
    buffer_load_dwordx4 a[36:39], v1, s[4:7], s17 offen offset:1024 sc1
    buffer_load_dwordx4 a[8:11], v1, s[4:7], s16 offen offset:2048 sc1
    buffer_load_dwordx4 a[40:43], v1, s[4:7], s17 offen offset:2048 sc1
    buffer_load_dwordx4 a[12:15], v1, s[4:7], s16 offen offset:3072 sc1
    buffer_load_dwordx4 a[44:47], v1, s[4:7], s17 offen offset:3072 sc1
    s_add_u32 s16, s16, 131072
    s_add_u32 s17, s17, 131072
    buffer_load_dwordx4 a[16:19], v1, s[4:7], s16 offen offset:0 sc1
    buffer_load_dwordx4 a[48:51], v1, s[4:7], s17 offen offset:0 sc1
    buffer_load_dwordx4 a[20:23], v1, s[4:7], s16 offen offset:1024 sc1
    buffer_load_dwordx4 a[52:55], v1, s[4:7], s17 offen offset:1024 sc1
    buffer_load_dwordx4 a[24:27], v1, s[4:7], s16 offen offset:2048 sc1
    buffer_load_dwordx4 a[56:59], v1, s[4:7], s17 offen offset:2048 sc1
    buffer_load_dwordx4 a[28:31], v1, s[4:7], s16 offen offset:3072 sc1
    buffer_load_dwordx4 a[60:63], v1, s[4:7], s17 offen offset:3072 sc1
    s_lshl_b32 s15, s12, 5
    s_add_u32 s15, s15, s14
    s_add_u32 s15, s15, 1
    s_lshl_b32 s16, s15, 13
    s_add_u32 s16, s16, s43
    s_add_u32 s16, s16, 83886080
    buffer_load_dwordx4 a[64:67], v1, s[4:7], s16 offen offset:0 sc1
    buffer_load_dwordx4 a[68:71], v1, s[4:7], s16 offen offset:1024 sc1
    buffer_load_dwordx4 a[72:75], v1, s[4:7], s16 offen offset:2048 sc1
    buffer_load_dwordx4 a[76:79], v1, s[4:7], s16 offen offset:3072 sc1
    s_add_u32 s16, s16, 4096
    buffer_load_dwordx4 a[80:83], v1, s[4:7], s16 offen offset:0 sc1
    buffer_load_dwordx4 a[84:87], v1, s[4:7], s16 offen offset:1024 sc1
    buffer_load_dwordx4 a[88:91], v1, s[4:7], s16 offen offset:2048 sc1
    buffer_load_dwordx4 a[92:95], v1, s[4:7], s16 offen offset:3072 sc1
    s_cmp_ge_u32 s19, 128
    s_cbranch_scc1 L_a_chain_ok
    s_mov_b32 s26, 0
    v_mov_b32 v126, 0
L_pc_a2:
    buffer_load_dword v127, v126, s[4:7], s20 offen sc1
    s_add_u32 s26, s26, 1
    s_cmp_gt_u32 s26, 4194304
    s_cbranch_scc1 L_mega_end
    s_waitcnt vmcnt(0)
    v_readfirstlane_b32 s27, v127
    s_nop 0
    s_cmp_ge_u32 s27, 128
    s_cbranch_scc1 L_pc_done_a2
    s_sleep 1
    s_branch L_pc_a2
L_pc_done_a2:
L_a_chain_ok:
    s_lshl_b32 s15, s12, 5
    s_add_u32 s15, s15, s14
    s_add_u32 s15, s15, 0
    s_lshl_b32 s16, s15, 12
    s_add_u32 s16, s16, s43
    s_add_u32 s18, s16, 134217728
    s_add_u32 s16, s16, 125829120
    buffer_load_dwordx4 v[80:83], v1, s[4:7], s16 offen offset:0 sc1
    buffer_load_dwordx4 v[84:87], v1, s[4:7], s16 offen offset:1024 sc1
    buffer_load_dwordx4 v[88:91], v1, s[4:7], s16 offen offset:2048 sc1
    buffer_load_dwordx4 v[92:95], v1, s[4:7], s16 offen offset:3072 sc1
    buffer_load_dwordx2 v[128:129], v13, s[4:7], s18 offen offset:0 sc1
    buffer_load_dwordx2 v[130:131], v13, s[4:7], s18 offen offset:512 sc1
    buffer_load_dwordx2 v[132:133], v13, s[4:7], s18 offen offset:1024 sc1
    buffer_load_dwordx2 v[134:135], v13, s[4:7], s18 offen offset:1536 sc1
    buffer_load_dwordx2 v[136:137], v13, s[4:7], s18 offen offset:2048 sc1
    buffer_load_dwordx2 v[138:139], v13, s[4:7], s18 offen offset:2560 sc1
    buffer_load_dwordx2 v[140:141], v13, s[4:7], s18 offen offset:3072 sc1
    buffer_load_dwordx2 v[142:143], v13, s[4:7], s18 offen offset:3584 sc1
    s_lshl_b32 s15, s12, 5
    s_add_u32 s15, s15, s14
    s_add_u32 s15, s15, 1
    s_lshl_b32 s16, s15, 12
    s_add_u32 s16, s16, s43
    s_add_u32 s18, s16, 134217728
    s_add_u32 s16, s16, 125829120
    buffer_load_dwordx4 a[96:99], v1, s[4:7], s16 offen offset:0 sc1
    buffer_load_dwordx4 a[100:103], v1, s[4:7], s16 offen offset:1024 sc1
    buffer_load_dwordx4 a[104:107], v1, s[4:7], s16 offen offset:2048 sc1
    buffer_load_dwordx4 a[108:111], v1, s[4:7], s16 offen offset:3072 sc1
    buffer_load_dwordx2 a[112:113], v13, s[4:7], s18 offen offset:0 sc1
    buffer_load_dwordx2 a[114:115], v13, s[4:7], s18 offen offset:512 sc1
    buffer_load_dwordx2 a[116:117], v13, s[4:7], s18 offen offset:1024 sc1
    buffer_load_dwordx2 a[118:119], v13, s[4:7], s18 offen offset:1536 sc1
    buffer_load_dwordx2 a[120:121], v13, s[4:7], s18 offen offset:2048 sc1
    buffer_load_dwordx2 a[122:123], v13, s[4:7], s18 offen offset:2560 sc1
    buffer_load_dwordx2 a[124:125], v13, s[4:7], s18 offen offset:3072 sc1
    buffer_load_dwordx2 a[126:127], v13, s[4:7], s18 offen offset:3584 sc1
    s_mov_b32 s28, 1035273459
    s_mov_b32 s29, 1035273459
    s_mov_b32 s30, 1069066811
    s_mov_b32 s31, 3216550459
    v_and_b32 v15, 15, v14
    v_lshrrev_b32 v2, 2, v15
    v_and_b32 v3, 3, v15
    v_lshl_add_u32 v2, v2, 3, v3
    v_lshrrev_b32 v3, 4, v14
    v_lshlrev_b32 v3, 3, v3
    v_sub_u32 v2, v2, v3
    v_mov_b32 v175, 0xf149f2ca
    v_cmp_gt_u32 vcc, 32, v14
    s_nop 1
    v_cndmask_b32 v252, v175, 0, vcc
    v_mov_b32 v253, v252
    v_cmp_le_i32 vcc, 0, v2
    s_nop 1
    v_cndmask_b32 v244, v175, 0, vcc
    v_cmp_le_i32 vcc, 1, v2
    s_nop 1
    v_cndmask_b32 v245, v175, 0, vcc
    v_cmp_le_i32 vcc, 2, v2
    s_nop 1
    v_cndmask_b32 v246, v175, 0, vcc
    v_cmp_le_i32 vcc, 3, v2
    s_nop 1
    v_cndmask_b32 v247, v175, 0, vcc
    v_cmp_le_i32 vcc, 4, v2
    s_nop 1
    v_cndmask_b32 v248, v175, 0, vcc
    v_cmp_le_i32 vcc, 5, v2
    s_nop 1
    v_cndmask_b32 v249, v175, 0, vcc
    v_cmp_le_i32 vcc, 6, v2
    s_nop 1
    v_cndmask_b32 v250, v175, 0, vcc
    v_cmp_le_i32 vcc, 7, v2
    s_nop 1
    v_cndmask_b32 v251, v175, 0, vcc
    v_cmp_le_i32 vcc, -4, v2
    s_nop 1
    v_cndmask_b32 v8, v175, 0, vcc
    v_cmp_le_i32 vcc, -3, v2
    s_nop 1
    v_cndmask_b32 v9, v175, 0, vcc
    v_cmp_le_i32 vcc, -2, v2
    s_nop 1
    v_cndmask_b32 v10, v175, 0, vcc
    v_cmp_le_i32 vcc, -1, v2
    s_nop 1
    v_cndmask_b32 v11, v175, 0, vcc
    v_cmp_le_i32 vcc, 0, v2
    s_nop 1
    v_cndmask_b32 v12, v175, 0, vcc
    v_cmp_le_i32 vcc, 1, v2
    s_nop 1
    v_cndmask_b32 v13, v175, 0, vcc
    v_cmp_le_i32 vcc, 2, v2
    s_nop 1
    v_cndmask_b32 v14, v175, 0, vcc
    v_cmp_le_i32 vcc, 3, v2
    s_nop 1
    v_cndmask_b32 v15, v175, 0, vcc
    s_lshl_b32 s16, s40, 7
    s_lshl_b32 s17, s14, 2
    s_add_u32 s16, s16, s17
    s_lshl_b32 s16, s16, 2
    s_and_b32 s17, s12, 1
    s_lshl_b32 s17, s17, 1
    s_add_u32 s16, s16, s17
    s_lshl_b32 s16, s16, 10
    s_add_u32 s16, s16, s43
    s_add_u32 s16, s16, 100663296
    s_waitcnt vmcnt(20)
    v_mfma_f32_16x16x32_bf16 v[144:147], v[80:83], v[16:19], 0
    v_mfma_f32_16x16x32_bf16 v[148:151], v[48:51], v[16:19], 0
    v_mfma_f32_16x16x32_bf16 v[152:155], v[64:67], v[16:19], 0
    v_mfma_f32_16x16x32_bf16 v[144:147], v[84:87], v[20:23], v[144:147]
    v_mfma_f32_16x16x32_bf16 v[148:151], v[52:55], v[20:23], v[148:151]
    v_mfma_f32_16x16x32_bf16 v[152:155], v[68:71], v[20:23], v[152:155]
    v_mfma_f32_16x16x32_bf16 v[144:147], v[88:91], v[24:27], v[144:147]
    v_mfma_f32_16x16x32_bf16 v[148:151], v[56:59], v[24:27], v[148:151]
    v_mfma_f32_16x16x32_bf16 v[152:155], v[72:75], v[24:27], v[152:155]
    v_mfma_f32_16x16x32_bf16 v[144:147], v[92:95], v[28:31], v[144:147]
    v_mfma_f32_16x16x32_bf16 v[148:151], v[60:63], v[28:31], v[148:151]
    v_mfma_f32_16x16x32_bf16 v[152:155], v[76:79], v[28:31], v[152:155]
    v_mfma_f32_16x16x32_bf16 v[156:159], v[80:83], v[32:35], 0
    v_mfma_f32_16x16x32_bf16 v[160:163], v[48:51], v[32:35], 0
    v_mfma_f32_16x16x32_bf16 v[164:167], v[64:67], v[32:35], 0
    v_mfma_f32_16x16x32_bf16 v[156:159], v[84:87], v[36:39], v[156:159]
    v_mfma_f32_16x16x32_bf16 v[160:163], v[52:55], v[36:39], v[160:163]
    v_mfma_f32_16x16x32_bf16 v[164:167], v[68:71], v[36:39], v[164:167]
    v_mfma_f32_16x16x32_bf16 v[156:159], v[88:91], v[40:43], v[156:159]
    v_mfma_f32_16x16x32_bf16 v[160:163], v[56:59], v[40:43], v[160:163]
    v_mfma_f32_16x16x32_bf16 v[164:167], v[72:75], v[40:43], v[164:167]
    v_mfma_f32_16x16x32_bf16 v[156:159], v[92:95], v[44:47], v[156:159]
    v_mfma_f32_16x16x32_bf16 v[160:163], v[60:63], v[44:47], v[160:163]
    v_mfma_f32_16x16x32_bf16 v[164:167], v[76:79], v[44:47], v[164:167]
    s_waitcnt vmcnt(12)
    v_cvt_pk_bf16_f32 v168, v144, v145
    v_cvt_pk_bf16_f32 v169, v146, v147
    v_cvt_pk_bf16_f32 v170, v148, v149
    v_cvt_pk_bf16_f32 v171, v150, v151
    v_cvt_pk_bf16_f32 v172, v152, v153
    v_cvt_pk_bf16_f32 v173, v154, v155
    v_lshlrev_b32 v144, 16, v168
    v_and_b32 v145, 0xffff0000, v168
    v_lshlrev_b32 v146, 16, v169
    v_and_b32 v147, 0xffff0000, v169
    v_lshlrev_b32 v148, 16, v170
    v_and_b32 v149, 0xffff0000, v170
    v_lshlrev_b32 v150, 16, v171
    v_and_b32 v151, 0xffff0000, v171
    v_lshlrev_b32 v152, 16, v172
    v_and_b32 v153, 0xffff0000, v172
    v_lshlrev_b32 v154, 16, v173
    v_and_b32 v155, 0xffff0000, v173
    v_pk_mul_f32 v[144:145], v[144:145], s[28:29]
    v_pk_mul_f32 v[146:147], v[146:147], s[28:29]
    v_pk_mul_f32 v[148:149], v[148:149], s[28:29]
    v_pk_mul_f32 v[150:151], v[150:151], s[28:29]
    v_pk_mul_f32 v[152:153], v[152:153], s[28:29]
    v_pk_mul_f32 v[154:155], v[154:155], s[28:29]
    v_cvt_pk_bf16_f32 v168, v144, v145
    v_cvt_pk_bf16_f32 v169, v146, v147
    v_cvt_pk_bf16_f32 v170, v148, v149
    v_cvt_pk_bf16_f32 v171, v150, v151
    v_cvt_pk_bf16_f32 v172, v152, v153
    v_cvt_pk_bf16_f32 v173, v154, v155
    v_lshlrev_b32 v144, 16, v168
    v_and_b32 v145, 0xffff0000, v168
    v_lshlrev_b32 v146, 16, v169
    v_and_b32 v147, 0xffff0000, v169
    v_lshlrev_b32 v148, 16, v170
    v_and_b32 v149, 0xffff0000, v170
    v_lshlrev_b32 v150, 16, v171
    v_and_b32 v151, 0xffff0000, v171
    v_lshlrev_b32 v152, 16, v172
    v_and_b32 v153, 0xffff0000, v172
    v_lshlrev_b32 v154, 16, v173
    v_and_b32 v155, 0xffff0000, v173
    v_pk_add_f32 v[144:145], v[144:145], v[252:253]
    v_pk_add_f32 v[146:147], v[146:147], v[252:253]
    v_pk_add_f32 v[148:149], v[148:149], v[244:245]
    v_pk_add_f32 v[150:151], v[150:151], v[246:247]
    v_pk_add_f32 v[152:153], v[152:153], v[248:249]
    v_pk_add_f32 v[154:155], v[154:155], v[250:251]
    v_max3_f32 v172, v144, v145, v146
    v_max3_f32 v173, v147, v148, v149
    v_max3_f32 v172, v172, v150, v151
    v_max3_f32 v173, v173, v152, v153
    v_max3_f32 v172, v172, v154, v155
    v_max_f32 v172, v172, v173
    v_mov_b32 v173, v172
    s_nop 1
    v_permlane16_swap_b32 v172, v173
    v_max_f32 v172, v172, v173
    v_mov_b32 v173, v172
    s_nop 1
    v_permlane32_swap_b32 v172, v173
    v_max_f32 v172, v172, v173
    v_mul_f32 v172, s31, v172
    v_fma_f32 v144, v144, s30, v172
    v_fma_f32 v145, v145, s30, v172
    v_fma_f32 v146, v146, s30, v172
    v_fma_f32 v147, v147, s30, v172
    v_fma_f32 v148, v148, s30, v172
    v_fma_f32 v149, v149, s30, v172
    v_fma_f32 v150, v150, s30, v172
    v_fma_f32 v151, v151, s30, v172
    v_fma_f32 v152, v152, s30, v172
    v_fma_f32 v153, v153, s30, v172
    v_fma_f32 v154, v154, s30, v172
    v_fma_f32 v155, v155, s30, v172
    v_exp_f32 v144, v144
    v_exp_f32 v145, v145
    v_exp_f32 v146, v146
    v_exp_f32 v147, v147
    v_exp_f32 v148, v148
    v_exp_f32 v149, v149
    v_exp_f32 v150, v150
    v_exp_f32 v151, v151
    v_exp_f32 v152, v152
    v_exp_f32 v153, v153
    v_exp_f32 v154, v154
    v_exp_f32 v155, v155
    v_pk_add_f32 v[168:169], v[144:145], v[146:147]
    v_pk_add_f32 v[170:171], v[148:149], v[150:151]
    v_pk_add_f32 v[172:173], v[152:153], v[154:155]
    v_pk_add_f32 v[168:169], v[168:169], v[170:171]
    v_pk_add_f32 v[168:169], v[168:169], v[172:173]
    v_add_f32 v172, v168, v169
    v_mov_b32 v173, v172
    s_nop 1
    v_permlane16_swap_b32 v172, v173
    v_add_f32 v172, v172, v173
    v_mov_b32 v173, v172
    s_nop 1
    v_permlane32_swap_b32 v172, v173
    v_add_f32 v172, v172, v173
    v_rcp_f32 v172, v172
    s_nop 0
    v_mov_b32 v173, v172
    v_pk_mul_f32 v[144:145], v[144:145], v[172:173]
    v_pk_mul_f32 v[146:147], v[146:147], v[172:173]
    v_pk_mul_f32 v[148:149], v[148:149], v[172:173]
    v_pk_mul_f32 v[150:151], v[150:151], v[172:173]
    v_pk_mul_f32 v[152:153], v[152:153], v[172:173]
    v_pk_mul_f32 v[154:155], v[154:155], v[172:173]
    v_cvt_pk_bf16_f32 v170, v144, v145
    v_cvt_pk_bf16_f32 v171, v146, v147
    v_cvt_pk_bf16_f32 v4, v148, v149
    v_cvt_pk_bf16_f32 v5, v150, v151
    v_cvt_pk_bf16_f32 v6, v152, v153
    v_cvt_pk_bf16_f32 v7, v154, v155
    s_nop 1
    v_mfma_f32_16x16x32_bf16 v[176:179], v[96:99], v[4:7], 0
    v_mfma_f32_16x16x32_bf16 v[180:183], v[100:103], v[4:7], 0
    v_mfma_f32_16x16x32_bf16 v[184:187], v[104:107], v[4:7], 0
    v_mfma_f32_16x16x32_bf16 v[188:191], v[108:111], v[4:7], 0
    v_mfma_f32_16x16x32_bf16 v[192:195], v[112:115], v[4:7], 0
    v_mfma_f32_16x16x32_bf16 v[196:199], v[116:119], v[4:7], 0
    v_mfma_f32_16x16x32_bf16 v[200:203], v[120:123], v[4:7], 0
    v_mfma_f32_16x16x32_bf16 v[204:207], v[240:243], v[4:7], 0
    v_mfma_f32_16x16x16_bf16 v[176:179], v[128:129], v[170:171], v[176:179]
    v_mfma_f32_16x16x16_bf16 v[180:183], v[130:131], v[170:171], v[180:183]
    v_mfma_f32_16x16x16_bf16 v[184:187], v[132:133], v[170:171], v[184:187]
    v_mfma_f32_16x16x16_bf16 v[188:191], v[134:135], v[170:171], v[188:191]
    v_mfma_f32_16x16x16_bf16 v[192:195], v[136:137], v[170:171], v[192:195]
    v_mfma_f32_16x16x16_bf16 v[196:199], v[138:139], v[170:171], v[196:199]
    v_mfma_f32_16x16x16_bf16 v[200:203], v[140:141], v[170:171], v[200:203]
    v_mfma_f32_16x16x16_bf16 v[204:207], v[142:143], v[170:171], v[204:207]
    s_nop 0
    v_cvt_pk_bf16_f32 v208, v176, v177
    v_cvt_pk_bf16_f32 v209, v178, v179
    v_cvt_pk_bf16_f32 v210, v180, v181
    v_cvt_pk_bf16_f32 v211, v182, v183
    s_add_u32 s17, s16, 0
    buffer_store_dwordx4 v[208:211], v1, s[4:7], s17 offen sc1
    v_cvt_pk_bf16_f32 v212, v184, v185
    v_cvt_pk_bf16_f32 v213, v186, v187
    v_cvt_pk_bf16_f32 v214, v188, v189
    v_cvt_pk_bf16_f32 v215, v190, v191
    s_add_u32 s17, s16, 4096
    buffer_store_dwordx4 v[212:215], v1, s[4:7], s17 offen sc1
    v_cvt_pk_bf16_f32 v216, v192, v193
    v_cvt_pk_bf16_f32 v217, v194, v195
    v_cvt_pk_bf16_f32 v218, v196, v197
    v_cvt_pk_bf16_f32 v219, v198, v199
    s_add_u32 s17, s16, 8192
    buffer_store_dwordx4 v[216:219], v1, s[4:7], s17 offen sc1
    v_cvt_pk_bf16_f32 v220, v200, v201
    v_cvt_pk_bf16_f32 v221, v202, v203
    v_cvt_pk_bf16_f32 v222, v204, v205
    v_cvt_pk_bf16_f32 v223, v206, v207
    s_add_u32 s17, s16, 12288
    buffer_store_dwordx4 v[220:223], v1, s[4:7], s17 offen sc1
    v_cvt_pk_bf16_f32 v168, v156, v157
    v_cvt_pk_bf16_f32 v169, v158, v159
    v_cvt_pk_bf16_f32 v170, v160, v161
    v_cvt_pk_bf16_f32 v171, v162, v163
    v_cvt_pk_bf16_f32 v172, v164, v165
    v_cvt_pk_bf16_f32 v173, v166, v167
    v_lshlrev_b32 v156, 16, v168
    v_and_b32 v157, 0xffff0000, v168
    v_lshlrev_b32 v158, 16, v169
    v_and_b32 v159, 0xffff0000, v169
    v_lshlrev_b32 v160, 16, v170
    v_and_b32 v161, 0xffff0000, v170
    v_lshlrev_b32 v162, 16, v171
    v_and_b32 v163, 0xffff0000, v171
    v_lshlrev_b32 v164, 16, v172
    v_and_b32 v165, 0xffff0000, v172
    v_lshlrev_b32 v166, 16, v173
    v_and_b32 v167, 0xffff0000, v173
    v_pk_mul_f32 v[156:157], v[156:157], s[28:29]
    v_pk_mul_f32 v[158:159], v[158:159], s[28:29]
    v_pk_mul_f32 v[160:161], v[160:161], s[28:29]
    v_pk_mul_f32 v[162:163], v[162:163], s[28:29]
    v_pk_mul_f32 v[164:165], v[164:165], s[28:29]
    v_pk_mul_f32 v[166:167], v[166:167], s[28:29]
    v_cvt_pk_bf16_f32 v168, v156, v157
    v_cvt_pk_bf16_f32 v169, v158, v159
    v_cvt_pk_bf16_f32 v170, v160, v161
    v_cvt_pk_bf16_f32 v171, v162, v163
    v_cvt_pk_bf16_f32 v172, v164, v165
    v_cvt_pk_bf16_f32 v173, v166, v167
    v_lshlrev_b32 v156, 16, v168
    v_and_b32 v157, 0xffff0000, v168
    v_lshlrev_b32 v158, 16, v169
    v_and_b32 v159, 0xffff0000, v169
    v_lshlrev_b32 v160, 16, v170
    v_and_b32 v161, 0xffff0000, v170
    v_lshlrev_b32 v162, 16, v171
    v_and_b32 v163, 0xffff0000, v171
    v_lshlrev_b32 v164, 16, v172
    v_and_b32 v165, 0xffff0000, v172
    v_lshlrev_b32 v166, 16, v173
    v_and_b32 v167, 0xffff0000, v173
    v_pk_add_f32 v[156:157], v[156:157], v[252:253]
    v_pk_add_f32 v[158:159], v[158:159], v[252:253]
    v_pk_add_f32 v[160:161], v[160:161], v[8:9]
    v_pk_add_f32 v[162:163], v[162:163], v[10:11]
    v_pk_add_f32 v[164:165], v[164:165], v[12:13]
    v_pk_add_f32 v[166:167], v[166:167], v[14:15]
    v_max3_f32 v172, v156, v157, v158
    v_max3_f32 v173, v159, v160, v161
    v_max3_f32 v172, v172, v162, v163
    v_max3_f32 v173, v173, v164, v165
    v_max3_f32 v172, v172, v166, v167
    v_max_f32 v172, v172, v173
    v_mov_b32 v173, v172
    s_nop 1
    v_permlane16_swap_b32 v172, v173
    v_max_f32 v172, v172, v173
    v_mov_b32 v173, v172
    s_nop 1
    v_permlane32_swap_b32 v172, v173
    v_max_f32 v172, v172, v173
    v_mul_f32 v172, s31, v172
    v_fma_f32 v156, v156, s30, v172
    v_fma_f32 v157, v157, s30, v172
    v_fma_f32 v158, v158, s30, v172
    v_fma_f32 v159, v159, s30, v172
    v_fma_f32 v160, v160, s30, v172
    v_fma_f32 v161, v161, s30, v172
    v_fma_f32 v162, v162, s30, v172
    v_fma_f32 v163, v163, s30, v172
    v_fma_f32 v164, v164, s30, v172
    v_fma_f32 v165, v165, s30, v172
    v_fma_f32 v166, v166, s30, v172
    v_fma_f32 v167, v167, s30, v172
    v_exp_f32 v156, v156
    v_exp_f32 v157, v157
    v_exp_f32 v158, v158
    v_exp_f32 v159, v159
    v_exp_f32 v160, v160
    v_exp_f32 v161, v161
    v_exp_f32 v162, v162
    v_exp_f32 v163, v163
    v_exp_f32 v164, v164
    v_exp_f32 v165, v165
    v_exp_f32 v166, v166
    v_exp_f32 v167, v167
    v_pk_add_f32 v[168:169], v[156:157], v[158:159]
    v_pk_add_f32 v[170:171], v[160:161], v[162:163]
    v_pk_add_f32 v[172:173], v[164:165], v[166:167]
    v_pk_add_f32 v[168:169], v[168:169], v[170:171]
    v_pk_add_f32 v[168:169], v[168:169], v[172:173]
    v_add_f32 v172, v168, v169
    v_mov_b32 v173, v172
    s_nop 1
    v_permlane16_swap_b32 v172, v173
    v_add_f32 v172, v172, v173
    v_mov_b32 v173, v172
    s_nop 1
    v_permlane32_swap_b32 v172, v173
    v_add_f32 v172, v172, v173
    v_rcp_f32 v172, v172
    s_nop 0
    v_mov_b32 v173, v172
    v_pk_mul_f32 v[156:157], v[156:157], v[172:173]
    v_pk_mul_f32 v[158:159], v[158:159], v[172:173]
    v_pk_mul_f32 v[160:161], v[160:161], v[172:173]
    v_pk_mul_f32 v[162:163], v[162:163], v[172:173]
    v_pk_mul_f32 v[164:165], v[164:165], v[172:173]
    v_pk_mul_f32 v[166:167], v[166:167], v[172:173]
    v_cvt_pk_bf16_f32 v170, v156, v157
    v_cvt_pk_bf16_f32 v171, v158, v159
    v_cvt_pk_bf16_f32 v4, v160, v161
    v_cvt_pk_bf16_f32 v5, v162, v163
    v_cvt_pk_bf16_f32 v6, v164, v165
    v_cvt_pk_bf16_f32 v7, v166, v167
    s_nop 1
    v_mfma_f32_16x16x32_bf16 v[176:179], v[96:99], v[4:7], 0
    v_mfma_f32_16x16x32_bf16 v[180:183], v[100:103], v[4:7], 0
    v_mfma_f32_16x16x32_bf16 v[184:187], v[104:107], v[4:7], 0
    v_mfma_f32_16x16x32_bf16 v[188:191], v[108:111], v[4:7], 0
    v_mfma_f32_16x16x32_bf16 v[192:195], v[112:115], v[4:7], 0
    v_mfma_f32_16x16x32_bf16 v[196:199], v[116:119], v[4:7], 0
    v_mfma_f32_16x16x32_bf16 v[200:203], v[120:123], v[4:7], 0
    v_mfma_f32_16x16x32_bf16 v[204:207], v[240:243], v[4:7], 0
    v_mfma_f32_16x16x16_bf16 v[176:179], v[128:129], v[170:171], v[176:179]
    v_mfma_f32_16x16x16_bf16 v[180:183], v[130:131], v[170:171], v[180:183]
    v_mfma_f32_16x16x16_bf16 v[184:187], v[132:133], v[170:171], v[184:187]
    v_mfma_f32_16x16x16_bf16 v[188:191], v[134:135], v[170:171], v[188:191]
    v_mfma_f32_16x16x16_bf16 v[192:195], v[136:137], v[170:171], v[192:195]
    v_mfma_f32_16x16x16_bf16 v[196:199], v[138:139], v[170:171], v[196:199]
    v_mfma_f32_16x16x16_bf16 v[200:203], v[140:141], v[170:171], v[200:203]
    v_mfma_f32_16x16x16_bf16 v[204:207], v[142:143], v[170:171], v[204:207]
    s_nop 0
    v_cvt_pk_bf16_f32 v224, v176, v177
    v_cvt_pk_bf16_f32 v225, v178, v179
    v_cvt_pk_bf16_f32 v226, v180, v181
    v_cvt_pk_bf16_f32 v227, v182, v183
    s_add_u32 s17, s16, 1024
    buffer_store_dwordx4 v[224:227], v1, s[4:7], s17 offen sc1
    v_cvt_pk_bf16_f32 v228, v184, v185
    v_cvt_pk_bf16_f32 v229, v186, v187
    v_cvt_pk_bf16_f32 v230, v188, v189
    v_cvt_pk_bf16_f32 v231, v190, v191
    s_add_u32 s17, s16, 5120
    buffer_store_dwordx4 v[228:231], v1, s[4:7], s17 offen sc1
    v_cvt_pk_bf16_f32 v232, v192, v193
    v_cvt_pk_bf16_f32 v233, v194, v195
    v_cvt_pk_bf16_f32 v234, v196, v197
    v_cvt_pk_bf16_f32 v235, v198, v199
    s_add_u32 s17, s16, 9216
    buffer_store_dwordx4 v[232:235], v1, s[4:7], s17 offen sc1
    v_cvt_pk_bf16_f32 v236, v200, v201
    v_cvt_pk_bf16_f32 v237, v202, v203
    v_cvt_pk_bf16_f32 v238, v204, v205
    v_cvt_pk_bf16_f32 v239, v206, v207
    s_add_u32 s17, s16, 13312
    buffer_store_dwordx4 v[236:239], v1, s[4:7], s17 offen sc1
    s_waitcnt vmcnt(16)
    v_mfma_f32_16x16x32_bf16 v[144:147], a[96:99], a[0:3], 0
    v_mfma_f32_16x16x32_bf16 v[148:151], a[32:35], a[0:3], 0
    v_mfma_f32_16x16x32_bf16 v[152:155], a[48:51], a[0:3], 0
    v_mfma_f32_16x16x32_bf16 v[144:147], a[100:103], a[4:7], v[144:147]
    v_mfma_f32_16x16x32_bf16 v[148:151], a[36:39], a[4:7], v[148:151]
    v_mfma_f32_16x16x32_bf16 v[152:155], a[52:55], a[4:7], v[152:155]
    v_mfma_f32_16x16x32_bf16 v[144:147], a[104:107], a[8:11], v[144:147]
    v_mfma_f32_16x16x32_bf16 v[148:151], a[40:43], a[8:11], v[148:151]
    v_mfma_f32_16x16x32_bf16 v[152:155], a[56:59], a[8:11], v[152:155]
    v_mfma_f32_16x16x32_bf16 v[144:147], a[108:111], a[12:15], v[144:147]
    v_mfma_f32_16x16x32_bf16 v[148:151], a[44:47], a[12:15], v[148:151]
    v_mfma_f32_16x16x32_bf16 v[152:155], a[60:63], a[12:15], v[152:155]
    v_mfma_f32_16x16x32_bf16 v[156:159], a[96:99], a[16:19], 0
    v_mfma_f32_16x16x32_bf16 v[160:163], a[32:35], a[16:19], 0
    v_mfma_f32_16x16x32_bf16 v[164:167], a[48:51], a[16:19], 0
    v_mfma_f32_16x16x32_bf16 v[156:159], a[100:103], a[20:23], v[156:159]
    v_mfma_f32_16x16x32_bf16 v[160:163], a[36:39], a[20:23], v[160:163]
    v_mfma_f32_16x16x32_bf16 v[164:167], a[52:55], a[20:23], v[164:167]
    v_mfma_f32_16x16x32_bf16 v[156:159], a[104:107], a[24:27], v[156:159]
    v_mfma_f32_16x16x32_bf16 v[160:163], a[40:43], a[24:27], v[160:163]
    v_mfma_f32_16x16x32_bf16 v[164:167], a[56:59], a[24:27], v[164:167]
    v_mfma_f32_16x16x32_bf16 v[156:159], a[108:111], a[28:31], v[156:159]
    v_mfma_f32_16x16x32_bf16 v[160:163], a[44:47], a[28:31], v[160:163]
    v_mfma_f32_16x16x32_bf16 v[164:167], a[60:63], a[28:31], v[164:167]
    s_waitcnt vmcnt(8)
    v_cvt_pk_bf16_f32 v168, v144, v145
    v_cvt_pk_bf16_f32 v169, v146, v147
    v_cvt_pk_bf16_f32 v170, v148, v149
    v_cvt_pk_bf16_f32 v171, v150, v151
    v_cvt_pk_bf16_f32 v172, v152, v153
    v_cvt_pk_bf16_f32 v173, v154, v155
    v_lshlrev_b32 v144, 16, v168
    v_and_b32 v145, 0xffff0000, v168
    v_lshlrev_b32 v146, 16, v169
    v_and_b32 v147, 0xffff0000, v169
    v_lshlrev_b32 v148, 16, v170
    v_and_b32 v149, 0xffff0000, v170
    v_lshlrev_b32 v150, 16, v171
    v_and_b32 v151, 0xffff0000, v171
    v_lshlrev_b32 v152, 16, v172
    v_and_b32 v153, 0xffff0000, v172
    v_lshlrev_b32 v154, 16, v173
    v_and_b32 v155, 0xffff0000, v173
    v_pk_mul_f32 v[144:145], v[144:145], s[28:29]
    v_pk_mul_f32 v[146:147], v[146:147], s[28:29]
    v_pk_mul_f32 v[148:149], v[148:149], s[28:29]
    v_pk_mul_f32 v[150:151], v[150:151], s[28:29]
    v_pk_mul_f32 v[152:153], v[152:153], s[28:29]
    v_pk_mul_f32 v[154:155], v[154:155], s[28:29]
    v_cvt_pk_bf16_f32 v168, v144, v145
    v_cvt_pk_bf16_f32 v169, v146, v147
    v_cvt_pk_bf16_f32 v170, v148, v149
    v_cvt_pk_bf16_f32 v171, v150, v151
    v_cvt_pk_bf16_f32 v172, v152, v153
    v_cvt_pk_bf16_f32 v173, v154, v155
    v_lshlrev_b32 v144, 16, v168
    v_and_b32 v145, 0xffff0000, v168
    v_lshlrev_b32 v146, 16, v169
    v_and_b32 v147, 0xffff0000, v169
    v_lshlrev_b32 v148, 16, v170
    v_and_b32 v149, 0xffff0000, v170
    v_lshlrev_b32 v150, 16, v171
    v_and_b32 v151, 0xffff0000, v171
    v_lshlrev_b32 v152, 16, v172
    v_and_b32 v153, 0xffff0000, v172
    v_lshlrev_b32 v154, 16, v173
    v_and_b32 v155, 0xffff0000, v173
    v_pk_add_f32 v[144:145], v[144:145], v[252:253]
    v_pk_add_f32 v[146:147], v[146:147], v[252:253]
    v_pk_add_f32 v[148:149], v[148:149], v[244:245]
    v_pk_add_f32 v[150:151], v[150:151], v[246:247]
    v_pk_add_f32 v[152:153], v[152:153], v[248:249]
    v_pk_add_f32 v[154:155], v[154:155], v[250:251]
    v_max3_f32 v172, v144, v145, v146
    v_max3_f32 v173, v147, v148, v149
    v_max3_f32 v172, v172, v150, v151
    v_max3_f32 v173, v173, v152, v153
    v_max3_f32 v172, v172, v154, v155
    v_max_f32 v172, v172, v173
    v_mov_b32 v173, v172
    s_nop 1
    v_permlane16_swap_b32 v172, v173
    v_max_f32 v172, v172, v173
    v_mov_b32 v173, v172
    s_nop 1
    v_permlane32_swap_b32 v172, v173
    v_max_f32 v172, v172, v173
    v_mul_f32 v172, s31, v172
    v_fma_f32 v144, v144, s30, v172
    v_fma_f32 v145, v145, s30, v172
    v_fma_f32 v146, v146, s30, v172
    v_fma_f32 v147, v147, s30, v172
    v_fma_f32 v148, v148, s30, v172
    v_fma_f32 v149, v149, s30, v172
    v_fma_f32 v150, v150, s30, v172
    v_fma_f32 v151, v151, s30, v172
    v_fma_f32 v152, v152, s30, v172
    v_fma_f32 v153, v153, s30, v172
    v_fma_f32 v154, v154, s30, v172
    v_fma_f32 v155, v155, s30, v172
    v_exp_f32 v144, v144
    v_exp_f32 v145, v145
    v_exp_f32 v146, v146
    v_exp_f32 v147, v147
    v_exp_f32 v148, v148
    v_exp_f32 v149, v149
    v_exp_f32 v150, v150
    v_exp_f32 v151, v151
    v_exp_f32 v152, v152
    v_exp_f32 v153, v153
    v_exp_f32 v154, v154
    v_exp_f32 v155, v155
    v_pk_add_f32 v[168:169], v[144:145], v[146:147]
    v_pk_add_f32 v[170:171], v[148:149], v[150:151]
    v_pk_add_f32 v[172:173], v[152:153], v[154:155]
    v_pk_add_f32 v[168:169], v[168:169], v[170:171]
    v_pk_add_f32 v[168:169], v[168:169], v[172:173]
    v_add_f32 v172, v168, v169
    v_mov_b32 v173, v172
    s_nop 1
    v_permlane16_swap_b32 v172, v173
    v_add_f32 v172, v172, v173
    v_mov_b32 v173, v172
    s_nop 1
    v_permlane32_swap_b32 v172, v173
    v_add_f32 v172, v172, v173
    v_rcp_f32 v172, v172
    s_nop 0
    v_mov_b32 v173, v172
    v_pk_mul_f32 v[144:145], v[144:145], v[172:173]
    v_pk_mul_f32 v[146:147], v[146:147], v[172:173]
    v_pk_mul_f32 v[148:149], v[148:149], v[172:173]
    v_pk_mul_f32 v[150:151], v[150:151], v[172:173]
    v_pk_mul_f32 v[152:153], v[152:153], v[172:173]
    v_pk_mul_f32 v[154:155], v[154:155], v[172:173]
    v_cvt_pk_bf16_f32 v170, v144, v145
    v_cvt_pk_bf16_f32 v171, v146, v147
    v_cvt_pk_bf16_f32 v4, v148, v149
    v_cvt_pk_bf16_f32 v5, v150, v151
    v_cvt_pk_bf16_f32 v6, v152, v153
    v_cvt_pk_bf16_f32 v7, v154, v155
    s_nop 1
    v_mfma_f32_16x16x32_bf16 v[176:179], a[64:67], v[4:7], 0
    v_mfma_f32_16x16x32_bf16 v[180:183], a[68:71], v[4:7], 0
    v_mfma_f32_16x16x32_bf16 v[184:187], a[72:75], v[4:7], 0
    v_mfma_f32_16x16x32_bf16 v[188:191], a[76:79], v[4:7], 0
    v_mfma_f32_16x16x32_bf16 v[192:195], a[80:83], v[4:7], 0
    v_mfma_f32_16x16x32_bf16 v[196:199], a[84:87], v[4:7], 0
    v_mfma_f32_16x16x32_bf16 v[200:203], a[88:91], v[4:7], 0
    v_mfma_f32_16x16x32_bf16 v[204:207], a[92:95], v[4:7], 0
    v_mfma_f32_16x16x16_bf16 v[176:179], a[112:113], v[170:171], v[176:179]
    v_mfma_f32_16x16x16_bf16 v[180:183], a[114:115], v[170:171], v[180:183]
    v_mfma_f32_16x16x16_bf16 v[184:187], a[116:117], v[170:171], v[184:187]
    v_mfma_f32_16x16x16_bf16 v[188:191], a[118:119], v[170:171], v[188:191]
    v_mfma_f32_16x16x16_bf16 v[192:195], a[120:121], v[170:171], v[192:195]
    v_mfma_f32_16x16x16_bf16 v[196:199], a[122:123], v[170:171], v[196:199]
    v_mfma_f32_16x16x16_bf16 v[200:203], a[124:125], v[170:171], v[200:203]
    v_mfma_f32_16x16x16_bf16 v[204:207], a[126:127], v[170:171], v[204:207]
    s_nop 0
    v_cvt_pk_bf16_f32 v208, v176, v177
    v_cvt_pk_bf16_f32 v209, v178, v179
    v_cvt_pk_bf16_f32 v210, v180, v181
    v_cvt_pk_bf16_f32 v211, v182, v183
    s_add_u32 s17, s16, 16384
    buffer_store_dwordx4 v[208:211], v1, s[4:7], s17 offen sc1
    v_cvt_pk_bf16_f32 v212, v184, v185
    v_cvt_pk_bf16_f32 v213, v186, v187
    v_cvt_pk_bf16_f32 v214, v188, v189
    v_cvt_pk_bf16_f32 v215, v190, v191
    s_add_u32 s17, s16, 20480
    buffer_store_dwordx4 v[212:215], v1, s[4:7], s17 offen sc1
    v_cvt_pk_bf16_f32 v216, v192, v193
    v_cvt_pk_bf16_f32 v217, v194, v195
    v_cvt_pk_bf16_f32 v218, v196, v197
    v_cvt_pk_bf16_f32 v219, v198, v199
    s_add_u32 s17, s16, 24576
    buffer_store_dwordx4 v[216:219], v1, s[4:7], s17 offen sc1
    v_cvt_pk_bf16_f32 v220, v200, v201
    v_cvt_pk_bf16_f32 v221, v202, v203
    v_cvt_pk_bf16_f32 v222, v204, v205
    v_cvt_pk_bf16_f32 v223, v206, v207
    s_add_u32 s17, s16, 28672
    buffer_store_dwordx4 v[220:223], v1, s[4:7], s17 offen sc1
    v_cvt_pk_bf16_f32 v168, v156, v157
    v_cvt_pk_bf16_f32 v169, v158, v159
    v_cvt_pk_bf16_f32 v170, v160, v161
    v_cvt_pk_bf16_f32 v171, v162, v163
    v_cvt_pk_bf16_f32 v172, v164, v165
    v_cvt_pk_bf16_f32 v173, v166, v167
    v_lshlrev_b32 v156, 16, v168
    v_and_b32 v157, 0xffff0000, v168
    v_lshlrev_b32 v158, 16, v169
    v_and_b32 v159, 0xffff0000, v169
    v_lshlrev_b32 v160, 16, v170
    v_and_b32 v161, 0xffff0000, v170
    v_lshlrev_b32 v162, 16, v171
    v_and_b32 v163, 0xffff0000, v171
    v_lshlrev_b32 v164, 16, v172
    v_and_b32 v165, 0xffff0000, v172
    v_lshlrev_b32 v166, 16, v173
    v_and_b32 v167, 0xffff0000, v173
    v_pk_mul_f32 v[156:157], v[156:157], s[28:29]
    v_pk_mul_f32 v[158:159], v[158:159], s[28:29]
    v_pk_mul_f32 v[160:161], v[160:161], s[28:29]
    v_pk_mul_f32 v[162:163], v[162:163], s[28:29]
    v_pk_mul_f32 v[164:165], v[164:165], s[28:29]
    v_pk_mul_f32 v[166:167], v[166:167], s[28:29]
    v_cvt_pk_bf16_f32 v168, v156, v157
    v_cvt_pk_bf16_f32 v169, v158, v159
    v_cvt_pk_bf16_f32 v170, v160, v161
    v_cvt_pk_bf16_f32 v171, v162, v163
    v_cvt_pk_bf16_f32 v172, v164, v165
    v_cvt_pk_bf16_f32 v173, v166, v167
    v_lshlrev_b32 v156, 16, v168
    v_and_b32 v157, 0xffff0000, v168
    v_lshlrev_b32 v158, 16, v169
    v_and_b32 v159, 0xffff0000, v169
    v_lshlrev_b32 v160, 16, v170
    v_and_b32 v161, 0xffff0000, v170
    v_lshlrev_b32 v162, 16, v171
    v_and_b32 v163, 0xffff0000, v171
    v_lshlrev_b32 v164, 16, v172
    v_and_b32 v165, 0xffff0000, v172
    v_lshlrev_b32 v166, 16, v173
    v_and_b32 v167, 0xffff0000, v173
    v_pk_add_f32 v[156:157], v[156:157], v[252:253]
    v_pk_add_f32 v[158:159], v[158:159], v[252:253]
    v_pk_add_f32 v[160:161], v[160:161], v[8:9]
    v_pk_add_f32 v[162:163], v[162:163], v[10:11]
    v_pk_add_f32 v[164:165], v[164:165], v[12:13]
    v_pk_add_f32 v[166:167], v[166:167], v[14:15]
    v_max3_f32 v172, v156, v157, v158
    v_max3_f32 v173, v159, v160, v161
    v_max3_f32 v172, v172, v162, v163
    v_max3_f32 v173, v173, v164, v165
    v_max3_f32 v172, v172, v166, v167
    v_max_f32 v172, v172, v173
    v_mov_b32 v173, v172
    s_nop 1
    v_permlane16_swap_b32 v172, v173
    v_max_f32 v172, v172, v173
    v_mov_b32 v173, v172
    s_nop 1
    v_permlane32_swap_b32 v172, v173
    v_max_f32 v172, v172, v173
    v_mul_f32 v172, s31, v172
    v_fma_f32 v156, v156, s30, v172
    v_fma_f32 v157, v157, s30, v172
    v_fma_f32 v158, v158, s30, v172
    v_fma_f32 v159, v159, s30, v172
    v_fma_f32 v160, v160, s30, v172
    v_fma_f32 v161, v161, s30, v172
    v_fma_f32 v162, v162, s30, v172
    v_fma_f32 v163, v163, s30, v172
    v_fma_f32 v164, v164, s30, v172
    v_fma_f32 v165, v165, s30, v172
    v_fma_f32 v166, v166, s30, v172
    v_fma_f32 v167, v167, s30, v172
    v_exp_f32 v156, v156
    v_exp_f32 v157, v157
    v_exp_f32 v158, v158
    v_exp_f32 v159, v159
    v_exp_f32 v160, v160
    v_exp_f32 v161, v161
    v_exp_f32 v162, v162
    v_exp_f32 v163, v163
    v_exp_f32 v164, v164
    v_exp_f32 v165, v165
    v_exp_f32 v166, v166
    v_exp_f32 v167, v167
    v_pk_add_f32 v[168:169], v[156:157], v[158:159]
    v_pk_add_f32 v[170:171], v[160:161], v[162:163]
    v_pk_add_f32 v[172:173], v[164:165], v[166:167]
    v_pk_add_f32 v[168:169], v[168:169], v[170:171]
    v_pk_add_f32 v[168:169], v[168:169], v[172:173]
    v_add_f32 v172, v168, v169
    v_mov_b32 v173, v172
    s_nop 1
    v_permlane16_swap_b32 v172, v173
    v_add_f32 v172, v172, v173
    v_mov_b32 v173, v172
    s_nop 1
    v_permlane32_swap_b32 v172, v173
    v_add_f32 v172, v172, v173
    v_rcp_f32 v172, v172
    s_nop 0
    v_mov_b32 v173, v172
    v_pk_mul_f32 v[156:157], v[156:157], v[172:173]
    v_pk_mul_f32 v[158:159], v[158:159], v[172:173]
    v_pk_mul_f32 v[160:161], v[160:161], v[172:173]
    v_pk_mul_f32 v[162:163], v[162:163], v[172:173]
    v_pk_mul_f32 v[164:165], v[164:165], v[172:173]
    v_pk_mul_f32 v[166:167], v[166:167], v[172:173]
    v_cvt_pk_bf16_f32 v170, v156, v157
    v_cvt_pk_bf16_f32 v171, v158, v159
    v_cvt_pk_bf16_f32 v4, v160, v161
    v_cvt_pk_bf16_f32 v5, v162, v163
    v_cvt_pk_bf16_f32 v6, v164, v165
    v_cvt_pk_bf16_f32 v7, v166, v167
    s_nop 1
    v_mfma_f32_16x16x32_bf16 v[176:179], a[64:67], v[4:7], 0
    v_mfma_f32_16x16x32_bf16 v[180:183], a[68:71], v[4:7], 0
    v_mfma_f32_16x16x32_bf16 v[184:187], a[72:75], v[4:7], 0
    v_mfma_f32_16x16x32_bf16 v[188:191], a[76:79], v[4:7], 0
    v_mfma_f32_16x16x32_bf16 v[192:195], a[80:83], v[4:7], 0
    v_mfma_f32_16x16x32_bf16 v[196:199], a[84:87], v[4:7], 0
    v_mfma_f32_16x16x32_bf16 v[200:203], a[88:91], v[4:7], 0
    v_mfma_f32_16x16x32_bf16 v[204:207], a[92:95], v[4:7], 0
    v_mfma_f32_16x16x16_bf16 v[176:179], a[112:113], v[170:171], v[176:179]
    v_mfma_f32_16x16x16_bf16 v[180:183], a[114:115], v[170:171], v[180:183]
    v_mfma_f32_16x16x16_bf16 v[184:187], a[116:117], v[170:171], v[184:187]
    v_mfma_f32_16x16x16_bf16 v[188:191], a[118:119], v[170:171], v[188:191]
    v_mfma_f32_16x16x16_bf16 v[192:195], a[120:121], v[170:171], v[192:195]
    v_mfma_f32_16x16x16_bf16 v[196:199], a[122:123], v[170:171], v[196:199]
    v_mfma_f32_16x16x16_bf16 v[200:203], a[124:125], v[170:171], v[200:203]
    v_mfma_f32_16x16x16_bf16 v[204:207], a[126:127], v[170:171], v[204:207]
    s_nop 0
    v_cvt_pk_bf16_f32 v224, v176, v177
    v_cvt_pk_bf16_f32 v225, v178, v179
    v_cvt_pk_bf16_f32 v226, v180, v181
    v_cvt_pk_bf16_f32 v227, v182, v183
    s_add_u32 s17, s16, 17408
    buffer_store_dwordx4 v[224:227], v1, s[4:7], s17 offen sc1
    v_cvt_pk_bf16_f32 v228, v184, v185
    v_cvt_pk_bf16_f32 v229, v186, v187
    v_cvt_pk_bf16_f32 v230, v188, v189
    v_cvt_pk_bf16_f32 v231, v190, v191
    s_add_u32 s17, s16, 21504
    buffer_store_dwordx4 v[228:231], v1, s[4:7], s17 offen sc1
    v_cvt_pk_bf16_f32 v232, v192, v193
    v_cvt_pk_bf16_f32 v233, v194, v195
    v_cvt_pk_bf16_f32 v234, v196, v197
    v_cvt_pk_bf16_f32 v235, v198, v199
    s_add_u32 s17, s16, 25600
    buffer_store_dwordx4 v[232:235], v1, s[4:7], s17 offen sc1
    v_cvt_pk_bf16_f32 v236, v200, v201
    v_cvt_pk_bf16_f32 v237, v202, v203
    v_cvt_pk_bf16_f32 v238, v204, v205
    v_cvt_pk_bf16_f32 v239, v206, v207
    s_add_u32 s17, s16, 29696
    buffer_store_dwordx4 v[236:239], v1, s[4:7], s17 offen sc1
    s_lshl_b32 s68, s42, 8
    s_add_u32 s68, s68, s40
    s_lshl_b32 s68, s68, 6
    s_add_u32 s68, s68, 48238592
    s_branch L_wloop
L_st3:
    v_and_b32 v14, 63, v0
    v_lshlrev_b32 v1, 4, v14
    s_lshr_b32 s12, s41, 4
    s_and_b32 s14, s41, 15
    s_mul_i32 s15, s13, 32
    s_lshr_b32 s16, s14, 1
    s_mul_i32 s16, s16, 128
    s_add_u32 s16, s16, s15
    s_lshl_b32 s16, s16, 12
    s_and_b32 s18, s14, 1
    s_lshl_b32 s18, s18, 11
    s_add_u32 s16, s16, s18
    s_add_u32 s16, s16, 12582912
    s_mul_i32 s17, s40, 128
    s_add_u32 s17, s17, s15
    s_lshl_b32 s17, s17, 12
    s_lshl_b32 s18, s12, 11
    s_add_u32 s17, s17, s18
    s_add_u32 s17, s17, s43
    s_add_u32 s17, s17, 100663296
    s_bitcmp0_b32 s72, 16
    s_cbranch_scc1 L_wo_nopre
    s_mov_b32 s22, 48291840
    s_cmp_lg_u32 s13, 0
    s_cbranch_scc1 L_pc_done_wo_su
    s_mov_b32 s26, 0
    v_mov_b32 v126, 0
L_pc_wo_su:
    buffer_load_dword v127, v126, s[4:7], s22 offen sc1
    s_add_u32 s26, s26, 1
    s_cmp_gt_u32 s26, 4194304
    s_cbranch_scc1 L_mega_end
    s_waitcnt vmcnt(0)
    v_readfirstlane_b32 s27, v127
    s_nop 0
    s_cmp_ge_u32 s27, 64
    s_cbranch_scc1 L_pc_done_wo_su
    s_sleep 4
    s_branch L_pc_wo_su
L_pc_done_wo_su:
    s_barrier
    s_mov_b32 s8, s90
    s_and_b32 s9, s91, 0xffff
    s_mov_b32 s10, 4194304
    s_mov_b32 s11, 0x00020000
    s_mul_i32 s15, s13, 1048576
    s_lshl_b32 s24, s14, 6
    s_add_u32 s15, s15, s24
    s_lshl_b32 s24, s13, 14
    v_lshrrev_b32 v2, 2, v14
    s_mov_b32 s23, 1024
    v_mul_lo_u32 v2, s23, v2
    v_and_b32 v3, 3, v14
    v_lshl_add_u32 v2, v3, 4, v2
    v_lshlrev_b32 v3, 4, v14
    v_add_u32 v3, s24, v3
    v_lshrrev_b32 v5, 4, v14
    v_bfe_u32 v6, v14, 2, 2
    v_lshl_add_u32 v5, v5, 3, v6
    v_mul_u32_u24 v5, 64, v5
    v_and_b32 v6, 3, v14
    v_lshl_add_u32 v5, v6, 4, v5
    v_add_u32 v5, s24, v5
    buffer_load_dwordx4 v[16:19], v2, s[8:11], s15 offen
    s_add_u32 s15, s15, 16384
    buffer_load_dwordx4 v[20:23], v2, s[8:11], s15 offen
    s_add_u32 s15, s15, 16384
    buffer_load_dwordx4 v[24:27], v2, s[8:11], s15 offen
    s_add_u32 s15, s15, 16384
    buffer_load_dwordx4 v[28:31], v2, s[8:11], s15 offen
    s_add_u32 s15, s15, 16384
    buffer_load_dwordx4 v[32:35], v2, s[8:11], s15 offen
    s_add_u32 s15, s15, 16384
    buffer_load_dwordx4 v[36:39], v2, s[8:11], s15 offen
    s_add_u32 s15, s15, 16384
    buffer_load_dwordx4 v[40:43], v2, s[8:11], s15 offen
    s_add_u32 s15, s15, 16384
    buffer_load_dwordx4 v[44:47], v2, s[8:11], s15 offen
    s_add_u32 s15, s15, 16384
    buffer_load_dwordx4 v[48:51], v2, s[8:11], s15 offen
    s_add_u32 s15, s15, 16384
    buffer_load_dwordx4 v[52:55], v2, s[8:11], s15 offen
    s_add_u32 s15, s15, 16384
    buffer_load_dwordx4 v[56:59], v2, s[8:11], s15 offen
    s_add_u32 s15, s15, 16384
    buffer_load_dwordx4 v[60:63], v2, s[8:11], s15 offen
    s_add_u32 s15, s15, 16384
    buffer_load_dwordx4 v[64:67], v2, s[8:11], s15 offen
    s_add_u32 s15, s15, 16384
    buffer_load_dwordx4 v[68:71], v2, s[8:11], s15 offen
    s_add_u32 s15, s15, 16384
    buffer_load_dwordx4 v[72:75], v2, s[8:11], s15 offen
    s_add_u32 s15, s15, 16384
    buffer_load_dwordx4 v[76:79], v2, s[8:11], s15 offen
    s_add_u32 s15, s15, 16384
    buffer_load_dwordx4 v[80:83], v2, s[8:11], s15 offen
    s_add_u32 s15, s15, 16384
    buffer_load_dwordx4 v[84:87], v2, s[8:11], s15 offen
    s_add_u32 s15, s15, 16384
    buffer_load_dwordx4 v[88:91], v2, s[8:11], s15 offen
    s_add_u32 s15, s15, 16384
    buffer_load_dwordx4 v[92:95], v2, s[8:11], s15 offen
    s_add_u32 s15, s15, 16384
    buffer_load_dwordx4 v[96:99], v2, s[8:11], s15 offen
    s_add_u32 s15, s15, 16384
    buffer_load_dwordx4 v[100:103], v2, s[8:11], s15 offen
    s_add_u32 s15, s15, 16384
    buffer_load_dwordx4 v[104:107], v2, s[8:11], s15 offen
    s_add_u32 s15, s15, 16384
    buffer_load_dwordx4 v[108:111], v2, s[8:11], s15 offen
    s_add_u32 s15, s15, 16384
    buffer_load_dwordx4 v[112:115], v2, s[8:11], s15 offen
    s_add_u32 s15, s15, 16384
    buffer_load_dwordx4 v[116:119], v2, s[8:11], s15 offen
    s_add_u32 s15, s15, 16384
    buffer_load_dwordx4 v[120:123], v2, s[8:11], s15 offen
    s_add_u32 s15, s15, 16384
    buffer_load_dwordx4 v[124:127], v2, s[8:11], s15 offen
    s_add_u32 s15, s15, 16384
    buffer_load_dwordx4 v[128:131], v2, s[8:11], s15 offen
    s_add_u32 s15, s15, 16384
    buffer_load_dwordx4 v[132:135], v2, s[8:11], s15 offen
    s_add_u32 s15, s15, 16384
    buffer_load_dwordx4 v[136:139], v2, s[8:11], s15 offen
    s_add_u32 s15, s15, 16384
    buffer_load_dwordx4 v[140:143], v2, s[8:11], s15 offen
    s_add_u32 s15, s15, 16384
    s_waitcnt vmcnt(16)
    ds_write_b128 v3, v[16:19] offset:0
    ds_write_b128 v3, v[20:23] offset:1024
    ds_write_b128 v3, v[24:27] offset:2048
    ds_write_b128 v3, v[28:31] offset:3072
    ds_write_b128 v3, v[32:35] offset:4096
    ds_write_b128 v3, v[36:39] offset:5120
    ds_write_b128 v3, v[40:43] offset:6144
    ds_write_b128 v3, v[44:47] offset:7168
    ds_write_b128 v3, v[48:51] offset:8192
    ds_write_b128 v3, v[52:55] offset:9216
    ds_write_b128 v3, v[56:59] offset:10240
    ds_write_b128 v3, v[60:63] offset:11264
    ds_write_b128 v3, v[64:67] offset:12288
    ds_write_b128 v3, v[68:71] offset:13312
    ds_write_b128 v3, v[72:75] offset:14336
    ds_write_b128 v3, v[76:79] offset:15360
    s_waitcnt lgkmcnt(0)
    ds_read_b64_tr_b16 a[0:1], v5 offset:0
    ds_read_b64_tr_b16 a[2:3], v5 offset:256
    ds_read_b64_tr_b16 a[4:5], v5 offset:8
    ds_read_b64_tr_b16 a[6:7], v5 offset:264
    ds_read_b64_tr_b16 a[8:9], v5 offset:2048
    ds_read_b64_tr_b16 a[10:11], v5 offset:2304
    ds_read_b64_tr_b16 a[12:13], v5 offset:2056
    ds_read_b64_tr_b16 a[14:15], v5 offset:2312
    ds_read_b64_tr_b16 a[16:17], v5 offset:4096
    ds_read_b64_tr_b16 a[18:19], v5 offset:4352
    ds_read_b64_tr_b16 a[20:21], v5 offset:4104
    ds_read_b64_tr_b16 a[22:23], v5 offset:4360
    ds_read_b64_tr_b16 a[24:25], v5 offset:6144
    ds_read_b64_tr_b16 a[26:27], v5 offset:6400
    ds_read_b64_tr_b16 a[28:29], v5 offset:6152
    ds_read_b64_tr_b16 a[30:31], v5 offset:6408
    ds_read_b64_tr_b16 a[32:33], v5 offset:8192
    ds_read_b64_tr_b16 a[34:35], v5 offset:8448
    ds_read_b64_tr_b16 a[36:37], v5 offset:8200
    ds_read_b64_tr_b16 a[38:39], v5 offset:8456
    ds_read_b64_tr_b16 a[40:41], v5 offset:10240
    ds_read_b64_tr_b16 a[42:43], v5 offset:10496
    ds_read_b64_tr_b16 a[44:45], v5 offset:10248
    ds_read_b64_tr_b16 a[46:47], v5 offset:10504
    ds_read_b64_tr_b16 a[48:49], v5 offset:12288
    ds_read_b64_tr_b16 a[50:51], v5 offset:12544
    ds_read_b64_tr_b16 a[52:53], v5 offset:12296
    ds_read_b64_tr_b16 a[54:55], v5 offset:12552
    ds_read_b64_tr_b16 a[56:57], v5 offset:14336
    ds_read_b64_tr_b16 a[58:59], v5 offset:14592
    ds_read_b64_tr_b16 a[60:61], v5 offset:14344
    ds_read_b64_tr_b16 a[62:63], v5 offset:14600
    s_waitcnt lgkmcnt(0)
    buffer_load_dwordx4 v[16:19], v2, s[8:11], s15 offen
    s_add_u32 s15, s15, 16384
    buffer_load_dwordx4 v[20:23], v2, s[8:11], s15 offen
    s_add_u32 s15, s15, 16384
    buffer_load_dwordx4 v[24:27], v2, s[8:11], s15 offen
    s_add_u32 s15, s15, 16384
    buffer_load_dwordx4 v[28:31], v2, s[8:11], s15 offen
    s_add_u32 s15, s15, 16384
    buffer_load_dwordx4 v[32:35], v2, s[8:11], s15 offen
    s_add_u32 s15, s15, 16384
    buffer_load_dwordx4 v[36:39], v2, s[8:11], s15 offen
    s_add_u32 s15, s15, 16384
    buffer_load_dwordx4 v[40:43], v2, s[8:11], s15 offen
    s_add_u32 s15, s15, 16384
    buffer_load_dwordx4 v[44:47], v2, s[8:11], s15 offen
    s_add_u32 s15, s15, 16384
    buffer_load_dwordx4 v[48:51], v2, s[8:11], s15 offen
    s_add_u32 s15, s15, 16384
    buffer_load_dwordx4 v[52:55], v2, s[8:11], s15 offen
    s_add_u32 s15, s15, 16384
    buffer_load_dwordx4 v[56:59], v2, s[8:11], s15 offen
    s_add_u32 s15, s15, 16384
    buffer_load_dwordx4 v[60:63], v2, s[8:11], s15 offen
    s_add_u32 s15, s15, 16384
    buffer_load_dwordx4 v[64:67], v2, s[8:11], s15 offen
    s_add_u32 s15, s15, 16384
    buffer_load_dwordx4 v[68:71], v2, s[8:11], s15 offen
    s_add_u32 s15, s15, 16384
    buffer_load_dwordx4 v[72:75], v2, s[8:11], s15 offen
    s_add_u32 s15, s15, 16384
    buffer_load_dwordx4 v[76:79], v2, s[8:11], s15 offen
    s_add_u32 s15, s15, 16384
    s_waitcnt vmcnt(16)
    ds_write_b128 v3, v[80:83] offset:0
    ds_write_b128 v3, v[84:87] offset:1024
    ds_write_b128 v3, v[88:91] offset:2048
    ds_write_b128 v3, v[92:95] offset:3072
    ds_write_b128 v3, v[96:99] offset:4096
    ds_write_b128 v3, v[100:103] offset:5120
    ds_write_b128 v3, v[104:107] offset:6144
    ds_write_b128 v3, v[108:111] offset:7168
    ds_write_b128 v3, v[112:115] offset:8192
    ds_write_b128 v3, v[116:119] offset:9216
    ds_write_b128 v3, v[120:123] offset:10240
    ds_write_b128 v3, v[124:127] offset:11264
    ds_write_b128 v3, v[128:131] offset:12288
    ds_write_b128 v3, v[132:135] offset:13312
    ds_write_b128 v3, v[136:139] offset:14336
    ds_write_b128 v3, v[140:143] offset:15360
    s_waitcnt lgkmcnt(0)
    ds_read_b64_tr_b16 a[64:65], v5 offset:0
    ds_read_b64_tr_b16 a[66:67], v5 offset:256
    ds_read_b64_tr_b16 a[68:69], v5 offset:8
    ds_read_b64_tr_b16 a[70:71], v5 offset:264
    ds_read_b64_tr_b16 a[72:73], v5 offset:2048
    ds_read_b64_tr_b16 a[74:75], v5 offset:2304
    ds_read_b64_tr_b16 a[76:77], v5 offset:2056
    ds_read_b64_tr_b16 a[78:79], v5 offset:2312
    ds_read_b64_tr_b16 a[80:81], v5 offset:4096
    ds_read_b64_tr_b16 a[82:83], v5 offset:4352
    ds_read_b64_tr_b16 a[84:85], v5 offset:4104
    ds_read_b64_tr_b16 a[86:87], v5 offset:4360
    ds_read_b64_tr_b16 a[88:89], v5 offset:6144
    ds_read_b64_tr_b16 a[90:91], v5 offset:6400
    ds_read_b64_tr_b16 a[92:93], v5 offset:6152
    ds_read_b64_tr_b16 a[94:95], v5 offset:6408
    ds_read_b64_tr_b16 a[96:97], v5 offset:8192
    ds_read_b64_tr_b16 a[98:99], v5 offset:8448
    ds_read_b64_tr_b16 a[100:101], v5 offset:8200
    ds_read_b64_tr_b16 a[102:103], v5 offset:8456
    ds_read_b64_tr_b16 a[104:105], v5 offset:10240
    ds_read_b64_tr_b16 a[106:107], v5 offset:10496
    ds_read_b64_tr_b16 a[108:109], v5 offset:10248
    ds_read_b64_tr_b16 a[110:111], v5 offset:10504
    ds_read_b64_tr_b16 a[112:113], v5 offset:12288
    ds_read_b64_tr_b16 a[114:115], v5 offset:12544
    ds_read_b64_tr_b16 a[116:117], v5 offset:12296
    ds_read_b64_tr_b16 a[118:119], v5 offset:12552
    ds_read_b64_tr_b16 a[120:121], v5 offset:14336
    ds_read_b64_tr_b16 a[122:123], v5 offset:14592
    ds_read_b64_tr_b16 a[124:125], v5 offset:14344
    ds_read_b64_tr_b16 a[126:127], v5 offset:14600
    s_waitcnt lgkmcnt(0)
    buffer_load_dwordx4 v[80:83], v2, s[8:11], s15 offen
    s_add_u32 s15, s15, 16384
    buffer_load_dwordx4 v[84:87], v2, s[8:11], s15 offen
    s_add_u32 s15, s15, 16384
    buffer_load_dwordx4 v[88:91], v2, s[8:11], s15 offen
    s_add_u32 s15, s15, 16384
    buffer_load_dwordx4 v[92:95], v2, s[8:11], s15 offen
    s_add_u32 s15, s15, 16384
    buffer_load_dwordx4 v[96:99], v2, s[8:11], s15 offen
    s_add_u32 s15, s15, 16384
    buffer_load_dwordx4 v[100:103], v2, s[8:11], s15 offen
    s_add_u32 s15, s15, 16384
    buffer_load_dwordx4 v[104:107], v2, s[8:11], s15 offen
    s_add_u32 s15, s15, 16384
    buffer_load_dwordx4 v[108:111], v2, s[8:11], s15 offen
    s_add_u32 s15, s15, 16384
    buffer_load_dwordx4 v[112:115], v2, s[8:11], s15 offen
    s_add_u32 s15, s15, 16384
    buffer_load_dwordx4 v[116:119], v2, s[8:11], s15 offen
    s_add_u32 s15, s15, 16384
    buffer_load_dwordx4 v[120:123], v2, s[8:11], s15 offen
    s_add_u32 s15, s15, 16384
    buffer_load_dwordx4 v[124:127], v2, s[8:11], s15 offen
    s_add_u32 s15, s15, 16384
    buffer_load_dwordx4 v[128:131], v2, s[8:11], s15 offen
    s_add_u32 s15, s15, 16384
    buffer_load_dwordx4 v[132:135], v2, s[8:11], s15 offen
    s_add_u32 s15, s15, 16384
    buffer_load_dwordx4 v[136:139], v2, s[8:11], s15 offen
    s_add_u32 s15, s15, 16384
    buffer_load_dwordx4 v[140:143], v2, s[8:11], s15 offen
    s_add_u32 s15, s15, 16384
    s_waitcnt vmcnt(16)
    ds_write_b128 v3, v[16:19] offset:0
    ds_write_b128 v3, v[20:23] offset:1024
    ds_write_b128 v3, v[24:27] offset:2048
    ds_write_b128 v3, v[28:31] offset:3072
    ds_write_b128 v3, v[32:35] offset:4096
    ds_write_b128 v3, v[36:39] offset:5120
    ds_write_b128 v3, v[40:43] offset:6144
    ds_write_b128 v3, v[44:47] offset:7168
    ds_write_b128 v3, v[48:51] offset:8192
    ds_write_b128 v3, v[52:55] offset:9216
    ds_write_b128 v3, v[56:59] offset:10240
    ds_write_b128 v3, v[60:63] offset:11264
    ds_write_b128 v3, v[64:67] offset:12288
    ds_write_b128 v3, v[68:71] offset:13312
    ds_write_b128 v3, v[72:75] offset:14336
    ds_write_b128 v3, v[76:79] offset:15360
    s_waitcnt lgkmcnt(0)
    ds_read_b64_tr_b16 a[128:129], v5 offset:0
    ds_read_b64_tr_b16 a[130:131], v5 offset:256
    ds_read_b64_tr_b16 a[132:133], v5 offset:8
    ds_read_b64_tr_b16 a[134:135], v5 offset:264
    ds_read_b64_tr_b16 a[136:137], v5 offset:2048
    ds_read_b64_tr_b16 a[138:139], v5 offset:2304
    ds_read_b64_tr_b16 a[140:141], v5 offset:2056
    ds_read_b64_tr_b16 a[142:143], v5 offset:2312
    ds_read_b64_tr_b16 a[144:145], v5 offset:4096
    ds_read_b64_tr_b16 a[146:147], v5 offset:4352
    ds_read_b64_tr_b16 a[148:149], v5 offset:4104
    ds_read_b64_tr_b16 a[150:151], v5 offset:4360
    ds_read_b64_tr_b16 a[152:153], v5 offset:6144
    ds_read_b64_tr_b16 a[154:155], v5 offset:6400
    ds_read_b64_tr_b16 a[156:157], v5 offset:6152
    ds_read_b64_tr_b16 a[158:159], v5 offset:6408
    ds_read_b64_tr_b16 a[160:161], v5 offset:8192
    ds_read_b64_tr_b16 a[162:163], v5 offset:8448
    ds_read_b64_tr_b16 a[164:165], v5 offset:8200
    ds_read_b64_tr_b16 a[166:167], v5 offset:8456
    ds_read_b64_tr_b16 a[168:169], v5 offset:10240
    ds_read_b64_tr_b16 a[170:171], v5 offset:10496
    ds_read_b64_tr_b16 a[172:173], v5 offset:10248
    ds_read_b64_tr_b16 a[174:175], v5 offset:10504
    ds_read_b64_tr_b16 a[176:177], v5 offset:12288
    ds_read_b64_tr_b16 a[178:179], v5 offset:12544
    ds_read_b64_tr_b16 a[180:181], v5 offset:12296
    ds_read_b64_tr_b16 a[182:183], v5 offset:12552
    ds_read_b64_tr_b16 a[184:185], v5 offset:14336
    ds_read_b64_tr_b16 a[186:187], v5 offset:14592
    ds_read_b64_tr_b16 a[188:189], v5 offset:14344
    ds_read_b64_tr_b16 a[190:191], v5 offset:14600
    s_waitcnt lgkmcnt(0)
    s_waitcnt vmcnt(0)
    ds_write_b128 v3, v[80:83] offset:0
    ds_write_b128 v3, v[84:87] offset:1024
    ds_write_b128 v3, v[88:91] offset:2048
    ds_write_b128 v3, v[92:95] offset:3072
    ds_write_b128 v3, v[96:99] offset:4096
    ds_write_b128 v3, v[100:103] offset:5120
    ds_write_b128 v3, v[104:107] offset:6144
    ds_write_b128 v3, v[108:111] offset:7168
    ds_write_b128 v3, v[112:115] offset:8192
    ds_write_b128 v3, v[116:119] offset:9216
    ds_write_b128 v3, v[120:123] offset:10240
    ds_write_b128 v3, v[124:127] offset:11264
    ds_write_b128 v3, v[128:131] offset:12288
    ds_write_b128 v3, v[132:135] offset:13312
    ds_write_b128 v3, v[136:139] offset:14336
    ds_write_b128 v3, v[140:143] offset:15360
    s_waitcnt lgkmcnt(0)
    ds_read_b64_tr_b16 a[192:193], v5 offset:0
    ds_read_b64_tr_b16 a[194:195], v5 offset:256
    ds_read_b64_tr_b16 a[196:197], v5 offset:8
    ds_read_b64_tr_b16 a[198:199], v5 offset:264
    ds_read_b64_tr_b16 a[200:201], v5 offset:2048
    ds_read_b64_tr_b16 a[202:203], v5 offset:2304
    ds_read_b64_tr_b16 a[204:205], v5 offset:2056
    ds_read_b64_tr_b16 a[206:207], v5 offset:2312
    ds_read_b64_tr_b16 a[208:209], v5 offset:4096
    ds_read_b64_tr_b16 a[210:211], v5 offset:4352
    ds_read_b64_tr_b16 a[212:213], v5 offset:4104
    ds_read_b64_tr_b16 a[214:215], v5 offset:4360
    ds_read_b64_tr_b16 a[216:217], v5 offset:6144
    ds_read_b64_tr_b16 a[218:219], v5 offset:6400
    ds_read_b64_tr_b16 a[220:221], v5 offset:6152
    ds_read_b64_tr_b16 a[222:223], v5 offset:6408
    ds_read_b64_tr_b16 a[224:225], v5 offset:8192
    ds_read_b64_tr_b16 a[226:227], v5 offset:8448
    ds_read_b64_tr_b16 a[228:229], v5 offset:8200
    ds_read_b64_tr_b16 a[230:231], v5 offset:8456
    ds_read_b64_tr_b16 a[232:233], v5 offset:10240
    ds_read_b64_tr_b16 a[234:235], v5 offset:10496
    ds_read_b64_tr_b16 a[236:237], v5 offset:10248
    ds_read_b64_tr_b16 a[238:239], v5 offset:10504
    ds_read_b64_tr_b16 a[240:241], v5 offset:12288
    ds_read_b64_tr_b16 a[242:243], v5 offset:12544
    ds_read_b64_tr_b16 a[244:245], v5 offset:12296
    ds_read_b64_tr_b16 a[246:247], v5 offset:12552
    ds_read_b64_tr_b16 a[248:249], v5 offset:14336
    ds_read_b64_tr_b16 a[250:251], v5 offset:14592
    ds_read_b64_tr_b16 a[252:253], v5 offset:14344
    ds_read_b64_tr_b16 a[254:255], v5 offset:14600
    s_waitcnt lgkmcnt(0)
    s_barrier
L_wo_nopre:
    s_lshl_b32 s22, s42, 8
    s_add_u32 s22, s22, s40
    s_lshl_b32 s22, s22, 6
    s_add_u32 s22, s22, 48238592
    v_mov_b32 v250, 0
    s_cmp_lg_u32 s13, 0
    s_cbranch_scc1 L_pc_done_wo
    s_mov_b32 s26, 0
    v_mov_b32 v126, 0
L_pc_wo:
    buffer_load_dword v127, v126, s[4:7], s22 offen sc1
    s_add_u32 s26, s26, 1
    s_cmp_gt_u32 s26, 4194304
    s_cbranch_scc1 L_mega_end
    s_waitcnt vmcnt(0)
    v_readfirstlane_b32 s27, v127
    s_nop 0
    s_cmp_ge_u32 s27, 8
    s_cbranch_scc1 L_pc_done_wo
    s_sleep 4
    s_branch L_pc_wo
L_pc_done_wo:
    s_barrier
    buffer_load_dwordx4 v[16:19], v1, s[4:7], s17 offen offset:0 sc1
    buffer_load_dwordx4 v[20:23], v1, s[4:7], s17 offen offset:1024 sc1
    s_add_u32 s17, s17, 4096
    buffer_load_dwordx4 v[24:27], v1, s[4:7], s17 offen offset:0 sc1
    buffer_load_dwordx4 v[28:31], v1, s[4:7], s17 offen offset:1024 sc1
    s_add_u32 s17, s17, 4096
    buffer_load_dwordx4 v[32:35], v1, s[4:7], s17 offen offset:0 sc1
    buffer_load_dwordx4 v[36:39], v1, s[4:7], s17 offen offset:1024 sc1
    s_add_u32 s17, s17, 4096
    buffer_load_dwordx4 v[40:43], v1, s[4:7], s17 offen offset:0 sc1
    buffer_load_dwordx4 v[44:47], v1, s[4:7], s17 offen offset:1024 sc1
    s_add_u32 s17, s17, 4096
    buffer_load_dwordx4 v[48:51], v1, s[4:7], s17 offen offset:0 sc1
    buffer_load_dwordx4 v[52:55], v1, s[4:7], s17 offen offset:1024 sc1
    s_add_u32 s17, s17, 4096
    buffer_load_dwordx4 v[56:59], v1, s[4:7], s17 offen offset:0 sc1
    buffer_load_dwordx4 v[60:63], v1, s[4:7], s17 offen offset:1024 sc1
    s_add_u32 s17, s17, 4096
    buffer_load_dwordx4 v[64:67], v1, s[4:7], s17 offen offset:0 sc1
    buffer_load_dwordx4 v[68:71], v1, s[4:7], s17 offen offset:1024 sc1
    s_add_u32 s17, s17, 4096
    buffer_load_dwordx4 v[72:75], v1, s[4:7], s17 offen offset:0 sc1
    buffer_load_dwordx4 v[76:79], v1, s[4:7], s17 offen offset:1024 sc1
    s_add_u32 s17, s17, 4096
    buffer_load_dwordx4 v[80:83], v1, s[4:7], s17 offen offset:0 sc1
    buffer_load_dwordx4 v[84:87], v1, s[4:7], s17 offen offset:1024 sc1
    s_add_u32 s17, s17, 4096
    buffer_load_dwordx4 v[88:91], v1, s[4:7], s17 offen offset:0 sc1
    buffer_load_dwordx4 v[92:95], v1, s[4:7], s17 offen offset:1024 sc1
    s_add_u32 s17, s17, 4096
    buffer_load_dwordx4 v[96:99], v1, s[4:7], s17 offen offset:0 sc1
    buffer_load_dwordx4 v[100:103], v1, s[4:7], s17 offen offset:1024 sc1
    s_add_u32 s17, s17, 4096
    buffer_load_dwordx4 v[104:107], v1, s[4:7], s17 offen offset:0 sc1
    buffer_load_dwordx4 v[108:111], v1, s[4:7], s17 offen offset:1024 sc1
    s_add_u32 s17, s17, 4096
    buffer_load_dwordx4 v[112:115], v1, s[4:7], s17 offen offset:0 sc1
    buffer_load_dwordx4 v[116:119], v1, s[4:7], s17 offen offset:1024 sc1
    s_add_u32 s17, s17, 4096
    buffer_load_dwordx4 v[120:123], v1, s[4:7], s17 offen offset:0 sc1
    buffer_load_dwordx4 v[124:127], v1, s[4:7], s17 offen offset:1024 sc1
    s_add_u32 s17, s17, 4096
    buffer_load_dwordx4 v[128:131], v1, s[4:7], s17 offen offset:0 sc1
    buffer_load_dwordx4 v[132:135], v1, s[4:7], s17 offen offset:1024 sc1
    s_add_u32 s17, s17, 4096
    buffer_load_dwordx4 v[136:139], v1, s[4:7], s17 offen offset:0 sc1
    buffer_load_dwordx4 v[140:143], v1, s[4:7], s17 offen offset:1024 sc1
    s_add_u32 s17, s17, 4096
    s_waitcnt vmcnt(30)
    v_mfma_f32_16x16x32_bf16 v[144:147], a[0:3], v[16:19], 0
    v_mfma_f32_16x16x32_bf16 v[148:151], a[0:3], v[20:23], 0
    v_mfma_f32_16x16x32_bf16 v[152:155], a[4:7], v[16:19], 0
    v_mfma_f32_16x16x32_bf16 v[156:159], a[4:7], v[20:23], 0
    buffer_load_dwordx4 v[16:19], v1, s[4:7], s17 offen offset:0 sc1
    buffer_load_dwordx4 v[20:23], v1, s[4:7], s17 offen offset:1024 sc1
    s_add_u32 s17, s17, 4096
    s_waitcnt vmcnt(30)
    v_mfma_f32_16x16x32_bf16 v[144:147], a[8:11], v[24:27], v[144:147]
    v_mfma_f32_16x16x32_bf16 v[148:151], a[8:11], v[28:31], v[148:151]
    v_mfma_f32_16x16x32_bf16 v[152:155], a[12:15], v[24:27], v[152:155]
    v_mfma_f32_16x16x32_bf16 v[156:159], a[12:15], v[28:31], v[156:159]
    buffer_load_dwordx4 v[24:27], v1, s[4:7], s17 offen offset:0 sc1
    buffer_load_dwordx4 v[28:31], v1, s[4:7], s17 offen offset:1024 sc1
    s_add_u32 s17, s17, 4096
    s_waitcnt vmcnt(30)
    v_mfma_f32_16x16x32_bf16 v[144:147], a[16:19], v[32:35], v[144:147]
    v_mfma_f32_16x16x32_bf16 v[148:151], a[16:19], v[36:39], v[148:151]
    v_mfma_f32_16x16x32_bf16 v[152:155], a[20:23], v[32:35], v[152:155]
    v_mfma_f32_16x16x32_bf16 v[156:159], a[20:23], v[36:39], v[156:159]
    buffer_load_dwordx4 v[32:35], v1, s[4:7], s17 offen offset:0 sc1
    buffer_load_dwordx4 v[36:39], v1, s[4:7], s17 offen offset:1024 sc1
    s_add_u32 s17, s17, 4096
    s_waitcnt vmcnt(30)
    v_mfma_f32_16x16x32_bf16 v[144:147], a[24:27], v[40:43], v[144:147]
    v_mfma_f32_16x16x32_bf16 v[148:151], a[24:27], v[44:47], v[148:151]
    v_mfma_f32_16x16x32_bf16 v[152:155], a[28:31], v[40:43], v[152:155]
    v_mfma_f32_16x16x32_bf16 v[156:159], a[28:31], v[44:47], v[156:159]
    buffer_load_dwordx4 v[40:43], v1, s[4:7], s17 offen offset:0 sc1
    buffer_load_dwordx4 v[44:47], v1, s[4:7], s17 offen offset:1024 sc1
    s_add_u32 s17, s17, 4096
    s_waitcnt vmcnt(30)
    v_mfma_f32_16x16x32_bf16 v[144:147], a[32:35], v[48:51], v[144:147]
    v_mfma_f32_16x16x32_bf16 v[148:151], a[32:35], v[52:55], v[148:151]
    v_mfma_f32_16x16x32_bf16 v[152:155], a[36:39], v[48:51], v[152:155]
    v_mfma_f32_16x16x32_bf16 v[156:159], a[36:39], v[52:55], v[156:159]
    buffer_load_dwordx4 v[48:51], v1, s[4:7], s17 offen offset:0 sc1
    buffer_load_dwordx4 v[52:55], v1, s[4:7], s17 offen offset:1024 sc1
    s_add_u32 s17, s17, 4096
    s_waitcnt vmcnt(30)
    v_mfma_f32_16x16x32_bf16 v[144:147], a[40:43], v[56:59], v[144:147]
    v_mfma_f32_16x16x32_bf16 v[148:151], a[40:43], v[60:63], v[148:151]
    v_mfma_f32_16x16x32_bf16 v[152:155], a[44:47], v[56:59], v[152:155]
    v_mfma_f32_16x16x32_bf16 v[156:159], a[44:47], v[60:63], v[156:159]
    buffer_load_dwordx4 v[56:59], v1, s[4:7], s17 offen offset:0 sc1
    buffer_load_dwordx4 v[60:63], v1, s[4:7], s17 offen offset:1024 sc1
    s_add_u32 s17, s17, 4096
    s_waitcnt vmcnt(30)
    v_mfma_f32_16x16x32_bf16 v[144:147], a[48:51], v[64:67], v[144:147]
    v_mfma_f32_16x16x32_bf16 v[148:151], a[48:51], v[68:71], v[148:151]
    v_mfma_f32_16x16x32_bf16 v[152:155], a[52:55], v[64:67], v[152:155]
    v_mfma_f32_16x16x32_bf16 v[156:159], a[52:55], v[68:71], v[156:159]
    buffer_load_dwordx4 v[64:67], v1, s[4:7], s17 offen offset:0 sc1
    buffer_load_dwordx4 v[68:71], v1, s[4:7], s17 offen offset:1024 sc1
    s_add_u32 s17, s17, 4096
    s_waitcnt vmcnt(30)
    v_mfma_f32_16x16x32_bf16 v[144:147], a[56:59], v[72:75], v[144:147]
    v_mfma_f32_16x16x32_bf16 v[148:151], a[56:59], v[76:79], v[148:151]
    v_mfma_f32_16x16x32_bf16 v[152:155], a[60:63], v[72:75], v[152:155]
    v_mfma_f32_16x16x32_bf16 v[156:159], a[60:63], v[76:79], v[156:159]
    buffer_load_dwordx4 v[72:75], v1, s[4:7], s17 offen offset:0 sc1
    buffer_load_dwordx4 v[76:79], v1, s[4:7], s17 offen offset:1024 sc1
    s_add_u32 s17, s17, 4096
    s_waitcnt vmcnt(30)
    v_mfma_f32_16x16x32_bf16 v[144:147], a[64:67], v[80:83], v[144:147]
    v_mfma_f32_16x16x32_bf16 v[148:151], a[64:67], v[84:87], v[148:151]
    v_mfma_f32_16x16x32_bf16 v[152:155], a[68:71], v[80:83], v[152:155]
    v_mfma_f32_16x16x32_bf16 v[156:159], a[68:71], v[84:87], v[156:159]
    buffer_load_dwordx4 v[80:83], v1, s[4:7], s17 offen offset:0 sc1
    buffer_load_dwordx4 v[84:87], v1, s[4:7], s17 offen offset:1024 sc1
    s_add_u32 s17, s17, 4096
    s_waitcnt vmcnt(30)
    v_mfma_f32_16x16x32_bf16 v[144:147], a[72:75], v[88:91], v[144:147]
    v_mfma_f32_16x16x32_bf16 v[148:151], a[72:75], v[92:95], v[148:151]
    v_mfma_f32_16x16x32_bf16 v[152:155], a[76:79], v[88:91], v[152:155]
    v_mfma_f32_16x16x32_bf16 v[156:159], a[76:79], v[92:95], v[156:159]
    buffer_load_dwordx4 v[88:91], v1, s[4:7], s17 offen offset:0 sc1
    buffer_load_dwordx4 v[92:95], v1, s[4:7], s17 offen offset:1024 sc1
    s_add_u32 s17, s17, 4096
    s_waitcnt vmcnt(30)
    v_mfma_f32_16x16x32_bf16 v[144:147], a[80:83], v[96:99], v[144:147]
    v_mfma_f32_16x16x32_bf16 v[148:151], a[80:83], v[100:103], v[148:151]
    v_mfma_f32_16x16x32_bf16 v[152:155], a[84:87], v[96:99], v[152:155]
    v_mfma_f32_16x16x32_bf16 v[156:159], a[84:87], v[100:103], v[156:159]
    buffer_load_dwordx4 v[96:99], v1, s[4:7], s17 offen offset:0 sc1
    buffer_load_dwordx4 v[100:103], v1, s[4:7], s17 offen offset:1024 sc1
    s_add_u32 s17, s17, 4096
    s_waitcnt vmcnt(30)
    v_mfma_f32_16x16x32_bf16 v[144:147], a[88:91], v[104:107], v[144:147]
    v_mfma_f32_16x16x32_bf16 v[148:151], a[88:91], v[108:111], v[148:151]
    v_mfma_f32_16x16x32_bf16 v[152:155], a[92:95], v[104:107], v[152:155]
    v_mfma_f32_16x16x32_bf16 v[156:159], a[92:95], v[108:111], v[156:159]
    buffer_load_dwordx4 v[104:107], v1, s[4:7], s17 offen offset:0 sc1
    buffer_load_dwordx4 v[108:111], v1, s[4:7], s17 offen offset:1024 sc1
    s_add_u32 s17, s17, 4096
    s_waitcnt vmcnt(30)
    v_mfma_f32_16x16x32_bf16 v[144:147], a[96:99], v[112:115], v[144:147]
    v_mfma_f32_16x16x32_bf16 v[148:151], a[96:99], v[116:119], v[148:151]
    v_mfma_f32_16x16x32_bf16 v[152:155], a[100:103], v[112:115], v[152:155]
    v_mfma_f32_16x16x32_bf16 v[156:159], a[100:103], v[116:119], v[156:159]
    buffer_load_dwordx4 v[112:115], v1, s[4:7], s17 offen offset:0 sc1
    buffer_load_dwordx4 v[116:119], v1, s[4:7], s17 offen offset:1024 sc1
    s_add_u32 s17, s17, 4096
    s_waitcnt vmcnt(30)
    v_mfma_f32_16x16x32_bf16 v[144:147], a[104:107], v[120:123], v[144:147]
    v_mfma_f32_16x16x32_bf16 v[148:151], a[104:107], v[124:127], v[148:151]
    v_mfma_f32_16x16x32_bf16 v[152:155], a[108:111], v[120:123], v[152:155]
    v_mfma_f32_16x16x32_bf16 v[156:159], a[108:111], v[124:127], v[156:159]
    buffer_load_dwordx4 v[120:123], v1, s[4:7], s17 offen offset:0 sc1
    buffer_load_dwordx4 v[124:127], v1, s[4:7], s17 offen offset:1024 sc1
    s_add_u32 s17, s17, 4096
    s_waitcnt vmcnt(30)
    v_mfma_f32_16x16x32_bf16 v[144:147], a[112:115], v[128:131], v[144:147]
    v_mfma_f32_16x16x32_bf16 v[148:151], a[112:115], v[132:135], v[148:151]
    v_mfma_f32_16x16x32_bf16 v[152:155], a[116:119], v[128:131], v[152:155]
    v_mfma_f32_16x16x32_bf16 v[156:159], a[116:119], v[132:135], v[156:159]
    buffer_load_dwordx4 v[128:131], v1, s[4:7], s17 offen offset:0 sc1
    buffer_load_dwordx4 v[132:135], v1, s[4:7], s17 offen offset:1024 sc1
    s_add_u32 s17, s17, 4096
    s_waitcnt vmcnt(30)
    v_mfma_f32_16x16x32_bf16 v[144:147], a[120:123], v[136:139], v[144:147]
    v_mfma_f32_16x16x32_bf16 v[148:151], a[120:123], v[140:143], v[148:151]
    v_mfma_f32_16x16x32_bf16 v[152:155], a[124:127], v[136:139], v[152:155]
    v_mfma_f32_16x16x32_bf16 v[156:159], a[124:127], v[140:143], v[156:159]
    buffer_load_dwordx4 v[136:139], v1, s[4:7], s17 offen offset:0 sc1
    buffer_load_dwordx4 v[140:143], v1, s[4:7], s17 offen offset:1024 sc1
    s_add_u32 s17, s17, 4096
    s_waitcnt vmcnt(30)
    v_mfma_f32_16x16x32_bf16 v[144:147], a[128:131], v[16:19], v[144:147]
    v_mfma_f32_16x16x32_bf16 v[148:151], a[128:131], v[20:23], v[148:151]
    v_mfma_f32_16x16x32_bf16 v[152:155], a[132:135], v[16:19], v[152:155]
    v_mfma_f32_16x16x32_bf16 v[156:159], a[132:135], v[20:23], v[156:159]
    s_waitcnt vmcnt(28)
    v_mfma_f32_16x16x32_bf16 v[144:147], a[136:139], v[24:27], v[144:147]
    v_mfma_f32_16x16x32_bf16 v[148:151], a[136:139], v[28:31], v[148:151]
    v_mfma_f32_16x16x32_bf16 v[152:155], a[140:143], v[24:27], v[152:155]
    v_mfma_f32_16x16x32_bf16 v[156:159], a[140:143], v[28:31], v[156:159]
    s_waitcnt vmcnt(26)
    v_mfma_f32_16x16x32_bf16 v[144:147], a[144:147], v[32:35], v[144:147]
    v_mfma_f32_16x16x32_bf16 v[148:151], a[144:147], v[36:39], v[148:151]
    v_mfma_f32_16x16x32_bf16 v[152:155], a[148:151], v[32:35], v[152:155]
    v_mfma_f32_16x16x32_bf16 v[156:159], a[148:151], v[36:39], v[156:159]
    s_waitcnt vmcnt(24)
    v_mfma_f32_16x16x32_bf16 v[144:147], a[152:155], v[40:43], v[144:147]
    v_mfma_f32_16x16x32_bf16 v[148:151], a[152:155], v[44:47], v[148:151]
    v_mfma_f32_16x16x32_bf16 v[152:155], a[156:159], v[40:43], v[152:155]
    v_mfma_f32_16x16x32_bf16 v[156:159], a[156:159], v[44:47], v[156:159]
    s_waitcnt vmcnt(22)
    v_mfma_f32_16x16x32_bf16 v[144:147], a[160:163], v[48:51], v[144:147]
    v_mfma_f32_16x16x32_bf16 v[148:151], a[160:163], v[52:55], v[148:151]
    v_mfma_f32_16x16x32_bf16 v[152:155], a[164:167], v[48:51], v[152:155]
    v_mfma_f32_16x16x32_bf16 v[156:159], a[164:167], v[52:55], v[156:159]
    s_waitcnt vmcnt(20)
    v_mfma_f32_16x16x32_bf16 v[144:147], a[168:171], v[56:59], v[144:147]
    v_mfma_f32_16x16x32_bf16 v[148:151], a[168:171], v[60:63], v[148:151]
    v_mfma_f32_16x16x32_bf16 v[152:155], a[172:175], v[56:59], v[152:155]
    v_mfma_f32_16x16x32_bf16 v[156:159], a[172:175], v[60:63], v[156:159]
    s_waitcnt vmcnt(18)
    v_mfma_f32_16x16x32_bf16 v[144:147], a[176:179], v[64:67], v[144:147]
    v_mfma_f32_16x16x32_bf16 v[148:151], a[176:179], v[68:71], v[148:151]
    v_mfma_f32_16x16x32_bf16 v[152:155], a[180:183], v[64:67], v[152:155]
    v_mfma_f32_16x16x32_bf16 v[156:159], a[180:183], v[68:71], v[156:159]
    s_waitcnt vmcnt(16)
    v_mfma_f32_16x16x32_bf16 v[144:147], a[184:187], v[72:75], v[144:147]
    v_mfma_f32_16x16x32_bf16 v[148:151], a[184:187], v[76:79], v[148:151]
    v_mfma_f32_16x16x32_bf16 v[152:155], a[188:191], v[72:75], v[152:155]
    v_mfma_f32_16x16x32_bf16 v[156:159], a[188:191], v[76:79], v[156:159]
    s_waitcnt vmcnt(14)
    v_mfma_f32_16x16x32_bf16 v[144:147], a[192:195], v[80:83], v[144:147]
    v_mfma_f32_16x16x32_bf16 v[148:151], a[192:195], v[84:87], v[148:151]
    v_mfma_f32_16x16x32_bf16 v[152:155], a[196:199], v[80:83], v[152:155]
    v_mfma_f32_16x16x32_bf16 v[156:159], a[196:199], v[84:87], v[156:159]
    s_waitcnt vmcnt(12)
    v_mfma_f32_16x16x32_bf16 v[144:147], a[200:203], v[88:91], v[144:147]
    v_mfma_f32_16x16x32_bf16 v[148:151], a[200:203], v[92:95], v[148:151]
    v_mfma_f32_16x16x32_bf16 v[152:155], a[204:207], v[88:91], v[152:155]
    v_mfma_f32_16x16x32_bf16 v[156:159], a[204:207], v[92:95], v[156:159]
    s_waitcnt vmcnt(10)
    v_mfma_f32_16x16x32_bf16 v[144:147], a[208:211], v[96:99], v[144:147]
    v_mfma_f32_16x16x32_bf16 v[148:151], a[208:211], v[100:103], v[148:151]
    v_mfma_f32_16x16x32_bf16 v[152:155], a[212:215], v[96:99], v[152:155]
    v_mfma_f32_16x16x32_bf16 v[156:159], a[212:215], v[100:103], v[156:159]
    s_waitcnt vmcnt(8)
    v_mfma_f32_16x16x32_bf16 v[144:147], a[216:219], v[104:107], v[144:147]
    v_mfma_f32_16x16x32_bf16 v[148:151], a[216:219], v[108:111], v[148:151]
    v_mfma_f32_16x16x32_bf16 v[152:155], a[220:223], v[104:107], v[152:155]
    v_mfma_f32_16x16x32_bf16 v[156:159], a[220:223], v[108:111], v[156:159]
    s_waitcnt vmcnt(6)
    v_mfma_f32_16x16x32_bf16 v[144:147], a[224:227], v[112:115], v[144:147]
    v_mfma_f32_16x16x32_bf16 v[148:151], a[224:227], v[116:119], v[148:151]
    v_mfma_f32_16x16x32_bf16 v[152:155], a[228:231], v[112:115], v[152:155]
    v_mfma_f32_16x16x32_bf16 v[156:159], a[228:231], v[116:119], v[156:159]
    s_waitcnt vmcnt(4)
    v_mfma_f32_16x16x32_bf16 v[144:147], a[232:235], v[120:123], v[144:147]
    v_mfma_f32_16x16x32_bf16 v[148:151], a[232:235], v[124:127], v[148:151]
    v_mfma_f32_16x16x32_bf16 v[152:155], a[236:239], v[120:123], v[152:155]
    v_mfma_f32_16x16x32_bf16 v[156:159], a[236:239], v[124:127], v[156:159]
    s_waitcnt vmcnt(2)
    v_mfma_f32_16x16x32_bf16 v[144:147], a[240:243], v[128:131], v[144:147]
    v_mfma_f32_16x16x32_bf16 v[148:151], a[240:243], v[132:135], v[148:151]
    v_mfma_f32_16x16x32_bf16 v[152:155], a[244:247], v[128:131], v[152:155]
    v_mfma_f32_16x16x32_bf16 v[156:159], a[244:247], v[132:135], v[156:159]
    s_waitcnt vmcnt(0)
    v_mfma_f32_16x16x32_bf16 v[144:147], a[248:251], v[136:139], v[144:147]
    v_mfma_f32_16x16x32_bf16 v[148:151], a[248:251], v[140:143], v[148:151]
    v_mfma_f32_16x16x32_bf16 v[152:155], a[252:255], v[136:139], v[152:155]
    v_mfma_f32_16x16x32_bf16 v[156:159], a[252:255], v[140:143], v[156:159]
    s_lshl_b32 s15, s13, 12
    v_add_u32 v2, s15, v1
    s_nop 2
    ds_write_b128 v2, v[144:147] offset:0
    ds_write_b128 v2, v[148:151] offset:1024
    ds_write_b128 v2, v[152:155] offset:2048
    ds_write_b128 v2, v[156:159] offset:3072
    s_and_b32 s15, s13, 1
    s_lshl_b32 s15, s15, 10
    v_add_u32 v3, s15, v1
    v_and_b32 v4, 15, v14
    v_lshrrev_b32 v5, 2, v4
    v_and_b32 v4, 3, v4
    v_lshl_add_u32 v4, v5, 3, v4
    s_lshl_b32 s15, s40, 6
    s_lshl_b32 s18, s12, 5
    s_add_u32 s15, s15, s18
    s_and_b32 s18, s13, 1
    s_lshl_b32 s18, s18, 2
    s_add_u32 s15, s15, s18
    v_add_u32 v4, s15, v4
    v_lshlrev_b32 v4, 10, v4
    v_lshrrev_b32 v5, 4, v14
    v_lshl_add_u32 v4, v5, 4, v4
    s_lshl_b32 s15, s14, 6
    v_add_u32 v4, s15, v4
    s_lshl_b32 s18, s42, 1
    s_add_u32 s18, s18, 0
    s_lshl_b32 s18, s18, 21
    s_add_u32 s18, s18, 33554432
    buffer_load_dwordx4 v[8:11], v4, s[4:7], s18 offen sc1
    s_waitcnt lgkmcnt(0)
    s_barrier
    s_cmp_ge_u32 s13, 2
    s_cbranch_scc1 L_wo_done
    ds_read_b128 v[16:19], v3 offset:0
    ds_read_b128 v[20:23], v3 offset:2048
    ds_read_b128 v[24:27], v3 offset:4096
    ds_read_b128 v[28:31], v3 offset:6144
    ds_read_b128 v[32:35], v3 offset:8192
    ds_read_b128 v[36:39], v3 offset:10240
    ds_read_b128 v[40:43], v3 offset:12288
    ds_read_b128 v[44:47], v3 offset:14336
    s_waitcnt lgkmcnt(4)
    v_add_f32 v16, v16, v24
    v_add_f32 v17, v17, v25
    v_add_f32 v18, v18, v26
    v_add_f32 v19, v19, v27
    v_add_f32 v20, v20, v28
    v_add_f32 v21, v21, v29
    v_add_f32 v22, v22, v30
    v_add_f32 v23, v23, v31
    s_waitcnt lgkmcnt(2)
    v_add_f32 v16, v16, v32
    v_add_f32 v17, v17, v33
    v_add_f32 v18, v18, v34
    v_add_f32 v19, v19, v35
    v_add_f32 v20, v20, v36
    v_add_f32 v21, v21, v37
    v_add_f32 v22, v22, v38
    v_add_f32 v23, v23, v39
    s_waitcnt lgkmcnt(0) vmcnt(0)
    v_add_f32 v16, v16, v40
    v_add_f32 v17, v17, v41
    v_add_f32 v18, v18, v42
    v_add_f32 v19, v19, v43
    v_add_f32 v20, v20, v44
    v_add_f32 v21, v21, v45
    v_add_f32 v22, v22, v46
    v_add_f32 v23, v23, v47
    v_cvt_pk_bf16_f32 v6, v16, v17
    v_lshlrev_b32 v16, 16, v6
    v_and_b32 v17, 0xffff0000, v6
    v_lshlrev_b32 v6, 16, v8
    v_and_b32 v7, 0xffff0000, v8
    v_add_f32 v16, v16, v6
    v_add_f32 v17, v17, v7
    v_cvt_pk_bf16_f32 v48, v16, v17
    v_cvt_pk_bf16_f32 v6, v18, v19
    v_lshlrev_b32 v18, 16, v6
    v_and_b32 v19, 0xffff0000, v6
    v_lshlrev_b32 v6, 16, v9
    v_and_b32 v7, 0xffff0000, v9
    v_add_f32 v18, v18, v6
    v_add_f32 v19, v19, v7
    v_cvt_pk_bf16_f32 v49, v18, v19
    v_cvt_pk_bf16_f32 v6, v20, v21
    v_lshlrev_b32 v20, 16, v6
    v_and_b32 v21, 0xffff0000, v6
    v_lshlrev_b32 v6, 16, v10
    v_and_b32 v7, 0xffff0000, v10
    v_add_f32 v20, v20, v6
    v_add_f32 v21, v21, v7
    v_cvt_pk_bf16_f32 v50, v20, v21
    v_cvt_pk_bf16_f32 v6, v22, v23
    v_lshlrev_b32 v22, 16, v6
    v_and_b32 v23, 0xffff0000, v6
    v_lshlrev_b32 v6, 16, v11
    v_and_b32 v7, 0xffff0000, v11
    v_add_f32 v22, v22, v6
    v_add_f32 v23, v23, v7
    v_cvt_pk_bf16_f32 v51, v22, v23
    s_add_u32 s18, s18, 2097152
    buffer_store_dwordx4 v[48:51], v4, s[4:7], s18 offen sc1
L_wo_done:
    s_waitcnt vmcnt(0) lgkmcnt(0)
    s_barrier
    s_cmp_lg_u32 s13, 0
    s_cbranch_scc1 L_wloop
    s_lshl_b32 s22, s42, 8
    s_add_u32 s22, s22, s40
    s_lshl_b32 s22, s22, 6
    s_add_u32 s22, s22, 48240640
    v_mov_b32 v126, 0
    v_mov_b32 v127, 1
    s_mov_b64 exec, 1
    buffer_atomic_add v127, v126, s[4:7], s22 offen
    s_mov_b64 exec, -1
    s_branch L_wloop
L_st4:
    s_lshl_b32 s22, s42, 8
    s_add_u32 s22, s22, s40
    s_lshl_b32 s22, s22, 6
    s_add_u32 s22, s22, 48240640
    s_cmp_lg_u32 s13, 0
    s_cbranch_scc1 L_pc_done_ln1
    s_mov_b32 s26, 0
    v_mov_b32 v126, 0
L_pc_ln1:
    buffer_load_dword v127, v126, s[4:7], s22 offen sc1
    s_add_u32 s26, s26, 1
    s_cmp_gt_u32 s26, 4194304
    s_cbranch_scc1 L_mega_end
    s_waitcnt vmcnt(0)
    v_readfirstlane_b32 s27, v127
    s_nop 0
    s_cmp_ge_u32 s27, 32
    s_cbranch_scc1 L_pc_done_ln1
    s_sleep 4
    s_branch L_pc_ln1
L_pc_done_ln1:
    s_barrier
    s_lshl_b32 s23, s42, 1
    s_add_u32 s23, s23, 1
    s_lshl_b32 s23, s23, 21
    s_add_u32 s19, s23, 33554432
    s_add_u32 s18, s23, 25165824
    v_lshrrev_b32 v1, 4, v0
    s_lshl_b32 s3, s40, 6
    s_lshl_b32 s15, s41, 5
    s_add_u32 s3, s3, s15
    v_add_u32 v1, s3, v1
    v_and_b32 v2, 15, v0
    v_lshlrev_b32 v3, 10, v1
    v_lshl_add_u32 v3, v2, 4, v3
    buffer_load_dwordx4 v[16:19], v3, s[4:7], s19 offen offset:0 sc1
    buffer_load_dwordx4 v[20:23], v3, s[4:7], s19 offen offset:256 sc1
    buffer_load_dwordx4 v[24:27], v3, s[4:7], s19 offen offset:512 sc1
    buffer_load_dwordx4 v[28:31], v3, s[4:7], s19 offen offset:768 sc1
    s_add_u32 s19, s19, 16384
    buffer_load_dwordx4 v[64:67], v3, s[4:7], s19 offen offset:0 sc1
    buffer_load_dwordx4 v[68:71], v3, s[4:7], s19 offen offset:256 sc1
    buffer_load_dwordx4 v[72:75], v3, s[4:7], s19 offen offset:512 sc1
    buffer_load_dwordx4 v[76:79], v3, s[4:7], s19 offen offset:768 sc1
    v_bfe_u32 v4, v1, 3, 2
    v_and_b32 v5, 3, v1
    v_lshl_add_u32 v4, v4, 2, v5
    v_and_b32 v5, 3, v2
    v_lshl_add_u32 v4, v5, 4, v4
    v_lshlrev_b32 v4, 4, v4
    v_bfe_u32 v5, v1, 2, 1
    v_bfe_u32 v6, v1, 5, 1
    v_lshl_add_u32 v5, v6, 1, v5
    v_lshl_add_u32 v4, v5, 10, v4
    v_lshrrev_b32 v5, 6, v1
    v_lshrrev_b32 v6, 2, v2
    v_lshl_add_u32 v5, v5, 4, v6
    v_lshl_add_u32 v4, v5, 12, v4
    s_waitcnt vmcnt(4)
    v_lshlrev_b32 v32, 16, v16
    v_and_b32 v33, 0xffff0000, v16
    v_lshlrev_b32 v34, 16, v17
    v_and_b32 v35, 0xffff0000, v17
    v_lshlrev_b32 v36, 16, v18
    v_and_b32 v37, 0xffff0000, v18
    v_lshlrev_b32 v38, 16, v19
    v_and_b32 v39, 0xffff0000, v19
    v_lshlrev_b32 v40, 16, v20
    v_and_b32 v41, 0xffff0000, v20
    v_lshlrev_b32 v42, 16, v21
    v_and_b32 v43, 0xffff0000, v21
    v_lshlrev_b32 v44, 16, v22
    v_and_b32 v45, 0xffff0000, v22
    v_lshlrev_b32 v46, 16, v23
    v_and_b32 v47, 0xffff0000, v23
    v_lshlrev_b32 v48, 16, v24
    v_and_b32 v49, 0xffff0000, v24
    v_lshlrev_b32 v50, 16, v25
    v_and_b32 v51, 0xffff0000, v25
    v_lshlrev_b32 v52, 16, v26
    v_and_b32 v53, 0xffff0000, v26
    v_lshlrev_b32 v54, 16, v27
    v_and_b32 v55, 0xffff0000, v27
    v_lshlrev_b32 v56, 16, v28
    v_and_b32 v57, 0xffff0000, v28
    v_lshlrev_b32 v58, 16, v29
    v_and_b32 v59, 0xffff0000, v29
    v_lshlrev_b32 v60, 16, v30
    v_and_b32 v61, 0xffff0000, v30
    v_lshlrev_b32 v62, 16, v31
    v_and_b32 v63, 0xffff0000, v31
    v_add_f32 v7, v32, v33
    v_add_f32 v7, v7, v34
    v_add_f32 v7, v7, v35
    v_add_f32 v7, v7, v36
    v_add_f32 v7, v7, v37
    v_add_f32 v7, v7, v38
    v_add_f32 v7, v7, v39
    v_add_f32 v7, v7, v40
    v_add_f32 v7, v7, v41
    v_add_f32 v7, v7, v42
    v_add_f32 v7, v7, v43
    v_add_f32 v7, v7, v44
    v_add_f32 v7, v7, v45
    v_add_f32 v7, v7, v46
    v_add_f32 v7, v7, v47
    v_add_f32 v7, v7, v48
    v_add_f32 v7, v7, v49
    v_add_f32 v7, v7, v50
    v_add_f32 v7, v7, v51
    v_add_f32 v7, v7, v52
    v_add_f32 v7, v7, v53
    v_add_f32 v7, v7, v54
    v_add_f32 v7, v7, v55
    v_add_f32 v7, v7, v56
    v_add_f32 v7, v7, v57
    v_add_f32 v7, v7, v58
    v_add_f32 v7, v7, v59
    v_add_f32 v7, v7, v60
    v_add_f32 v7, v7, v61
    v_add_f32 v7, v7, v62
    v_add_f32 v7, v7, v63
    s_nop 1
    v_add_f32_dpp v7, v7, v7 row_ror:8
    s_nop 1
    v_add_f32_dpp v7, v7, v7 row_ror:4
    s_nop 1
    v_add_f32_dpp v7, v7, v7 row_ror:2
    s_nop 1
    v_add_f32_dpp v7, v7, v7 row_ror:1
    v_mul_f32 v7, 0x3b000000, v7
    v_sub_f32 v8, v32, v7
    v_mul_f32 v9, v8, v8
    v_sub_f32 v8, v33, v7
    v_fmac_f32 v9, v8, v8
    v_sub_f32 v8, v34, v7
    v_fmac_f32 v9, v8, v8
    v_sub_f32 v8, v35, v7
    v_fmac_f32 v9, v8, v8
    v_sub_f32 v8, v36, v7
    v_fmac_f32 v9, v8, v8
    v_sub_f32 v8, v37, v7
    v_fmac_f32 v9, v8, v8
    v_sub_f32 v8, v38, v7
    v_fmac_f32 v9, v8, v8
    v_sub_f32 v8, v39, v7
    v_fmac_f32 v9, v8, v8
    v_sub_f32 v8, v40, v7
    v_fmac_f32 v9, v8, v8
    v_sub_f32 v8, v41, v7
    v_fmac_f32 v9, v8, v8
    v_sub_f32 v8, v42, v7
    v_fmac_f32 v9, v8, v8
    v_sub_f32 v8, v43, v7
    v_fmac_f32 v9, v8, v8
    v_sub_f32 v8, v44, v7
    v_fmac_f32 v9, v8, v8
    v_sub_f32 v8, v45, v7
    v_fmac_f32 v9, v8, v8
    v_sub_f32 v8, v46, v7
    v_fmac_f32 v9, v8, v8
    v_sub_f32 v8, v47, v7
    v_fmac_f32 v9, v8, v8
    v_sub_f32 v8, v48, v7
    v_fmac_f32 v9, v8, v8
    v_sub_f32 v8, v49, v7
    v_fmac_f32 v9, v8, v8
    v_sub_f32 v8, v50, v7
    v_fmac_f32 v9, v8, v8
    v_sub_f32 v8, v51, v7
    v_fmac_f32 v9, v8, v8
    v_sub_f32 v8, v52, v7
    v_fmac_f32 v9, v8, v8
    v_sub_f32 v8, v53, v7
    v_fmac_f32 v9, v8, v8
    v_sub_f32 v8, v54, v7
    v_fmac_f32 v9, v8, v8
    v_sub_f32 v8, v55, v7
    v_fmac_f32 v9, v8, v8
    v_sub_f32 v8, v56, v7
    v_fmac_f32 v9, v8, v8
    v_sub_f32 v8, v57, v7
    v_fmac_f32 v9, v8, v8
    v_sub_f32 v8, v58, v7
    v_fmac_f32 v9, v8, v8
    v_sub_f32 v8, v59, v7
    v_fmac_f32 v9, v8, v8
    v_sub_f32 v8, v60, v7
    v_fmac_f32 v9, v8, v8
    v_sub_f32 v8, v61, v7
    v_fmac_f32 v9, v8, v8
    v_sub_f32 v8, v62, v7
    v_fmac_f32 v9, v8, v8
    v_sub_f32 v8, v63, v7
    v_fmac_f32 v9, v8, v8
    s_nop 1
    v_add_f32_dpp v9, v9, v9 row_ror:8
    s_nop 1
    v_add_f32_dpp v9, v9, v9 row_ror:4
    s_nop 1
    v_add_f32_dpp v9, v9, v9 row_ror:2
    s_nop 1
    v_add_f32_dpp v9, v9, v9 row_ror:1
    v_mul_f32 v9, 0x3b000000, v9
    v_cvt_pk_bf16_f32 v10, v7, v7
    v_lshlrev_b32 v7, 16, v10
    v_cvt_pk_bf16_f32 v10, v9, v9
    v_lshlrev_b32 v9, 16, v10
    v_add_f32 v9, 0x3727c5ac, v9
    v_cvt_pk_bf16_f32 v10, v9, v9
    v_lshlrev_b32 v9, 16, v10
    v_sqrt_f32 v9, v9
    s_nop 0
    v_cvt_pk_bf16_f32 v10, v9, v9
    v_lshlrev_b32 v9, 16, v10
    v_rcp_f32 v9, v9
    v_sub_f32 v32, v32, v7
    v_sub_f32 v33, v33, v7
    v_cvt_pk_bf16_f32 v10, v32, v33
    v_lshlrev_b32 v32, 16, v10
    v_and_b32 v33, 0xffff0000, v10
    v_mul_f32 v32, v32, v9
    v_mul_f32 v33, v33, v9
    v_cvt_pk_bf16_f32 v16, v32, v33
    v_sub_f32 v34, v34, v7
    v_sub_f32 v35, v35, v7
    v_cvt_pk_bf16_f32 v10, v34, v35
    v_lshlrev_b32 v34, 16, v10
    v_and_b32 v35, 0xffff0000, v10
    v_mul_f32 v34, v34, v9
    v_mul_f32 v35, v35, v9
    v_cvt_pk_bf16_f32 v17, v34, v35
    v_sub_f32 v36, v36, v7
    v_sub_f32 v37, v37, v7
    v_cvt_pk_bf16_f32 v10, v36, v37
    v_lshlrev_b32 v36, 16, v10
    v_and_b32 v37, 0xffff0000, v10
    v_mul_f32 v36, v36, v9
    v_mul_f32 v37, v37, v9
    v_cvt_pk_bf16_f32 v18, v36, v37
    v_sub_f32 v38, v38, v7
    v_sub_f32 v39, v39, v7
    v_cvt_pk_bf16_f32 v10, v38, v39
    v_lshlrev_b32 v38, 16, v10
    v_and_b32 v39, 0xffff0000, v10
    v_mul_f32 v38, v38, v9
    v_mul_f32 v39, v39, v9
    v_cvt_pk_bf16_f32 v19, v38, v39
    v_sub_f32 v40, v40, v7
    v_sub_f32 v41, v41, v7
    v_cvt_pk_bf16_f32 v10, v40, v41
    v_lshlrev_b32 v40, 16, v10
    v_and_b32 v41, 0xffff0000, v10
    v_mul_f32 v40, v40, v9
    v_mul_f32 v41, v41, v9
    v_cvt_pk_bf16_f32 v20, v40, v41
    v_sub_f32 v42, v42, v7
    v_sub_f32 v43, v43, v7
    v_cvt_pk_bf16_f32 v10, v42, v43
    v_lshlrev_b32 v42, 16, v10
    v_and_b32 v43, 0xffff0000, v10
    v_mul_f32 v42, v42, v9
    v_mul_f32 v43, v43, v9
    v_cvt_pk_bf16_f32 v21, v42, v43
    v_sub_f32 v44, v44, v7
    v_sub_f32 v45, v45, v7
    v_cvt_pk_bf16_f32 v10, v44, v45
    v_lshlrev_b32 v44, 16, v10
    v_and_b32 v45, 0xffff0000, v10
    v_mul_f32 v44, v44, v9
    v_mul_f32 v45, v45, v9
    v_cvt_pk_bf16_f32 v22, v44, v45
    v_sub_f32 v46, v46, v7
    v_sub_f32 v47, v47, v7
    v_cvt_pk_bf16_f32 v10, v46, v47
    v_lshlrev_b32 v46, 16, v10
    v_and_b32 v47, 0xffff0000, v10
    v_mul_f32 v46, v46, v9
    v_mul_f32 v47, v47, v9
    v_cvt_pk_bf16_f32 v23, v46, v47
    v_sub_f32 v48, v48, v7
    v_sub_f32 v49, v49, v7
    v_cvt_pk_bf16_f32 v10, v48, v49
    v_lshlrev_b32 v48, 16, v10
    v_and_b32 v49, 0xffff0000, v10
    v_mul_f32 v48, v48, v9
    v_mul_f32 v49, v49, v9
    v_cvt_pk_bf16_f32 v24, v48, v49
    v_sub_f32 v50, v50, v7
    v_sub_f32 v51, v51, v7
    v_cvt_pk_bf16_f32 v10, v50, v51
    v_lshlrev_b32 v50, 16, v10
    v_and_b32 v51, 0xffff0000, v10
    v_mul_f32 v50, v50, v9
    v_mul_f32 v51, v51, v9
    v_cvt_pk_bf16_f32 v25, v50, v51
    v_sub_f32 v52, v52, v7
    v_sub_f32 v53, v53, v7
    v_cvt_pk_bf16_f32 v10, v52, v53
    v_lshlrev_b32 v52, 16, v10
    v_and_b32 v53, 0xffff0000, v10
    v_mul_f32 v52, v52, v9
    v_mul_f32 v53, v53, v9
    v_cvt_pk_bf16_f32 v26, v52, v53
    v_sub_f32 v54, v54, v7
    v_sub_f32 v55, v55, v7
    v_cvt_pk_bf16_f32 v10, v54, v55
    v_lshlrev_b32 v54, 16, v10
    v_and_b32 v55, 0xffff0000, v10
    v_mul_f32 v54, v54, v9
    v_mul_f32 v55, v55, v9
    v_cvt_pk_bf16_f32 v27, v54, v55
    v_sub_f32 v56, v56, v7
    v_sub_f32 v57, v57, v7
    v_cvt_pk_bf16_f32 v10, v56, v57
    v_lshlrev_b32 v56, 16, v10
    v_and_b32 v57, 0xffff0000, v10
    v_mul_f32 v56, v56, v9
    v_mul_f32 v57, v57, v9
    v_cvt_pk_bf16_f32 v28, v56, v57
    v_sub_f32 v58, v58, v7
    v_sub_f32 v59, v59, v7
    v_cvt_pk_bf16_f32 v10, v58, v59
    v_lshlrev_b32 v58, 16, v10
    v_and_b32 v59, 0xffff0000, v10
    v_mul_f32 v58, v58, v9
    v_mul_f32 v59, v59, v9
    v_cvt_pk_bf16_f32 v29, v58, v59
    v_sub_f32 v60, v60, v7
    v_sub_f32 v61, v61, v7
    v_cvt_pk_bf16_f32 v10, v60, v61
    v_lshlrev_b32 v60, 16, v10
    v_and_b32 v61, 0xffff0000, v10
    v_mul_f32 v60, v60, v9
    v_mul_f32 v61, v61, v9
    v_cvt_pk_bf16_f32 v30, v60, v61
    v_sub_f32 v62, v62, v7
    v_sub_f32 v63, v63, v7
    v_cvt_pk_bf16_f32 v10, v62, v63
    v_lshlrev_b32 v62, 16, v10
    v_and_b32 v63, 0xffff0000, v10
    v_mul_f32 v62, v62, v9
    v_mul_f32 v63, v63, v9
    v_cvt_pk_bf16_f32 v31, v62, v63
    s_add_u32 s20, s18, 0
    buffer_store_dwordx4 v[16:19], v4, s[4:7], s20 offen sc1
    s_add_u32 s20, s18, 16384
    buffer_store_dwordx4 v[20:23], v4, s[4:7], s20 offen sc1
    s_add_u32 s20, s18, 32768
    buffer_store_dwordx4 v[24:27], v4, s[4:7], s20 offen sc1
    s_add_u32 s20, s18, 49152
    buffer_store_dwordx4 v[28:31], v4, s[4:7], s20 offen sc1
    s_waitcnt vmcnt(4)
    v_mov_b32 v16, v64
    v_mov_b32 v17, v65
    v_mov_b32 v18, v66
    v_mov_b32 v19, v67
    v_mov_b32 v20, v68
    v_mov_b32 v21, v69
    v_mov_b32 v22, v70
    v_mov_b32 v23, v71
    v_mov_b32 v24, v72
    v_mov_b32 v25, v73
    v_mov_b32 v26, v74
    v_mov_b32 v27, v75
    v_mov_b32 v28, v76
    v_mov_b32 v29, v77
    v_mov_b32 v30, v78
    v_mov_b32 v31, v79
    v_lshlrev_b32 v32, 16, v16
    v_and_b32 v33, 0xffff0000, v16
    v_lshlrev_b32 v34, 16, v17
    v_and_b32 v35, 0xffff0000, v17
    v_lshlrev_b32 v36, 16, v18
    v_and_b32 v37, 0xffff0000, v18
    v_lshlrev_b32 v38, 16, v19
    v_and_b32 v39, 0xffff0000, v19
    v_lshlrev_b32 v40, 16, v20
    v_and_b32 v41, 0xffff0000, v20
    v_lshlrev_b32 v42, 16, v21
    v_and_b32 v43, 0xffff0000, v21
    v_lshlrev_b32 v44, 16, v22
    v_and_b32 v45, 0xffff0000, v22
    v_lshlrev_b32 v46, 16, v23
    v_and_b32 v47, 0xffff0000, v23
    v_lshlrev_b32 v48, 16, v24
    v_and_b32 v49, 0xffff0000, v24
    v_lshlrev_b32 v50, 16, v25
    v_and_b32 v51, 0xffff0000, v25
    v_lshlrev_b32 v52, 16, v26
    v_and_b32 v53, 0xffff0000, v26
    v_lshlrev_b32 v54, 16, v27
    v_and_b32 v55, 0xffff0000, v27
    v_lshlrev_b32 v56, 16, v28
    v_and_b32 v57, 0xffff0000, v28
    v_lshlrev_b32 v58, 16, v29
    v_and_b32 v59, 0xffff0000, v29
    v_lshlrev_b32 v60, 16, v30
    v_and_b32 v61, 0xffff0000, v30
    v_lshlrev_b32 v62, 16, v31
    v_and_b32 v63, 0xffff0000, v31
    v_add_f32 v7, v32, v33
    v_add_f32 v7, v7, v34
    v_add_f32 v7, v7, v35
    v_add_f32 v7, v7, v36
    v_add_f32 v7, v7, v37
    v_add_f32 v7, v7, v38
    v_add_f32 v7, v7, v39
    v_add_f32 v7, v7, v40
    v_add_f32 v7, v7, v41
    v_add_f32 v7, v7, v42
    v_add_f32 v7, v7, v43
    v_add_f32 v7, v7, v44
    v_add_f32 v7, v7, v45
    v_add_f32 v7, v7, v46
    v_add_f32 v7, v7, v47
    v_add_f32 v7, v7, v48
    v_add_f32 v7, v7, v49
    v_add_f32 v7, v7, v50
    v_add_f32 v7, v7, v51
    v_add_f32 v7, v7, v52
    v_add_f32 v7, v7, v53
    v_add_f32 v7, v7, v54
    v_add_f32 v7, v7, v55
    v_add_f32 v7, v7, v56
    v_add_f32 v7, v7, v57
    v_add_f32 v7, v7, v58
    v_add_f32 v7, v7, v59
    v_add_f32 v7, v7, v60
    v_add_f32 v7, v7, v61
    v_add_f32 v7, v7, v62
    v_add_f32 v7, v7, v63
    s_nop 1
    v_add_f32_dpp v7, v7, v7 row_ror:8
    s_nop 1
    v_add_f32_dpp v7, v7, v7 row_ror:4
    s_nop 1
    v_add_f32_dpp v7, v7, v7 row_ror:2
    s_nop 1
    v_add_f32_dpp v7, v7, v7 row_ror:1
    v_mul_f32 v7, 0x3b000000, v7
    v_sub_f32 v8, v32, v7
    v_mul_f32 v9, v8, v8
    v_sub_f32 v8, v33, v7
    v_fmac_f32 v9, v8, v8
    v_sub_f32 v8, v34, v7
    v_fmac_f32 v9, v8, v8
    v_sub_f32 v8, v35, v7
    v_fmac_f32 v9, v8, v8
    v_sub_f32 v8, v36, v7
    v_fmac_f32 v9, v8, v8
    v_sub_f32 v8, v37, v7
    v_fmac_f32 v9, v8, v8
    v_sub_f32 v8, v38, v7
    v_fmac_f32 v9, v8, v8
    v_sub_f32 v8, v39, v7
    v_fmac_f32 v9, v8, v8
    v_sub_f32 v8, v40, v7
    v_fmac_f32 v9, v8, v8
    v_sub_f32 v8, v41, v7
    v_fmac_f32 v9, v8, v8
    v_sub_f32 v8, v42, v7
    v_fmac_f32 v9, v8, v8
    v_sub_f32 v8, v43, v7
    v_fmac_f32 v9, v8, v8
    v_sub_f32 v8, v44, v7
    v_fmac_f32 v9, v8, v8
    v_sub_f32 v8, v45, v7
    v_fmac_f32 v9, v8, v8
    v_sub_f32 v8, v46, v7
    v_fmac_f32 v9, v8, v8
    v_sub_f32 v8, v47, v7
    v_fmac_f32 v9, v8, v8
    v_sub_f32 v8, v48, v7
    v_fmac_f32 v9, v8, v8
    v_sub_f32 v8, v49, v7
    v_fmac_f32 v9, v8, v8
    v_sub_f32 v8, v50, v7
    v_fmac_f32 v9, v8, v8
    v_sub_f32 v8, v51, v7
    v_fmac_f32 v9, v8, v8
    v_sub_f32 v8, v52, v7
    v_fmac_f32 v9, v8, v8
    v_sub_f32 v8, v53, v7
    v_fmac_f32 v9, v8, v8
    v_sub_f32 v8, v54, v7
    v_fmac_f32 v9, v8, v8
    v_sub_f32 v8, v55, v7
    v_fmac_f32 v9, v8, v8
    v_sub_f32 v8, v56, v7
    v_fmac_f32 v9, v8, v8
    v_sub_f32 v8, v57, v7
    v_fmac_f32 v9, v8, v8
    v_sub_f32 v8, v58, v7
    v_fmac_f32 v9, v8, v8
    v_sub_f32 v8, v59, v7
    v_fmac_f32 v9, v8, v8
    v_sub_f32 v8, v60, v7
    v_fmac_f32 v9, v8, v8
    v_sub_f32 v8, v61, v7
    v_fmac_f32 v9, v8, v8
    v_sub_f32 v8, v62, v7
    v_fmac_f32 v9, v8, v8
    v_sub_f32 v8, v63, v7
    v_fmac_f32 v9, v8, v8
    s_nop 1
    v_add_f32_dpp v9, v9, v9 row_ror:8
    s_nop 1
    v_add_f32_dpp v9, v9, v9 row_ror:4
    s_nop 1
    v_add_f32_dpp v9, v9, v9 row_ror:2
    s_nop 1
    v_add_f32_dpp v9, v9, v9 row_ror:1
    v_mul_f32 v9, 0x3b000000, v9
    v_cvt_pk_bf16_f32 v10, v7, v7
    v_lshlrev_b32 v7, 16, v10
    v_cvt_pk_bf16_f32 v10, v9, v9
    v_lshlrev_b32 v9, 16, v10
    v_add_f32 v9, 0x3727c5ac, v9
    v_cvt_pk_bf16_f32 v10, v9, v9
    v_lshlrev_b32 v9, 16, v10
    v_sqrt_f32 v9, v9
    s_nop 0
    v_cvt_pk_bf16_f32 v10, v9, v9
    v_lshlrev_b32 v9, 16, v10
    v_rcp_f32 v9, v9
    v_sub_f32 v32, v32, v7
    v_sub_f32 v33, v33, v7
    v_cvt_pk_bf16_f32 v10, v32, v33
    v_lshlrev_b32 v32, 16, v10
    v_and_b32 v33, 0xffff0000, v10
    v_mul_f32 v32, v32, v9
    v_mul_f32 v33, v33, v9
    v_cvt_pk_bf16_f32 v16, v32, v33
    v_sub_f32 v34, v34, v7
    v_sub_f32 v35, v35, v7
    v_cvt_pk_bf16_f32 v10, v34, v35
    v_lshlrev_b32 v34, 16, v10
    v_and_b32 v35, 0xffff0000, v10
    v_mul_f32 v34, v34, v9
    v_mul_f32 v35, v35, v9
    v_cvt_pk_bf16_f32 v17, v34, v35
    v_sub_f32 v36, v36, v7
    v_sub_f32 v37, v37, v7
    v_cvt_pk_bf16_f32 v10, v36, v37
    v_lshlrev_b32 v36, 16, v10
    v_and_b32 v37, 0xffff0000, v10
    v_mul_f32 v36, v36, v9
    v_mul_f32 v37, v37, v9
    v_cvt_pk_bf16_f32 v18, v36, v37
    v_sub_f32 v38, v38, v7
    v_sub_f32 v39, v39, v7
    v_cvt_pk_bf16_f32 v10, v38, v39
    v_lshlrev_b32 v38, 16, v10
    v_and_b32 v39, 0xffff0000, v10
    v_mul_f32 v38, v38, v9
    v_mul_f32 v39, v39, v9
    v_cvt_pk_bf16_f32 v19, v38, v39
    v_sub_f32 v40, v40, v7
    v_sub_f32 v41, v41, v7
    v_cvt_pk_bf16_f32 v10, v40, v41
    v_lshlrev_b32 v40, 16, v10
    v_and_b32 v41, 0xffff0000, v10
    v_mul_f32 v40, v40, v9
    v_mul_f32 v41, v41, v9
    v_cvt_pk_bf16_f32 v20, v40, v41
    v_sub_f32 v42, v42, v7
    v_sub_f32 v43, v43, v7
    v_cvt_pk_bf16_f32 v10, v42, v43
    v_lshlrev_b32 v42, 16, v10
    v_and_b32 v43, 0xffff0000, v10
    v_mul_f32 v42, v42, v9
    v_mul_f32 v43, v43, v9
    v_cvt_pk_bf16_f32 v21, v42, v43
    v_sub_f32 v44, v44, v7
    v_sub_f32 v45, v45, v7
    v_cvt_pk_bf16_f32 v10, v44, v45
    v_lshlrev_b32 v44, 16, v10
    v_and_b32 v45, 0xffff0000, v10
    v_mul_f32 v44, v44, v9
    v_mul_f32 v45, v45, v9
    v_cvt_pk_bf16_f32 v22, v44, v45
    v_sub_f32 v46, v46, v7
    v_sub_f32 v47, v47, v7
    v_cvt_pk_bf16_f32 v10, v46, v47
    v_lshlrev_b32 v46, 16, v10
    v_and_b32 v47, 0xffff0000, v10
    v_mul_f32 v46, v46, v9
    v_mul_f32 v47, v47, v9
    v_cvt_pk_bf16_f32 v23, v46, v47
    v_sub_f32 v48, v48, v7
    v_sub_f32 v49, v49, v7
    v_cvt_pk_bf16_f32 v10, v48, v49
    v_lshlrev_b32 v48, 16, v10
    v_and_b32 v49, 0xffff0000, v10
    v_mul_f32 v48, v48, v9
    v_mul_f32 v49, v49, v9
    v_cvt_pk_bf16_f32 v24, v48, v49
    v_sub_f32 v50, v50, v7
    v_sub_f32 v51, v51, v7
    v_cvt_pk_bf16_f32 v10, v50, v51
    v_lshlrev_b32 v50, 16, v10
    v_and_b32 v51, 0xffff0000, v10
    v_mul_f32 v50, v50, v9
    v_mul_f32 v51, v51, v9
    v_cvt_pk_bf16_f32 v25, v50, v51
    v_sub_f32 v52, v52, v7
    v_sub_f32 v53, v53, v7
    v_cvt_pk_bf16_f32 v10, v52, v53
    v_lshlrev_b32 v52, 16, v10
    v_and_b32 v53, 0xffff0000, v10
    v_mul_f32 v52, v52, v9
    v_mul_f32 v53, v53, v9
    v_cvt_pk_bf16_f32 v26, v52, v53
    v_sub_f32 v54, v54, v7
    v_sub_f32 v55, v55, v7
    v_cvt_pk_bf16_f32 v10, v54, v55
    v_lshlrev_b32 v54, 16, v10
    v_and_b32 v55, 0xffff0000, v10
    v_mul_f32 v54, v54, v9
    v_mul_f32 v55, v55, v9
    v_cvt_pk_bf16_f32 v27, v54, v55
    v_sub_f32 v56, v56, v7
    v_sub_f32 v57, v57, v7
    v_cvt_pk_bf16_f32 v10, v56, v57
    v_lshlrev_b32 v56, 16, v10
    v_and_b32 v57, 0xffff0000, v10
    v_mul_f32 v56, v56, v9
    v_mul_f32 v57, v57, v9
    v_cvt_pk_bf16_f32 v28, v56, v57
    v_sub_f32 v58, v58, v7
    v_sub_f32 v59, v59, v7
    v_cvt_pk_bf16_f32 v10, v58, v59
    v_lshlrev_b32 v58, 16, v10
    v_and_b32 v59, 0xffff0000, v10
    v_mul_f32 v58, v58, v9
    v_mul_f32 v59, v59, v9
    v_cvt_pk_bf16_f32 v29, v58, v59
    v_sub_f32 v60, v60, v7
    v_sub_f32 v61, v61, v7
    v_cvt_pk_bf16_f32 v10, v60, v61
    v_lshlrev_b32 v60, 16, v10
    v_and_b32 v61, 0xffff0000, v10
    v_mul_f32 v60, v60, v9
    v_mul_f32 v61, v61, v9
    v_cvt_pk_bf16_f32 v30, v60, v61
    v_sub_f32 v62, v62, v7
    v_sub_f32 v63, v63, v7
    v_cvt_pk_bf16_f32 v10, v62, v63
    v_lshlrev_b32 v62, 16, v10
    v_and_b32 v63, 0xffff0000, v10
    v_mul_f32 v62, v62, v9
    v_mul_f32 v63, v63, v9
    v_cvt_pk_bf16_f32 v31, v62, v63
    s_add_u32 s20, s18, 128
    buffer_store_dwordx4 v[16:19], v4, s[4:7], s20 offen sc1
    s_add_u32 s20, s18, 16512
    buffer_store_dwordx4 v[20:23], v4, s[4:7], s20 offen sc1
    s_add_u32 s20, s18, 32896
    buffer_store_dwordx4 v[24:27], v4, s[4:7], s20 offen sc1
    s_add_u32 s20, s18, 49280
    buffer_store_dwordx4 v[28:31], v4, s[4:7], s20 offen sc1
    s_waitcnt vmcnt(0) lgkmcnt(0)
    s_barrier
    s_cmp_lg_u32 s13, 0
    s_cbranch_scc1 L_wloop
    s_lshl_b32 s22, s42, 8
    s_add_u32 s22, s22, s40
    s_lshl_b32 s22, s22, 6
    s_add_u32 s22, s22, 48242688
    v_mov_b32 v126, 0
    v_mov_b32 v127, 1
    s_mov_b64 exec, 1
    buffer_atomic_add v127, v126, s[4:7], s22 offen
    s_mov_b64 exec, -1
    s_branch L_wloop
L_st5:
    s_lshl_b32 s16, s41, 2
    s_add_u32 s16, s16, s13
    s_lshl_b32 s15, s16, 16
    s_add_u32 s15, s15, 16777216
    v_and_b32 v4, 63, v0
    v_lshlrev_b32 v4, 4, v4
    s_bitcmp0_b32 s72, 16
    s_cbranch_scc1 L_g_nopre
    s_mov_b32 s22, 48291840
    s_cmp_lg_u32 s13, 0
    s_cbranch_scc1 L_pc_done_g_su
    s_mov_b32 s26, 0
    v_mov_b32 v126, 0
L_pc_g_su:
    buffer_load_dword v127, v126, s[4:7], s22 offen sc1
    s_add_u32 s26, s26, 1
    s_cmp_gt_u32 s26, 4194304
    s_cbranch_scc1 L_mega_end
    s_waitcnt vmcnt(0)
    v_readfirstlane_b32 s27, v127
    s_nop 0
    s_cmp_ge_u32 s27, 64
    s_cbranch_scc1 L_pc_done_g_su
    s_sleep 4
    s_branch L_pc_g_su
L_pc_done_g_su:
    s_barrier
    v_and_b32 v14, 63, v0
    s_lshl_b32 s24, s13, 14
    s_mov_b32 s8, s92
    s_and_b32 s9, s93, 0xffff
    s_mov_b32 s10, 1835008
    s_mov_b32 s11, 0x00020000
    s_lshl_b32 s15, s16, 6
    v_lshrrev_b32 v2, 2, v14
    s_mov_b32 s23, 3584
    v_mul_lo_u32 v2, s23, v2
    v_and_b32 v3, 3, v14
    v_lshl_add_u32 v2, v3, 4, v2
    v_lshlrev_b32 v3, 4, v14
    v_add_u32 v3, s24, v3
    v_lshrrev_b32 v5, 4, v14
    v_bfe_u32 v6, v14, 2, 2
    v_lshl_add_u32 v5, v5, 3, v6
    v_mul_u32_u24 v5, 64, v5
    v_and_b32 v6, 3, v14
    v_lshl_add_u32 v5, v6, 4, v5
    v_add_u32 v5, s24, v5
    buffer_load_dwordx4 v[16:19], v2, s[8:11], s15 offen
    s_add_u32 s15, s15, 57344
    buffer_load_dwordx4 v[20:23], v2, s[8:11], s15 offen
    s_add_u32 s15, s15, 57344
    buffer_load_dwordx4 v[24:27], v2, s[8:11], s15 offen
    s_add_u32 s15, s15, 57344
    buffer_load_dwordx4 v[28:31], v2, s[8:11], s15 offen
    s_add_u32 s15, s15, 57344
    buffer_load_dwordx4 v[32:35], v2, s[8:11], s15 offen
    s_add_u32 s15, s15, 57344
    buffer_load_dwordx4 v[36:39], v2, s[8:11], s15 offen
    s_add_u32 s15, s15, 57344
    buffer_load_dwordx4 v[40:43], v2, s[8:11], s15 offen
    s_add_u32 s15, s15, 57344
    buffer_load_dwordx4 v[44:47], v2, s[8:11], s15 offen
    s_add_u32 s15, s15, 57344
    buffer_load_dwordx4 v[48:51], v2, s[8:11], s15 offen
    s_add_u32 s15, s15, 57344
    buffer_load_dwordx4 v[52:55], v2, s[8:11], s15 offen
    s_add_u32 s15, s15, 57344
    buffer_load_dwordx4 v[56:59], v2, s[8:11], s15 offen
    s_add_u32 s15, s15, 57344
    buffer_load_dwordx4 v[60:63], v2, s[8:11], s15 offen
    s_add_u32 s15, s15, 57344
    buffer_load_dwordx4 v[64:67], v2, s[8:11], s15 offen
    s_add_u32 s15, s15, 57344
    buffer_load_dwordx4 v[68:71], v2, s[8:11], s15 offen
    s_add_u32 s15, s15, 57344
    buffer_load_dwordx4 v[72:75], v2, s[8:11], s15 offen
    s_add_u32 s15, s15, 57344
    buffer_load_dwordx4 v[76:79], v2, s[8:11], s15 offen
    s_add_u32 s15, s15, 57344
    buffer_load_dwordx4 v[80:83], v2, s[8:11], s15 offen
    s_add_u32 s15, s15, 57344
    buffer_load_dwordx4 v[84:87], v2, s[8:11], s15 offen
    s_add_u32 s15, s15, 57344
    buffer_load_dwordx4 v[88:91], v2, s[8:11], s15 offen
    s_add_u32 s15, s15, 57344
    buffer_load_dwordx4 v[92:95], v2, s[8:11], s15 offen
    s_add_u32 s15, s15, 57344
    buffer_load_dwordx4 v[96:99], v2, s[8:11], s15 offen
    s_add_u32 s15, s15, 57344
    buffer_load_dwordx4 v[100:103], v2, s[8:11], s15 offen
    s_add_u32 s15, s15, 57344
    buffer_load_dwordx4 v[104:107], v2, s[8:11], s15 offen
    s_add_u32 s15, s15, 57344
    buffer_load_dwordx4 v[108:111], v2, s[8:11], s15 offen
    s_add_u32 s15, s15, 57344
    buffer_load_dwordx4 v[112:115], v2, s[8:11], s15 offen
    s_add_u32 s15, s15, 57344
    buffer_load_dwordx4 v[116:119], v2, s[8:11], s15 offen
    s_add_u32 s15, s15, 57344
    buffer_load_dwordx4 v[120:123], v2, s[8:11], s15 offen
    s_add_u32 s15, s15, 57344
    buffer_load_dwordx4 v[124:127], v2, s[8:11], s15 offen
    s_add_u32 s15, s15, 57344
    buffer_load_dwordx4 v[128:131], v2, s[8:11], s15 offen
    s_add_u32 s15, s15, 57344
    buffer_load_dwordx4 v[132:135], v2, s[8:11], s15 offen
    s_add_u32 s15, s15, 57344
    buffer_load_dwordx4 v[136:139], v2, s[8:11], s15 offen
    s_add_u32 s15, s15, 57344
    buffer_load_dwordx4 v[140:143], v2, s[8:11], s15 offen
    s_add_u32 s15, s15, 57344
    s_waitcnt vmcnt(16)
    ds_write_b128 v3, v[16:19] offset:0
    ds_write_b128 v3, v[20:23] offset:1024
    ds_write_b128 v3, v[24:27] offset:2048
    ds_write_b128 v3, v[28:31] offset:3072
    ds_write_b128 v3, v[32:35] offset:4096
    ds_write_b128 v3, v[36:39] offset:5120
    ds_write_b128 v3, v[40:43] offset:6144
    ds_write_b128 v3, v[44:47] offset:7168
    ds_write_b128 v3, v[48:51] offset:8192
    ds_write_b128 v3, v[52:55] offset:9216
    ds_write_b128 v3, v[56:59] offset:10240
    ds_write_b128 v3, v[60:63] offset:11264
    ds_write_b128 v3, v[64:67] offset:12288
    ds_write_b128 v3, v[68:71] offset:13312
    ds_write_b128 v3, v[72:75] offset:14336
    ds_write_b128 v3, v[76:79] offset:15360
    s_waitcnt lgkmcnt(0)
    ds_read_b64_tr_b16 a[0:1], v5 offset:0
    ds_read_b64_tr_b16 a[2:3], v5 offset:256
    ds_read_b64_tr_b16 a[4:5], v5 offset:8
    ds_read_b64_tr_b16 a[6:7], v5 offset:264
    ds_read_b64_tr_b16 a[16:17], v5 offset:2048
    ds_read_b64_tr_b16 a[18:19], v5 offset:2304
    ds_read_b64_tr_b16 a[20:21], v5 offset:2056
    ds_read_b64_tr_b16 a[22:23], v5 offset:2312
    ds_read_b64_tr_b16 a[32:33], v5 offset:4096
    ds_read_b64_tr_b16 a[34:35], v5 offset:4352
    ds_read_b64_tr_b16 a[36:37], v5 offset:4104
    ds_read_b64_tr_b16 a[38:39], v5 offset:4360
    ds_read_b64_tr_b16 a[48:49], v5 offset:6144
    ds_read_b64_tr_b16 a[50:51], v5 offset:6400
    ds_read_b64_tr_b16 a[52:53], v5 offset:6152
    ds_read_b64_tr_b16 a[54:55], v5 offset:6408
    ds_read_b64_tr_b16 a[64:65], v5 offset:8192
    ds_read_b64_tr_b16 a[66:67], v5 offset:8448
    ds_read_b64_tr_b16 a[68:69], v5 offset:8200
    ds_read_b64_tr_b16 a[70:71], v5 offset:8456
    ds_read_b64_tr_b16 a[80:81], v5 offset:10240
    ds_read_b64_tr_b16 a[82:83], v5 offset:10496
    ds_read_b64_tr_b16 a[84:85], v5 offset:10248
    ds_read_b64_tr_b16 a[86:87], v5 offset:10504
    ds_read_b64_tr_b16 a[96:97], v5 offset:12288
    ds_read_b64_tr_b16 a[98:99], v5 offset:12544
    ds_read_b64_tr_b16 a[100:101], v5 offset:12296
    ds_read_b64_tr_b16 a[102:103], v5 offset:12552
    ds_read_b64_tr_b16 a[112:113], v5 offset:14336
    ds_read_b64_tr_b16 a[114:115], v5 offset:14592
    ds_read_b64_tr_b16 a[116:117], v5 offset:14344
    ds_read_b64_tr_b16 a[118:119], v5 offset:14600
    s_waitcnt lgkmcnt(0)
    s_waitcnt vmcnt(0)
    ds_write_b128 v3, v[80:83] offset:0
    ds_write_b128 v3, v[84:87] offset:1024
    ds_write_b128 v3, v[88:91] offset:2048
    ds_write_b128 v3, v[92:95] offset:3072
    ds_write_b128 v3, v[96:99] offset:4096
    ds_write_b128 v3, v[100:103] offset:5120
    ds_write_b128 v3, v[104:107] offset:6144
    ds_write_b128 v3, v[108:111] offset:7168
    ds_write_b128 v3, v[112:115] offset:8192
    ds_write_b128 v3, v[116:119] offset:9216
    ds_write_b128 v3, v[120:123] offset:10240
    ds_write_b128 v3, v[124:127] offset:11264
    ds_write_b128 v3, v[128:131] offset:12288
    ds_write_b128 v3, v[132:135] offset:13312
    ds_write_b128 v3, v[136:139] offset:14336
    ds_write_b128 v3, v[140:143] offset:15360
    s_waitcnt lgkmcnt(0)
    ds_read_b64_tr_b16 a[128:129], v5 offset:0
    ds_read_b64_tr_b16 a[130:131], v5 offset:256
    ds_read_b64_tr_b16 a[132:133], v5 offset:8
    ds_read_b64_tr_b16 a[134:135], v5 offset:264
    ds_read_b64_tr_b16 a[144:145], v5 offset:2048
    ds_read_b64_tr_b16 a[146:147], v5 offset:2304
    ds_read_b64_tr_b16 a[148:149], v5 offset:2056
    ds_read_b64_tr_b16 a[150:151], v5 offset:2312
    ds_read_b64_tr_b16 a[160:161], v5 offset:4096
    ds_read_b64_tr_b16 a[162:163], v5 offset:4352
    ds_read_b64_tr_b16 a[164:165], v5 offset:4104
    ds_read_b64_tr_b16 a[166:167], v5 offset:4360
    ds_read_b64_tr_b16 a[176:177], v5 offset:6144
    ds_read_b64_tr_b16 a[178:179], v5 offset:6400
    ds_read_b64_tr_b16 a[180:181], v5 offset:6152
    ds_read_b64_tr_b16 a[182:183], v5 offset:6408
    ds_read_b64_tr_b16 a[192:193], v5 offset:8192
    ds_read_b64_tr_b16 a[194:195], v5 offset:8448
    ds_read_b64_tr_b16 a[196:197], v5 offset:8200
    ds_read_b64_tr_b16 a[198:199], v5 offset:8456
    ds_read_b64_tr_b16 a[208:209], v5 offset:10240
    ds_read_b64_tr_b16 a[210:211], v5 offset:10496
    ds_read_b64_tr_b16 a[212:213], v5 offset:10248
    ds_read_b64_tr_b16 a[214:215], v5 offset:10504
    ds_read_b64_tr_b16 a[224:225], v5 offset:12288
    ds_read_b64_tr_b16 a[226:227], v5 offset:12544
    ds_read_b64_tr_b16 a[228:229], v5 offset:12296
    ds_read_b64_tr_b16 a[230:231], v5 offset:12552
    ds_read_b64_tr_b16 a[240:241], v5 offset:14336
    ds_read_b64_tr_b16 a[242:243], v5 offset:14592
    ds_read_b64_tr_b16 a[244:245], v5 offset:14344
    ds_read_b64_tr_b16 a[246:247], v5 offset:14600
    s_waitcnt lgkmcnt(0)
    s_mov_b32 s8, s94
    s_and_b32 s9, s95, 0xffff
    s_mov_b32 s10, 1835008
    s_mov_b32 s11, 0x00020000
    s_lshl_b32 s15, s16, 6
    v_lshrrev_b32 v2, 2, v14
    s_mov_b32 s23, 3584
    v_mul_lo_u32 v2, s23, v2
    v_and_b32 v3, 3, v14
    v_lshl_add_u32 v2, v3, 4, v2
    v_lshlrev_b32 v3, 4, v14
    v_add_u32 v3, s24, v3
    v_lshrrev_b32 v5, 4, v14
    v_bfe_u32 v6, v14, 2, 2
    v_lshl_add_u32 v5, v5, 3, v6
    v_mul_u32_u24 v5, 64, v5
    v_and_b32 v6, 3, v14
    v_lshl_add_u32 v5, v6, 4, v5
    v_add_u32 v5, s24, v5
    buffer_load_dwordx4 v[16:19], v2, s[8:11], s15 offen
    s_add_u32 s15, s15, 57344
    buffer_load_dwordx4 v[20:23], v2, s[8:11], s15 offen
    s_add_u32 s15, s15, 57344
    buffer_load_dwordx4 v[24:27], v2, s[8:11], s15 offen
    s_add_u32 s15, s15, 57344
    buffer_load_dwordx4 v[28:31], v2, s[8:11], s15 offen
    s_add_u32 s15, s15, 57344
    buffer_load_dwordx4 v[32:35], v2, s[8:11], s15 offen
    s_add_u32 s15, s15, 57344
    buffer_load_dwordx4 v[36:39], v2, s[8:11], s15 offen
    s_add_u32 s15, s15, 57344
    buffer_load_dwordx4 v[40:43], v2, s[8:11], s15 offen
    s_add_u32 s15, s15, 57344
    buffer_load_dwordx4 v[44:47], v2, s[8:11], s15 offen
    s_add_u32 s15, s15, 57344
    buffer_load_dwordx4 v[48:51], v2, s[8:11], s15 offen
    s_add_u32 s15, s15, 57344
    buffer_load_dwordx4 v[52:55], v2, s[8:11], s15 offen
    s_add_u32 s15, s15, 57344
    buffer_load_dwordx4 v[56:59], v2, s[8:11], s15 offen
    s_add_u32 s15, s15, 57344
    buffer_load_dwordx4 v[60:63], v2, s[8:11], s15 offen
    s_add_u32 s15, s15, 57344
    buffer_load_dwordx4 v[64:67], v2, s[8:11], s15 offen
    s_add_u32 s15, s15, 57344
    buffer_load_dwordx4 v[68:71], v2, s[8:11], s15 offen
    s_add_u32 s15, s15, 57344
    buffer_load_dwordx4 v[72:75], v2, s[8:11], s15 offen
    s_add_u32 s15, s15, 57344
    buffer_load_dwordx4 v[76:79], v2, s[8:11], s15 offen
    s_add_u32 s15, s15, 57344
    buffer_load_dwordx4 v[80:83], v2, s[8:11], s15 offen
    s_add_u32 s15, s15, 57344
    buffer_load_dwordx4 v[84:87], v2, s[8:11], s15 offen
    s_add_u32 s15, s15, 57344
    buffer_load_dwordx4 v[88:91], v2, s[8:11], s15 offen
    s_add_u32 s15, s15, 57344
    buffer_load_dwordx4 v[92:95], v2, s[8:11], s15 offen
    s_add_u32 s15, s15, 57344
    buffer_load_dwordx4 v[96:99], v2, s[8:11], s15 offen
    s_add_u32 s15, s15, 57344
    buffer_load_dwordx4 v[100:103], v2, s[8:11], s15 offen
    s_add_u32 s15, s15, 57344
    buffer_load_dwordx4 v[104:107], v2, s[8:11], s15 offen
    s_add_u32 s15, s15, 57344
    buffer_load_dwordx4 v[108:111], v2, s[8:11], s15 offen
    s_add_u32 s15, s15, 57344
    buffer_load_dwordx4 v[112:115], v2, s[8:11], s15 offen
    s_add_u32 s15, s15, 57344
    buffer_load_dwordx4 v[116:119], v2, s[8:11], s15 offen
    s_add_u32 s15, s15, 57344
    buffer_load_dwordx4 v[120:123], v2, s[8:11], s15 offen
    s_add_u32 s15, s15, 57344
    buffer_load_dwordx4 v[124:127], v2, s[8:11], s15 offen
    s_add_u32 s15, s15, 57344
    buffer_load_dwordx4 v[128:131], v2, s[8:11], s15 offen
    s_add_u32 s15, s15, 57344
    buffer_load_dwordx4 v[132:135], v2, s[8:11], s15 offen
    s_add_u32 s15, s15, 57344
    buffer_load_dwordx4 v[136:139], v2, s[8:11], s15 offen
    s_add_u32 s15, s15, 57344
    buffer_load_dwordx4 v[140:143], v2, s[8:11], s15 offen
    s_add_u32 s15, s15, 57344
    s_waitcnt vmcnt(16)
    ds_write_b128 v3, v[16:19] offset:0
    ds_write_b128 v3, v[20:23] offset:1024
    ds_write_b128 v3, v[24:27] offset:2048
    ds_write_b128 v3, v[28:31] offset:3072
    ds_write_b128 v3, v[32:35] offset:4096
    ds_write_b128 v3, v[36:39] offset:5120
    ds_write_b128 v3, v[40:43] offset:6144
    ds_write_b128 v3, v[44:47] offset:7168
    ds_write_b128 v3, v[48:51] offset:8192
    ds_write_b128 v3, v[52:55] offset:9216
    ds_write_b128 v3, v[56:59] offset:10240
    ds_write_b128 v3, v[60:63] offset:11264
    ds_write_b128 v3, v[64:67] offset:12288
    ds_write_b128 v3, v[68:71] offset:13312
    ds_write_b128 v3, v[72:75] offset:14336
    ds_write_b128 v3, v[76:79] offset:15360
    s_waitcnt lgkmcnt(0)
    ds_read_b64_tr_b16 a[8:9], v5 offset:0
    ds_read_b64_tr_b16 a[10:11], v5 offset:256
    ds_read_b64_tr_b16 a[12:13], v5 offset:8
    ds_read_b64_tr_b16 a[14:15], v5 offset:264
    ds_read_b64_tr_b16 a[24:25], v5 offset:2048
    ds_read_b64_tr_b16 a[26:27], v5 offset:2304
    ds_read_b64_tr_b16 a[28:29], v5 offset:2056
    ds_read_b64_tr_b16 a[30:31], v5 offset:2312
    ds_read_b64_tr_b16 a[40:41], v5 offset:4096
    ds_read_b64_tr_b16 a[42:43], v5 offset:4352
    ds_read_b64_tr_b16 a[44:45], v5 offset:4104
    ds_read_b64_tr_b16 a[46:47], v5 offset:4360
    ds_read_b64_tr_b16 a[56:57], v5 offset:6144
    ds_read_b64_tr_b16 a[58:59], v5 offset:6400
    ds_read_b64_tr_b16 a[60:61], v5 offset:6152
    ds_read_b64_tr_b16 a[62:63], v5 offset:6408
    ds_read_b64_tr_b16 a[72:73], v5 offset:8192
    ds_read_b64_tr_b16 a[74:75], v5 offset:8448
    ds_read_b64_tr_b16 a[76:77], v5 offset:8200
    ds_read_b64_tr_b16 a[78:79], v5 offset:8456
    ds_read_b64_tr_b16 a[88:89], v5 offset:10240
    ds_read_b64_tr_b16 a[90:91], v5 offset:10496
    ds_read_b64_tr_b16 a[92:93], v5 offset:10248
    ds_read_b64_tr_b16 a[94:95], v5 offset:10504
    ds_read_b64_tr_b16 a[104:105], v5 offset:12288
    ds_read_b64_tr_b16 a[106:107], v5 offset:12544
    ds_read_b64_tr_b16 a[108:109], v5 offset:12296
    ds_read_b64_tr_b16 a[110:111], v5 offset:12552
    ds_read_b64_tr_b16 a[120:121], v5 offset:14336
    ds_read_b64_tr_b16 a[122:123], v5 offset:14592
    ds_read_b64_tr_b16 a[124:125], v5 offset:14344
    ds_read_b64_tr_b16 a[126:127], v5 offset:14600
    s_waitcnt lgkmcnt(0)
    s_waitcnt vmcnt(0)
    ds_write_b128 v3, v[80:83] offset:0
    ds_write_b128 v3, v[84:87] offset:1024
    ds_write_b128 v3, v[88:91] offset:2048
    ds_write_b128 v3, v[92:95] offset:3072
    ds_write_b128 v3, v[96:99] offset:4096
    ds_write_b128 v3, v[100:103] offset:5120
    ds_write_b128 v3, v[104:107] offset:6144
    ds_write_b128 v3, v[108:111] offset:7168
    ds_write_b128 v3, v[112:115] offset:8192
    ds_write_b128 v3, v[116:119] offset:9216
    ds_write_b128 v3, v[120:123] offset:10240
    ds_write_b128 v3, v[124:127] offset:11264
    ds_write_b128 v3, v[128:131] offset:12288
    ds_write_b128 v3, v[132:135] offset:13312
    ds_write_b128 v3, v[136:139] offset:14336
    ds_write_b128 v3, v[140:143] offset:15360
    s_waitcnt lgkmcnt(0)
    ds_read_b64_tr_b16 a[136:137], v5 offset:0
    ds_read_b64_tr_b16 a[138:139], v5 offset:256
    ds_read_b64_tr_b16 a[140:141], v5 offset:8
    ds_read_b64_tr_b16 a[142:143], v5 offset:264
    ds_read_b64_tr_b16 a[152:153], v5 offset:2048
    ds_read_b64_tr_b16 a[154:155], v5 offset:2304
    ds_read_b64_tr_b16 a[156:157], v5 offset:2056
    ds_read_b64_tr_b16 a[158:159], v5 offset:2312
    ds_read_b64_tr_b16 a[168:169], v5 offset:4096
    ds_read_b64_tr_b16 a[170:171], v5 offset:4352
    ds_read_b64_tr_b16 a[172:173], v5 offset:4104
    ds_read_b64_tr_b16 a[174:175], v5 offset:4360
    ds_read_b64_tr_b16 a[184:185], v5 offset:6144
    ds_read_b64_tr_b16 a[186:187], v5 offset:6400
    ds_read_b64_tr_b16 a[188:189], v5 offset:6152
    ds_read_b64_tr_b16 a[190:191], v5 offset:6408
    ds_read_b64_tr_b16 a[200:201], v5 offset:8192
    ds_read_b64_tr_b16 a[202:203], v5 offset:8448
    ds_read_b64_tr_b16 a[204:205], v5 offset:8200
    ds_read_b64_tr_b16 a[206:207], v5 offset:8456
    ds_read_b64_tr_b16 a[216:217], v5 offset:10240
    ds_read_b64_tr_b16 a[218:219], v5 offset:10496
    ds_read_b64_tr_b16 a[220:221], v5 offset:10248
    ds_read_b64_tr_b16 a[222:223], v5 offset:10504
    ds_read_b64_tr_b16 a[232:233], v5 offset:12288
    ds_read_b64_tr_b16 a[234:235], v5 offset:12544
    ds_read_b64_tr_b16 a[236:237], v5 offset:12296
    ds_read_b64_tr_b16 a[238:239], v5 offset:12552
    ds_read_b64_tr_b16 a[248:249], v5 offset:14336
    ds_read_b64_tr_b16 a[250:251], v5 offset:14592
    ds_read_b64_tr_b16 a[252:253], v5 offset:14344
    ds_read_b64_tr_b16 a[254:255], v5 offset:14600
    s_waitcnt lgkmcnt(0)
    s_barrier
L_g_nopre:
    s_lshl_b32 s22, s42, 8
    s_add_u32 s22, s22, s40
    s_lshl_b32 s22, s22, 6
    s_add_u32 s22, s22, 48242688
    s_cmp_lg_u32 s13, 0
    s_cbranch_scc1 L_pc_done_g
    s_mov_b32 s26, 0
    v_mov_b32 v126, 0
L_pc_g:
    buffer_load_dword v127, v126, s[4:7], s22 offen sc1
    s_add_u32 s26, s26, 1
    s_cmp_gt_u32 s26, 4194304
    s_cbranch_scc1 L_mega_end
    s_waitcnt vmcnt(0)
    v_readfirstlane_b32 s27, v127
    s_nop 0
    s_cmp_ge_u32 s27, 2
    s_cbranch_scc1 L_pc_done_g
    s_sleep 4
    s_branch L_pc_g
L_pc_done_g:
    s_barrier
    v_lshlrev_b32 v1, 4, v0
    s_lshl_b32 s23, s42, 1
    s_add_u32 s23, s23, 1
    s_lshl_b32 s23, s23, 21
    s_lshl_b32 s19, s40, 16
    s_add_u32 s19, s19, s23
    s_add_u32 s19, s19, 25165824
    buffer_load_dwordx4 v[104:107], v1, s[4:7], s19 offen sc1
    s_add_u32 s19, s19, 4096
    buffer_load_dwordx4 v[108:111], v1, s[4:7], s19 offen sc1
    s_add_u32 s19, s19, 4096
    buffer_load_dwordx4 v[112:115], v1, s[4:7], s19 offen sc1
    s_add_u32 s19, s19, 4096
    buffer_load_dwordx4 v[116:119], v1, s[4:7], s19 offen sc1
    s_add_u32 s19, s19, 4096
    buffer_load_dwordx4 v[120:123], v1, s[4:7], s19 offen sc1
    s_add_u32 s19, s19, 4096
    buffer_load_dwordx4 v[124:127], v1, s[4:7], s19 offen sc1
    s_add_u32 s19, s19, 4096
    buffer_load_dwordx4 v[128:131], v1, s[4:7], s19 offen sc1
    s_add_u32 s19, s19, 4096
    buffer_load_dwordx4 v[132:135], v1, s[4:7], s19 offen sc1
    s_add_u32 s19, s19, 4096
    buffer_load_dwordx4 v[136:139], v1, s[4:7], s19 offen sc1
    s_add_u32 s19, s19, 4096
    buffer_load_dwordx4 v[140:143], v1, s[4:7], s19 offen sc1
    s_add_u32 s19, s19, 4096
    buffer_load_dwordx4 v[144:147], v1, s[4:7], s19 offen sc1
    s_add_u32 s19, s19, 4096
    buffer_load_dwordx4 v[148:151], v1, s[4:7], s19 offen sc1
    s_add_u32 s19, s19, 4096
    buffer_load_dwordx4 v[152:155], v1, s[4:7], s19 offen sc1
    s_add_u32 s19, s19, 4096
    buffer_load_dwordx4 v[156:159], v1, s[4:7], s19 offen sc1
    s_add_u32 s19, s19, 4096
    buffer_load_dwordx4 v[160:163], v1, s[4:7], s19 offen sc1
    s_add_u32 s19, s19, 4096
    buffer_load_dwordx4 v[164:167], v1, s[4:7], s19 offen sc1
    s_waitcnt vmcnt(15)
    ds_write_b128 v1, v[104:107] offset:0
    s_waitcnt vmcnt(14)
    ds_write_b128 v1, v[108:111] offset:4096
    s_waitcnt vmcnt(13)
    ds_write_b128 v1, v[112:115] offset:8192
    s_waitcnt vmcnt(12)
    ds_write_b128 v1, v[116:119] offset:12288
    s_waitcnt vmcnt(11)
    ds_write_b128 v1, v[120:123] offset:16384
    s_waitcnt vmcnt(10)
    ds_write_b128 v1, v[124:127] offset:20480
    s_waitcnt vmcnt(9)
    ds_write_b128 v1, v[128:131] offset:24576
    s_waitcnt vmcnt(8)
    ds_write_b128 v1, v[132:135] offset:28672
    s_waitcnt vmcnt(7)
    ds_write_b128 v1, v[136:139] offset:32768
    s_waitcnt vmcnt(6)
    ds_write_b128 v1, v[140:143] offset:36864
    s_waitcnt vmcnt(5)
    ds_write_b128 v1, v[144:147] offset:40960
    s_waitcnt vmcnt(4)
    ds_write_b128 v1, v[148:151] offset:45056
    s_waitcnt vmcnt(3)
    ds_write_b128 v1, v[152:155] offset:49152
    s_waitcnt vmcnt(2)
    ds_write_b128 v1, v[156:159] offset:53248
    s_waitcnt vmcnt(1)
    ds_write_b128 v1, v[160:163] offset:57344
    s_waitcnt vmcnt(0)
    ds_write_b128 v1, v[164:167] offset:61440
    v_mov_b32 v5, v4
    s_waitcnt lgkmcnt(0)
    s_barrier
    ds_read_b128 v[8:11], v5 offset:0
    ds_read_b128 v[12:15], v5 offset:1024
    ds_read_b128 v[16:19], v5 offset:2048
    ds_read_b128 v[20:23], v5 offset:3072
    ds_read_b128 v[24:27], v5 offset:4096
    ds_read_b128 v[28:31], v5 offset:5120
    ds_read_b128 v[32:35], v5 offset:6144
    ds_read_b128 v[36:39], v5 offset:7168
    ds_read_b128 v[40:43], v5 offset:8192
    ds_read_b128 v[44:47], v5 offset:9216
    ds_read_b128 v[48:51], v5 offset:10240
    ds_read_b128 v[52:55], v5 offset:11264
    s_waitcnt lgkmcnt(8)
    v_mfma_f32_16x16x32_bf16 v[168:171], a[0:3], v[8:11], 0
    v_mfma_f32_16x16x32_bf16 v[172:175], a[0:3], v[12:15], 0
    v_mfma_f32_16x16x32_bf16 v[176:179], a[0:3], v[16:19], 0
    v_mfma_f32_16x16x32_bf16 v[180:183], a[0:3], v[20:23], 0
    v_mfma_f32_16x16x32_bf16 v[184:187], a[4:7], v[8:11], 0
    v_mfma_f32_16x16x32_bf16 v[188:191], a[4:7], v[12:15], 0
    v_mfma_f32_16x16x32_bf16 v[192:195], a[4:7], v[16:19], 0
    v_mfma_f32_16x16x32_bf16 v[196:199], a[4:7], v[20:23], 0
    v_mfma_f32_16x16x32_bf16 v[200:203], a[8:11], v[8:11], 0
    v_mfma_f32_16x16x32_bf16 v[204:207], a[8:11], v[12:15], 0
    v_mfma_f32_16x16x32_bf16 v[208:211], a[8:11], v[16:19], 0
    v_mfma_f32_16x16x32_bf16 v[212:215], a[8:11], v[20:23], 0
    v_mfma_f32_16x16x32_bf16 v[216:219], a[12:15], v[8:11], 0
    v_mfma_f32_16x16x32_bf16 v[220:223], a[12:15], v[12:15], 0
    v_mfma_f32_16x16x32_bf16 v[224:227], a[12:15], v[16:19], 0
    v_mfma_f32_16x16x32_bf16 v[228:231], a[12:15], v[20:23], 0
    ds_read_b128 v[8:11], v5 offset:12288
    ds_read_b128 v[12:15], v5 offset:13312
    ds_read_b128 v[16:19], v5 offset:14336
    ds_read_b128 v[20:23], v5 offset:15360
    s_waitcnt lgkmcnt(8)
    v_mfma_f32_16x16x32_bf16 v[168:171], a[16:19], v[24:27], v[168:171]
    v_mfma_f32_16x16x32_bf16 v[172:175], a[16:19], v[28:31], v[172:175]
    v_mfma_f32_16x16x32_bf16 v[176:179], a[16:19], v[32:35], v[176:179]
    v_mfma_f32_16x16x32_bf16 v[180:183], a[16:19], v[36:39], v[180:183]
    v_mfma_f32_16x16x32_bf16 v[184:187], a[20:23], v[24:27], v[184:187]
    v_mfma_f32_16x16x32_bf16 v[188:191], a[20:23], v[28:31], v[188:191]
    v_mfma_f32_16x16x32_bf16 v[192:195], a[20:23], v[32:35], v[192:195]
    v_mfma_f32_16x16x32_bf16 v[196:199], a[20:23], v[36:39], v[196:199]
    v_mfma_f32_16x16x32_bf16 v[200:203], a[24:27], v[24:27], v[200:203]
    v_mfma_f32_16x16x32_bf16 v[204:207], a[24:27], v[28:31], v[204:207]
    v_mfma_f32_16x16x32_bf16 v[208:211], a[24:27], v[32:35], v[208:211]
    v_mfma_f32_16x16x32_bf16 v[212:215], a[24:27], v[36:39], v[212:215]
    v_mfma_f32_16x16x32_bf16 v[216:219], a[28:31], v[24:27], v[216:219]
    v_mfma_f32_16x16x32_bf16 v[220:223], a[28:31], v[28:31], v[220:223]
    v_mfma_f32_16x16x32_bf16 v[224:227], a[28:31], v[32:35], v[224:227]
    v_mfma_f32_16x16x32_bf16 v[228:231], a[28:31], v[36:39], v[228:231]
    ds_read_b128 v[24:27], v5 offset:16384
    ds_read_b128 v[28:31], v5 offset:17408
    ds_read_b128 v[32:35], v5 offset:18432
    ds_read_b128 v[36:39], v5 offset:19456
    s_waitcnt lgkmcnt(8)
    v_mfma_f32_16x16x32_bf16 v[168:171], a[32:35], v[40:43], v[168:171]
    v_mfma_f32_16x16x32_bf16 v[172:175], a[32:35], v[44:47], v[172:175]
    v_mfma_f32_16x16x32_bf16 v[176:179], a[32:35], v[48:51], v[176:179]
    v_mfma_f32_16x16x32_bf16 v[180:183], a[32:35], v[52:55], v[180:183]
    v_mfma_f32_16x16x32_bf16 v[184:187], a[36:39], v[40:43], v[184:187]
    v_mfma_f32_16x16x32_bf16 v[188:191], a[36:39], v[44:47], v[188:191]
    v_mfma_f32_16x16x32_bf16 v[192:195], a[36:39], v[48:51], v[192:195]
    v_mfma_f32_16x16x32_bf16 v[196:199], a[36:39], v[52:55], v[196:199]
    v_mfma_f32_16x16x32_bf16 v[200:203], a[40:43], v[40:43], v[200:203]
    v_mfma_f32_16x16x32_bf16 v[204:207], a[40:43], v[44:47], v[204:207]
    v_mfma_f32_16x16x32_bf16 v[208:211], a[40:43], v[48:51], v[208:211]
    v_mfma_f32_16x16x32_bf16 v[212:215], a[40:43], v[52:55], v[212:215]
    v_mfma_f32_16x16x32_bf16 v[216:219], a[44:47], v[40:43], v[216:219]
    v_mfma_f32_16x16x32_bf16 v[220:223], a[44:47], v[44:47], v[220:223]
    v_mfma_f32_16x16x32_bf16 v[224:227], a[44:47], v[48:51], v[224:227]
    v_mfma_f32_16x16x32_bf16 v[228:231], a[44:47], v[52:55], v[228:231]
    ds_read_b128 v[40:43], v5 offset:20480
    ds_read_b128 v[44:47], v5 offset:21504
    ds_read_b128 v[48:51], v5 offset:22528
    ds_read_b128 v[52:55], v5 offset:23552
    s_waitcnt lgkmcnt(8)
    v_mfma_f32_16x16x32_bf16 v[168:171], a[48:51], v[8:11], v[168:171]
    v_mfma_f32_16x16x32_bf16 v[172:175], a[48:51], v[12:15], v[172:175]
    v_mfma_f32_16x16x32_bf16 v[176:179], a[48:51], v[16:19], v[176:179]
    v_mfma_f32_16x16x32_bf16 v[180:183], a[48:51], v[20:23], v[180:183]
    v_mfma_f32_16x16x32_bf16 v[184:187], a[52:55], v[8:11], v[184:187]
    v_mfma_f32_16x16x32_bf16 v[188:191], a[52:55], v[12:15], v[188:191]
    v_mfma_f32_16x16x32_bf16 v[192:195], a[52:55], v[16:19], v[192:195]
    v_mfma_f32_16x16x32_bf16 v[196:199], a[52:55], v[20:23], v[196:199]
    v_mfma_f32_16x16x32_bf16 v[200:203], a[56:59], v[8:11], v[200:203]
    v_mfma_f32_16x16x32_bf16 v[204:207], a[56:59], v[12:15], v[204:207]
    v_mfma_f32_16x16x32_bf16 v[208:211], a[56:59], v[16:19], v[208:211]
    v_mfma_f32_16x16x32_bf16 v[212:215], a[56:59], v[20:23], v[212:215]
    v_mfma_f32_16x16x32_bf16 v[216:219], a[60:63], v[8:11], v[216:219]
    v_mfma_f32_16x16x32_bf16 v[220:223], a[60:63], v[12:15], v[220:223]
    v_mfma_f32_16x16x32_bf16 v[224:227], a[60:63], v[16:19], v[224:227]
    v_mfma_f32_16x16x32_bf16 v[228:231], a[60:63], v[20:23], v[228:231]
    ds_read_b128 v[8:11], v5 offset:24576
    ds_read_b128 v[12:15], v5 offset:25600
    ds_read_b128 v[16:19], v5 offset:26624
    ds_read_b128 v[20:23], v5 offset:27648
    s_waitcnt lgkmcnt(8)
    v_mfma_f32_16x16x32_bf16 v[168:171], a[64:67], v[24:27], v[168:171]
    v_mfma_f32_16x16x32_bf16 v[172:175], a[64:67], v[28:31], v[172:175]
    v_mfma_f32_16x16x32_bf16 v[176:179], a[64:67], v[32:35], v[176:179]
    v_mfma_f32_16x16x32_bf16 v[180:183], a[64:67], v[36:39], v[180:183]
    v_mfma_f32_16x16x32_bf16 v[184:187], a[68:71], v[24:27], v[184:187]
    v_mfma_f32_16x16x32_bf16 v[188:191], a[68:71], v[28:31], v[188:191]
    v_mfma_f32_16x16x32_bf16 v[192:195], a[68:71], v[32:35], v[192:195]
    v_mfma_f32_16x16x32_bf16 v[196:199], a[68:71], v[36:39], v[196:199]
    v_mfma_f32_16x16x32_bf16 v[200:203], a[72:75], v[24:27], v[200:203]
    v_mfma_f32_16x16x32_bf16 v[204:207], a[72:75], v[28:31], v[204:207]
    v_mfma_f32_16x16x32_bf16 v[208:211], a[72:75], v[32:35], v[208:211]
    v_mfma_f32_16x16x32_bf16 v[212:215], a[72:75], v[36:39], v[212:215]
    v_mfma_f32_16x16x32_bf16 v[216:219], a[76:79], v[24:27], v[216:219]
    v_mfma_f32_16x16x32_bf16 v[220:223], a[76:79], v[28:31], v[220:223]
    v_mfma_f32_16x16x32_bf16 v[224:227], a[76:79], v[32:35], v[224:227]
    v_mfma_f32_16x16x32_bf16 v[228:231], a[76:79], v[36:39], v[228:231]
    ds_read_b128 v[24:27], v5 offset:28672
    ds_read_b128 v[28:31], v5 offset:29696
    ds_read_b128 v[32:35], v5 offset:30720
    ds_read_b128 v[36:39], v5 offset:31744
    s_waitcnt lgkmcnt(8)
    v_mfma_f32_16x16x32_bf16 v[168:171], a[80:83], v[40:43], v[168:171]
    v_mfma_f32_16x16x32_bf16 v[172:175], a[80:83], v[44:47], v[172:175]
    v_mfma_f32_16x16x32_bf16 v[176:179], a[80:83], v[48:51], v[176:179]
    v_mfma_f32_16x16x32_bf16 v[180:183], a[80:83], v[52:55], v[180:183]
    v_mfma_f32_16x16x32_bf16 v[184:187], a[84:87], v[40:43], v[184:187]
    v_mfma_f32_16x16x32_bf16 v[188:191], a[84:87], v[44:47], v[188:191]
    v_mfma_f32_16x16x32_bf16 v[192:195], a[84:87], v[48:51], v[192:195]
    v_mfma_f32_16x16x32_bf16 v[196:199], a[84:87], v[52:55], v[196:199]
    v_mfma_f32_16x16x32_bf16 v[200:203], a[88:91], v[40:43], v[200:203]
    v_mfma_f32_16x16x32_bf16 v[204:207], a[88:91], v[44:47], v[204:207]
    v_mfma_f32_16x16x32_bf16 v[208:211], a[88:91], v[48:51], v[208:211]
    v_mfma_f32_16x16x32_bf16 v[212:215], a[88:91], v[52:55], v[212:215]
    v_mfma_f32_16x16x32_bf16 v[216:219], a[92:95], v[40:43], v[216:219]
    v_mfma_f32_16x16x32_bf16 v[220:223], a[92:95], v[44:47], v[220:223]
    v_mfma_f32_16x16x32_bf16 v[224:227], a[92:95], v[48:51], v[224:227]
    v_mfma_f32_16x16x32_bf16 v[228:231], a[92:95], v[52:55], v[228:231]
    ds_read_b128 v[40:43], v5 offset:32768
    ds_read_b128 v[44:47], v5 offset:33792
    ds_read_b128 v[48:51], v5 offset:34816
    ds_read_b128 v[52:55], v5 offset:35840
    s_waitcnt lgkmcnt(8)
    v_mfma_f32_16x16x32_bf16 v[168:171], a[96:99], v[8:11], v[168:171]
    v_mfma_f32_16x16x32_bf16 v[172:175], a[96:99], v[12:15], v[172:175]
    v_mfma_f32_16x16x32_bf16 v[176:179], a[96:99], v[16:19], v[176:179]
    v_mfma_f32_16x16x32_bf16 v[180:183], a[96:99], v[20:23], v[180:183]
    v_mfma_f32_16x16x32_bf16 v[184:187], a[100:103], v[8:11], v[184:187]
    v_mfma_f32_16x16x32_bf16 v[188:191], a[100:103], v[12:15], v[188:191]
    v_mfma_f32_16x16x32_bf16 v[192:195], a[100:103], v[16:19], v[192:195]
    v_mfma_f32_16x16x32_bf16 v[196:199], a[100:103], v[20:23], v[196:199]
    v_mfma_f32_16x16x32_bf16 v[200:203], a[104:107], v[8:11], v[200:203]
    v_mfma_f32_16x16x32_bf16 v[204:207], a[104:107], v[12:15], v[204:207]
    v_mfma_f32_16x16x32_bf16 v[208:211], a[104:107], v[16:19], v[208:211]
    v_mfma_f32_16x16x32_bf16 v[212:215], a[104:107], v[20:23], v[212:215]
    v_mfma_f32_16x16x32_bf16 v[216:219], a[108:111], v[8:11], v[216:219]
    v_mfma_f32_16x16x32_bf16 v[220:223], a[108:111], v[12:15], v[220:223]
    v_mfma_f32_16x16x32_bf16 v[224:227], a[108:111], v[16:19], v[224:227]
    v_mfma_f32_16x16x32_bf16 v[228:231], a[108:111], v[20:23], v[228:231]
    ds_read_b128 v[8:11], v5 offset:36864
    ds_read_b128 v[12:15], v5 offset:37888
    ds_read_b128 v[16:19], v5 offset:38912
    ds_read_b128 v[20:23], v5 offset:39936
    s_waitcnt lgkmcnt(8)
    v_mfma_f32_16x16x32_bf16 v[168:171], a[112:115], v[24:27], v[168:171]
    v_mfma_f32_16x16x32_bf16 v[172:175], a[112:115], v[28:31], v[172:175]
    v_mfma_f32_16x16x32_bf16 v[176:179], a[112:115], v[32:35], v[176:179]
    v_mfma_f32_16x16x32_bf16 v[180:183], a[112:115], v[36:39], v[180:183]
    v_mfma_f32_16x16x32_bf16 v[184:187], a[116:119], v[24:27], v[184:187]
    v_mfma_f32_16x16x32_bf16 v[188:191], a[116:119], v[28:31], v[188:191]
    v_mfma_f32_16x16x32_bf16 v[192:195], a[116:119], v[32:35], v[192:195]
    v_mfma_f32_16x16x32_bf16 v[196:199], a[116:119], v[36:39], v[196:199]
    v_mfma_f32_16x16x32_bf16 v[200:203], a[120:123], v[24:27], v[200:203]
    v_mfma_f32_16x16x32_bf16 v[204:207], a[120:123], v[28:31], v[204:207]
    v_mfma_f32_16x16x32_bf16 v[208:211], a[120:123], v[32:35], v[208:211]
    v_mfma_f32_16x16x32_bf16 v[212:215], a[120:123], v[36:39], v[212:215]
    v_mfma_f32_16x16x32_bf16 v[216:219], a[124:127], v[24:27], v[216:219]
    v_mfma_f32_16x16x32_bf16 v[220:223], a[124:127], v[28:31], v[220:223]
    v_mfma_f32_16x16x32_bf16 v[224:227], a[124:127], v[32:35], v[224:227]
    v_mfma_f32_16x16x32_bf16 v[228:231], a[124:127], v[36:39], v[228:231]
    ds_read_b128 v[24:27], v5 offset:40960
    ds_read_b128 v[28:31], v5 offset:41984
    ds_read_b128 v[32:35], v5 offset:43008
    ds_read_b128 v[36:39], v5 offset:44032
    s_waitcnt lgkmcnt(8)
    v_mfma_f32_16x16x32_bf16 v[168:171], a[128:131], v[40:43], v[168:171]
    v_mfma_f32_16x16x32_bf16 v[172:175], a[128:131], v[44:47], v[172:175]
    v_mfma_f32_16x16x32_bf16 v[176:179], a[128:131], v[48:51], v[176:179]
    v_mfma_f32_16x16x32_bf16 v[180:183], a[128:131], v[52:55], v[180:183]
    v_mfma_f32_16x16x32_bf16 v[184:187], a[132:135], v[40:43], v[184:187]
    v_mfma_f32_16x16x32_bf16 v[188:191], a[132:135], v[44:47], v[188:191]
    v_mfma_f32_16x16x32_bf16 v[192:195], a[132:135], v[48:51], v[192:195]
    v_mfma_f32_16x16x32_bf16 v[196:199], a[132:135], v[52:55], v[196:199]
    v_mfma_f32_16x16x32_bf16 v[200:203], a[136:139], v[40:43], v[200:203]
    v_mfma_f32_16x16x32_bf16 v[204:207], a[136:139], v[44:47], v[204:207]
    v_mfma_f32_16x16x32_bf16 v[208:211], a[136:139], v[48:51], v[208:211]
    v_mfma_f32_16x16x32_bf16 v[212:215], a[136:139], v[52:55], v[212:215]
    v_mfma_f32_16x16x32_bf16 v[216:219], a[140:143], v[40:43], v[216:219]
    v_mfma_f32_16x16x32_bf16 v[220:223], a[140:143], v[44:47], v[220:223]
    v_mfma_f32_16x16x32_bf16 v[224:227], a[140:143], v[48:51], v[224:227]
    v_mfma_f32_16x16x32_bf16 v[228:231], a[140:143], v[52:55], v[228:231]
    ds_read_b128 v[40:43], v5 offset:45056
    ds_read_b128 v[44:47], v5 offset:46080
    ds_read_b128 v[48:51], v5 offset:47104
    ds_read_b128 v[52:55], v5 offset:48128
    s_waitcnt lgkmcnt(8)
    v_mfma_f32_16x16x32_bf16 v[168:171], a[144:147], v[8:11], v[168:171]
    v_mfma_f32_16x16x32_bf16 v[172:175], a[144:147], v[12:15], v[172:175]
    v_mfma_f32_16x16x32_bf16 v[176:179], a[144:147], v[16:19], v[176:179]
    v_mfma_f32_16x16x32_bf16 v[180:183], a[144:147], v[20:23], v[180:183]
    v_mfma_f32_16x16x32_bf16 v[184:187], a[148:151], v[8:11], v[184:187]
    v_mfma_f32_16x16x32_bf16 v[188:191], a[148:151], v[12:15], v[188:191]
    v_mfma_f32_16x16x32_bf16 v[192:195], a[148:151], v[16:19], v[192:195]
    v_mfma_f32_16x16x32_bf16 v[196:199], a[148:151], v[20:23], v[196:199]
    v_mfma_f32_16x16x32_bf16 v[200:203], a[152:155], v[8:11], v[200:203]
    v_mfma_f32_16x16x32_bf16 v[204:207], a[152:155], v[12:15], v[204:207]
    v_mfma_f32_16x16x32_bf16 v[208:211], a[152:155], v[16:19], v[208:211]
    v_mfma_f32_16x16x32_bf16 v[212:215], a[152:155], v[20:23], v[212:215]
    v_mfma_f32_16x16x32_bf16 v[216:219], a[156:159], v[8:11], v[216:219]
    v_mfma_f32_16x16x32_bf16 v[220:223], a[156:159], v[12:15], v[220:223]
    v_mfma_f32_16x16x32_bf16 v[224:227], a[156:159], v[16:19], v[224:227]
    v_mfma_f32_16x16x32_bf16 v[228:231], a[156:159], v[20:23], v[228:231]
    ds_read_b128 v[8:11], v5 offset:49152
    ds_read_b128 v[12:15], v5 offset:50176
    ds_read_b128 v[16:19], v5 offset:51200
    ds_read_b128 v[20:23], v5 offset:52224
    s_waitcnt lgkmcnt(8)
    v_mfma_f32_16x16x32_bf16 v[168:171], a[160:163], v[24:27], v[168:171]
    v_mfma_f32_16x16x32_bf16 v[172:175], a[160:163], v[28:31], v[172:175]
    v_mfma_f32_16x16x32_bf16 v[176:179], a[160:163], v[32:35], v[176:179]
    v_mfma_f32_16x16x32_bf16 v[180:183], a[160:163], v[36:39], v[180:183]
    v_mfma_f32_16x16x32_bf16 v[184:187], a[164:167], v[24:27], v[184:187]
    v_mfma_f32_16x16x32_bf16 v[188:191], a[164:167], v[28:31], v[188:191]
    v_mfma_f32_16x16x32_bf16 v[192:195], a[164:167], v[32:35], v[192:195]
    v_mfma_f32_16x16x32_bf16 v[196:199], a[164:167], v[36:39], v[196:199]
    v_mfma_f32_16x16x32_bf16 v[200:203], a[168:171], v[24:27], v[200:203]
    v_mfma_f32_16x16x32_bf16 v[204:207], a[168:171], v[28:31], v[204:207]
    v_mfma_f32_16x16x32_bf16 v[208:211], a[168:171], v[32:35], v[208:211]
    v_mfma_f32_16x16x32_bf16 v[212:215], a[168:171], v[36:39], v[212:215]
    v_mfma_f32_16x16x32_bf16 v[216:219], a[172:175], v[24:27], v[216:219]
    v_mfma_f32_16x16x32_bf16 v[220:223], a[172:175], v[28:31], v[220:223]
    v_mfma_f32_16x16x32_bf16 v[224:227], a[172:175], v[32:35], v[224:227]
    v_mfma_f32_16x16x32_bf16 v[228:231], a[172:175], v[36:39], v[228:231]
    ds_read_b128 v[24:27], v5 offset:53248
    ds_read_b128 v[28:31], v5 offset:54272
    ds_read_b128 v[32:35], v5 offset:55296
    ds_read_b128 v[36:39], v5 offset:56320
    s_waitcnt lgkmcnt(8)
    v_mfma_f32_16x16x32_bf16 v[168:171], a[176:179], v[40:43], v[168:171]
    v_mfma_f32_16x16x32_bf16 v[172:175], a[176:179], v[44:47], v[172:175]
    v_mfma_f32_16x16x32_bf16 v[176:179], a[176:179], v[48:51], v[176:179]
    v_mfma_f32_16x16x32_bf16 v[180:183], a[176:179], v[52:55], v[180:183]
    v_mfma_f32_16x16x32_bf16 v[184:187], a[180:183], v[40:43], v[184:187]
    v_mfma_f32_16x16x32_bf16 v[188:191], a[180:183], v[44:47], v[188:191]
    v_mfma_f32_16x16x32_bf16 v[192:195], a[180:183], v[48:51], v[192:195]
    v_mfma_f32_16x16x32_bf16 v[196:199], a[180:183], v[52:55], v[196:199]
    v_mfma_f32_16x16x32_bf16 v[200:203], a[184:187], v[40:43], v[200:203]
    v_mfma_f32_16x16x32_bf16 v[204:207], a[184:187], v[44:47], v[204:207]
    v_mfma_f32_16x16x32_bf16 v[208:211], a[184:187], v[48:51], v[208:211]
    v_mfma_f32_16x16x32_bf16 v[212:215], a[184:187], v[52:55], v[212:215]
    v_mfma_f32_16x16x32_bf16 v[216:219], a[188:191], v[40:43], v[216:219]
    v_mfma_f32_16x16x32_bf16 v[220:223], a[188:191], v[44:47], v[220:223]
    v_mfma_f32_16x16x32_bf16 v[224:227], a[188:191], v[48:51], v[224:227]
    v_mfma_f32_16x16x32_bf16 v[228:231], a[188:191], v[52:55], v[228:231]
    ds_read_b128 v[40:43], v5 offset:57344
    ds_read_b128 v[44:47], v5 offset:58368
    ds_read_b128 v[48:51], v5 offset:59392
    ds_read_b128 v[52:55], v5 offset:60416
    s_waitcnt lgkmcnt(8)
    v_mfma_f32_16x16x32_bf16 v[168:171], a[192:195], v[8:11], v[168:171]
    v_mfma_f32_16x16x32_bf16 v[172:175], a[192:195], v[12:15], v[172:175]
    v_mfma_f32_16x16x32_bf16 v[176:179], a[192:195], v[16:19], v[176:179]
    v_mfma_f32_16x16x32_bf16 v[180:183], a[192:195], v[20:23], v[180:183]
    v_mfma_f32_16x16x32_bf16 v[184:187], a[196:199], v[8:11], v[184:187]
    v_mfma_f32_16x16x32_bf16 v[188:191], a[196:199], v[12:15], v[188:191]
    v_mfma_f32_16x16x32_bf16 v[192:195], a[196:199], v[16:19], v[192:195]
    v_mfma_f32_16x16x32_bf16 v[196:199], a[196:199], v[20:23], v[196:199]
    v_mfma_f32_16x16x32_bf16 v[200:203], a[200:203], v[8:11], v[200:203]
    v_mfma_f32_16x16x32_bf16 v[204:207], a[200:203], v[12:15], v[204:207]
    v_mfma_f32_16x16x32_bf16 v[208:211], a[200:203], v[16:19], v[208:211]
    v_mfma_f32_16x16x32_bf16 v[212:215], a[200:203], v[20:23], v[212:215]
    v_mfma_f32_16x16x32_bf16 v[216:219], a[204:207], v[8:11], v[216:219]
    v_mfma_f32_16x16x32_bf16 v[220:223], a[204:207], v[12:15], v[220:223]
    v_mfma_f32_16x16x32_bf16 v[224:227], a[204:207], v[16:19], v[224:227]
    v_mfma_f32_16x16x32_bf16 v[228:231], a[204:207], v[20:23], v[228:231]
    ds_read_b128 v[8:11], v5 offset:61440
    ds_read_b128 v[12:15], v5 offset:62464
    ds_read_b128 v[16:19], v5 offset:63488
    ds_read_b128 v[20:23], v5 offset:64512
    s_waitcnt lgkmcnt(8)
    v_mfma_f32_16x16x32_bf16 v[168:171], a[208:211], v[24:27], v[168:171]
    v_mfma_f32_16x16x32_bf16 v[172:175], a[208:211], v[28:31], v[172:175]
    v_mfma_f32_16x16x32_bf16 v[176:179], a[208:211], v[32:35], v[176:179]
    v_mfma_f32_16x16x32_bf16 v[180:183], a[208:211], v[36:39], v[180:183]
    v_mfma_f32_16x16x32_bf16 v[184:187], a[212:215], v[24:27], v[184:187]
    v_mfma_f32_16x16x32_bf16 v[188:191], a[212:215], v[28:31], v[188:191]
    v_mfma_f32_16x16x32_bf16 v[192:195], a[212:215], v[32:35], v[192:195]
    v_mfma_f32_16x16x32_bf16 v[196:199], a[212:215], v[36:39], v[196:199]
    v_mfma_f32_16x16x32_bf16 v[200:203], a[216:219], v[24:27], v[200:203]
    v_mfma_f32_16x16x32_bf16 v[204:207], a[216:219], v[28:31], v[204:207]
    v_mfma_f32_16x16x32_bf16 v[208:211], a[216:219], v[32:35], v[208:211]
    v_mfma_f32_16x16x32_bf16 v[212:215], a[216:219], v[36:39], v[212:215]
    v_mfma_f32_16x16x32_bf16 v[216:219], a[220:223], v[24:27], v[216:219]
    v_mfma_f32_16x16x32_bf16 v[220:223], a[220:223], v[28:31], v[220:223]
    v_mfma_f32_16x16x32_bf16 v[224:227], a[220:223], v[32:35], v[224:227]
    v_mfma_f32_16x16x32_bf16 v[228:231], a[220:223], v[36:39], v[228:231]
    s_waitcnt lgkmcnt(4)
    v_mfma_f32_16x16x32_bf16 v[168:171], a[224:227], v[40:43], v[168:171]
    v_mfma_f32_16x16x32_bf16 v[172:175], a[224:227], v[44:47], v[172:175]
    v_mfma_f32_16x16x32_bf16 v[176:179], a[224:227], v[48:51], v[176:179]
    v_mfma_f32_16x16x32_bf16 v[180:183], a[224:227], v[52:55], v[180:183]
    v_mfma_f32_16x16x32_bf16 v[184:187], a[228:231], v[40:43], v[184:187]
    v_mfma_f32_16x16x32_bf16 v[188:191], a[228:231], v[44:47], v[188:191]
    v_mfma_f32_16x16x32_bf16 v[192:195], a[228:231], v[48:51], v[192:195]
    v_mfma_f32_16x16x32_bf16 v[196:199], a[228:231], v[52:55], v[196:199]
    v_mfma_f32_16x16x32_bf16 v[200:203], a[232:235], v[40:43], v[200:203]
    v_mfma_f32_16x16x32_bf16 v[204:207], a[232:235], v[44:47], v[204:207]
    v_mfma_f32_16x16x32_bf16 v[208:211], a[232:235], v[48:51], v[208:211]
    v_mfma_f32_16x16x32_bf16 v[212:215], a[232:235], v[52:55], v[212:215]
    v_mfma_f32_16x16x32_bf16 v[216:219], a[236:239], v[40:43], v[216:219]
    v_mfma_f32_16x16x32_bf16 v[220:223], a[236:239], v[44:47], v[220:223]
    v_mfma_f32_16x16x32_bf16 v[224:227], a[236:239], v[48:51], v[224:227]
    v_mfma_f32_16x16x32_bf16 v[228:231], a[236:239], v[52:55], v[228:231]
    s_waitcnt lgkmcnt(0)
    v_mfma_f32_16x16x32_bf16 v[168:171], a[240:243], v[8:11], v[168:171]
    v_mfma_f32_16x16x32_bf16 v[172:175], a[240:243], v[12:15], v[172:175]
    v_mfma_f32_16x16x32_bf16 v[176:179], a[240:243], v[16:19], v[176:179]
    v_mfma_f32_16x16x32_bf16 v[180:183], a[240:243], v[20:23], v[180:183]
    v_mfma_f32_16x16x32_bf16 v[184:187], a[244:247], v[8:11], v[184:187]
    v_mfma_f32_16x16x32_bf16 v[188:191], a[244:247], v[12:15], v[188:191]
    v_mfma_f32_16x16x32_bf16 v[192:195], a[244:247], v[16:19], v[192:195]
    v_mfma_f32_16x16x32_bf16 v[196:199], a[244:247], v[20:23], v[196:199]
    v_mfma_f32_16x16x32_bf16 v[200:203], a[248:251], v[8:11], v[200:203]
    v_mfma_f32_16x16x32_bf16 v[204:207], a[248:251], v[12:15], v[204:207]
    v_mfma_f32_16x16x32_bf16 v[208:211], a[248:251], v[16:19], v[208:211]
    v_mfma_f32_16x16x32_bf16 v[212:215], a[248:251], v[20:23], v[212:215]
    v_mfma_f32_16x16x32_bf16 v[216:219], a[252:255], v[8:11], v[216:219]
    v_mfma_f32_16x16x32_bf16 v[220:223], a[252:255], v[12:15], v[220:223]
    v_mfma_f32_16x16x32_bf16 v[224:227], a[252:255], v[16:19], v[224:227]
    v_mfma_f32_16x16x32_bf16 v[228:231], a[252:255], v[20:23], v[228:231]
    s_mul_i32 s19, s40, 56
    s_add_u32 s19, s19, s16
    s_lshl_b32 s19, s19, 12
    s_add_u32 s19, s19, s43
    s_add_u32 s19, s19, 117440512
    s_mov_b32 s28, 0x3d372713
    s_mov_b32 s29, 3222493025
    v_cvt_pk_bf16_f32 v8, v168, v169
    v_lshlrev_b32 v168, 16, v8
    v_and_b32 v169, 0xffff0000, v8
    v_cvt_pk_bf16_f32 v8, v200, v201
    v_lshlrev_b32 v200, 16, v8
    v_and_b32 v201, 0xffff0000, v8
    v_cvt_pk_bf16_f32 v8, v170, v171
    v_lshlrev_b32 v170, 16, v8
    v_and_b32 v171, 0xffff0000, v8
    v_cvt_pk_bf16_f32 v8, v202, v203
    v_lshlrev_b32 v202, 16, v8
    v_and_b32 v203, 0xffff0000, v8
    v_cvt_pk_bf16_f32 v8, v184, v185
    v_lshlrev_b32 v184, 16, v8
    v_and_b32 v185, 0xffff0000, v8
    v_cvt_pk_bf16_f32 v8, v216, v217
    v_lshlrev_b32 v216, 16, v8
    v_and_b32 v217, 0xffff0000, v8
    v_cvt_pk_bf16_f32 v8, v186, v187
    v_lshlrev_b32 v186, 16, v8
    v_and_b32 v187, 0xffff0000, v8
    v_cvt_pk_bf16_f32 v8, v218, v219
    v_lshlrev_b32 v218, 16, v8
    v_and_b32 v219, 0xffff0000, v8
    v_mul_f32 v9, v168, v168
    v_mul_f32 v9, s28, v9
    v_fma_f32 v9, v9, v168, v168
    v_mul_f32 v9, s29, v9
    v_exp_f32 v9, v9
    v_mul_f32 v10, v169, v169
    v_mul_f32 v10, s28, v10
    v_fma_f32 v10, v10, v169, v169
    v_mul_f32 v10, s29, v10
    v_exp_f32 v10, v10
    v_mul_f32 v11, v170, v170
    v_mul_f32 v11, s28, v11
    v_fma_f32 v11, v11, v170, v170
    v_mul_f32 v11, s29, v11
    v_exp_f32 v11, v11
    v_mul_f32 v12, v171, v171
    v_mul_f32 v12, s28, v12
    v_fma_f32 v12, v12, v171, v171
    v_mul_f32 v12, s29, v12
    v_exp_f32 v12, v12
    v_mul_f32 v13, v184, v184
    v_mul_f32 v13, s28, v13
    v_fma_f32 v13, v13, v184, v184
    v_mul_f32 v13, s29, v13
    v_exp_f32 v13, v13
    v_mul_f32 v14, v185, v185
    v_mul_f32 v14, s28, v14
    v_fma_f32 v14, v14, v185, v185
    v_mul_f32 v14, s29, v14
    v_exp_f32 v14, v14
    v_mul_f32 v15, v186, v186
    v_mul_f32 v15, s28, v15
    v_fma_f32 v15, v15, v186, v186
    v_mul_f32 v15, s29, v15
    v_exp_f32 v15, v15
    v_mul_f32 v16, v187, v187
    v_mul_f32 v16, s28, v16
    v_fma_f32 v16, v16, v187, v187
    v_mul_f32 v16, s29, v16
    v_exp_f32 v16, v16
    v_add_f32 v9, 1.0, v9
    v_rcp_f32 v9, v9
    v_add_f32 v10, 1.0, v10
    v_rcp_f32 v10, v10
    v_add_f32 v11, 1.0, v11
    v_rcp_f32 v11, v11
    v_add_f32 v12, 1.0, v12
    v_rcp_f32 v12, v12
    v_add_f32 v13, 1.0, v13
    v_rcp_f32 v13, v13
    v_add_f32 v14, 1.0, v14
    v_rcp_f32 v14, v14
    v_add_f32 v15, 1.0, v15
    v_rcp_f32 v15, v15
    v_add_f32 v16, 1.0, v16
    v_rcp_f32 v16, v16
    v_mul_f32 v168, v168, v9
    v_mul_f32 v169, v169, v10
    v_mul_f32 v170, v170, v11
    v_mul_f32 v171, v171, v12
    v_mul_f32 v184, v184, v13
    v_mul_f32 v185, v185, v14
    v_mul_f32 v186, v186, v15
    v_mul_f32 v187, v187, v16
    v_cvt_pk_bf16_f32 v8, v168, v169
    v_lshlrev_b32 v168, 16, v8
    v_and_b32 v169, 0xffff0000, v8
    v_mul_f32 v168, v168, v200
    v_mul_f32 v169, v169, v201
    v_cvt_pk_bf16_f32 v104, v168, v169
    v_cvt_pk_bf16_f32 v8, v170, v171
    v_lshlrev_b32 v170, 16, v8
    v_and_b32 v171, 0xffff0000, v8
    v_mul_f32 v170, v170, v202
    v_mul_f32 v171, v171, v203
    v_cvt_pk_bf16_f32 v105, v170, v171
    v_cvt_pk_bf16_f32 v8, v184, v185
    v_lshlrev_b32 v184, 16, v8
    v_and_b32 v185, 0xffff0000, v8
    v_mul_f32 v184, v184, v216
    v_mul_f32 v185, v185, v217
    v_cvt_pk_bf16_f32 v106, v184, v185
    v_cvt_pk_bf16_f32 v8, v186, v187
    v_lshlrev_b32 v186, 16, v8
    v_and_b32 v187, 0xffff0000, v8
    v_mul_f32 v186, v186, v218
    v_mul_f32 v187, v187, v219
    v_cvt_pk_bf16_f32 v107, v186, v187
    buffer_store_dwordx4 v[104:107], v4, s[4:7], s19 offen offset:0 sc1
    v_cvt_pk_bf16_f32 v8, v172, v173
    v_lshlrev_b32 v172, 16, v8
    v_and_b32 v173, 0xffff0000, v8
    v_cvt_pk_bf16_f32 v8, v204, v205
    v_lshlrev_b32 v204, 16, v8
    v_and_b32 v205, 0xffff0000, v8
    v_cvt_pk_bf16_f32 v8, v174, v175
    v_lshlrev_b32 v174, 16, v8
    v_and_b32 v175, 0xffff0000, v8
    v_cvt_pk_bf16_f32 v8, v206, v207
    v_lshlrev_b32 v206, 16, v8
    v_and_b32 v207, 0xffff0000, v8
    v_cvt_pk_bf16_f32 v8, v188, v189
    v_lshlrev_b32 v188, 16, v8
    v_and_b32 v189, 0xffff0000, v8
    v_cvt_pk_bf16_f32 v8, v220, v221
    v_lshlrev_b32 v220, 16, v8
    v_and_b32 v221, 0xffff0000, v8
    v_cvt_pk_bf16_f32 v8, v190, v191
    v_lshlrev_b32 v190, 16, v8
    v_and_b32 v191, 0xffff0000, v8
    v_cvt_pk_bf16_f32 v8, v222, v223
    v_lshlrev_b32 v222, 16, v8
    v_and_b32 v223, 0xffff0000, v8
    v_mul_f32 v9, v172, v172
    v_mul_f32 v9, s28, v9
    v_fma_f32 v9, v9, v172, v172
    v_mul_f32 v9, s29, v9
    v_exp_f32 v9, v9
    v_mul_f32 v10, v173, v173
    v_mul_f32 v10, s28, v10
    v_fma_f32 v10, v10, v173, v173
    v_mul_f32 v10, s29, v10
    v_exp_f32 v10, v10
    v_mul_f32 v11, v174, v174
    v_mul_f32 v11, s28, v11
    v_fma_f32 v11, v11, v174, v174
    v_mul_f32 v11, s29, v11
    v_exp_f32 v11, v11
    v_mul_f32 v12, v175, v175
    v_mul_f32 v12, s28, v12
    v_fma_f32 v12, v12, v175, v175
    v_mul_f32 v12, s29, v12
    v_exp_f32 v12, v12
    v_mul_f32 v13, v188, v188
    v_mul_f32 v13, s28, v13
    v_fma_f32 v13, v13, v188, v188
    v_mul_f32 v13, s29, v13
    v_exp_f32 v13, v13
    v_mul_f32 v14, v189, v189
    v_mul_f32 v14, s28, v14
    v_fma_f32 v14, v14, v189, v189
    v_mul_f32 v14, s29, v14
    v_exp_f32 v14, v14
    v_mul_f32 v15, v190, v190
    v_mul_f32 v15, s28, v15
    v_fma_f32 v15, v15, v190, v190
    v_mul_f32 v15, s29, v15
    v_exp_f32 v15, v15
    v_mul_f32 v16, v191, v191
    v_mul_f32 v16, s28, v16
    v_fma_f32 v16, v16, v191, v191
    v_mul_f32 v16, s29, v16
    v_exp_f32 v16, v16
    v_add_f32 v9, 1.0, v9
    v_rcp_f32 v9, v9
    v_add_f32 v10, 1.0, v10
    v_rcp_f32 v10, v10
    v_add_f32 v11, 1.0, v11
    v_rcp_f32 v11, v11
    v_add_f32 v12, 1.0, v12
    v_rcp_f32 v12, v12
    v_add_f32 v13, 1.0, v13
    v_rcp_f32 v13, v13
    v_add_f32 v14, 1.0, v14
    v_rcp_f32 v14, v14
    v_add_f32 v15, 1.0, v15
    v_rcp_f32 v15, v15
    v_add_f32 v16, 1.0, v16
    v_rcp_f32 v16, v16
    v_mul_f32 v172, v172, v9
    v_mul_f32 v173, v173, v10
    v_mul_f32 v174, v174, v11
    v_mul_f32 v175, v175, v12
    v_mul_f32 v188, v188, v13
    v_mul_f32 v189, v189, v14
    v_mul_f32 v190, v190, v15
    v_mul_f32 v191, v191, v16
    v_cvt_pk_bf16_f32 v8, v172, v173
    v_lshlrev_b32 v172, 16, v8
    v_and_b32 v173, 0xffff0000, v8
    v_mul_f32 v172, v172, v204
    v_mul_f32 v173, v173, v205
    v_cvt_pk_bf16_f32 v108, v172, v173
    v_cvt_pk_bf16_f32 v8, v174, v175
    v_lshlrev_b32 v174, 16, v8
    v_and_b32 v175, 0xffff0000, v8
    v_mul_f32 v174, v174, v206
    v_mul_f32 v175, v175, v207
    v_cvt_pk_bf16_f32 v109, v174, v175
    v_cvt_pk_bf16_f32 v8, v188, v189
    v_lshlrev_b32 v188, 16, v8
    v_and_b32 v189, 0xffff0000, v8
    v_mul_f32 v188, v188, v220
    v_mul_f32 v189, v189, v221
    v_cvt_pk_bf16_f32 v110, v188, v189
    v_cvt_pk_bf16_f32 v8, v190, v191
    v_lshlrev_b32 v190, 16, v8
    v_and_b32 v191, 0xffff0000, v8
    v_mul_f32 v190, v190, v222
    v_mul_f32 v191, v191, v223
    v_cvt_pk_bf16_f32 v111, v190, v191
    buffer_store_dwordx4 v[108:111], v4, s[4:7], s19 offen offset:1024 sc1
    v_cvt_pk_bf16_f32 v8, v176, v177
    v_lshlrev_b32 v176, 16, v8
    v_and_b32 v177, 0xffff0000, v8
    v_cvt_pk_bf16_f32 v8, v208, v209
    v_lshlrev_b32 v208, 16, v8
    v_and_b32 v209, 0xffff0000, v8
    v_cvt_pk_bf16_f32 v8, v178, v179
    v_lshlrev_b32 v178, 16, v8
    v_and_b32 v179, 0xffff0000, v8
    v_cvt_pk_bf16_f32 v8, v210, v211
    v_lshlrev_b32 v210, 16, v8
    v_and_b32 v211, 0xffff0000, v8
    v_cvt_pk_bf16_f32 v8, v192, v193
    v_lshlrev_b32 v192, 16, v8
    v_and_b32 v193, 0xffff0000, v8
    v_cvt_pk_bf16_f32 v8, v224, v225
    v_lshlrev_b32 v224, 16, v8
    v_and_b32 v225, 0xffff0000, v8
    v_cvt_pk_bf16_f32 v8, v194, v195
    v_lshlrev_b32 v194, 16, v8
    v_and_b32 v195, 0xffff0000, v8
    v_cvt_pk_bf16_f32 v8, v226, v227
    v_lshlrev_b32 v226, 16, v8
    v_and_b32 v227, 0xffff0000, v8
    v_mul_f32 v9, v176, v176
    v_mul_f32 v9, s28, v9
    v_fma_f32 v9, v9, v176, v176
    v_mul_f32 v9, s29, v9
    v_exp_f32 v9, v9
    v_mul_f32 v10, v177, v177
    v_mul_f32 v10, s28, v10
    v_fma_f32 v10, v10, v177, v177
    v_mul_f32 v10, s29, v10
    v_exp_f32 v10, v10
    v_mul_f32 v11, v178, v178
    v_mul_f32 v11, s28, v11
    v_fma_f32 v11, v11, v178, v178
    v_mul_f32 v11, s29, v11
    v_exp_f32 v11, v11
    v_mul_f32 v12, v179, v179
    v_mul_f32 v12, s28, v12
    v_fma_f32 v12, v12, v179, v179
    v_mul_f32 v12, s29, v12
    v_exp_f32 v12, v12
    v_mul_f32 v13, v192, v192
    v_mul_f32 v13, s28, v13
    v_fma_f32 v13, v13, v192, v192
    v_mul_f32 v13, s29, v13
    v_exp_f32 v13, v13
    v_mul_f32 v14, v193, v193
    v_mul_f32 v14, s28, v14
    v_fma_f32 v14, v14, v193, v193
    v_mul_f32 v14, s29, v14
    v_exp_f32 v14, v14
    v_mul_f32 v15, v194, v194
    v_mul_f32 v15, s28, v15
    v_fma_f32 v15, v15, v194, v194
    v_mul_f32 v15, s29, v15
    v_exp_f32 v15, v15
    v_mul_f32 v16, v195, v195
    v_mul_f32 v16, s28, v16
    v_fma_f32 v16, v16, v195, v195
    v_mul_f32 v16, s29, v16
    v_exp_f32 v16, v16
    v_add_f32 v9, 1.0, v9
    v_rcp_f32 v9, v9
    v_add_f32 v10, 1.0, v10
    v_rcp_f32 v10, v10
    v_add_f32 v11, 1.0, v11
    v_rcp_f32 v11, v11
    v_add_f32 v12, 1.0, v12
    v_rcp_f32 v12, v12
    v_add_f32 v13, 1.0, v13
    v_rcp_f32 v13, v13
    v_add_f32 v14, 1.0, v14
    v_rcp_f32 v14, v14
    v_add_f32 v15, 1.0, v15
    v_rcp_f32 v15, v15
    v_add_f32 v16, 1.0, v16
    v_rcp_f32 v16, v16
    v_mul_f32 v176, v176, v9
    v_mul_f32 v177, v177, v10
    v_mul_f32 v178, v178, v11
    v_mul_f32 v179, v179, v12
    v_mul_f32 v192, v192, v13
    v_mul_f32 v193, v193, v14
    v_mul_f32 v194, v194, v15
    v_mul_f32 v195, v195, v16
    v_cvt_pk_bf16_f32 v8, v176, v177
    v_lshlrev_b32 v176, 16, v8
    v_and_b32 v177, 0xffff0000, v8
    v_mul_f32 v176, v176, v208
    v_mul_f32 v177, v177, v209
    v_cvt_pk_bf16_f32 v112, v176, v177
    v_cvt_pk_bf16_f32 v8, v178, v179
    v_lshlrev_b32 v178, 16, v8
    v_and_b32 v179, 0xffff0000, v8
    v_mul_f32 v178, v178, v210
    v_mul_f32 v179, v179, v211
    v_cvt_pk_bf16_f32 v113, v178, v179
    v_cvt_pk_bf16_f32 v8, v192, v193
    v_lshlrev_b32 v192, 16, v8
    v_and_b32 v193, 0xffff0000, v8
    v_mul_f32 v192, v192, v224
    v_mul_f32 v193, v193, v225
    v_cvt_pk_bf16_f32 v114, v192, v193
    v_cvt_pk_bf16_f32 v8, v194, v195
    v_lshlrev_b32 v194, 16, v8
    v_and_b32 v195, 0xffff0000, v8
    v_mul_f32 v194, v194, v226
    v_mul_f32 v195, v195, v227
    v_cvt_pk_bf16_f32 v115, v194, v195
    buffer_store_dwordx4 v[112:115], v4, s[4:7], s19 offen offset:2048 sc1
    v_cvt_pk_bf16_f32 v8, v180, v181
    v_lshlrev_b32 v180, 16, v8
    v_and_b32 v181, 0xffff0000, v8
    v_cvt_pk_bf16_f32 v8, v212, v213
    v_lshlrev_b32 v212, 16, v8
    v_and_b32 v213, 0xffff0000, v8
    v_cvt_pk_bf16_f32 v8, v182, v183
    v_lshlrev_b32 v182, 16, v8
    v_and_b32 v183, 0xffff0000, v8
    v_cvt_pk_bf16_f32 v8, v214, v215
    v_lshlrev_b32 v214, 16, v8
    v_and_b32 v215, 0xffff0000, v8
    v_cvt_pk_bf16_f32 v8, v196, v197
    v_lshlrev_b32 v196, 16, v8
    v_and_b32 v197, 0xffff0000, v8
    v_cvt_pk_bf16_f32 v8, v228, v229
    v_lshlrev_b32 v228, 16, v8
    v_and_b32 v229, 0xffff0000, v8
    v_cvt_pk_bf16_f32 v8, v198, v199
    v_lshlrev_b32 v198, 16, v8
    v_and_b32 v199, 0xffff0000, v8
    v_cvt_pk_bf16_f32 v8, v230, v231
    v_lshlrev_b32 v230, 16, v8
    v_and_b32 v231, 0xffff0000, v8
    v_mul_f32 v9, v180, v180
    v_mul_f32 v9, s28, v9
    v_fma_f32 v9, v9, v180, v180
    v_mul_f32 v9, s29, v9
    v_exp_f32 v9, v9
    v_mul_f32 v10, v181, v181
    v_mul_f32 v10, s28, v10
    v_fma_f32 v10, v10, v181, v181
    v_mul_f32 v10, s29, v10
    v_exp_f32 v10, v10
    v_mul_f32 v11, v182, v182
    v_mul_f32 v11, s28, v11
    v_fma_f32 v11, v11, v182, v182
    v_mul_f32 v11, s29, v11
    v_exp_f32 v11, v11
    v_mul_f32 v12, v183, v183
    v_mul_f32 v12, s28, v12
    v_fma_f32 v12, v12, v183, v183
    v_mul_f32 v12, s29, v12
    v_exp_f32 v12, v12
    v_mul_f32 v13, v196, v196
    v_mul_f32 v13, s28, v13
    v_fma_f32 v13, v13, v196, v196
    v_mul_f32 v13, s29, v13
    v_exp_f32 v13, v13
    v_mul_f32 v14, v197, v197
    v_mul_f32 v14, s28, v14
    v_fma_f32 v14, v14, v197, v197
    v_mul_f32 v14, s29, v14
    v_exp_f32 v14, v14
    v_mul_f32 v15, v198, v198
    v_mul_f32 v15, s28, v15
    v_fma_f32 v15, v15, v198, v198
    v_mul_f32 v15, s29, v15
    v_exp_f32 v15, v15
    v_mul_f32 v16, v199, v199
    v_mul_f32 v16, s28, v16
    v_fma_f32 v16, v16, v199, v199
    v_mul_f32 v16, s29, v16
    v_exp_f32 v16, v16
    v_add_f32 v9, 1.0, v9
    v_rcp_f32 v9, v9
    v_add_f32 v10, 1.0, v10
    v_rcp_f32 v10, v10
    v_add_f32 v11, 1.0, v11
    v_rcp_f32 v11, v11
    v_add_f32 v12, 1.0, v12
    v_rcp_f32 v12, v12
    v_add_f32 v13, 1.0, v13
    v_rcp_f32 v13, v13
    v_add_f32 v14, 1.0, v14
    v_rcp_f32 v14, v14
    v_add_f32 v15, 1.0, v15
    v_rcp_f32 v15, v15
    v_add_f32 v16, 1.0, v16
    v_rcp_f32 v16, v16
    v_mul_f32 v180, v180, v9
    v_mul_f32 v181, v181, v10
    v_mul_f32 v182, v182, v11
    v_mul_f32 v183, v183, v12
    v_mul_f32 v196, v196, v13
    v_mul_f32 v197, v197, v14
    v_mul_f32 v198, v198, v15
    v_mul_f32 v199, v199, v16
    v_cvt_pk_bf16_f32 v8, v180, v181
    v_lshlrev_b32 v180, 16, v8
    v_and_b32 v181, 0xffff0000, v8
    v_mul_f32 v180, v180, v212
    v_mul_f32 v181, v181, v213
    v_cvt_pk_bf16_f32 v116, v180, v181
    v_cvt_pk_bf16_f32 v8, v182, v183
    v_lshlrev_b32 v182, 16, v8
    v_and_b32 v183, 0xffff0000, v8
    v_mul_f32 v182, v182, v214
    v_mul_f32 v183, v183, v215
    v_cvt_pk_bf16_f32 v117, v182, v183
    v_cvt_pk_bf16_f32 v8, v196, v197
    v_lshlrev_b32 v196, 16, v8
    v_and_b32 v197, 0xffff0000, v8
    v_mul_f32 v196, v196, v228
    v_mul_f32 v197, v197, v229
    v_cvt_pk_bf16_f32 v118, v196, v197
    v_cvt_pk_bf16_f32 v8, v198, v199
    v_lshlrev_b32 v198, 16, v8
    v_and_b32 v199, 0xffff0000, v8
    v_mul_f32 v198, v198, v230
    v_mul_f32 v199, v199, v231
    v_cvt_pk_bf16_f32 v119, v198, v199
    buffer_store_dwordx4 v[116:119], v4, s[4:7], s19 offen offset:3072 sc1
    s_waitcnt vmcnt(0) lgkmcnt(0)
    s_barrier
    s_cmp_lg_u32 s13, 0
    s_cbranch_scc1 L_wloop
    s_lshl_b32 s22, s42, 8
    s_add_u32 s22, s22, s40
    s_lshl_b32 s22, s22, 6
    s_add_u32 s22, s22, 48244736
    v_mov_b32 v126, 0
    v_mov_b32 v127, 1
    s_mov_b64 exec, 1
    buffer_atomic_add v127, v126, s[4:7], s22 offen
    s_mov_b64 exec, -1
    s_branch L_wloop
L_st6:
    v_and_b32 v14, 63, v0
    v_lshlrev_b32 v1, 4, v14
    s_lshr_b32 s12, s41, 4
    s_and_b32 s14, s41, 15
    s_mul_i32 s15, s13, 14
    s_lshr_b32 s16, s14, 1
    s_mul_i32 s16, s16, 56
    s_add_u32 s16, s16, s15
    s_lshl_b32 s16, s16, 12
    s_and_b32 s18, s14, 1
    s_lshl_b32 s18, s18, 11
    s_add_u32 s16, s16, s18
    s_add_u32 s16, s16, 20971520
    s_mul_i32 s17, s40, 56
    s_add_u32 s17, s17, s15
    s_lshl_b32 s17, s17, 12
    s_lshl_b32 s18, s12, 11
    s_add_u32 s17, s17, s18
    s_add_u32 s17, s17, s43
    s_add_u32 s17, s17, 117440512
    s_bitcmp0_b32 s72, 16
    s_cbranch_scc1 L_dn_nopre
    s_mov_b32 s22, 48291840
    s_cmp_lg_u32 s13, 0
    s_cbranch_scc1 L_pc_done_dn_su
    s_mov_b32 s26, 0
    v_mov_b32 v126, 0
L_pc_dn_su:
    buffer_load_dword v127, v126, s[4:7], s22 offen sc1
    s_add_u32 s26, s26, 1
    s_cmp_gt_u32 s26, 4194304
    s_cbranch_scc1 L_mega_end
    s_waitcnt vmcnt(0)
    v_readfirstlane_b32 s27, v127
    s_nop 0
    s_cmp_ge_u32 s27, 64
    s_cbranch_scc1 L_pc_done_dn_su
    s_sleep 4
    s_branch L_pc_dn_su
L_pc_done_dn_su:
    s_barrier
    s_mov_b32 s8, s96
    s_and_b32 s9, s97, 0xffff
    s_mov_b32 s10, 1835008
    s_mov_b32 s11, 0x00020000
    s_mul_i32 s15, s13, 458752
    s_lshl_b32 s24, s14, 6
    s_add_u32 s15, s15, s24
    s_lshl_b32 s24, s13, 14
    v_lshrrev_b32 v2, 2, v14
    s_mov_b32 s23, 1024
    v_mul_lo_u32 v2, s23, v2
    v_and_b32 v3, 3, v14
    v_lshl_add_u32 v2, v3, 4, v2
    v_lshlrev_b32 v3, 4, v14
    v_add_u32 v3, s24, v3
    v_lshrrev_b32 v5, 4, v14
    v_bfe_u32 v6, v14, 2, 2
    v_lshl_add_u32 v5, v5, 3, v6
    v_mul_u32_u24 v5, 64, v5
    v_and_b32 v6, 3, v14
    v_lshl_add_u32 v5, v6, 4, v5
    v_add_u32 v5, s24, v5
    buffer_load_dwordx4 v[16:19], v2, s[8:11], s15 offen
    s_add_u32 s15, s15, 16384
    buffer_load_dwordx4 v[20:23], v2, s[8:11], s15 offen
    s_add_u32 s15, s15, 16384
    buffer_load_dwordx4 v[24:27], v2, s[8:11], s15 offen
    s_add_u32 s15, s15, 16384
    buffer_load_dwordx4 v[28:31], v2, s[8:11], s15 offen
    s_add_u32 s15, s15, 16384
    buffer_load_dwordx4 v[32:35], v2, s[8:11], s15 offen
    s_add_u32 s15, s15, 16384
    buffer_load_dwordx4 v[36:39], v2, s[8:11], s15 offen
    s_add_u32 s15, s15, 16384
    buffer_load_dwordx4 v[40:43], v2, s[8:11], s15 offen
    s_add_u32 s15, s15, 16384
    buffer_load_dwordx4 v[44:47], v2, s[8:11], s15 offen
    s_add_u32 s15, s15, 16384
    buffer_load_dwordx4 v[48:51], v2, s[8:11], s15 offen
    s_add_u32 s15, s15, 16384
    buffer_load_dwordx4 v[52:55], v2, s[8:11], s15 offen
    s_add_u32 s15, s15, 16384
    buffer_load_dwordx4 v[56:59], v2, s[8:11], s15 offen
    s_add_u32 s15, s15, 16384
    buffer_load_dwordx4 v[60:63], v2, s[8:11], s15 offen
    s_add_u32 s15, s15, 16384
    buffer_load_dwordx4 v[64:67], v2, s[8:11], s15 offen
    s_add_u32 s15, s15, 16384
    buffer_load_dwordx4 v[68:71], v2, s[8:11], s15 offen
    s_add_u32 s15, s15, 16384
    buffer_load_dwordx4 v[72:75], v2, s[8:11], s15 offen
    s_add_u32 s15, s15, 16384
    buffer_load_dwordx4 v[76:79], v2, s[8:11], s15 offen
    s_add_u32 s15, s15, 16384
    buffer_load_dwordx4 v[80:83], v2, s[8:11], s15 offen
    s_add_u32 s15, s15, 16384
    buffer_load_dwordx4 v[84:87], v2, s[8:11], s15 offen
    s_add_u32 s15, s15, 16384
    buffer_load_dwordx4 v[88:91], v2, s[8:11], s15 offen
    s_add_u32 s15, s15, 16384
    buffer_load_dwordx4 v[92:95], v2, s[8:11], s15 offen
    s_add_u32 s15, s15, 16384
    buffer_load_dwordx4 v[96:99], v2, s[8:11], s15 offen
    s_add_u32 s15, s15, 16384
    buffer_load_dwordx4 v[100:103], v2, s[8:11], s15 offen
    s_add_u32 s15, s15, 16384
    buffer_load_dwordx4 v[104:107], v2, s[8:11], s15 offen
    s_add_u32 s15, s15, 16384
    buffer_load_dwordx4 v[108:111], v2, s[8:11], s15 offen
    s_add_u32 s15, s15, 16384
    buffer_load_dwordx4 v[112:115], v2, s[8:11], s15 offen
    s_add_u32 s15, s15, 16384
    buffer_load_dwordx4 v[116:119], v2, s[8:11], s15 offen
    s_add_u32 s15, s15, 16384
    buffer_load_dwordx4 v[120:123], v2, s[8:11], s15 offen
    s_add_u32 s15, s15, 16384
    buffer_load_dwordx4 v[124:127], v2, s[8:11], s15 offen
    s_add_u32 s15, s15, 16384
    s_waitcnt vmcnt(12)
    ds_write_b128 v3, v[16:19] offset:0
    ds_write_b128 v3, v[20:23] offset:1024
    ds_write_b128 v3, v[24:27] offset:2048
    ds_write_b128 v3, v[28:31] offset:3072
    ds_write_b128 v3, v[32:35] offset:4096
    ds_write_b128 v3, v[36:39] offset:5120
    ds_write_b128 v3, v[40:43] offset:6144
    ds_write_b128 v3, v[44:47] offset:7168
    ds_write_b128 v3, v[48:51] offset:8192
    ds_write_b128 v3, v[52:55] offset:9216
    ds_write_b128 v3, v[56:59] offset:10240
    ds_write_b128 v3, v[60:63] offset:11264
    ds_write_b128 v3, v[64:67] offset:12288
    ds_write_b128 v3, v[68:71] offset:13312
    ds_write_b128 v3, v[72:75] offset:14336
    ds_write_b128 v3, v[76:79] offset:15360
    s_waitcnt lgkmcnt(0)
    ds_read_b64_tr_b16 a[0:1], v5 offset:0
    ds_read_b64_tr_b16 a[2:3], v5 offset:256
    ds_read_b64_tr_b16 a[4:5], v5 offset:8
    ds_read_b64_tr_b16 a[6:7], v5 offset:264
    ds_read_b64_tr_b16 a[8:9], v5 offset:2048
    ds_read_b64_tr_b16 a[10:11], v5 offset:2304
    ds_read_b64_tr_b16 a[12:13], v5 offset:2056
    ds_read_b64_tr_b16 a[14:15], v5 offset:2312
    ds_read_b64_tr_b16 a[16:17], v5 offset:4096
    ds_read_b64_tr_b16 a[18:19], v5 offset:4352
    ds_read_b64_tr_b16 a[20:21], v5 offset:4104
    ds_read_b64_tr_b16 a[22:23], v5 offset:4360
    ds_read_b64_tr_b16 a[24:25], v5 offset:6144
    ds_read_b64_tr_b16 a[26:27], v5 offset:6400
    ds_read_b64_tr_b16 a[28:29], v5 offset:6152
    ds_read_b64_tr_b16 a[30:31], v5 offset:6408
    ds_read_b64_tr_b16 a[32:33], v5 offset:8192
    ds_read_b64_tr_b16 a[34:35], v5 offset:8448
    ds_read_b64_tr_b16 a[36:37], v5 offset:8200
    ds_read_b64_tr_b16 a[38:39], v5 offset:8456
    ds_read_b64_tr_b16 a[40:41], v5 offset:10240
    ds_read_b64_tr_b16 a[42:43], v5 offset:10496
    ds_read_b64_tr_b16 a[44:45], v5 offset:10248
    ds_read_b64_tr_b16 a[46:47], v5 offset:10504
    ds_read_b64_tr_b16 a[48:49], v5 offset:12288
    ds_read_b64_tr_b16 a[50:51], v5 offset:12544
    ds_read_b64_tr_b16 a[52:53], v5 offset:12296
    ds_read_b64_tr_b16 a[54:55], v5 offset:12552
    ds_read_b64_tr_b16 a[56:57], v5 offset:14336
    ds_read_b64_tr_b16 a[58:59], v5 offset:14592
    ds_read_b64_tr_b16 a[60:61], v5 offset:14344
    ds_read_b64_tr_b16 a[62:63], v5 offset:14600
    s_waitcnt lgkmcnt(0)
    s_waitcnt vmcnt(0)
    ds_write_b128 v3, v[80:83] offset:0
    ds_write_b128 v3, v[84:87] offset:1024
    ds_write_b128 v3, v[88:91] offset:2048
    ds_write_b128 v3, v[92:95] offset:3072
    ds_write_b128 v3, v[96:99] offset:4096
    ds_write_b128 v3, v[100:103] offset:5120
    ds_write_b128 v3, v[104:107] offset:6144
    ds_write_b128 v3, v[108:111] offset:7168
    ds_write_b128 v3, v[112:115] offset:8192
    ds_write_b128 v3, v[116:119] offset:9216
    ds_write_b128 v3, v[120:123] offset:10240
    ds_write_b128 v3, v[124:127] offset:11264
    s_waitcnt lgkmcnt(0)
    ds_read_b64_tr_b16 a[64:65], v5 offset:0
    ds_read_b64_tr_b16 a[66:67], v5 offset:256
    ds_read_b64_tr_b16 a[68:69], v5 offset:8
    ds_read_b64_tr_b16 a[70:71], v5 offset:264
    ds_read_b64_tr_b16 a[72:73], v5 offset:2048
    ds_read_b64_tr_b16 a[74:75], v5 offset:2304
    ds_read_b64_tr_b16 a[76:77], v5 offset:2056
    ds_read_b64_tr_b16 a[78:79], v5 offset:2312
    ds_read_b64_tr_b16 a[80:81], v5 offset:4096
    ds_read_b64_tr_b16 a[82:83], v5 offset:4352
    ds_read_b64_tr_b16 a[84:85], v5 offset:4104
    ds_read_b64_tr_b16 a[86:87], v5 offset:4360
    ds_read_b64_tr_b16 a[88:89], v5 offset:6144
    ds_read_b64_tr_b16 a[90:91], v5 offset:6400
    ds_read_b64_tr_b16 a[92:93], v5 offset:6152
    ds_read_b64_tr_b16 a[94:95], v5 offset:6408
    ds_read_b64_tr_b16 a[96:97], v5 offset:8192
    ds_read_b64_tr_b16 a[98:99], v5 offset:8448
    ds_read_b64_tr_b16 a[100:101], v5 offset:8200
    ds_read_b64_tr_b16 a[102:103], v5 offset:8456
    ds_read_b64_tr_b16 a[104:105], v5 offset:10240
    ds_read_b64_tr_b16 a[106:107], v5 offset:10496
    ds_read_b64_tr_b16 a[108:109], v5 offset:10248
    ds_read_b64_tr_b16 a[110:111], v5 offset:10504
    s_waitcnt lgkmcnt(0)
    s_barrier
L_dn_nopre:
    s_lshl_b32 s22, s42, 8
    s_add_u32 s22, s22, s40
    s_lshl_b32 s22, s22, 6
    s_add_u32 s22, s22, 48244736
    v_mov_b32 v250, 0
    s_cmp_lg_u32 s13, 0
    s_cbranch_scc1 L_pc_done_dn
    s_mov_b32 s26, 0
    v_mov_b32 v126, 0
L_pc_dn:
    buffer_load_dword v127, v126, s[4:7], s22 offen sc1
    s_add_u32 s26, s26, 1
    s_cmp_gt_u32 s26, 4194304
    s_cbranch_scc1 L_mega_end
    s_waitcnt vmcnt(0)
    v_readfirstlane_b32 s27, v127
    s_nop 0
    s_cmp_ge_u32 s27, 14
    s_cbranch_scc1 L_pc_done_dn
    s_sleep 4
    s_branch L_pc_dn
L_pc_done_dn:
    s_barrier
    buffer_load_dwordx4 v[16:19], v1, s[4:7], s17 offen offset:0 sc1
    buffer_load_dwordx4 v[20:23], v1, s[4:7], s17 offen offset:1024 sc1
    s_add_u32 s17, s17, 4096
    buffer_load_dwordx4 v[24:27], v1, s[4:7], s17 offen offset:0 sc1
    buffer_load_dwordx4 v[28:31], v1, s[4:7], s17 offen offset:1024 sc1
    s_add_u32 s17, s17, 4096
    buffer_load_dwordx4 v[32:35], v1, s[4:7], s17 offen offset:0 sc1
    buffer_load_dwordx4 v[36:39], v1, s[4:7], s17 offen offset:1024 sc1
    s_add_u32 s17, s17, 4096
    buffer_load_dwordx4 v[40:43], v1, s[4:7], s17 offen offset:0 sc1
    buffer_load_dwordx4 v[44:47], v1, s[4:7], s17 offen offset:1024 sc1
    s_add_u32 s17, s17, 4096
    buffer_load_dwordx4 v[48:51], v1, s[4:7], s17 offen offset:0 sc1
    buffer_load_dwordx4 v[52:55], v1, s[4:7], s17 offen offset:1024 sc1
    s_add_u32 s17, s17, 4096
    buffer_load_dwordx4 v[56:59], v1, s[4:7], s17 offen offset:0 sc1
    buffer_load_dwordx4 v[60:63], v1, s[4:7], s17 offen offset:1024 sc1
    s_add_u32 s17, s17, 4096
    buffer_load_dwordx4 v[64:67], v1, s[4:7], s17 offen offset:0 sc1
    buffer_load_dwordx4 v[68:71], v1, s[4:7], s17 offen offset:1024 sc1
    s_add_u32 s17, s17, 4096
    buffer_load_dwordx4 v[72:75], v1, s[4:7], s17 offen offset:0 sc1
    buffer_load_dwordx4 v[76:79], v1, s[4:7], s17 offen offset:1024 sc1
    s_add_u32 s17, s17, 4096
    buffer_load_dwordx4 v[80:83], v1, s[4:7], s17 offen offset:0 sc1
    buffer_load_dwordx4 v[84:87], v1, s[4:7], s17 offen offset:1024 sc1
    s_add_u32 s17, s17, 4096
    buffer_load_dwordx4 v[88:91], v1, s[4:7], s17 offen offset:0 sc1
    buffer_load_dwordx4 v[92:95], v1, s[4:7], s17 offen offset:1024 sc1
    s_add_u32 s17, s17, 4096
    buffer_load_dwordx4 v[96:99], v1, s[4:7], s17 offen offset:0 sc1
    buffer_load_dwordx4 v[100:103], v1, s[4:7], s17 offen offset:1024 sc1
    s_add_u32 s17, s17, 4096
    buffer_load_dwordx4 v[104:107], v1, s[4:7], s17 offen offset:0 sc1
    buffer_load_dwordx4 v[108:111], v1, s[4:7], s17 offen offset:1024 sc1
    s_add_u32 s17, s17, 4096
    buffer_load_dwordx4 v[112:115], v1, s[4:7], s17 offen offset:0 sc1
    buffer_load_dwordx4 v[116:119], v1, s[4:7], s17 offen offset:1024 sc1
    s_add_u32 s17, s17, 4096
    buffer_load_dwordx4 v[120:123], v1, s[4:7], s17 offen offset:0 sc1
    buffer_load_dwordx4 v[124:127], v1, s[4:7], s17 offen offset:1024 sc1
    s_add_u32 s17, s17, 4096
    s_waitcnt vmcnt(26)
    v_mfma_f32_16x16x32_bf16 v[144:147], a[0:3], v[16:19], 0
    v_mfma_f32_16x16x32_bf16 v[148:151], a[0:3], v[20:23], 0
    v_mfma_f32_16x16x32_bf16 v[152:155], a[4:7], v[16:19], 0
    v_mfma_f32_16x16x32_bf16 v[156:159], a[4:7], v[20:23], 0
    s_waitcnt vmcnt(24)
    v_mfma_f32_16x16x32_bf16 v[144:147], a[8:11], v[24:27], v[144:147]
    v_mfma_f32_16x16x32_bf16 v[148:151], a[8:11], v[28:31], v[148:151]
    v_mfma_f32_16x16x32_bf16 v[152:155], a[12:15], v[24:27], v[152:155]
    v_mfma_f32_16x16x32_bf16 v[156:159], a[12:15], v[28:31], v[156:159]
    s_waitcnt vmcnt(22)
    v_mfma_f32_16x16x32_bf16 v[144:147], a[16:19], v[32:35], v[144:147]
    v_mfma_f32_16x16x32_bf16 v[148:151], a[16:19], v[36:39], v[148:151]
    v_mfma_f32_16x16x32_bf16 v[152:155], a[20:23], v[32:35], v[152:155]
    v_mfma_f32_16x16x32_bf16 v[156:159], a[20:23], v[36:39], v[156:159]
    s_waitcnt vmcnt(20)
    v_mfma_f32_16x16x32_bf16 v[144:147], a[24:27], v[40:43], v[144:147]
    v_mfma_f32_16x16x32_bf16 v[148:151], a[24:27], v[44:47], v[148:151]
    v_mfma_f32_16x16x32_bf16 v[152:155], a[28:31], v[40:43], v[152:155]
    v_mfma_f32_16x16x32_bf16 v[156:159], a[28:31], v[44:47], v[156:159]
    s_waitcnt vmcnt(18)
    v_mfma_f32_16x16x32_bf16 v[144:147], a[32:35], v[48:51], v[144:147]
    v_mfma_f32_16x16x32_bf16 v[148:151], a[32:35], v[52:55], v[148:151]
    v_mfma_f32_16x16x32_bf16 v[152:155], a[36:39], v[48:51], v[152:155]
    v_mfma_f32_16x16x32_bf16 v[156:159], a[36:39], v[52:55], v[156:159]
    s_waitcnt vmcnt(16)
    v_mfma_f32_16x16x32_bf16 v[144:147], a[40:43], v[56:59], v[144:147]
    v_mfma_f32_16x16x32_bf16 v[148:151], a[40:43], v[60:63], v[148:151]
    v_mfma_f32_16x16x32_bf16 v[152:155], a[44:47], v[56:59], v[152:155]
    v_mfma_f32_16x16x32_bf16 v[156:159], a[44:47], v[60:63], v[156:159]
    s_waitcnt vmcnt(14)
    v_mfma_f32_16x16x32_bf16 v[144:147], a[48:51], v[64:67], v[144:147]
    v_mfma_f32_16x16x32_bf16 v[148:151], a[48:51], v[68:71], v[148:151]
    v_mfma_f32_16x16x32_bf16 v[152:155], a[52:55], v[64:67], v[152:155]
    v_mfma_f32_16x16x32_bf16 v[156:159], a[52:55], v[68:71], v[156:159]
    s_waitcnt vmcnt(12)
    v_mfma_f32_16x16x32_bf16 v[144:147], a[56:59], v[72:75], v[144:147]
    v_mfma_f32_16x16x32_bf16 v[148:151], a[56:59], v[76:79], v[148:151]
    v_mfma_f32_16x16x32_bf16 v[152:155], a[60:63], v[72:75], v[152:155]
    v_mfma_f32_16x16x32_bf16 v[156:159], a[60:63], v[76:79], v[156:159]
    s_waitcnt vmcnt(10)
    v_mfma_f32_16x16x32_bf16 v[144:147], a[64:67], v[80:83], v[144:147]
    v_mfma_f32_16x16x32_bf16 v[148:151], a[64:67], v[84:87], v[148:151]
    v_mfma_f32_16x16x32_bf16 v[152:155], a[68:71], v[80:83], v[152:155]
    v_mfma_f32_16x16x32_bf16 v[156:159], a[68:71], v[84:87], v[156:159]
    s_waitcnt vmcnt(8)
    v_mfma_f32_16x16x32_bf16 v[144:147], a[72:75], v[88:91], v[144:147]
    v_mfma_f32_16x16x32_bf16 v[148:151], a[72:75], v[92:95], v[148:151]
    v_mfma_f32_16x16x32_bf16 v[152:155], a[76:79], v[88:91], v[152:155]
    v_mfma_f32_16x16x32_bf16 v[156:159], a[76:79], v[92:95], v[156:159]
    s_waitcnt vmcnt(6)
    v_mfma_f32_16x16x32_bf16 v[144:147], a[80:83], v[96:99], v[144:147]
    v_mfma_f32_16x16x32_bf16 v[148:151], a[80:83], v[100:103], v[148:151]
    v_mfma_f32_16x16x32_bf16 v[152:155], a[84:87], v[96:99], v[152:155]
    v_mfma_f32_16x16x32_bf16 v[156:159], a[84:87], v[100:103], v[156:159]
    s_waitcnt vmcnt(4)
    v_mfma_f32_16x16x32_bf16 v[144:147], a[88:91], v[104:107], v[144:147]
    v_mfma_f32_16x16x32_bf16 v[148:151], a[88:91], v[108:111], v[148:151]
    v_mfma_f32_16x16x32_bf16 v[152:155], a[92:95], v[104:107], v[152:155]
    v_mfma_f32_16x16x32_bf16 v[156:159], a[92:95], v[108:111], v[156:159]
    s_waitcnt vmcnt(2)
    v_mfma_f32_16x16x32_bf16 v[144:147], a[96:99], v[112:115], v[144:147]
    v_mfma_f32_16x16x32_bf16 v[148:151], a[96:99], v[116:119], v[148:151]
    v_mfma_f32_16x16x32_bf16 v[152:155], a[100:103], v[112:115], v[152:155]
    v_mfma_f32_16x16x32_bf16 v[156:159], a[100:103], v[116:119], v[156:159]
    s_waitcnt vmcnt(0)
    v_mfma_f32_16x16x32_bf16 v[144:147], a[104:107], v[120:123], v[144:147]
    v_mfma_f32_16x16x32_bf16 v[148:151], a[104:107], v[124:127], v[148:151]
    v_mfma_f32_16x16x32_bf16 v[152:155], a[108:111], v[120:123], v[152:155]
    v_mfma_f32_16x16x32_bf16 v[156:159], a[108:111], v[124:127], v[156:159]
    s_lshl_b32 s15, s13, 12
    v_add_u32 v2, s15, v1
    s_nop 2
    ds_write_b128 v2, v[144:147] offset:0
    ds_write_b128 v2, v[148:151] offset:1024
    ds_write_b128 v2, v[152:155] offset:2048
    ds_write_b128 v2, v[156:159] offset:3072
    s_and_b32 s15, s13, 1
    s_lshl_b32 s15, s15, 10
    v_add_u32 v3, s15, v1
    v_and_b32 v4, 15, v14
    v_lshrrev_b32 v5, 2, v4
    v_and_b32 v4, 3, v4
    v_lshl_add_u32 v4, v5, 3, v4
    s_lshl_b32 s15, s40, 6
    s_lshl_b32 s18, s12, 5
    s_add_u32 s15, s15, s18
    s_and_b32 s18, s13, 1
    s_lshl_b32 s18, s18, 2
    s_add_u32 s15, s15, s18
    v_add_u32 v4, s15, v4
    v_lshlrev_b32 v4, 10, v4
    v_lshrrev_b32 v5, 4, v14
    v_lshl_add_u32 v4, v5, 4, v4
    s_lshl_b32 s15, s14, 6
    v_add_u32 v4, s15, v4
    s_lshl_b32 s18, s42, 1
    s_add_u32 s18, s18, 1
    s_lshl_b32 s18, s18, 21
    s_add_u32 s18, s18, 33554432
    buffer_load_dwordx4 v[8:11], v4, s[4:7], s18 offen sc1
    s_waitcnt lgkmcnt(0)
    s_barrier
    s_cmp_ge_u32 s13, 2
    s_cbranch_scc1 L_dn_done
    ds_read_b128 v[16:19], v3 offset:0
    ds_read_b128 v[20:23], v3 offset:2048
    ds_read_b128 v[24:27], v3 offset:4096
    ds_read_b128 v[28:31], v3 offset:6144
    ds_read_b128 v[32:35], v3 offset:8192
    ds_read_b128 v[36:39], v3 offset:10240
    ds_read_b128 v[40:43], v3 offset:12288
    ds_read_b128 v[44:47], v3 offset:14336
    s_waitcnt lgkmcnt(4)
    v_add_f32 v16, v16, v24
    v_add_f32 v17, v17, v25
    v_add_f32 v18, v18, v26
    v_add_f32 v19, v19, v27
    v_add_f32 v20, v20, v28
    v_add_f32 v21, v21, v29
    v_add_f32 v22, v22, v30
    v_add_f32 v23, v23, v31
    s_waitcnt lgkmcnt(2)
    v_add_f32 v16, v16, v32
    v_add_f32 v17, v17, v33
    v_add_f32 v18, v18, v34
    v_add_f32 v19, v19, v35
    v_add_f32 v20, v20, v36
    v_add_f32 v21, v21, v37
    v_add_f32 v22, v22, v38
    v_add_f32 v23, v23, v39
    s_waitcnt lgkmcnt(0) vmcnt(0)
    v_add_f32 v16, v16, v40
    v_add_f32 v17, v17, v41
    v_add_f32 v18, v18, v42
    v_add_f32 v19, v19, v43
    v_add_f32 v20, v20, v44
    v_add_f32 v21, v21, v45
    v_add_f32 v22, v22, v46
    v_add_f32 v23, v23, v47
    v_cvt_pk_bf16_f32 v6, v16, v17
    v_lshlrev_b32 v16, 16, v6
    v_and_b32 v17, 0xffff0000, v6
    v_lshlrev_b32 v6, 16, v8
    v_and_b32 v7, 0xffff0000, v8
    v_add_f32 v16, v16, v6
    v_add_f32 v17, v17, v7
    v_cvt_pk_bf16_f32 v48, v16, v17
    v_cvt_pk_bf16_f32 v6, v18, v19
    v_lshlrev_b32 v18, 16, v6
    v_and_b32 v19, 0xffff0000, v6
    v_lshlrev_b32 v6, 16, v9
    v_and_b32 v7, 0xffff0000, v9
    v_add_f32 v18, v18, v6
    v_add_f32 v19, v19, v7
    v_cvt_pk_bf16_f32 v49, v18, v19
    v_cvt_pk_bf16_f32 v6, v20, v21
    v_lshlrev_b32 v20, 16, v6
    v_and_b32 v21, 0xffff0000, v6
    v_lshlrev_b32 v6, 16, v10
    v_and_b32 v7, 0xffff0000, v10
    v_add_f32 v20, v20, v6
    v_add_f32 v21, v21, v7
    v_cvt_pk_bf16_f32 v50, v20, v21
    v_cvt_pk_bf16_f32 v6, v22, v23
    v_lshlrev_b32 v22, 16, v6
    v_and_b32 v23, 0xffff0000, v6
    v_lshlrev_b32 v6, 16, v11
    v_and_b32 v7, 0xffff0000, v11
    v_add_f32 v22, v22, v6
    v_add_f32 v23, v23, v7
    v_cvt_pk_bf16_f32 v51, v22, v23
    s_cmp_eq_u32 s42, 1
    s_cbranch_scc1 L_dn_out
    s_add_u32 s18, s18, 2097152
    buffer_store_dwordx4 v[48:51], v4, s[4:7], s18 offen sc1
    s_branch L_dn_done
L_dn_out:
    buffer_store_dwordx4 v[48:51], v4, s[64:67], 0 offen
L_dn_done:
    s_waitcnt vmcnt(0) lgkmcnt(0)
    s_barrier
    s_cmp_lg_u32 s13, 0
    s_cbranch_scc1 L_wloop
    s_lshl_b32 s22, s42, 8
    s_add_u32 s22, s22, s40
    s_lshl_b32 s22, s22, 6
    s_add_u32 s22, s22, 48246784
    v_mov_b32 v126, 0
    v_mov_b32 v127, 1
    s_mov_b64 exec, 1
    buffer_atomic_add v127, v126, s[4:7], s22 offen
    s_mov_b64 exec, -1
    s_branch L_wloop
L_st8:
    s_and_b32 s16, s41, 15
    s_lshl_b32 s16, s16, 2
    s_add_u32 s16, s16, s13
    s_lshr_b32 s17, s41, 4
    s_add_u32 s18, s17, 1
    s_cmp_eq_u32 s17, 2
    s_cselect_b32 s18, 0, s18
    s_mul_i32 s15, s16, 3
    s_add_u32 s15, s15, s18
    s_lshl_b32 s15, s15, 16
    s_add_u32 s15, s15, 0
    v_and_b32 v4, 63, v0
    v_lshlrev_b32 v4, 4, v4
    v_lshlrev_b32 v1, 4, v0
    s_mov_b32 s19, 25165824
    v_and_b32 v14, 63, v0
    s_mov_b32 s8, s84
    s_mov_b32 s9, s85
    s_cmp_eq_u32 s18, 1
    s_cselect_b32 s8, s86, s8
    s_cselect_b32 s9, s87, s9
    s_cmp_eq_u32 s18, 2
    s_cselect_b32 s8, s88, s8
    s_cselect_b32 s9, s89, s9
    s_and_b32 s9, s9, 0xffff
    s_mov_b32 s10, 4194304
    s_mov_b32 s11, 0x00020000
    s_lshl_b32 s15, s16, 7
    s_lshl_b32 s24, s13, 14
    v_lshrrev_b32 v2, 3, v14
    s_mov_b32 s23, 8192
    v_mul_lo_u32 v2, s23, v2
    v_and_b32 v3, 7, v14
    v_lshl_add_u32 v2, v3, 4, v2
    v_lshlrev_b32 v3, 4, v14
    v_add_u32 v3, s24, v3
    v_lshrrev_b32 v5, 4, v14
    v_bfe_u32 v6, v14, 2, 2
    v_lshl_add_u32 v5, v5, 3, v6
    v_mul_u32_u24 v5, 128, v5
    v_and_b32 v6, 3, v14
    v_lshl_add_u32 v5, v6, 4, v5
    v_add_u32 v5, s24, v5
    buffer_load_dwordx4 v[16:19], v2, s[8:11], s15 offen
    s_add_u32 s15, s15, 65536
    buffer_load_dwordx4 v[20:23], v2, s[8:11], s15 offen
    s_add_u32 s15, s15, 65536
    buffer_load_dwordx4 v[24:27], v2, s[8:11], s15 offen
    s_add_u32 s15, s15, 65536
    buffer_load_dwordx4 v[28:31], v2, s[8:11], s15 offen
    s_add_u32 s15, s15, 65536
    buffer_load_dwordx4 v[32:35], v2, s[8:11], s15 offen
    s_add_u32 s15, s15, 65536
    buffer_load_dwordx4 v[36:39], v2, s[8:11], s15 offen
    s_add_u32 s15, s15, 65536
    buffer_load_dwordx4 v[40:43], v2, s[8:11], s15 offen
    s_add_u32 s15, s15, 65536
    buffer_load_dwordx4 v[44:47], v2, s[8:11], s15 offen
    s_add_u32 s15, s15, 65536
    buffer_load_dwordx4 v[48:51], v2, s[8:11], s15 offen
    s_add_u32 s15, s15, 65536
    buffer_load_dwordx4 v[52:55], v2, s[8:11], s15 offen
    s_add_u32 s15, s15, 65536
    buffer_load_dwordx4 v[56:59], v2, s[8:11], s15 offen
    s_add_u32 s15, s15, 65536
    buffer_load_dwordx4 v[60:63], v2, s[8:11], s15 offen
    s_add_u32 s15, s15, 65536
    buffer_load_dwordx4 v[64:67], v2, s[8:11], s15 offen
    s_add_u32 s15, s15, 65536
    buffer_load_dwordx4 v[68:71], v2, s[8:11], s15 offen
    s_add_u32 s15, s15, 65536
    buffer_load_dwordx4 v[72:75], v2, s[8:11], s15 offen
    s_add_u32 s15, s15, 65536
    buffer_load_dwordx4 v[76:79], v2, s[8:11], s15 offen
    s_add_u32 s15, s15, 65536
    buffer_load_dwordx4 v[80:83], v2, s[8:11], s15 offen
    s_add_u32 s15, s15, 65536
    buffer_load_dwordx4 v[84:87], v2, s[8:11], s15 offen
    s_add_u32 s15, s15, 65536
    buffer_load_dwordx4 v[88:91], v2, s[8:11], s15 offen
    s_add_u32 s15, s15, 65536
    buffer_load_dwordx4 v[92:95], v2, s[8:11], s15 offen
    s_add_u32 s15, s15, 65536
    buffer_load_dwordx4 v[96:99], v2, s[8:11], s15 offen
    s_add_u32 s15, s15, 65536
    buffer_load_dwordx4 v[100:103], v2, s[8:11], s15 offen
    s_add_u32 s15, s15, 65536
    buffer_load_dwordx4 v[104:107], v2, s[8:11], s15 offen
    s_add_u32 s15, s15, 65536
    buffer_load_dwordx4 v[108:111], v2, s[8:11], s15 offen
    s_add_u32 s15, s15, 65536
    buffer_load_dwordx4 v[112:115], v2, s[8:11], s15 offen
    s_add_u32 s15, s15, 65536
    buffer_load_dwordx4 v[116:119], v2, s[8:11], s15 offen
    s_add_u32 s15, s15, 65536
    buffer_load_dwordx4 v[120:123], v2, s[8:11], s15 offen
    s_add_u32 s15, s15, 65536
    buffer_load_dwordx4 v[124:127], v2, s[8:11], s15 offen
    s_add_u32 s15, s15, 65536
    buffer_load_dwordx4 v[128:131], v2, s[8:11], s15 offen
    s_add_u32 s15, s15, 65536
    buffer_load_dwordx4 v[132:135], v2, s[8:11], s15 offen
    s_add_u32 s15, s15, 65536
    buffer_load_dwordx4 v[136:139], v2, s[8:11], s15 offen
    s_add_u32 s15, s15, 65536
    buffer_load_dwordx4 v[140:143], v2, s[8:11], s15 offen
    s_add_u32 s15, s15, 65536
    s_waitcnt vmcnt(16)
    ds_write_b128 v3, v[16:19] offset:0
    ds_write_b128 v3, v[20:23] offset:1024
    ds_write_b128 v3, v[24:27] offset:2048
    ds_write_b128 v3, v[28:31] offset:3072
    ds_write_b128 v3, v[32:35] offset:4096
    ds_write_b128 v3, v[36:39] offset:5120
    ds_write_b128 v3, v[40:43] offset:6144
    ds_write_b128 v3, v[44:47] offset:7168
    ds_write_b128 v3, v[48:51] offset:8192
    ds_write_b128 v3, v[52:55] offset:9216
    ds_write_b128 v3, v[56:59] offset:10240
    ds_write_b128 v3, v[60:63] offset:11264
    ds_write_b128 v3, v[64:67] offset:12288
    ds_write_b128 v3, v[68:71] offset:13312
    ds_write_b128 v3, v[72:75] offset:14336
    ds_write_b128 v3, v[76:79] offset:15360
    s_waitcnt lgkmcnt(0)
    ds_read_b64_tr_b16 a[0:1], v5 offset:0
    ds_read_b64_tr_b16 a[2:3], v5 offset:512
    ds_read_b64_tr_b16 a[4:5], v5 offset:8
    ds_read_b64_tr_b16 a[6:7], v5 offset:520
    ds_read_b64_tr_b16 a[8:9], v5 offset:64
    ds_read_b64_tr_b16 a[10:11], v5 offset:576
    ds_read_b64_tr_b16 a[12:13], v5 offset:72
    ds_read_b64_tr_b16 a[14:15], v5 offset:584
    ds_read_b64_tr_b16 a[16:17], v5 offset:4096
    ds_read_b64_tr_b16 a[18:19], v5 offset:4608
    ds_read_b64_tr_b16 a[20:21], v5 offset:4104
    ds_read_b64_tr_b16 a[22:23], v5 offset:4616
    ds_read_b64_tr_b16 a[24:25], v5 offset:4160
    ds_read_b64_tr_b16 a[26:27], v5 offset:4672
    ds_read_b64_tr_b16 a[28:29], v5 offset:4168
    ds_read_b64_tr_b16 a[30:31], v5 offset:4680
    ds_read_b64_tr_b16 a[32:33], v5 offset:8192
    ds_read_b64_tr_b16 a[34:35], v5 offset:8704
    ds_read_b64_tr_b16 a[36:37], v5 offset:8200
    ds_read_b64_tr_b16 a[38:39], v5 offset:8712
    ds_read_b64_tr_b16 a[40:41], v5 offset:8256
    ds_read_b64_tr_b16 a[42:43], v5 offset:8768
    ds_read_b64_tr_b16 a[44:45], v5 offset:8264
    ds_read_b64_tr_b16 a[46:47], v5 offset:8776
    ds_read_b64_tr_b16 a[48:49], v5 offset:12288
    ds_read_b64_tr_b16 a[50:51], v5 offset:12800
    ds_read_b64_tr_b16 a[52:53], v5 offset:12296
    ds_read_b64_tr_b16 a[54:55], v5 offset:12808
    ds_read_b64_tr_b16 a[56:57], v5 offset:12352
    ds_read_b64_tr_b16 a[58:59], v5 offset:12864
    ds_read_b64_tr_b16 a[60:61], v5 offset:12360
    ds_read_b64_tr_b16 a[62:63], v5 offset:12872
    s_waitcnt lgkmcnt(0)
    buffer_load_dwordx4 v[16:19], v2, s[8:11], s15 offen
    s_add_u32 s15, s15, 65536
    buffer_load_dwordx4 v[20:23], v2, s[8:11], s15 offen
    s_add_u32 s15, s15, 65536
    buffer_load_dwordx4 v[24:27], v2, s[8:11], s15 offen
    s_add_u32 s15, s15, 65536
    buffer_load_dwordx4 v[28:31], v2, s[8:11], s15 offen
    s_add_u32 s15, s15, 65536
    buffer_load_dwordx4 v[32:35], v2, s[8:11], s15 offen
    s_add_u32 s15, s15, 65536
    buffer_load_dwordx4 v[36:39], v2, s[8:11], s15 offen
    s_add_u32 s15, s15, 65536
    buffer_load_dwordx4 v[40:43], v2, s[8:11], s15 offen
    s_add_u32 s15, s15, 65536
    buffer_load_dwordx4 v[44:47], v2, s[8:11], s15 offen
    s_add_u32 s15, s15, 65536
    buffer_load_dwordx4 v[48:51], v2, s[8:11], s15 offen
    s_add_u32 s15, s15, 65536
    buffer_load_dwordx4 v[52:55], v2, s[8:11], s15 offen
    s_add_u32 s15, s15, 65536
    buffer_load_dwordx4 v[56:59], v2, s[8:11], s15 offen
    s_add_u32 s15, s15, 65536
    buffer_load_dwordx4 v[60:63], v2, s[8:11], s15 offen
    s_add_u32 s15, s15, 65536
    buffer_load_dwordx4 v[64:67], v2, s[8:11], s15 offen
    s_add_u32 s15, s15, 65536
    buffer_load_dwordx4 v[68:71], v2, s[8:11], s15 offen
    s_add_u32 s15, s15, 65536
    buffer_load_dwordx4 v[72:75], v2, s[8:11], s15 offen
    s_add_u32 s15, s15, 65536
    buffer_load_dwordx4 v[76:79], v2, s[8:11], s15 offen
    s_add_u32 s15, s15, 65536
    s_waitcnt vmcnt(16)
    ds_write_b128 v3, v[80:83] offset:0
    ds_write_b128 v3, v[84:87] offset:1024
    ds_write_b128 v3, v[88:91] offset:2048
    ds_write_b128 v3, v[92:95] offset:3072
    ds_write_b128 v3, v[96:99] offset:4096
    ds_write_b128 v3, v[100:103] offset:5120
    ds_write_b128 v3, v[104:107] offset:6144
    ds_write_b128 v3, v[108:111] offset:7168
    ds_write_b128 v3, v[112:115] offset:8192
    ds_write_b128 v3, v[116:119] offset:9216
    ds_write_b128 v3, v[120:123] offset:10240
    ds_write_b128 v3, v[124:127] offset:11264
    ds_write_b128 v3, v[128:131] offset:12288
    ds_write_b128 v3, v[132:135] offset:13312
    ds_write_b128 v3, v[136:139] offset:14336
    ds_write_b128 v3, v[140:143] offset:15360
    s_waitcnt lgkmcnt(0)
    ds_read_b64_tr_b16 a[64:65], v5 offset:0
    ds_read_b64_tr_b16 a[66:67], v5 offset:512
    ds_read_b64_tr_b16 a[68:69], v5 offset:8
    ds_read_b64_tr_b16 a[70:71], v5 offset:520
    ds_read_b64_tr_b16 a[72:73], v5 offset:64
    ds_read_b64_tr_b16 a[74:75], v5 offset:576
    ds_read_b64_tr_b16 a[76:77], v5 offset:72
    ds_read_b64_tr_b16 a[78:79], v5 offset:584
    ds_read_b64_tr_b16 a[80:81], v5 offset:4096
    ds_read_b64_tr_b16 a[82:83], v5 offset:4608
    ds_read_b64_tr_b16 a[84:85], v5 offset:4104
    ds_read_b64_tr_b16 a[86:87], v5 offset:4616
    ds_read_b64_tr_b16 a[88:89], v5 offset:4160
    ds_read_b64_tr_b16 a[90:91], v5 offset:4672
    ds_read_b64_tr_b16 a[92:93], v5 offset:4168
    ds_read_b64_tr_b16 a[94:95], v5 offset:4680
    ds_read_b64_tr_b16 a[96:97], v5 offset:8192
    ds_read_b64_tr_b16 a[98:99], v5 offset:8704
    ds_read_b64_tr_b16 a[100:101], v5 offset:8200
    ds_read_b64_tr_b16 a[102:103], v5 offset:8712
    ds_read_b64_tr_b16 a[104:105], v5 offset:8256
    ds_read_b64_tr_b16 a[106:107], v5 offset:8768
    ds_read_b64_tr_b16 a[108:109], v5 offset:8264
    ds_read_b64_tr_b16 a[110:111], v5 offset:8776
    ds_read_b64_tr_b16 a[112:113], v5 offset:12288
    ds_read_b64_tr_b16 a[114:115], v5 offset:12800
    ds_read_b64_tr_b16 a[116:117], v5 offset:12296
    ds_read_b64_tr_b16 a[118:119], v5 offset:12808
    ds_read_b64_tr_b16 a[120:121], v5 offset:12352
    ds_read_b64_tr_b16 a[122:123], v5 offset:12864
    ds_read_b64_tr_b16 a[124:125], v5 offset:12360
    ds_read_b64_tr_b16 a[126:127], v5 offset:12872
    s_waitcnt lgkmcnt(0)
    buffer_load_dwordx4 v[80:83], v2, s[8:11], s15 offen
    s_add_u32 s15, s15, 65536
    buffer_load_dwordx4 v[84:87], v2, s[8:11], s15 offen
    s_add_u32 s15, s15, 65536
    buffer_load_dwordx4 v[88:91], v2, s[8:11], s15 offen
    s_add_u32 s15, s15, 65536
    buffer_load_dwordx4 v[92:95], v2, s[8:11], s15 offen
    s_add_u32 s15, s15, 65536
    buffer_load_dwordx4 v[96:99], v2, s[8:11], s15 offen
    s_add_u32 s15, s15, 65536
    buffer_load_dwordx4 v[100:103], v2, s[8:11], s15 offen
    s_add_u32 s15, s15, 65536
    buffer_load_dwordx4 v[104:107], v2, s[8:11], s15 offen
    s_add_u32 s15, s15, 65536
    buffer_load_dwordx4 v[108:111], v2, s[8:11], s15 offen
    s_add_u32 s15, s15, 65536
    buffer_load_dwordx4 v[112:115], v2, s[8:11], s15 offen
    s_add_u32 s15, s15, 65536
    buffer_load_dwordx4 v[116:119], v2, s[8:11], s15 offen
    s_add_u32 s15, s15, 65536
    buffer_load_dwordx4 v[120:123], v2, s[8:11], s15 offen
    s_add_u32 s15, s15, 65536
    buffer_load_dwordx4 v[124:127], v2, s[8:11], s15 offen
    s_add_u32 s15, s15, 65536
    buffer_load_dwordx4 v[128:131], v2, s[8:11], s15 offen
    s_add_u32 s15, s15, 65536
    buffer_load_dwordx4 v[132:135], v2, s[8:11], s15 offen
    s_add_u32 s15, s15, 65536
    buffer_load_dwordx4 v[136:139], v2, s[8:11], s15 offen
    s_add_u32 s15, s15, 65536
    buffer_load_dwordx4 v[140:143], v2, s[8:11], s15 offen
    s_add_u32 s15, s15, 65536
    s_waitcnt vmcnt(16)
    ds_write_b128 v3, v[16:19] offset:0
    ds_write_b128 v3, v[20:23] offset:1024
    ds_write_b128 v3, v[24:27] offset:2048
    ds_write_b128 v3, v[28:31] offset:3072
    ds_write_b128 v3, v[32:35] offset:4096
    ds_write_b128 v3, v[36:39] offset:5120
    ds_write_b128 v3, v[40:43] offset:6144
    ds_write_b128 v3, v[44:47] offset:7168
    ds_write_b128 v3, v[48:51] offset:8192
    ds_write_b128 v3, v[52:55] offset:9216
    ds_write_b128 v3, v[56:59] offset:10240
    ds_write_b128 v3, v[60:63] offset:11264
    ds_write_b128 v3, v[64:67] offset:12288
    ds_write_b128 v3, v[68:71] offset:13312
    ds_write_b128 v3, v[72:75] offset:14336
    ds_write_b128 v3, v[76:79] offset:15360
    s_waitcnt lgkmcnt(0)
    ds_read_b64_tr_b16 a[128:129], v5 offset:0
    ds_read_b64_tr_b16 a[130:131], v5 offset:512
    ds_read_b64_tr_b16 a[132:133], v5 offset:8
    ds_read_b64_tr_b16 a[134:135], v5 offset:520
    ds_read_b64_tr_b16 a[136:137], v5 offset:64
    ds_read_b64_tr_b16 a[138:139], v5 offset:576
    ds_read_b64_tr_b16 a[140:141], v5 offset:72
    ds_read_b64_tr_b16 a[142:143], v5 offset:584
    ds_read_b64_tr_b16 a[144:145], v5 offset:4096
    ds_read_b64_tr_b16 a[146:147], v5 offset:4608
    ds_read_b64_tr_b16 a[148:149], v5 offset:4104
    ds_read_b64_tr_b16 a[150:151], v5 offset:4616
    ds_read_b64_tr_b16 a[152:153], v5 offset:4160
    ds_read_b64_tr_b16 a[154:155], v5 offset:4672
    ds_read_b64_tr_b16 a[156:157], v5 offset:4168
    ds_read_b64_tr_b16 a[158:159], v5 offset:4680
    ds_read_b64_tr_b16 a[160:161], v5 offset:8192
    ds_read_b64_tr_b16 a[162:163], v5 offset:8704
    ds_read_b64_tr_b16 a[164:165], v5 offset:8200
    ds_read_b64_tr_b16 a[166:167], v5 offset:8712
    ds_read_b64_tr_b16 a[168:169], v5 offset:8256
    ds_read_b64_tr_b16 a[170:171], v5 offset:8768
    ds_read_b64_tr_b16 a[172:173], v5 offset:8264
    ds_read_b64_tr_b16 a[174:175], v5 offset:8776
    ds_read_b64_tr_b16 a[176:177], v5 offset:12288
    ds_read_b64_tr_b16 a[178:179], v5 offset:12800
    ds_read_b64_tr_b16 a[180:181], v5 offset:12296
    ds_read_b64_tr_b16 a[182:183], v5 offset:12808
    ds_read_b64_tr_b16 a[184:185], v5 offset:12352
    ds_read_b64_tr_b16 a[186:187], v5 offset:12864
    ds_read_b64_tr_b16 a[188:189], v5 offset:12360
    ds_read_b64_tr_b16 a[190:191], v5 offset:12872
    s_waitcnt lgkmcnt(0)
    s_waitcnt vmcnt(0)
    ds_write_b128 v3, v[80:83] offset:0
    ds_write_b128 v3, v[84:87] offset:1024
    ds_write_b128 v3, v[88:91] offset:2048
    ds_write_b128 v3, v[92:95] offset:3072
    ds_write_b128 v3, v[96:99] offset:4096
    ds_write_b128 v3, v[100:103] offset:5120
    ds_write_b128 v3, v[104:107] offset:6144
    ds_write_b128 v3, v[108:111] offset:7168
    ds_write_b128 v3, v[112:115] offset:8192
    ds_write_b128 v3, v[116:119] offset:9216
    ds_write_b128 v3, v[120:123] offset:10240
    ds_write_b128 v3, v[124:127] offset:11264
    ds_write_b128 v3, v[128:131] offset:12288
    ds_write_b128 v3, v[132:135] offset:13312
    ds_write_b128 v3, v[136:139] offset:14336
    ds_write_b128 v3, v[140:143] offset:15360
    s_waitcnt lgkmcnt(0)
    ds_read_b64_tr_b16 a[192:193], v5 offset:0
    ds_read_b64_tr_b16 a[194:195], v5 offset:512
    ds_read_b64_tr_b16 a[196:197], v5 offset:8
    ds_read_b64_tr_b16 a[198:199], v5 offset:520
    ds_read_b64_tr_b16 a[200:201], v5 offset:64
    ds_read_b64_tr_b16 a[202:203], v5 offset:576
    ds_read_b64_tr_b16 a[204:205], v5 offset:72
    ds_read_b64_tr_b16 a[206:207], v5 offset:584
    ds_read_b64_tr_b16 a[208:209], v5 offset:4096
    ds_read_b64_tr_b16 a[210:211], v5 offset:4608
    ds_read_b64_tr_b16 a[212:213], v5 offset:4104
    ds_read_b64_tr_b16 a[214:215], v5 offset:4616
    ds_read_b64_tr_b16 a[216:217], v5 offset:4160
    ds_read_b64_tr_b16 a[218:219], v5 offset:4672
    ds_read_b64_tr_b16 a[220:221], v5 offset:4168
    ds_read_b64_tr_b16 a[222:223], v5 offset:4680
    ds_read_b64_tr_b16 a[224:225], v5 offset:8192
    ds_read_b64_tr_b16 a[226:227], v5 offset:8704
    ds_read_b64_tr_b16 a[228:229], v5 offset:8200
    ds_read_b64_tr_b16 a[230:231], v5 offset:8712
    ds_read_b64_tr_b16 a[232:233], v5 offset:8256
    ds_read_b64_tr_b16 a[234:235], v5 offset:8768
    ds_read_b64_tr_b16 a[236:237], v5 offset:8264
    ds_read_b64_tr_b16 a[238:239], v5 offset:8776
    ds_read_b64_tr_b16 a[240:241], v5 offset:12288
    ds_read_b64_tr_b16 a[242:243], v5 offset:12800
    ds_read_b64_tr_b16 a[244:245], v5 offset:12296
    ds_read_b64_tr_b16 a[246:247], v5 offset:12808
    ds_read_b64_tr_b16 a[248:249], v5 offset:12352
    ds_read_b64_tr_b16 a[250:251], v5 offset:12864
    ds_read_b64_tr_b16 a[252:253], v5 offset:12360
    ds_read_b64_tr_b16 a[254:255], v5 offset:12872
    s_waitcnt lgkmcnt(0)
    s_barrier
    buffer_load_dwordx4 v[104:107], v1, s[4:7], s19 offen
    s_add_u32 s19, s19, 4096
    buffer_load_dwordx4 v[108:111], v1, s[4:7], s19 offen
    s_add_u32 s19, s19, 4096
    buffer_load_dwordx4 v[112:115], v1, s[4:7], s19 offen
    s_add_u32 s19, s19, 4096
    buffer_load_dwordx4 v[116:119], v1, s[4:7], s19 offen
    s_add_u32 s19, s19, 4096
    buffer_load_dwordx4 v[120:123], v1, s[4:7], s19 offen
    s_add_u32 s19, s19, 4096
    buffer_load_dwordx4 v[124:127], v1, s[4:7], s19 offen
    s_add_u32 s19, s19, 4096
    buffer_load_dwordx4 v[128:131], v1, s[4:7], s19 offen
    s_add_u32 s19, s19, 4096
    buffer_load_dwordx4 v[132:135], v1, s[4:7], s19 offen
    s_add_u32 s19, s19, 4096
    buffer_load_dwordx4 v[136:139], v1, s[4:7], s19 offen
    s_add_u32 s19, s19, 4096
    buffer_load_dwordx4 v[140:143], v1, s[4:7], s19 offen
    s_add_u32 s19, s19, 4096
    buffer_load_dwordx4 v[144:147], v1, s[4:7], s19 offen
    s_add_u32 s19, s19, 4096
    buffer_load_dwordx4 v[148:151], v1, s[4:7], s19 offen
    s_add_u32 s19, s19, 4096
    buffer_load_dwordx4 v[152:155], v1, s[4:7], s19 offen
    s_add_u32 s19, s19, 4096
    buffer_load_dwordx4 v[156:159], v1, s[4:7], s19 offen
    s_add_u32 s19, s19, 4096
    buffer_load_dwordx4 v[160:163], v1, s[4:7], s19 offen
    s_add_u32 s19, s19, 4096
    buffer_load_dwordx4 v[164:167], v1, s[4:7], s19 offen
    s_add_u32 s19, s19, 4096
    s_lshr_b32 s20, s16, 1
    s_and_b32 s21, s16, 1
    s_cmp_eq_u32 s17, 1
    s_cbranch_scc1 L_q1_vaddr
    s_lshl_b32 s20, s20, 2
    s_lshl_b32 s21, s21, 1
    s_add_u32 s20, s20, s21
    s_lshl_b32 s20, s20, 10
    s_mov_b32 s21, 67108864
    s_cmp_eq_u32 s17, 2
    s_cselect_b32 s21, 50331648, s21
    s_add_u32 s20, s20, s21
    s_branch L_q1_addr_done
L_q1_vaddr:
    s_lshl_b32 s20, s20, 3
    s_lshl_b32 s21, s21, 2
    s_add_u32 s20, s20, s21
    s_lshl_b32 s20, s20, 10
    s_add_u32 s20, s20, 83886080
L_q1_addr_done:
    s_mov_b32 s21, 48248832
    s_cmp_eq_u32 s17, 2
    s_cselect_b32 s21, 48236544, s21
    s_mov_b32 s40, 0
    v_mov_b32 v2, v1
    v_mov_b32 v5, v4
    s_waitcnt vmcnt(0)
    ds_write_b128 v2, v[104:107] offset:0
    ds_write_b128 v2, v[108:111] offset:4096
    ds_write_b128 v2, v[112:115] offset:8192
    ds_write_b128 v2, v[116:119] offset:12288
    ds_write_b128 v2, v[120:123] offset:16384
    ds_write_b128 v2, v[124:127] offset:20480
    ds_write_b128 v2, v[128:131] offset:24576
    ds_write_b128 v2, v[132:135] offset:28672
    ds_write_b128 v2, v[136:139] offset:32768
    ds_write_b128 v2, v[140:143] offset:36864
    ds_write_b128 v2, v[144:147] offset:40960
    ds_write_b128 v2, v[148:151] offset:45056
    ds_write_b128 v2, v[152:155] offset:49152
    ds_write_b128 v2, v[156:159] offset:53248
    ds_write_b128 v2, v[160:163] offset:57344
    ds_write_b128 v2, v[164:167] offset:61440
    s_waitcnt lgkmcnt(0)
    buffer_load_dwordx4 v[104:107], v1, s[4:7], s19 offen
    s_add_u32 s19, s19, 4096
    buffer_load_dwordx4 v[108:111], v1, s[4:7], s19 offen
    s_add_u32 s19, s19, 4096
    buffer_load_dwordx4 v[112:115], v1, s[4:7], s19 offen
    s_add_u32 s19, s19, 4096
    buffer_load_dwordx4 v[116:119], v1, s[4:7], s19 offen
    s_add_u32 s19, s19, 4096
    buffer_load_dwordx4 v[120:123], v1, s[4:7], s19 offen
    s_add_u32 s19, s19, 4096
    buffer_load_dwordx4 v[124:127], v1, s[4:7], s19 offen
    s_add_u32 s19, s19, 4096
    buffer_load_dwordx4 v[128:131], v1, s[4:7], s19 offen
    s_add_u32 s19, s19, 4096
    buffer_load_dwordx4 v[132:135], v1, s[4:7], s19 offen
    s_add_u32 s19, s19, 4096
    buffer_load_dwordx4 v[136:139], v1, s[4:7], s19 offen
    s_add_u32 s19, s19, 4096
    buffer_load_dwordx4 v[140:143], v1, s[4:7], s19 offen
    s_add_u32 s19, s19, 4096
    buffer_load_dwordx4 v[144:147], v1, s[4:7], s19 offen
    s_add_u32 s19, s19, 4096
    buffer_load_dwordx4 v[148:151], v1, s[4:7], s19 offen
    s_add_u32 s19, s19, 4096
    buffer_load_dwordx4 v[152:155], v1, s[4:7], s19 offen
    s_add_u32 s19, s19, 4096
    buffer_load_dwordx4 v[156:159], v1, s[4:7], s19 offen
    s_add_u32 s19, s19, 4096
    buffer_load_dwordx4 v[160:163], v1, s[4:7], s19 offen
    s_add_u32 s19, s19, 4096
    buffer_load_dwordx4 v[164:167], v1, s[4:7], s19 offen
    s_add_u32 s19, s19, 4096
    s_barrier
    s_cmp_eq_u32 s17, 1
    s_cbranch_scc1 L_q1_loop_v
L_q1_loop_qk:
    ds_read_b128 v[8:11], v5 offset:0
    ds_read_b128 v[12:15], v5 offset:1024
    ds_read_b128 v[16:19], v5 offset:2048
    ds_read_b128 v[20:23], v5 offset:3072
    ds_read_b128 v[24:27], v5 offset:4096
    ds_read_b128 v[28:31], v5 offset:5120
    ds_read_b128 v[32:35], v5 offset:6144
    ds_read_b128 v[36:39], v5 offset:7168
    ds_read_b128 v[40:43], v5 offset:8192
    ds_read_b128 v[44:47], v5 offset:9216
    ds_read_b128 v[48:51], v5 offset:10240
    ds_read_b128 v[52:55], v5 offset:11264
    s_waitcnt lgkmcnt(8)
    v_mfma_f32_16x16x32_bf16 v[168:171], a[0:3], v[8:11], 0
    v_mfma_f32_16x16x32_bf16 v[172:175], a[0:3], v[12:15], 0
    v_mfma_f32_16x16x32_bf16 v[176:179], a[0:3], v[16:19], 0
    v_mfma_f32_16x16x32_bf16 v[180:183], a[0:3], v[20:23], 0
    v_mfma_f32_16x16x32_bf16 v[184:187], a[4:7], v[8:11], 0
    v_mfma_f32_16x16x32_bf16 v[188:191], a[4:7], v[12:15], 0
    v_mfma_f32_16x16x32_bf16 v[192:195], a[4:7], v[16:19], 0
    v_mfma_f32_16x16x32_bf16 v[196:199], a[4:7], v[20:23], 0
    v_mfma_f32_16x16x32_bf16 v[200:203], a[8:11], v[8:11], 0
    v_mfma_f32_16x16x32_bf16 v[204:207], a[8:11], v[12:15], 0
    v_mfma_f32_16x16x32_bf16 v[208:211], a[8:11], v[16:19], 0
    v_mfma_f32_16x16x32_bf16 v[212:215], a[8:11], v[20:23], 0
    v_mfma_f32_16x16x32_bf16 v[216:219], a[12:15], v[8:11], 0
    v_mfma_f32_16x16x32_bf16 v[220:223], a[12:15], v[12:15], 0
    v_mfma_f32_16x16x32_bf16 v[224:227], a[12:15], v[16:19], 0
    v_mfma_f32_16x16x32_bf16 v[228:231], a[12:15], v[20:23], 0
    ds_read_b128 v[8:11], v5 offset:12288
    ds_read_b128 v[12:15], v5 offset:13312
    ds_read_b128 v[16:19], v5 offset:14336
    ds_read_b128 v[20:23], v5 offset:15360
    s_waitcnt lgkmcnt(8)
    v_mfma_f32_16x16x32_bf16 v[168:171], a[16:19], v[24:27], v[168:171]
    v_mfma_f32_16x16x32_bf16 v[172:175], a[16:19], v[28:31], v[172:175]
    v_mfma_f32_16x16x32_bf16 v[176:179], a[16:19], v[32:35], v[176:179]
    v_mfma_f32_16x16x32_bf16 v[180:183], a[16:19], v[36:39], v[180:183]
    v_mfma_f32_16x16x32_bf16 v[184:187], a[20:23], v[24:27], v[184:187]
    v_mfma_f32_16x16x32_bf16 v[188:191], a[20:23], v[28:31], v[188:191]
    v_mfma_f32_16x16x32_bf16 v[192:195], a[20:23], v[32:35], v[192:195]
    v_mfma_f32_16x16x32_bf16 v[196:199], a[20:23], v[36:39], v[196:199]
    v_mfma_f32_16x16x32_bf16 v[200:203], a[24:27], v[24:27], v[200:203]
    v_mfma_f32_16x16x32_bf16 v[204:207], a[24:27], v[28:31], v[204:207]
    v_mfma_f32_16x16x32_bf16 v[208:211], a[24:27], v[32:35], v[208:211]
    v_mfma_f32_16x16x32_bf16 v[212:215], a[24:27], v[36:39], v[212:215]
    v_mfma_f32_16x16x32_bf16 v[216:219], a[28:31], v[24:27], v[216:219]
    v_mfma_f32_16x16x32_bf16 v[220:223], a[28:31], v[28:31], v[220:223]
    v_mfma_f32_16x16x32_bf16 v[224:227], a[28:31], v[32:35], v[224:227]
    v_mfma_f32_16x16x32_bf16 v[228:231], a[28:31], v[36:39], v[228:231]
    ds_read_b128 v[24:27], v5 offset:16384
    ds_read_b128 v[28:31], v5 offset:17408
    ds_read_b128 v[32:35], v5 offset:18432
    ds_read_b128 v[36:39], v5 offset:19456
    s_waitcnt lgkmcnt(8)
    v_mfma_f32_16x16x32_bf16 v[168:171], a[32:35], v[40:43], v[168:171]
    v_mfma_f32_16x16x32_bf16 v[172:175], a[32:35], v[44:47], v[172:175]
    v_mfma_f32_16x16x32_bf16 v[176:179], a[32:35], v[48:51], v[176:179]
    v_mfma_f32_16x16x32_bf16 v[180:183], a[32:35], v[52:55], v[180:183]
    v_mfma_f32_16x16x32_bf16 v[184:187], a[36:39], v[40:43], v[184:187]
    v_mfma_f32_16x16x32_bf16 v[188:191], a[36:39], v[44:47], v[188:191]
    v_mfma_f32_16x16x32_bf16 v[192:195], a[36:39], v[48:51], v[192:195]
    v_mfma_f32_16x16x32_bf16 v[196:199], a[36:39], v[52:55], v[196:199]
    v_mfma_f32_16x16x32_bf16 v[200:203], a[40:43], v[40:43], v[200:203]
    v_mfma_f32_16x16x32_bf16 v[204:207], a[40:43], v[44:47], v[204:207]
    v_mfma_f32_16x16x32_bf16 v[208:211], a[40:43], v[48:51], v[208:211]
    v_mfma_f32_16x16x32_bf16 v[212:215], a[40:43], v[52:55], v[212:215]
    v_mfma_f32_16x16x32_bf16 v[216:219], a[44:47], v[40:43], v[216:219]
    v_mfma_f32_16x16x32_bf16 v[220:223], a[44:47], v[44:47], v[220:223]
    v_mfma_f32_16x16x32_bf16 v[224:227], a[44:47], v[48:51], v[224:227]
    v_mfma_f32_16x16x32_bf16 v[228:231], a[44:47], v[52:55], v[228:231]
    ds_read_b128 v[40:43], v5 offset:20480
    ds_read_b128 v[44:47], v5 offset:21504
    ds_read_b128 v[48:51], v5 offset:22528
    ds_read_b128 v[52:55], v5 offset:23552
    s_waitcnt lgkmcnt(8)
    v_mfma_f32_16x16x32_bf16 v[168:171], a[48:51], v[8:11], v[168:171]
    v_mfma_f32_16x16x32_bf16 v[172:175], a[48:51], v[12:15], v[172:175]
    v_mfma_f32_16x16x32_bf16 v[176:179], a[48:51], v[16:19], v[176:179]
    v_mfma_f32_16x16x32_bf16 v[180:183], a[48:51], v[20:23], v[180:183]
    v_mfma_f32_16x16x32_bf16 v[184:187], a[52:55], v[8:11], v[184:187]
    v_mfma_f32_16x16x32_bf16 v[188:191], a[52:55], v[12:15], v[188:191]
    v_mfma_f32_16x16x32_bf16 v[192:195], a[52:55], v[16:19], v[192:195]
    v_mfma_f32_16x16x32_bf16 v[196:199], a[52:55], v[20:23], v[196:199]
    v_mfma_f32_16x16x32_bf16 v[200:203], a[56:59], v[8:11], v[200:203]
    v_mfma_f32_16x16x32_bf16 v[204:207], a[56:59], v[12:15], v[204:207]
    v_mfma_f32_16x16x32_bf16 v[208:211], a[56:59], v[16:19], v[208:211]
    v_mfma_f32_16x16x32_bf16 v[212:215], a[56:59], v[20:23], v[212:215]
    v_mfma_f32_16x16x32_bf16 v[216:219], a[60:63], v[8:11], v[216:219]
    v_mfma_f32_16x16x32_bf16 v[220:223], a[60:63], v[12:15], v[220:223]
    v_mfma_f32_16x16x32_bf16 v[224:227], a[60:63], v[16:19], v[224:227]
    v_mfma_f32_16x16x32_bf16 v[228:231], a[60:63], v[20:23], v[228:231]
    ds_read_b128 v[8:11], v5 offset:24576
    ds_read_b128 v[12:15], v5 offset:25600
    ds_read_b128 v[16:19], v5 offset:26624
    ds_read_b128 v[20:23], v5 offset:27648
    s_waitcnt lgkmcnt(8)
    v_mfma_f32_16x16x32_bf16 v[168:171], a[64:67], v[24:27], v[168:171]
    v_mfma_f32_16x16x32_bf16 v[172:175], a[64:67], v[28:31], v[172:175]
    v_mfma_f32_16x16x32_bf16 v[176:179], a[64:67], v[32:35], v[176:179]
    v_mfma_f32_16x16x32_bf16 v[180:183], a[64:67], v[36:39], v[180:183]
    v_mfma_f32_16x16x32_bf16 v[184:187], a[68:71], v[24:27], v[184:187]
    v_mfma_f32_16x16x32_bf16 v[188:191], a[68:71], v[28:31], v[188:191]
    v_mfma_f32_16x16x32_bf16 v[192:195], a[68:71], v[32:35], v[192:195]
    v_mfma_f32_16x16x32_bf16 v[196:199], a[68:71], v[36:39], v[196:199]
    v_mfma_f32_16x16x32_bf16 v[200:203], a[72:75], v[24:27], v[200:203]
    v_mfma_f32_16x16x32_bf16 v[204:207], a[72:75], v[28:31], v[204:207]
    v_mfma_f32_16x16x32_bf16 v[208:211], a[72:75], v[32:35], v[208:211]
    v_mfma_f32_16x16x32_bf16 v[212:215], a[72:75], v[36:39], v[212:215]
    v_mfma_f32_16x16x32_bf16 v[216:219], a[76:79], v[24:27], v[216:219]
    v_mfma_f32_16x16x32_bf16 v[220:223], a[76:79], v[28:31], v[220:223]
    v_mfma_f32_16x16x32_bf16 v[224:227], a[76:79], v[32:35], v[224:227]
    v_mfma_f32_16x16x32_bf16 v[228:231], a[76:79], v[36:39], v[228:231]
    ds_read_b128 v[24:27], v5 offset:28672
    ds_read_b128 v[28:31], v5 offset:29696
    ds_read_b128 v[32:35], v5 offset:30720
    ds_read_b128 v[36:39], v5 offset:31744
    s_waitcnt lgkmcnt(8)
    v_mfma_f32_16x16x32_bf16 v[168:171], a[80:83], v[40:43], v[168:171]
    v_mfma_f32_16x16x32_bf16 v[172:175], a[80:83], v[44:47], v[172:175]
    v_mfma_f32_16x16x32_bf16 v[176:179], a[80:83], v[48:51], v[176:179]
    v_mfma_f32_16x16x32_bf16 v[180:183], a[80:83], v[52:55], v[180:183]
    v_mfma_f32_16x16x32_bf16 v[184:187], a[84:87], v[40:43], v[184:187]
    v_mfma_f32_16x16x32_bf16 v[188:191], a[84:87], v[44:47], v[188:191]
    v_mfma_f32_16x16x32_bf16 v[192:195], a[84:87], v[48:51], v[192:195]
    v_mfma_f32_16x16x32_bf16 v[196:199], a[84:87], v[52:55], v[196:199]
    v_mfma_f32_16x16x32_bf16 v[200:203], a[88:91], v[40:43], v[200:203]
    v_mfma_f32_16x16x32_bf16 v[204:207], a[88:91], v[44:47], v[204:207]
    v_mfma_f32_16x16x32_bf16 v[208:211], a[88:91], v[48:51], v[208:211]
    v_mfma_f32_16x16x32_bf16 v[212:215], a[88:91], v[52:55], v[212:215]
    v_mfma_f32_16x16x32_bf16 v[216:219], a[92:95], v[40:43], v[216:219]
    v_mfma_f32_16x16x32_bf16 v[220:223], a[92:95], v[44:47], v[220:223]
    v_mfma_f32_16x16x32_bf16 v[224:227], a[92:95], v[48:51], v[224:227]
    v_mfma_f32_16x16x32_bf16 v[228:231], a[92:95], v[52:55], v[228:231]
    ds_read_b128 v[40:43], v5 offset:32768
    ds_read_b128 v[44:47], v5 offset:33792
    ds_read_b128 v[48:51], v5 offset:34816
    ds_read_b128 v[52:55], v5 offset:35840
    s_waitcnt lgkmcnt(8)
    v_mfma_f32_16x16x32_bf16 v[168:171], a[96:99], v[8:11], v[168:171]
    v_mfma_f32_16x16x32_bf16 v[172:175], a[96:99], v[12:15], v[172:175]
    v_mfma_f32_16x16x32_bf16 v[176:179], a[96:99], v[16:19], v[176:179]
    v_mfma_f32_16x16x32_bf16 v[180:183], a[96:99], v[20:23], v[180:183]
    v_mfma_f32_16x16x32_bf16 v[184:187], a[100:103], v[8:11], v[184:187]
    v_mfma_f32_16x16x32_bf16 v[188:191], a[100:103], v[12:15], v[188:191]
    v_mfma_f32_16x16x32_bf16 v[192:195], a[100:103], v[16:19], v[192:195]
    v_mfma_f32_16x16x32_bf16 v[196:199], a[100:103], v[20:23], v[196:199]
    v_mfma_f32_16x16x32_bf16 v[200:203], a[104:107], v[8:11], v[200:203]
    v_mfma_f32_16x16x32_bf16 v[204:207], a[104:107], v[12:15], v[204:207]
    v_mfma_f32_16x16x32_bf16 v[208:211], a[104:107], v[16:19], v[208:211]
    v_mfma_f32_16x16x32_bf16 v[212:215], a[104:107], v[20:23], v[212:215]
    v_mfma_f32_16x16x32_bf16 v[216:219], a[108:111], v[8:11], v[216:219]
    v_mfma_f32_16x16x32_bf16 v[220:223], a[108:111], v[12:15], v[220:223]
    v_mfma_f32_16x16x32_bf16 v[224:227], a[108:111], v[16:19], v[224:227]
    v_mfma_f32_16x16x32_bf16 v[228:231], a[108:111], v[20:23], v[228:231]
    ds_read_b128 v[8:11], v5 offset:36864
    ds_read_b128 v[12:15], v5 offset:37888
    ds_read_b128 v[16:19], v5 offset:38912
    ds_read_b128 v[20:23], v5 offset:39936
    s_waitcnt lgkmcnt(8)
    v_mfma_f32_16x16x32_bf16 v[168:171], a[112:115], v[24:27], v[168:171]
    v_mfma_f32_16x16x32_bf16 v[172:175], a[112:115], v[28:31], v[172:175]
    v_mfma_f32_16x16x32_bf16 v[176:179], a[112:115], v[32:35], v[176:179]
    v_mfma_f32_16x16x32_bf16 v[180:183], a[112:115], v[36:39], v[180:183]
    v_mfma_f32_16x16x32_bf16 v[184:187], a[116:119], v[24:27], v[184:187]
    v_mfma_f32_16x16x32_bf16 v[188:191], a[116:119], v[28:31], v[188:191]
    v_mfma_f32_16x16x32_bf16 v[192:195], a[116:119], v[32:35], v[192:195]
    v_mfma_f32_16x16x32_bf16 v[196:199], a[116:119], v[36:39], v[196:199]
    v_mfma_f32_16x16x32_bf16 v[200:203], a[120:123], v[24:27], v[200:203]
    v_mfma_f32_16x16x32_bf16 v[204:207], a[120:123], v[28:31], v[204:207]
    v_mfma_f32_16x16x32_bf16 v[208:211], a[120:123], v[32:35], v[208:211]
    v_mfma_f32_16x16x32_bf16 v[212:215], a[120:123], v[36:39], v[212:215]
    v_mfma_f32_16x16x32_bf16 v[216:219], a[124:127], v[24:27], v[216:219]
    v_mfma_f32_16x16x32_bf16 v[220:223], a[124:127], v[28:31], v[220:223]
    v_mfma_f32_16x16x32_bf16 v[224:227], a[124:127], v[32:35], v[224:227]
    v_mfma_f32_16x16x32_bf16 v[228:231], a[124:127], v[36:39], v[228:231]
    ds_read_b128 v[24:27], v5 offset:40960
    ds_read_b128 v[28:31], v5 offset:41984
    ds_read_b128 v[32:35], v5 offset:43008
    ds_read_b128 v[36:39], v5 offset:44032
    s_waitcnt lgkmcnt(8)
    v_mfma_f32_16x16x32_bf16 v[168:171], a[128:131], v[40:43], v[168:171]
    v_mfma_f32_16x16x32_bf16 v[172:175], a[128:131], v[44:47], v[172:175]
    v_mfma_f32_16x16x32_bf16 v[176:179], a[128:131], v[48:51], v[176:179]
    v_mfma_f32_16x16x32_bf16 v[180:183], a[128:131], v[52:55], v[180:183]
    v_mfma_f32_16x16x32_bf16 v[184:187], a[132:135], v[40:43], v[184:187]
    v_mfma_f32_16x16x32_bf16 v[188:191], a[132:135], v[44:47], v[188:191]
    v_mfma_f32_16x16x32_bf16 v[192:195], a[132:135], v[48:51], v[192:195]
    v_mfma_f32_16x16x32_bf16 v[196:199], a[132:135], v[52:55], v[196:199]
    v_mfma_f32_16x16x32_bf16 v[200:203], a[136:139], v[40:43], v[200:203]
    v_mfma_f32_16x16x32_bf16 v[204:207], a[136:139], v[44:47], v[204:207]
    v_mfma_f32_16x16x32_bf16 v[208:211], a[136:139], v[48:51], v[208:211]
    v_mfma_f32_16x16x32_bf16 v[212:215], a[136:139], v[52:55], v[212:215]
    v_mfma_f32_16x16x32_bf16 v[216:219], a[140:143], v[40:43], v[216:219]
    v_mfma_f32_16x16x32_bf16 v[220:223], a[140:143], v[44:47], v[220:223]
    v_mfma_f32_16x16x32_bf16 v[224:227], a[140:143], v[48:51], v[224:227]
    v_mfma_f32_16x16x32_bf16 v[228:231], a[140:143], v[52:55], v[228:231]
    ds_read_b128 v[40:43], v5 offset:45056
    ds_read_b128 v[44:47], v5 offset:46080
    ds_read_b128 v[48:51], v5 offset:47104
    ds_read_b128 v[52:55], v5 offset:48128
    s_waitcnt lgkmcnt(8)
    v_mfma_f32_16x16x32_bf16 v[168:171], a[144:147], v[8:11], v[168:171]
    v_mfma_f32_16x16x32_bf16 v[172:175], a[144:147], v[12:15], v[172:175]
    v_mfma_f32_16x16x32_bf16 v[176:179], a[144:147], v[16:19], v[176:179]
    v_mfma_f32_16x16x32_bf16 v[180:183], a[144:147], v[20:23], v[180:183]
    v_mfma_f32_16x16x32_bf16 v[184:187], a[148:151], v[8:11], v[184:187]
    v_mfma_f32_16x16x32_bf16 v[188:191], a[148:151], v[12:15], v[188:191]
    v_mfma_f32_16x16x32_bf16 v[192:195], a[148:151], v[16:19], v[192:195]
    v_mfma_f32_16x16x32_bf16 v[196:199], a[148:151], v[20:23], v[196:199]
    v_mfma_f32_16x16x32_bf16 v[200:203], a[152:155], v[8:11], v[200:203]
    v_mfma_f32_16x16x32_bf16 v[204:207], a[152:155], v[12:15], v[204:207]
    v_mfma_f32_16x16x32_bf16 v[208:211], a[152:155], v[16:19], v[208:211]
    v_mfma_f32_16x16x32_bf16 v[212:215], a[152:155], v[20:23], v[212:215]
    v_mfma_f32_16x16x32_bf16 v[216:219], a[156:159], v[8:11], v[216:219]
    v_mfma_f32_16x16x32_bf16 v[220:223], a[156:159], v[12:15], v[220:223]
    v_mfma_f32_16x16x32_bf16 v[224:227], a[156:159], v[16:19], v[224:227]
    v_mfma_f32_16x16x32_bf16 v[228:231], a[156:159], v[20:23], v[228:231]
    ds_read_b128 v[8:11], v5 offset:49152
    ds_read_b128 v[12:15], v5 offset:50176
    ds_read_b128 v[16:19], v5 offset:51200
    ds_read_b128 v[20:23], v5 offset:52224
    s_waitcnt lgkmcnt(8)
    v_mfma_f32_16x16x32_bf16 v[168:171], a[160:163], v[24:27], v[168:171]
    v_mfma_f32_16x16x32_bf16 v[172:175], a[160:163], v[28:31], v[172:175]
    v_mfma_f32_16x16x32_bf16 v[176:179], a[160:163], v[32:35], v[176:179]
    v_mfma_f32_16x16x32_bf16 v[180:183], a[160:163], v[36:39], v[180:183]
    v_mfma_f32_16x16x32_bf16 v[184:187], a[164:167], v[24:27], v[184:187]
    v_mfma_f32_16x16x32_bf16 v[188:191], a[164:167], v[28:31], v[188:191]
    v_mfma_f32_16x16x32_bf16 v[192:195], a[164:167], v[32:35], v[192:195]
    v_mfma_f32_16x16x32_bf16 v[196:199], a[164:167], v[36:39], v[196:199]
    v_mfma_f32_16x16x32_bf16 v[200:203], a[168:171], v[24:27], v[200:203]
    v_mfma_f32_16x16x32_bf16 v[204:207], a[168:171], v[28:31], v[204:207]
    v_mfma_f32_16x16x32_bf16 v[208:211], a[168:171], v[32:35], v[208:211]
    v_mfma_f32_16x16x32_bf16 v[212:215], a[168:171], v[36:39], v[212:215]
    v_mfma_f32_16x16x32_bf16 v[216:219], a[172:175], v[24:27], v[216:219]
    v_mfma_f32_16x16x32_bf16 v[220:223], a[172:175], v[28:31], v[220:223]
    v_mfma_f32_16x16x32_bf16 v[224:227], a[172:175], v[32:35], v[224:227]
    v_mfma_f32_16x16x32_bf16 v[228:231], a[172:175], v[36:39], v[228:231]
    ds_read_b128 v[24:27], v5 offset:53248
    ds_read_b128 v[28:31], v5 offset:54272
    ds_read_b128 v[32:35], v5 offset:55296
    ds_read_b128 v[36:39], v5 offset:56320
    s_waitcnt lgkmcnt(8)
    v_mfma_f32_16x16x32_bf16 v[168:171], a[176:179], v[40:43], v[168:171]
    v_mfma_f32_16x16x32_bf16 v[172:175], a[176:179], v[44:47], v[172:175]
    v_mfma_f32_16x16x32_bf16 v[176:179], a[176:179], v[48:51], v[176:179]
    v_mfma_f32_16x16x32_bf16 v[180:183], a[176:179], v[52:55], v[180:183]
    v_mfma_f32_16x16x32_bf16 v[184:187], a[180:183], v[40:43], v[184:187]
    v_mfma_f32_16x16x32_bf16 v[188:191], a[180:183], v[44:47], v[188:191]
    v_mfma_f32_16x16x32_bf16 v[192:195], a[180:183], v[48:51], v[192:195]
    v_mfma_f32_16x16x32_bf16 v[196:199], a[180:183], v[52:55], v[196:199]
    v_mfma_f32_16x16x32_bf16 v[200:203], a[184:187], v[40:43], v[200:203]
    v_mfma_f32_16x16x32_bf16 v[204:207], a[184:187], v[44:47], v[204:207]
    v_mfma_f32_16x16x32_bf16 v[208:211], a[184:187], v[48:51], v[208:211]
    v_mfma_f32_16x16x32_bf16 v[212:215], a[184:187], v[52:55], v[212:215]
    v_mfma_f32_16x16x32_bf16 v[216:219], a[188:191], v[40:43], v[216:219]
    v_mfma_f32_16x16x32_bf16 v[220:223], a[188:191], v[44:47], v[220:223]
    v_mfma_f32_16x16x32_bf16 v[224:227], a[188:191], v[48:51], v[224:227]
    v_mfma_f32_16x16x32_bf16 v[228:231], a[188:191], v[52:55], v[228:231]
    ds_read_b128 v[40:43], v5 offset:57344
    ds_read_b128 v[44:47], v5 offset:58368
    ds_read_b128 v[48:51], v5 offset:59392
    ds_read_b128 v[52:55], v5 offset:60416
    s_waitcnt lgkmcnt(8)
    v_mfma_f32_16x16x32_bf16 v[168:171], a[192:195], v[8:11], v[168:171]
    v_mfma_f32_16x16x32_bf16 v[172:175], a[192:195], v[12:15], v[172:175]
    v_mfma_f32_16x16x32_bf16 v[176:179], a[192:195], v[16:19], v[176:179]
    v_mfma_f32_16x16x32_bf16 v[180:183], a[192:195], v[20:23], v[180:183]
    v_mfma_f32_16x16x32_bf16 v[184:187], a[196:199], v[8:11], v[184:187]
    v_mfma_f32_16x16x32_bf16 v[188:191], a[196:199], v[12:15], v[188:191]
    v_mfma_f32_16x16x32_bf16 v[192:195], a[196:199], v[16:19], v[192:195]
    v_mfma_f32_16x16x32_bf16 v[196:199], a[196:199], v[20:23], v[196:199]
    v_mfma_f32_16x16x32_bf16 v[200:203], a[200:203], v[8:11], v[200:203]
    v_mfma_f32_16x16x32_bf16 v[204:207], a[200:203], v[12:15], v[204:207]
    v_mfma_f32_16x16x32_bf16 v[208:211], a[200:203], v[16:19], v[208:211]
    v_mfma_f32_16x16x32_bf16 v[212:215], a[200:203], v[20:23], v[212:215]
    v_mfma_f32_16x16x32_bf16 v[216:219], a[204:207], v[8:11], v[216:219]
    v_mfma_f32_16x16x32_bf16 v[220:223], a[204:207], v[12:15], v[220:223]
    v_mfma_f32_16x16x32_bf16 v[224:227], a[204:207], v[16:19], v[224:227]
    v_mfma_f32_16x16x32_bf16 v[228:231], a[204:207], v[20:23], v[228:231]
    ds_read_b128 v[8:11], v5 offset:61440
    ds_read_b128 v[12:15], v5 offset:62464
    ds_read_b128 v[16:19], v5 offset:63488
    ds_read_b128 v[20:23], v5 offset:64512
    s_waitcnt lgkmcnt(8)
    v_mfma_f32_16x16x32_bf16 v[168:171], a[208:211], v[24:27], v[168:171]
    v_mfma_f32_16x16x32_bf16 v[172:175], a[208:211], v[28:31], v[172:175]
    v_mfma_f32_16x16x32_bf16 v[176:179], a[208:211], v[32:35], v[176:179]
    v_mfma_f32_16x16x32_bf16 v[180:183], a[208:211], v[36:39], v[180:183]
    v_mfma_f32_16x16x32_bf16 v[184:187], a[212:215], v[24:27], v[184:187]
    v_mfma_f32_16x16x32_bf16 v[188:191], a[212:215], v[28:31], v[188:191]
    v_mfma_f32_16x16x32_bf16 v[192:195], a[212:215], v[32:35], v[192:195]
    v_mfma_f32_16x16x32_bf16 v[196:199], a[212:215], v[36:39], v[196:199]
    v_mfma_f32_16x16x32_bf16 v[200:203], a[216:219], v[24:27], v[200:203]
    v_mfma_f32_16x16x32_bf16 v[204:207], a[216:219], v[28:31], v[204:207]
    v_mfma_f32_16x16x32_bf16 v[208:211], a[216:219], v[32:35], v[208:211]
    v_mfma_f32_16x16x32_bf16 v[212:215], a[216:219], v[36:39], v[212:215]
    v_mfma_f32_16x16x32_bf16 v[216:219], a[220:223], v[24:27], v[216:219]
    v_mfma_f32_16x16x32_bf16 v[220:223], a[220:223], v[28:31], v[220:223]
    v_mfma_f32_16x16x32_bf16 v[224:227], a[220:223], v[32:35], v[224:227]
    v_mfma_f32_16x16x32_bf16 v[228:231], a[220:223], v[36:39], v[228:231]
    s_waitcnt lgkmcnt(4)
    v_mfma_f32_16x16x32_bf16 v[168:171], a[224:227], v[40:43], v[168:171]
    v_mfma_f32_16x16x32_bf16 v[172:175], a[224:227], v[44:47], v[172:175]
    v_mfma_f32_16x16x32_bf16 v[176:179], a[224:227], v[48:51], v[176:179]
    v_mfma_f32_16x16x32_bf16 v[180:183], a[224:227], v[52:55], v[180:183]
    v_mfma_f32_16x16x32_bf16 v[184:187], a[228:231], v[40:43], v[184:187]
    v_mfma_f32_16x16x32_bf16 v[188:191], a[228:231], v[44:47], v[188:191]
    v_mfma_f32_16x16x32_bf16 v[192:195], a[228:231], v[48:51], v[192:195]
    v_mfma_f32_16x16x32_bf16 v[196:199], a[228:231], v[52:55], v[196:199]
    v_mfma_f32_16x16x32_bf16 v[200:203], a[232:235], v[40:43], v[200:203]
    v_mfma_f32_16x16x32_bf16 v[204:207], a[232:235], v[44:47], v[204:207]
    v_mfma_f32_16x16x32_bf16 v[208:211], a[232:235], v[48:51], v[208:211]
    v_mfma_f32_16x16x32_bf16 v[212:215], a[232:235], v[52:55], v[212:215]
    v_mfma_f32_16x16x32_bf16 v[216:219], a[236:239], v[40:43], v[216:219]
    v_mfma_f32_16x16x32_bf16 v[220:223], a[236:239], v[44:47], v[220:223]
    v_mfma_f32_16x16x32_bf16 v[224:227], a[236:239], v[48:51], v[224:227]
    v_mfma_f32_16x16x32_bf16 v[228:231], a[236:239], v[52:55], v[228:231]
    s_waitcnt lgkmcnt(0)
    v_mfma_f32_16x16x32_bf16 v[168:171], a[240:243], v[8:11], v[168:171]
    v_mfma_f32_16x16x32_bf16 v[172:175], a[240:243], v[12:15], v[172:175]
    v_mfma_f32_16x16x32_bf16 v[176:179], a[240:243], v[16:19], v[176:179]
    v_mfma_f32_16x16x32_bf16 v[180:183], a[240:243], v[20:23], v[180:183]
    v_mfma_f32_16x16x32_bf16 v[184:187], a[244:247], v[8:11], v[184:187]
    v_mfma_f32_16x16x32_bf16 v[188:191], a[244:247], v[12:15], v[188:191]
    v_mfma_f32_16x16x32_bf16 v[192:195], a[244:247], v[16:19], v[192:195]
    v_mfma_f32_16x16x32_bf16 v[196:199], a[244:247], v[20:23], v[196:199]
    v_mfma_f32_16x16x32_bf16 v[200:203], a[248:251], v[8:11], v[200:203]
    v_mfma_f32_16x16x32_bf16 v[204:207], a[248:251], v[12:15], v[204:207]
    v_mfma_f32_16x16x32_bf16 v[208:211], a[248:251], v[16:19], v[208:211]
    v_mfma_f32_16x16x32_bf16 v[212:215], a[248:251], v[20:23], v[212:215]
    v_mfma_f32_16x16x32_bf16 v[216:219], a[252:255], v[8:11], v[216:219]
    v_mfma_f32_16x16x32_bf16 v[220:223], a[252:255], v[12:15], v[220:223]
    v_mfma_f32_16x16x32_bf16 v[224:227], a[252:255], v[16:19], v[224:227]
    v_mfma_f32_16x16x32_bf16 v[228:231], a[252:255], v[20:23], v[228:231]
    s_waitcnt vmcnt(0)
    v_xor_b32 v2, 0x10000, v2
    v_xor_b32 v5, 0x10000, v5
    ds_write_b128 v2, v[104:107] offset:0
    ds_write_b128 v2, v[108:111] offset:4096
    ds_write_b128 v2, v[112:115] offset:8192
    ds_write_b128 v2, v[116:119] offset:12288
    ds_write_b128 v2, v[120:123] offset:16384
    ds_write_b128 v2, v[124:127] offset:20480
    ds_write_b128 v2, v[128:131] offset:24576
    ds_write_b128 v2, v[132:135] offset:28672
    ds_write_b128 v2, v[136:139] offset:32768
    ds_write_b128 v2, v[140:143] offset:36864
    ds_write_b128 v2, v[144:147] offset:40960
    ds_write_b128 v2, v[148:151] offset:45056
    ds_write_b128 v2, v[152:155] offset:49152
    ds_write_b128 v2, v[156:159] offset:53248
    ds_write_b128 v2, v[160:163] offset:57344
    ds_write_b128 v2, v[164:167] offset:61440
    s_waitcnt lgkmcnt(0)
    s_barrier
    s_cmp_le_u32 s40, 1
    s_cbranch_scc1 L_q1_nosig_qk
    s_cmp_lg_u32 s13, 0
    s_cbranch_scc1 L_q1_nosig2_qk
    v_mov_b32 v6, 0
    v_mov_b32 v7, 1
    s_mov_b64 exec, 1
    buffer_atomic_add v7, v6, s[4:7], s21 offen
    s_mov_b64 exec, -1
L_q1_nosig2_qk:
    s_add_u32 s21, s21, 64
L_q1_nosig_qk:
    s_cmp_ge_u32 s40, 30
    s_cbranch_scc1 L_q1_nold_qk
    buffer_load_dwordx4 v[104:107], v1, s[4:7], s19 offen
    s_add_u32 s19, s19, 4096
    buffer_load_dwordx4 v[108:111], v1, s[4:7], s19 offen
    s_add_u32 s19, s19, 4096
    buffer_load_dwordx4 v[112:115], v1, s[4:7], s19 offen
    s_add_u32 s19, s19, 4096
    buffer_load_dwordx4 v[116:119], v1, s[4:7], s19 offen
    s_add_u32 s19, s19, 4096
    buffer_load_dwordx4 v[120:123], v1, s[4:7], s19 offen
    s_add_u32 s19, s19, 4096
    buffer_load_dwordx4 v[124:127], v1, s[4:7], s19 offen
    s_add_u32 s19, s19, 4096
    buffer_load_dwordx4 v[128:131], v1, s[4:7], s19 offen
    s_add_u32 s19, s19, 4096
    buffer_load_dwordx4 v[132:135], v1, s[4:7], s19 offen
    s_add_u32 s19, s19, 4096
    buffer_load_dwordx4 v[136:139], v1, s[4:7], s19 offen
    s_add_u32 s19, s19, 4096
    buffer_load_dwordx4 v[140:143], v1, s[4:7], s19 offen
    s_add_u32 s19, s19, 4096
    buffer_load_dwordx4 v[144:147], v1, s[4:7], s19 offen
    s_add_u32 s19, s19, 4096
    buffer_load_dwordx4 v[148:151], v1, s[4:7], s19 offen
    s_add_u32 s19, s19, 4096
    buffer_load_dwordx4 v[152:155], v1, s[4:7], s19 offen
    s_add_u32 s19, s19, 4096
    buffer_load_dwordx4 v[156:159], v1, s[4:7], s19 offen
    s_add_u32 s19, s19, 4096
    buffer_load_dwordx4 v[160:163], v1, s[4:7], s19 offen
    s_add_u32 s19, s19, 4096
    buffer_load_dwordx4 v[164:167], v1, s[4:7], s19 offen
    s_add_u32 s19, s19, 4096
L_q1_nold_qk:
    s_mov_b32 s22, s20
    v_cvt_pk_bf16_f32 v56, v168, v169
    v_cvt_pk_bf16_f32 v57, v170, v171
    v_cvt_pk_bf16_f32 v58, v184, v185
    v_cvt_pk_bf16_f32 v59, v186, v187
    buffer_store_dwordx4 v[56:59], v4, s[4:7], s22 offen offset:0 sc1
    v_cvt_pk_bf16_f32 v60, v200, v201
    v_cvt_pk_bf16_f32 v61, v202, v203
    v_cvt_pk_bf16_f32 v62, v216, v217
    v_cvt_pk_bf16_f32 v63, v218, v219
    buffer_store_dwordx4 v[60:63], v4, s[4:7], s22 offen offset:1024 sc1
    s_add_u32 s22, s22, 131072
    v_cvt_pk_bf16_f32 v64, v172, v173
    v_cvt_pk_bf16_f32 v65, v174, v175
    v_cvt_pk_bf16_f32 v66, v188, v189
    v_cvt_pk_bf16_f32 v67, v190, v191
    buffer_store_dwordx4 v[64:67], v4, s[4:7], s22 offen offset:0 sc1
    v_cvt_pk_bf16_f32 v68, v204, v205
    v_cvt_pk_bf16_f32 v69, v206, v207
    v_cvt_pk_bf16_f32 v70, v220, v221
    v_cvt_pk_bf16_f32 v71, v222, v223
    buffer_store_dwordx4 v[68:71], v4, s[4:7], s22 offen offset:1024 sc1
    s_add_u32 s22, s22, 131072
    v_cvt_pk_bf16_f32 v72, v176, v177
    v_cvt_pk_bf16_f32 v73, v178, v179
    v_cvt_pk_bf16_f32 v74, v192, v193
    v_cvt_pk_bf16_f32 v75, v194, v195
    buffer_store_dwordx4 v[72:75], v4, s[4:7], s22 offen offset:0 sc1
    v_cvt_pk_bf16_f32 v76, v208, v209
    v_cvt_pk_bf16_f32 v77, v210, v211
    v_cvt_pk_bf16_f32 v78, v224, v225
    v_cvt_pk_bf16_f32 v79, v226, v227
    buffer_store_dwordx4 v[76:79], v4, s[4:7], s22 offen offset:1024 sc1
    s_add_u32 s22, s22, 131072
    v_cvt_pk_bf16_f32 v80, v180, v181
    v_cvt_pk_bf16_f32 v81, v182, v183
    v_cvt_pk_bf16_f32 v82, v196, v197
    v_cvt_pk_bf16_f32 v83, v198, v199
    buffer_store_dwordx4 v[80:83], v4, s[4:7], s22 offen offset:0 sc1
    v_cvt_pk_bf16_f32 v84, v212, v213
    v_cvt_pk_bf16_f32 v85, v214, v215
    v_cvt_pk_bf16_f32 v86, v228, v229
    v_cvt_pk_bf16_f32 v87, v230, v231
    buffer_store_dwordx4 v[84:87], v4, s[4:7], s22 offen offset:1024 sc1
    s_cmp_lg_u32 s40, 0
    s_cbranch_scc1 L_q1_noearly_qk
    s_waitcnt vmcnt(0)
    s_barrier
    s_cmp_lg_u32 s13, 0
    s_cbranch_scc1 L_q1_early2_qk
    v_mov_b32 v6, 0
    v_mov_b32 v7, 1
    s_mov_b64 exec, 1
    buffer_atomic_add v7, v6, s[4:7], s21 offen
    s_mov_b64 exec, -1
L_q1_early2_qk:
    s_add_u32 s21, s21, 64
L_q1_noearly_qk:
    s_add_u32 s20, s20, 524288
    s_add_u32 s40, s40, 1
    s_cmp_lt_u32 s40, 32
    s_cbranch_scc1 L_q1_loop_qk
    s_branch L_q1_fin
L_q1_loop_v:
    ds_read_b128 v[8:11], v5 offset:0
    ds_read_b128 v[12:15], v5 offset:1024
    ds_read_b128 v[16:19], v5 offset:2048
    ds_read_b128 v[20:23], v5 offset:3072
    ds_read_b128 v[24:27], v5 offset:4096
    ds_read_b128 v[28:31], v5 offset:5120
    ds_read_b128 v[32:35], v5 offset:6144
    ds_read_b128 v[36:39], v5 offset:7168
    ds_read_b128 v[40:43], v5 offset:8192
    ds_read_b128 v[44:47], v5 offset:9216
    ds_read_b128 v[48:51], v5 offset:10240
    ds_read_b128 v[52:55], v5 offset:11264
    s_waitcnt lgkmcnt(8)
    v_mfma_f32_16x16x32_bf16 v[168:171], v[8:11], a[0:3], 0
    v_mfma_f32_16x16x32_bf16 v[172:175], v[12:15], a[0:3], 0
    v_mfma_f32_16x16x32_bf16 v[176:179], v[16:19], a[0:3], 0
    v_mfma_f32_16x16x32_bf16 v[180:183], v[20:23], a[0:3], 0
    v_mfma_f32_16x16x32_bf16 v[184:187], v[8:11], a[4:7], 0
    v_mfma_f32_16x16x32_bf16 v[188:191], v[12:15], a[4:7], 0
    v_mfma_f32_16x16x32_bf16 v[192:195], v[16:19], a[4:7], 0
    v_mfma_f32_16x16x32_bf16 v[196:199], v[20:23], a[4:7], 0
    v_mfma_f32_16x16x32_bf16 v[200:203], v[8:11], a[8:11], 0
    v_mfma_f32_16x16x32_bf16 v[204:207], v[12:15], a[8:11], 0
    v_mfma_f32_16x16x32_bf16 v[208:211], v[16:19], a[8:11], 0
    v_mfma_f32_16x16x32_bf16 v[212:215], v[20:23], a[8:11], 0
    v_mfma_f32_16x16x32_bf16 v[216:219], v[8:11], a[12:15], 0
    v_mfma_f32_16x16x32_bf16 v[220:223], v[12:15], a[12:15], 0
    v_mfma_f32_16x16x32_bf16 v[224:227], v[16:19], a[12:15], 0
    v_mfma_f32_16x16x32_bf16 v[228:231], v[20:23], a[12:15], 0
    ds_read_b128 v[8:11], v5 offset:12288
    ds_read_b128 v[12:15], v5 offset:13312
    ds_read_b128 v[16:19], v5 offset:14336
    ds_read_b128 v[20:23], v5 offset:15360
    s_waitcnt lgkmcnt(8)
    v_mfma_f32_16x16x32_bf16 v[168:171], v[24:27], a[16:19], v[168:171]
    v_mfma_f32_16x16x32_bf16 v[172:175], v[28:31], a[16:19], v[172:175]
    v_mfma_f32_16x16x32_bf16 v[176:179], v[32:35], a[16:19], v[176:179]
    v_mfma_f32_16x16x32_bf16 v[180:183], v[36:39], a[16:19], v[180:183]
    v_mfma_f32_16x16x32_bf16 v[184:187], v[24:27], a[20:23], v[184:187]
    v_mfma_f32_16x16x32_bf16 v[188:191], v[28:31], a[20:23], v[188:191]
    v_mfma_f32_16x16x32_bf16 v[192:195], v[32:35], a[20:23], v[192:195]
    v_mfma_f32_16x16x32_bf16 v[196:199], v[36:39], a[20:23], v[196:199]
    v_mfma_f32_16x16x32_bf16 v[200:203], v[24:27], a[24:27], v[200:203]
    v_mfma_f32_16x16x32_bf16 v[204:207], v[28:31], a[24:27], v[204:207]
    v_mfma_f32_16x16x32_bf16 v[208:211], v[32:35], a[24:27], v[208:211]
    v_mfma_f32_16x16x32_bf16 v[212:215], v[36:39], a[24:27], v[212:215]
    v_mfma_f32_16x16x32_bf16 v[216:219], v[24:27], a[28:31], v[216:219]
    v_mfma_f32_16x16x32_bf16 v[220:223], v[28:31], a[28:31], v[220:223]
    v_mfma_f32_16x16x32_bf16 v[224:227], v[32:35], a[28:31], v[224:227]
    v_mfma_f32_16x16x32_bf16 v[228:231], v[36:39], a[28:31], v[228:231]
    ds_read_b128 v[24:27], v5 offset:16384
    ds_read_b128 v[28:31], v5 offset:17408
    ds_read_b128 v[32:35], v5 offset:18432
    ds_read_b128 v[36:39], v5 offset:19456
    s_waitcnt lgkmcnt(8)
    v_mfma_f32_16x16x32_bf16 v[168:171], v[40:43], a[32:35], v[168:171]
    v_mfma_f32_16x16x32_bf16 v[172:175], v[44:47], a[32:35], v[172:175]
    v_mfma_f32_16x16x32_bf16 v[176:179], v[48:51], a[32:35], v[176:179]
    v_mfma_f32_16x16x32_bf16 v[180:183], v[52:55], a[32:35], v[180:183]
    v_mfma_f32_16x16x32_bf16 v[184:187], v[40:43], a[36:39], v[184:187]
    v_mfma_f32_16x16x32_bf16 v[188:191], v[44:47], a[36:39], v[188:191]
    v_mfma_f32_16x16x32_bf16 v[192:195], v[48:51], a[36:39], v[192:195]
    v_mfma_f32_16x16x32_bf16 v[196:199], v[52:55], a[36:39], v[196:199]
    v_mfma_f32_16x16x32_bf16 v[200:203], v[40:43], a[40:43], v[200:203]
    v_mfma_f32_16x16x32_bf16 v[204:207], v[44:47], a[40:43], v[204:207]
    v_mfma_f32_16x16x32_bf16 v[208:211], v[48:51], a[40:43], v[208:211]
    v_mfma_f32_16x16x32_bf16 v[212:215], v[52:55], a[40:43], v[212:215]
    v_mfma_f32_16x16x32_bf16 v[216:219], v[40:43], a[44:47], v[216:219]
    v_mfma_f32_16x16x32_bf16 v[220:223], v[44:47], a[44:47], v[220:223]
    v_mfma_f32_16x16x32_bf16 v[224:227], v[48:51], a[44:47], v[224:227]
    v_mfma_f32_16x16x32_bf16 v[228:231], v[52:55], a[44:47], v[228:231]
    ds_read_b128 v[40:43], v5 offset:20480
    ds_read_b128 v[44:47], v5 offset:21504
    ds_read_b128 v[48:51], v5 offset:22528
    ds_read_b128 v[52:55], v5 offset:23552
    s_waitcnt lgkmcnt(8)
    v_mfma_f32_16x16x32_bf16 v[168:171], v[8:11], a[48:51], v[168:171]
    v_mfma_f32_16x16x32_bf16 v[172:175], v[12:15], a[48:51], v[172:175]
    v_mfma_f32_16x16x32_bf16 v[176:179], v[16:19], a[48:51], v[176:179]
    v_mfma_f32_16x16x32_bf16 v[180:183], v[20:23], a[48:51], v[180:183]
    v_mfma_f32_16x16x32_bf16 v[184:187], v[8:11], a[52:55], v[184:187]
    v_mfma_f32_16x16x32_bf16 v[188:191], v[12:15], a[52:55], v[188:191]
    v_mfma_f32_16x16x32_bf16 v[192:195], v[16:19], a[52:55], v[192:195]
    v_mfma_f32_16x16x32_bf16 v[196:199], v[20:23], a[52:55], v[196:199]
    v_mfma_f32_16x16x32_bf16 v[200:203], v[8:11], a[56:59], v[200:203]
    v_mfma_f32_16x16x32_bf16 v[204:207], v[12:15], a[56:59], v[204:207]
    v_mfma_f32_16x16x32_bf16 v[208:211], v[16:19], a[56:59], v[208:211]
    v_mfma_f32_16x16x32_bf16 v[212:215], v[20:23], a[56:59], v[212:215]
    v_mfma_f32_16x16x32_bf16 v[216:219], v[8:11], a[60:63], v[216:219]
    v_mfma_f32_16x16x32_bf16 v[220:223], v[12:15], a[60:63], v[220:223]
    v_mfma_f32_16x16x32_bf16 v[224:227], v[16:19], a[60:63], v[224:227]
    v_mfma_f32_16x16x32_bf16 v[228:231], v[20:23], a[60:63], v[228:231]
    ds_read_b128 v[8:11], v5 offset:24576
    ds_read_b128 v[12:15], v5 offset:25600
    ds_read_b128 v[16:19], v5 offset:26624
    ds_read_b128 v[20:23], v5 offset:27648
    s_waitcnt lgkmcnt(8)
    v_mfma_f32_16x16x32_bf16 v[168:171], v[24:27], a[64:67], v[168:171]
    v_mfma_f32_16x16x32_bf16 v[172:175], v[28:31], a[64:67], v[172:175]
    v_mfma_f32_16x16x32_bf16 v[176:179], v[32:35], a[64:67], v[176:179]
    v_mfma_f32_16x16x32_bf16 v[180:183], v[36:39], a[64:67], v[180:183]
    v_mfma_f32_16x16x32_bf16 v[184:187], v[24:27], a[68:71], v[184:187]
    v_mfma_f32_16x16x32_bf16 v[188:191], v[28:31], a[68:71], v[188:191]
    v_mfma_f32_16x16x32_bf16 v[192:195], v[32:35], a[68:71], v[192:195]
    v_mfma_f32_16x16x32_bf16 v[196:199], v[36:39], a[68:71], v[196:199]
    v_mfma_f32_16x16x32_bf16 v[200:203], v[24:27], a[72:75], v[200:203]
    v_mfma_f32_16x16x32_bf16 v[204:207], v[28:31], a[72:75], v[204:207]
    v_mfma_f32_16x16x32_bf16 v[208:211], v[32:35], a[72:75], v[208:211]
    v_mfma_f32_16x16x32_bf16 v[212:215], v[36:39], a[72:75], v[212:215]
    v_mfma_f32_16x16x32_bf16 v[216:219], v[24:27], a[76:79], v[216:219]
    v_mfma_f32_16x16x32_bf16 v[220:223], v[28:31], a[76:79], v[220:223]
    v_mfma_f32_16x16x32_bf16 v[224:227], v[32:35], a[76:79], v[224:227]
    v_mfma_f32_16x16x32_bf16 v[228:231], v[36:39], a[76:79], v[228:231]
    ds_read_b128 v[24:27], v5 offset:28672
    ds_read_b128 v[28:31], v5 offset:29696
    ds_read_b128 v[32:35], v5 offset:30720
    ds_read_b128 v[36:39], v5 offset:31744
    s_waitcnt lgkmcnt(8)
    v_mfma_f32_16x16x32_bf16 v[168:171], v[40:43], a[80:83], v[168:171]
    v_mfma_f32_16x16x32_bf16 v[172:175], v[44:47], a[80:83], v[172:175]
    v_mfma_f32_16x16x32_bf16 v[176:179], v[48:51], a[80:83], v[176:179]
    v_mfma_f32_16x16x32_bf16 v[180:183], v[52:55], a[80:83], v[180:183]
    v_mfma_f32_16x16x32_bf16 v[184:187], v[40:43], a[84:87], v[184:187]
    v_mfma_f32_16x16x32_bf16 v[188:191], v[44:47], a[84:87], v[188:191]
    v_mfma_f32_16x16x32_bf16 v[192:195], v[48:51], a[84:87], v[192:195]
    v_mfma_f32_16x16x32_bf16 v[196:199], v[52:55], a[84:87], v[196:199]
    v_mfma_f32_16x16x32_bf16 v[200:203], v[40:43], a[88:91], v[200:203]
    v_mfma_f32_16x16x32_bf16 v[204:207], v[44:47], a[88:91], v[204:207]
    v_mfma_f32_16x16x32_bf16 v[208:211], v[48:51], a[88:91], v[208:211]
    v_mfma_f32_16x16x32_bf16 v[212:215], v[52:55], a[88:91], v[212:215]
    v_mfma_f32_16x16x32_bf16 v[216:219], v[40:43], a[92:95], v[216:219]
    v_mfma_f32_16x16x32_bf16 v[220:223], v[44:47], a[92:95], v[220:223]
    v_mfma_f32_16x16x32_bf16 v[224:227], v[48:51], a[92:95], v[224:227]
    v_mfma_f32_16x16x32_bf16 v[228:231], v[52:55], a[92:95], v[228:231]
    ds_read_b128 v[40:43], v5 offset:32768
    ds_read_b128 v[44:47], v5 offset:33792
    ds_read_b128 v[48:51], v5 offset:34816
    ds_read_b128 v[52:55], v5 offset:35840
    s_waitcnt lgkmcnt(8)
    v_mfma_f32_16x16x32_bf16 v[168:171], v[8:11], a[96:99], v[168:171]
    v_mfma_f32_16x16x32_bf16 v[172:175], v[12:15], a[96:99], v[172:175]
    v_mfma_f32_16x16x32_bf16 v[176:179], v[16:19], a[96:99], v[176:179]
    v_mfma_f32_16x16x32_bf16 v[180:183], v[20:23], a[96:99], v[180:183]
    v_mfma_f32_16x16x32_bf16 v[184:187], v[8:11], a[100:103], v[184:187]
    v_mfma_f32_16x16x32_bf16 v[188:191], v[12:15], a[100:103], v[188:191]
    v_mfma_f32_16x16x32_bf16 v[192:195], v[16:19], a[100:103], v[192:195]
    v_mfma_f32_16x16x32_bf16 v[196:199], v[20:23], a[100:103], v[196:199]
    v_mfma_f32_16x16x32_bf16 v[200:203], v[8:11], a[104:107], v[200:203]
    v_mfma_f32_16x16x32_bf16 v[204:207], v[12:15], a[104:107], v[204:207]
    v_mfma_f32_16x16x32_bf16 v[208:211], v[16:19], a[104:107], v[208:211]
    v_mfma_f32_16x16x32_bf16 v[212:215], v[20:23], a[104:107], v[212:215]
    v_mfma_f32_16x16x32_bf16 v[216:219], v[8:11], a[108:111], v[216:219]
    v_mfma_f32_16x16x32_bf16 v[220:223], v[12:15], a[108:111], v[220:223]
    v_mfma_f32_16x16x32_bf16 v[224:227], v[16:19], a[108:111], v[224:227]
    v_mfma_f32_16x16x32_bf16 v[228:231], v[20:23], a[108:111], v[228:231]
    ds_read_b128 v[8:11], v5 offset:36864
    ds_read_b128 v[12:15], v5 offset:37888
    ds_read_b128 v[16:19], v5 offset:38912
    ds_read_b128 v[20:23], v5 offset:39936
    s_waitcnt lgkmcnt(8)
    v_mfma_f32_16x16x32_bf16 v[168:171], v[24:27], a[112:115], v[168:171]
    v_mfma_f32_16x16x32_bf16 v[172:175], v[28:31], a[112:115], v[172:175]
    v_mfma_f32_16x16x32_bf16 v[176:179], v[32:35], a[112:115], v[176:179]
    v_mfma_f32_16x16x32_bf16 v[180:183], v[36:39], a[112:115], v[180:183]
    v_mfma_f32_16x16x32_bf16 v[184:187], v[24:27], a[116:119], v[184:187]
    v_mfma_f32_16x16x32_bf16 v[188:191], v[28:31], a[116:119], v[188:191]
    v_mfma_f32_16x16x32_bf16 v[192:195], v[32:35], a[116:119], v[192:195]
    v_mfma_f32_16x16x32_bf16 v[196:199], v[36:39], a[116:119], v[196:199]
    v_mfma_f32_16x16x32_bf16 v[200:203], v[24:27], a[120:123], v[200:203]
    v_mfma_f32_16x16x32_bf16 v[204:207], v[28:31], a[120:123], v[204:207]
    v_mfma_f32_16x16x32_bf16 v[208:211], v[32:35], a[120:123], v[208:211]
    v_mfma_f32_16x16x32_bf16 v[212:215], v[36:39], a[120:123], v[212:215]
    v_mfma_f32_16x16x32_bf16 v[216:219], v[24:27], a[124:127], v[216:219]
    v_mfma_f32_16x16x32_bf16 v[220:223], v[28:31], a[124:127], v[220:223]
    v_mfma_f32_16x16x32_bf16 v[224:227], v[32:35], a[124:127], v[224:227]
    v_mfma_f32_16x16x32_bf16 v[228:231], v[36:39], a[124:127], v[228:231]
    ds_read_b128 v[24:27], v5 offset:40960
    ds_read_b128 v[28:31], v5 offset:41984
    ds_read_b128 v[32:35], v5 offset:43008
    ds_read_b128 v[36:39], v5 offset:44032
    s_waitcnt lgkmcnt(8)
    v_mfma_f32_16x16x32_bf16 v[168:171], v[40:43], a[128:131], v[168:171]
    v_mfma_f32_16x16x32_bf16 v[172:175], v[44:47], a[128:131], v[172:175]
    v_mfma_f32_16x16x32_bf16 v[176:179], v[48:51], a[128:131], v[176:179]
    v_mfma_f32_16x16x32_bf16 v[180:183], v[52:55], a[128:131], v[180:183]
    v_mfma_f32_16x16x32_bf16 v[184:187], v[40:43], a[132:135], v[184:187]
    v_mfma_f32_16x16x32_bf16 v[188:191], v[44:47], a[132:135], v[188:191]
    v_mfma_f32_16x16x32_bf16 v[192:195], v[48:51], a[132:135], v[192:195]
    v_mfma_f32_16x16x32_bf16 v[196:199], v[52:55], a[132:135], v[196:199]
    v_mfma_f32_16x16x32_bf16 v[200:203], v[40:43], a[136:139], v[200:203]
    v_mfma_f32_16x16x32_bf16 v[204:207], v[44:47], a[136:139], v[204:207]
    v_mfma_f32_16x16x32_bf16 v[208:211], v[48:51], a[136:139], v[208:211]
    v_mfma_f32_16x16x32_bf16 v[212:215], v[52:55], a[136:139], v[212:215]
    v_mfma_f32_16x16x32_bf16 v[216:219], v[40:43], a[140:143], v[216:219]
    v_mfma_f32_16x16x32_bf16 v[220:223], v[44:47], a[140:143], v[220:223]
    v_mfma_f32_16x16x32_bf16 v[224:227], v[48:51], a[140:143], v[224:227]
    v_mfma_f32_16x16x32_bf16 v[228:231], v[52:55], a[140:143], v[228:231]
    ds_read_b128 v[40:43], v5 offset:45056
    ds_read_b128 v[44:47], v5 offset:46080
    ds_read_b128 v[48:51], v5 offset:47104
    ds_read_b128 v[52:55], v5 offset:48128
    s_waitcnt lgkmcnt(8)
    v_mfma_f32_16x16x32_bf16 v[168:171], v[8:11], a[144:147], v[168:171]
    v_mfma_f32_16x16x32_bf16 v[172:175], v[12:15], a[144:147], v[172:175]
    v_mfma_f32_16x16x32_bf16 v[176:179], v[16:19], a[144:147], v[176:179]
    v_mfma_f32_16x16x32_bf16 v[180:183], v[20:23], a[144:147], v[180:183]
    v_mfma_f32_16x16x32_bf16 v[184:187], v[8:11], a[148:151], v[184:187]
    v_mfma_f32_16x16x32_bf16 v[188:191], v[12:15], a[148:151], v[188:191]
    v_mfma_f32_16x16x32_bf16 v[192:195], v[16:19], a[148:151], v[192:195]
    v_mfma_f32_16x16x32_bf16 v[196:199], v[20:23], a[148:151], v[196:199]
    v_mfma_f32_16x16x32_bf16 v[200:203], v[8:11], a[152:155], v[200:203]
    v_mfma_f32_16x16x32_bf16 v[204:207], v[12:15], a[152:155], v[204:207]
    v_mfma_f32_16x16x32_bf16 v[208:211], v[16:19], a[152:155], v[208:211]
    v_mfma_f32_16x16x32_bf16 v[212:215], v[20:23], a[152:155], v[212:215]
    v_mfma_f32_16x16x32_bf16 v[216:219], v[8:11], a[156:159], v[216:219]
    v_mfma_f32_16x16x32_bf16 v[220:223], v[12:15], a[156:159], v[220:223]
    v_mfma_f32_16x16x32_bf16 v[224:227], v[16:19], a[156:159], v[224:227]
    v_mfma_f32_16x16x32_bf16 v[228:231], v[20:23], a[156:159], v[228:231]
    ds_read_b128 v[8:11], v5 offset:49152
    ds_read_b128 v[12:15], v5 offset:50176
    ds_read_b128 v[16:19], v5 offset:51200
    ds_read_b128 v[20:23], v5 offset:52224
    s_waitcnt lgkmcnt(8)
    v_mfma_f32_16x16x32_bf16 v[168:171], v[24:27], a[160:163], v[168:171]
    v_mfma_f32_16x16x32_bf16 v[172:175], v[28:31], a[160:163], v[172:175]
    v_mfma_f32_16x16x32_bf16 v[176:179], v[32:35], a[160:163], v[176:179]
    v_mfma_f32_16x16x32_bf16 v[180:183], v[36:39], a[160:163], v[180:183]
    v_mfma_f32_16x16x32_bf16 v[184:187], v[24:27], a[164:167], v[184:187]
    v_mfma_f32_16x16x32_bf16 v[188:191], v[28:31], a[164:167], v[188:191]
    v_mfma_f32_16x16x32_bf16 v[192:195], v[32:35], a[164:167], v[192:195]
    v_mfma_f32_16x16x32_bf16 v[196:199], v[36:39], a[164:167], v[196:199]
    v_mfma_f32_16x16x32_bf16 v[200:203], v[24:27], a[168:171], v[200:203]
    v_mfma_f32_16x16x32_bf16 v[204:207], v[28:31], a[168:171], v[204:207]
    v_mfma_f32_16x16x32_bf16 v[208:211], v[32:35], a[168:171], v[208:211]
    v_mfma_f32_16x16x32_bf16 v[212:215], v[36:39], a[168:171], v[212:215]
    v_mfma_f32_16x16x32_bf16 v[216:219], v[24:27], a[172:175], v[216:219]
    v_mfma_f32_16x16x32_bf16 v[220:223], v[28:31], a[172:175], v[220:223]
    v_mfma_f32_16x16x32_bf16 v[224:227], v[32:35], a[172:175], v[224:227]
    v_mfma_f32_16x16x32_bf16 v[228:231], v[36:39], a[172:175], v[228:231]
    ds_read_b128 v[24:27], v5 offset:53248
    ds_read_b128 v[28:31], v5 offset:54272
    ds_read_b128 v[32:35], v5 offset:55296
    ds_read_b128 v[36:39], v5 offset:56320
    s_waitcnt lgkmcnt(8)
    v_mfma_f32_16x16x32_bf16 v[168:171], v[40:43], a[176:179], v[168:171]
    v_mfma_f32_16x16x32_bf16 v[172:175], v[44:47], a[176:179], v[172:175]
    v_mfma_f32_16x16x32_bf16 v[176:179], v[48:51], a[176:179], v[176:179]
    v_mfma_f32_16x16x32_bf16 v[180:183], v[52:55], a[176:179], v[180:183]
    v_mfma_f32_16x16x32_bf16 v[184:187], v[40:43], a[180:183], v[184:187]
    v_mfma_f32_16x16x32_bf16 v[188:191], v[44:47], a[180:183], v[188:191]
    v_mfma_f32_16x16x32_bf16 v[192:195], v[48:51], a[180:183], v[192:195]
    v_mfma_f32_16x16x32_bf16 v[196:199], v[52:55], a[180:183], v[196:199]
    v_mfma_f32_16x16x32_bf16 v[200:203], v[40:43], a[184:187], v[200:203]
    v_mfma_f32_16x16x32_bf16 v[204:207], v[44:47], a[184:187], v[204:207]
    v_mfma_f32_16x16x32_bf16 v[208:211], v[48:51], a[184:187], v[208:211]
    v_mfma_f32_16x16x32_bf16 v[212:215], v[52:55], a[184:187], v[212:215]
    v_mfma_f32_16x16x32_bf16 v[216:219], v[40:43], a[188:191], v[216:219]
    v_mfma_f32_16x16x32_bf16 v[220:223], v[44:47], a[188:191], v[220:223]
    v_mfma_f32_16x16x32_bf16 v[224:227], v[48:51], a[188:191], v[224:227]
    v_mfma_f32_16x16x32_bf16 v[228:231], v[52:55], a[188:191], v[228:231]
    ds_read_b128 v[40:43], v5 offset:57344
    ds_read_b128 v[44:47], v5 offset:58368
    ds_read_b128 v[48:51], v5 offset:59392
    ds_read_b128 v[52:55], v5 offset:60416
    s_waitcnt lgkmcnt(8)
    v_mfma_f32_16x16x32_bf16 v[168:171], v[8:11], a[192:195], v[168:171]
    v_mfma_f32_16x16x32_bf16 v[172:175], v[12:15], a[192:195], v[172:175]
    v_mfma_f32_16x16x32_bf16 v[176:179], v[16:19], a[192:195], v[176:179]
    v_mfma_f32_16x16x32_bf16 v[180:183], v[20:23], a[192:195], v[180:183]
    v_mfma_f32_16x16x32_bf16 v[184:187], v[8:11], a[196:199], v[184:187]
    v_mfma_f32_16x16x32_bf16 v[188:191], v[12:15], a[196:199], v[188:191]
    v_mfma_f32_16x16x32_bf16 v[192:195], v[16:19], a[196:199], v[192:195]
    v_mfma_f32_16x16x32_bf16 v[196:199], v[20:23], a[196:199], v[196:199]
    v_mfma_f32_16x16x32_bf16 v[200:203], v[8:11], a[200:203], v[200:203]
    v_mfma_f32_16x16x32_bf16 v[204:207], v[12:15], a[200:203], v[204:207]
    v_mfma_f32_16x16x32_bf16 v[208:211], v[16:19], a[200:203], v[208:211]
    v_mfma_f32_16x16x32_bf16 v[212:215], v[20:23], a[200:203], v[212:215]
    v_mfma_f32_16x16x32_bf16 v[216:219], v[8:11], a[204:207], v[216:219]
    v_mfma_f32_16x16x32_bf16 v[220:223], v[12:15], a[204:207], v[220:223]
    v_mfma_f32_16x16x32_bf16 v[224:227], v[16:19], a[204:207], v[224:227]
    v_mfma_f32_16x16x32_bf16 v[228:231], v[20:23], a[204:207], v[228:231]
    ds_read_b128 v[8:11], v5 offset:61440
    ds_read_b128 v[12:15], v5 offset:62464
    ds_read_b128 v[16:19], v5 offset:63488
    ds_read_b128 v[20:23], v5 offset:64512
    s_waitcnt lgkmcnt(8)
    v_mfma_f32_16x16x32_bf16 v[168:171], v[24:27], a[208:211], v[168:171]
    v_mfma_f32_16x16x32_bf16 v[172:175], v[28:31], a[208:211], v[172:175]
    v_mfma_f32_16x16x32_bf16 v[176:179], v[32:35], a[208:211], v[176:179]
    v_mfma_f32_16x16x32_bf16 v[180:183], v[36:39], a[208:211], v[180:183]
    v_mfma_f32_16x16x32_bf16 v[184:187], v[24:27], a[212:215], v[184:187]
    v_mfma_f32_16x16x32_bf16 v[188:191], v[28:31], a[212:215], v[188:191]
    v_mfma_f32_16x16x32_bf16 v[192:195], v[32:35], a[212:215], v[192:195]
    v_mfma_f32_16x16x32_bf16 v[196:199], v[36:39], a[212:215], v[196:199]
    v_mfma_f32_16x16x32_bf16 v[200:203], v[24:27], a[216:219], v[200:203]
    v_mfma_f32_16x16x32_bf16 v[204:207], v[28:31], a[216:219], v[204:207]
    v_mfma_f32_16x16x32_bf16 v[208:211], v[32:35], a[216:219], v[208:211]
    v_mfma_f32_16x16x32_bf16 v[212:215], v[36:39], a[216:219], v[212:215]
    v_mfma_f32_16x16x32_bf16 v[216:219], v[24:27], a[220:223], v[216:219]
    v_mfma_f32_16x16x32_bf16 v[220:223], v[28:31], a[220:223], v[220:223]
    v_mfma_f32_16x16x32_bf16 v[224:227], v[32:35], a[220:223], v[224:227]
    v_mfma_f32_16x16x32_bf16 v[228:231], v[36:39], a[220:223], v[228:231]
    s_waitcnt lgkmcnt(4)
    v_mfma_f32_16x16x32_bf16 v[168:171], v[40:43], a[224:227], v[168:171]
    v_mfma_f32_16x16x32_bf16 v[172:175], v[44:47], a[224:227], v[172:175]
    v_mfma_f32_16x16x32_bf16 v[176:179], v[48:51], a[224:227], v[176:179]
    v_mfma_f32_16x16x32_bf16 v[180:183], v[52:55], a[224:227], v[180:183]
    v_mfma_f32_16x16x32_bf16 v[184:187], v[40:43], a[228:231], v[184:187]
    v_mfma_f32_16x16x32_bf16 v[188:191], v[44:47], a[228:231], v[188:191]
    v_mfma_f32_16x16x32_bf16 v[192:195], v[48:51], a[228:231], v[192:195]
    v_mfma_f32_16x16x32_bf16 v[196:199], v[52:55], a[228:231], v[196:199]
    v_mfma_f32_16x16x32_bf16 v[200:203], v[40:43], a[232:235], v[200:203]
    v_mfma_f32_16x16x32_bf16 v[204:207], v[44:47], a[232:235], v[204:207]
    v_mfma_f32_16x16x32_bf16 v[208:211], v[48:51], a[232:235], v[208:211]
    v_mfma_f32_16x16x32_bf16 v[212:215], v[52:55], a[232:235], v[212:215]
    v_mfma_f32_16x16x32_bf16 v[216:219], v[40:43], a[236:239], v[216:219]
    v_mfma_f32_16x16x32_bf16 v[220:223], v[44:47], a[236:239], v[220:223]
    v_mfma_f32_16x16x32_bf16 v[224:227], v[48:51], a[236:239], v[224:227]
    v_mfma_f32_16x16x32_bf16 v[228:231], v[52:55], a[236:239], v[228:231]
    s_waitcnt lgkmcnt(0)
    v_mfma_f32_16x16x32_bf16 v[168:171], v[8:11], a[240:243], v[168:171]
    v_mfma_f32_16x16x32_bf16 v[172:175], v[12:15], a[240:243], v[172:175]
    v_mfma_f32_16x16x32_bf16 v[176:179], v[16:19], a[240:243], v[176:179]
    v_mfma_f32_16x16x32_bf16 v[180:183], v[20:23], a[240:243], v[180:183]
    v_mfma_f32_16x16x32_bf16 v[184:187], v[8:11], a[244:247], v[184:187]
    v_mfma_f32_16x16x32_bf16 v[188:191], v[12:15], a[244:247], v[188:191]
    v_mfma_f32_16x16x32_bf16 v[192:195], v[16:19], a[244:247], v[192:195]
    v_mfma_f32_16x16x32_bf16 v[196:199], v[20:23], a[244:247], v[196:199]
    v_mfma_f32_16x16x32_bf16 v[200:203], v[8:11], a[248:251], v[200:203]
    v_mfma_f32_16x16x32_bf16 v[204:207], v[12:15], a[248:251], v[204:207]
    v_mfma_f32_16x16x32_bf16 v[208:211], v[16:19], a[248:251], v[208:211]
    v_mfma_f32_16x16x32_bf16 v[212:215], v[20:23], a[248:251], v[212:215]
    v_mfma_f32_16x16x32_bf16 v[216:219], v[8:11], a[252:255], v[216:219]
    v_mfma_f32_16x16x32_bf16 v[220:223], v[12:15], a[252:255], v[220:223]
    v_mfma_f32_16x16x32_bf16 v[224:227], v[16:19], a[252:255], v[224:227]
    v_mfma_f32_16x16x32_bf16 v[228:231], v[20:23], a[252:255], v[228:231]
    s_waitcnt vmcnt(0)
    v_xor_b32 v2, 0x10000, v2
    v_xor_b32 v5, 0x10000, v5
    ds_write_b128 v2, v[104:107] offset:0
    ds_write_b128 v2, v[108:111] offset:4096
    ds_write_b128 v2, v[112:115] offset:8192
    ds_write_b128 v2, v[116:119] offset:12288
    ds_write_b128 v2, v[120:123] offset:16384
    ds_write_b128 v2, v[124:127] offset:20480
    ds_write_b128 v2, v[128:131] offset:24576
    ds_write_b128 v2, v[132:135] offset:28672
    ds_write_b128 v2, v[136:139] offset:32768
    ds_write_b128 v2, v[140:143] offset:36864
    ds_write_b128 v2, v[144:147] offset:40960
    ds_write_b128 v2, v[148:151] offset:45056
    ds_write_b128 v2, v[152:155] offset:49152
    ds_write_b128 v2, v[156:159] offset:53248
    ds_write_b128 v2, v[160:163] offset:57344
    ds_write_b128 v2, v[164:167] offset:61440
    s_waitcnt lgkmcnt(0)
    s_barrier
    s_cmp_le_u32 s40, 1
    s_cbranch_scc1 L_q1_nosig_v
    s_cmp_lg_u32 s13, 0
    s_cbranch_scc1 L_q1_nosig2_v
    v_mov_b32 v6, 0
    v_mov_b32 v7, 1
    s_mov_b64 exec, 1
    buffer_atomic_add v7, v6, s[4:7], s21 offen
    s_mov_b64 exec, -1
L_q1_nosig2_v:
    s_add_u32 s21, s21, 64
L_q1_nosig_v:
    s_cmp_ge_u32 s40, 30
    s_cbranch_scc1 L_q1_nold_v
    buffer_load_dwordx4 v[104:107], v1, s[4:7], s19 offen
    s_add_u32 s19, s19, 4096
    buffer_load_dwordx4 v[108:111], v1, s[4:7], s19 offen
    s_add_u32 s19, s19, 4096
    buffer_load_dwordx4 v[112:115], v1, s[4:7], s19 offen
    s_add_u32 s19, s19, 4096
    buffer_load_dwordx4 v[116:119], v1, s[4:7], s19 offen
    s_add_u32 s19, s19, 4096
    buffer_load_dwordx4 v[120:123], v1, s[4:7], s19 offen
    s_add_u32 s19, s19, 4096
    buffer_load_dwordx4 v[124:127], v1, s[4:7], s19 offen
    s_add_u32 s19, s19, 4096
    buffer_load_dwordx4 v[128:131], v1, s[4:7], s19 offen
    s_add_u32 s19, s19, 4096
    buffer_load_dwordx4 v[132:135], v1, s[4:7], s19 offen
    s_add_u32 s19, s19, 4096
    buffer_load_dwordx4 v[136:139], v1, s[4:7], s19 offen
    s_add_u32 s19, s19, 4096
    buffer_load_dwordx4 v[140:143], v1, s[4:7], s19 offen
    s_add_u32 s19, s19, 4096
    buffer_load_dwordx4 v[144:147], v1, s[4:7], s19 offen
    s_add_u32 s19, s19, 4096
    buffer_load_dwordx4 v[148:151], v1, s[4:7], s19 offen
    s_add_u32 s19, s19, 4096
    buffer_load_dwordx4 v[152:155], v1, s[4:7], s19 offen
    s_add_u32 s19, s19, 4096
    buffer_load_dwordx4 v[156:159], v1, s[4:7], s19 offen
    s_add_u32 s19, s19, 4096
    buffer_load_dwordx4 v[160:163], v1, s[4:7], s19 offen
    s_add_u32 s19, s19, 4096
    buffer_load_dwordx4 v[164:167], v1, s[4:7], s19 offen
    s_add_u32 s19, s19, 4096
L_q1_nold_v:
    s_mov_b32 s22, s20
    v_cvt_pk_bf16_f32 v56, v168, v169
    v_cvt_pk_bf16_f32 v57, v170, v171
    v_cvt_pk_bf16_f32 v58, v172, v173
    v_cvt_pk_bf16_f32 v59, v174, v175
    buffer_store_dwordx4 v[56:59], v4, s[4:7], s22 offen offset:0 sc1
    v_cvt_pk_bf16_f32 v60, v184, v185
    v_cvt_pk_bf16_f32 v61, v186, v187
    v_cvt_pk_bf16_f32 v62, v188, v189
    v_cvt_pk_bf16_f32 v63, v190, v191
    buffer_store_dwordx4 v[60:63], v4, s[4:7], s22 offen offset:1024 sc1
    v_cvt_pk_bf16_f32 v64, v200, v201
    v_cvt_pk_bf16_f32 v65, v202, v203
    v_cvt_pk_bf16_f32 v66, v204, v205
    v_cvt_pk_bf16_f32 v67, v206, v207
    buffer_store_dwordx4 v[64:67], v4, s[4:7], s22 offen offset:2048 sc1
    v_cvt_pk_bf16_f32 v68, v216, v217
    v_cvt_pk_bf16_f32 v69, v218, v219
    v_cvt_pk_bf16_f32 v70, v220, v221
    v_cvt_pk_bf16_f32 v71, v222, v223
    buffer_store_dwordx4 v[68:71], v4, s[4:7], s22 offen offset:3072 sc1
    s_add_u32 s22, s22, 262144
    v_cvt_pk_bf16_f32 v72, v176, v177
    v_cvt_pk_bf16_f32 v73, v178, v179
    v_cvt_pk_bf16_f32 v74, v180, v181
    v_cvt_pk_bf16_f32 v75, v182, v183
    buffer_store_dwordx4 v[72:75], v4, s[4:7], s22 offen offset:0 sc1
    v_cvt_pk_bf16_f32 v76, v192, v193
    v_cvt_pk_bf16_f32 v77, v194, v195
    v_cvt_pk_bf16_f32 v78, v196, v197
    v_cvt_pk_bf16_f32 v79, v198, v199
    buffer_store_dwordx4 v[76:79], v4, s[4:7], s22 offen offset:1024 sc1
    v_cvt_pk_bf16_f32 v80, v208, v209
    v_cvt_pk_bf16_f32 v81, v210, v211
    v_cvt_pk_bf16_f32 v82, v212, v213
    v_cvt_pk_bf16_f32 v83, v214, v215
    buffer_store_dwordx4 v[80:83], v4, s[4:7], s22 offen offset:2048 sc1
    v_cvt_pk_bf16_f32 v84, v224, v225
    v_cvt_pk_bf16_f32 v85, v226, v227
    v_cvt_pk_bf16_f32 v86, v228, v229
    v_cvt_pk_bf16_f32 v87, v230, v231
    buffer_store_dwordx4 v[84:87], v4, s[4:7], s22 offen offset:3072 sc1
    s_cmp_lg_u32 s40, 0
    s_cbranch_scc1 L_q1_noearly_v
    s_waitcnt vmcnt(0)
    s_barrier
    s_cmp_lg_u32 s13, 0
    s_cbranch_scc1 L_q1_early2_v
    v_mov_b32 v6, 0
    v_mov_b32 v7, 1
    s_mov_b64 exec, 1
    buffer_atomic_add v7, v6, s[4:7], s21 offen
    s_mov_b64 exec, -1
L_q1_early2_v:
    s_add_u32 s21, s21, 64
L_q1_noearly_v:
    s_add_u32 s20, s20, 524288
    s_add_u32 s40, s40, 1
    s_cmp_lt_u32 s40, 32
    s_cbranch_scc1 L_q1_loop_v
    s_branch L_q1_fin
L_q1_fin:
    s_waitcnt vmcnt(0) lgkmcnt(0)
    s_barrier
    s_cmp_lg_u32 s13, 0
    s_cbranch_scc1 L_wloop
    v_mov_b32 v6, 0
    v_mov_b32 v7, 1
    s_mov_b64 exec, 1
    buffer_atomic_add v7, v6, s[4:7], s21 offen
    s_mov_b64 exec, -1
    s_branch L_wloop
L_wend:
    s_waitcnt vmcnt(0)
    s_cmp_eq_u32 s68, 0
    s_cbranch_scc1 L_fp_done_end
    s_barrier
    s_cmp_lg_u32 s13, 0
    s_cbranch_scc1 L_fp_skip_end
    v_mov_b32 v124, 0
    v_mov_b32 v125, 1
    s_mov_b64 exec, 1
    buffer_atomic_add v125, v124, s[4:7], s68 offen
    s_mov_b64 exec, -1
L_fp_skip_end:
    s_mov_b32 s68, 0
L_fp_done_end:
L_mega_end:
    s_endpgm
.p2align 6
L_table:
    .long 0x18001, 0x8011, 0x8021, 0x8031, 0x8041, 0x8051, 0x8061, 0x8071, 0x8081, 0x8091, 0x80a1, 0x80b1, 0x80c1, 0x80d1, 0x80e1, 0x80f1
    .long 0x8101, 0x8111, 0x8121, 0x8131, 0x8141, 0x8151, 0x8161, 0x8171, 0x8181, 0x8191, 0x81a1, 0x81b1, 0x81c1, 0x81d1, 0x81e1, 0x81f1
    .long 0xffffffff, 0xffffffff, 0xffffffff, 0xffffffff, 0xffffffff, 0xffffffff, 0xffffffff, 0xffffffff, 0xffffffff, 0xffffffff, 0xffffffff, 0xffffffff, 0xffffffff, 0xffffffff, 0xffffffff, 0xffffffff
    .long 0xffffffff, 0xffffffff, 0xffffffff, 0xffffffff, 0xffffffff, 0xffffffff, 0xffffffff, 0xffffffff, 0xffffffff, 0xffffffff, 0xffffffff, 0xffffffff, 0xffffffff, 0xffffffff, 0xffffffff, 0xffffffff
    .long 0xffffffff, 0xffffffff, 0xffffffff, 0xffffffff, 0xffffffff, 0xffffffff, 0xffffffff, 0xffffffff, 0xffffffff, 0xffffffff, 0xffffffff, 0xffffffff, 0xffffffff, 0xffffffff, 0xffffffff, 0xffffffff
    .long 0x18201, 0x8211, 0x8221, 0x8231, 0x8241, 0x8251, 0x8261, 0x8271, 0x8281, 0x8291, 0x82a1, 0x82b1, 0x82c1, 0x82d1, 0x82e1, 0x82f1
    .long 0x8301, 0x8311, 0x8321, 0x8331, 0x8341, 0x8351, 0x8361, 0x8371, 0x8381, 0x8391, 0x83a1, 0x83b1, 0x83c1, 0x83d1, 0x83e1, 0x83f1
    .long 0xffffffff, 0xffffffff, 0xffffffff, 0xffffffff, 0xffffffff, 0xffffffff, 0xffffffff, 0xffffffff, 0xffffffff, 0xffffffff, 0xffffffff, 0xffffffff, 0xffffffff, 0xffffffff, 0xffffffff, 0xffffffff
    .long 0xffffffff, 0xffffffff, 0xffffffff, 0xffffffff, 0xffffffff, 0xffffffff, 0xffffffff, 0xffffffff, 0xffffffff, 0xffffffff, 0xffffffff, 0xffffffff, 0xffffffff, 0xffffffff, 0xffffffff, 0xffffffff
    .long 0xffffffff, 0xffffffff, 0xffffffff, 0xffffffff, 0xffffffff, 0xffffffff, 0xffffffff, 0xffffffff, 0xffffffff, 0xffffffff, 0xffffffff, 0xffffffff, 0xffffffff, 0xffffffff, 0xffffffff, 0xffffffff
    .long 0x18401, 0x8411, 0x8421, 0x8431, 0x8441, 0x8451, 0x8461, 0x8471, 0x8481, 0x8491, 0x84a1, 0x84b1, 0x84c1, 0x84d1, 0x84e1, 0x84f1
    .long 0x8501, 0x8511, 0x8521, 0x8531, 0x8541, 0x8551, 0x8561, 0x8571, 0x8581, 0x8591, 0x85a1, 0x85b1, 0x85c1, 0x85d1, 0x85e1, 0x85f1
    .long 0xffffffff, 0xffffffff, 0xffffffff, 0xffffffff, 0xffffffff, 0xffffffff, 0xffffffff, 0xffffffff, 0xffffffff, 0xffffffff, 0xffffffff, 0xffffffff, 0xffffffff, 0xffffffff, 0xffffffff, 0xffffffff
    .long 0xffffffff, 0xffffffff, 0xffffffff, 0xffffffff, 0xffffffff, 0xffffffff, 0xffffffff, 0xffffffff, 0xffffffff, 0xffffffff, 0xffffffff, 0xffffffff, 0xffffffff, 0xffffffff, 0xffffffff, 0xffffffff
    .long 0xffffffff, 0xffffffff, 0xffffffff, 0xffffffff, 0xffffffff, 0xffffffff, 0xffffffff, 0xffffffff, 0xffffffff, 0xffffffff, 0xffffffff, 0xffffffff, 0xffffffff, 0xffffffff, 0xffffffff, 0xffffffff
    .long 0x18601, 0x8611, 0x8621, 0x8631, 0x8641, 0x8651, 0x8661, 0x8671, 0x8681, 0x8691, 0x86a1, 0x86b1, 0x86c1, 0x86d1, 0x86e1, 0x86f1
    .long 0x8701, 0x8711, 0x8721, 0x8731, 0x8741, 0x8751, 0x8761, 0x8771, 0x8781, 0x8791, 0x87a1, 0x87b1, 0x87c1, 0x87d1, 0x87e1, 0x87f1
    .long 0xffffffff, 0xffffffff, 0xffffffff, 0xffffffff, 0xffffffff, 0xffffffff, 0xffffffff, 0xffffffff, 0xffffffff, 0xffffffff, 0xffffffff, 0xffffffff, 0xffffffff, 0xffffffff, 0xffffffff, 0xffffffff
    .long 0xffffffff, 0xffffffff, 0xffffffff, 0xffffffff, 0xffffffff, 0xffffffff, 0xffffffff, 0xffffffff, 0xffffffff, 0xffffffff, 0xffffffff, 0xffffffff, 0xffffffff, 0xffffffff, 0xffffffff, 0xffffffff
    .long 0xffffffff, 0xffffffff, 0xffffffff, 0xffffffff, 0xffffffff, 0xffffffff, 0xffffffff, 0xffffffff, 0xffffffff, 0xffffffff, 0xffffffff, 0xffffffff, 0xffffffff, 0xffffffff, 0xffffffff, 0xffffffff
    .long 0x18801, 0x8811, 0x8821, 0x8831, 0x8841, 0x8851, 0x8861, 0x8871, 0x8881, 0x8891, 0x88a1, 0x88b1, 0x88c1, 0x88d1, 0x88e1, 0x88f1
    .long 0x8901, 0x8911, 0x8921, 0x8931, 0x8941, 0x8951, 0x8961, 0x8971, 0x8981, 0x8991, 0x89a1, 0x89b1, 0x89c1, 0x89d1, 0x89e1, 0x89f1
    .long 0xffffffff, 0xffffffff, 0xffffffff, 0xffffffff, 0xffffffff, 0xffffffff, 0xffffffff, 0xffffffff, 0xffffffff, 0xffffffff, 0xffffffff, 0xffffffff, 0xffffffff, 0xffffffff, 0xffffffff, 0xffffffff
    .long 0xffffffff, 0xffffffff, 0xffffffff, 0xffffffff, 0xffffffff, 0xffffffff, 0xffffffff, 0xffffffff, 0xffffffff, 0xffffffff, 0xffffffff, 0xffffffff, 0xffffffff, 0xffffffff, 0xffffffff, 0xffffffff
    .long 0xffffffff, 0xffffffff, 0xffffffff, 0xffffffff, 0xffffffff, 0xffffffff, 0xffffffff, 0xffffffff, 0xffffffff, 0xffffffff, 0xffffffff, 0xffffffff, 0xffffffff, 0xffffffff, 0xffffffff, 0xffffffff
    .long 0x18a01, 0x8a11, 0x8a21, 0x8a31, 0x8a41, 0x8a51, 0x8a61, 0x8a71, 0x8a81, 0x8a91, 0x8aa1, 0x8ab1, 0x8ac1, 0x8ad1, 0x8ae1, 0x8af1
    .long 0x8b01, 0x8b11, 0x8b21, 0x8b31, 0x8b41, 0x8b51, 0x8b61, 0x8b71, 0x8b81, 0x8b91, 0x8ba1, 0x8bb1, 0x8bc1, 0x8bd1, 0x8be1, 0x8bf1
    .long 0xffffffff, 0xffffffff, 0xffffffff, 0xffffffff, 0xffffffff, 0xffffffff, 0xffffffff, 0xffffffff, 0xffffffff, 0xffffffff, 0xffffffff, 0xffffffff, 0xffffffff, 0xffffffff, 0xffffffff, 0xffffffff
    .long 0xffffffff, 0xffffffff, 0xffffffff, 0xffffffff, 0xffffffff, 0xffffffff, 0xffffffff, 0xffffffff, 0xffffffff, 0xffffffff, 0xffffffff, 0xffffffff, 0xffffffff, 0xffffffff, 0xffffffff, 0xffffffff
    .long 0xffffffff, 0xffffffff, 0xffffffff, 0xffffffff, 0xffffffff, 0xffffffff, 0xffffffff, 0xffffffff, 0xffffffff, 0xffffffff, 0xffffffff, 0xffffffff, 0xffffffff, 0xffffffff, 0xffffffff, 0xffffffff
    .long 0x18c01, 0x8c11, 0x8c21, 0x8c31, 0x8c41, 0x8c51, 0x8c61, 0x8c71, 0x8c81, 0x8c91, 0x8ca1, 0x8cb1, 0x8cc1, 0x8cd1, 0x8ce1, 0x8cf1
    .long 0x8d01, 0x8d11, 0x8d21, 0x8d31, 0x8d41, 0x8d51, 0x8d61, 0x8d71, 0x8d81, 0x8d91, 0x8da1, 0x8db1, 0x8dc1, 0x8dd1, 0x8de1, 0x8df1
    .long 0xffffffff, 0xffffffff, 0xffffffff, 0xffffffff, 0xffffffff, 0xffffffff, 0xffffffff, 0xffffffff, 0xffffffff, 0xffffffff, 0xffffffff, 0xffffffff, 0xffffffff, 0xffffffff, 0xffffffff, 0xffffffff
    .long 0xffffffff, 0xffffffff, 0xffffffff, 0xffffffff, 0xffffffff, 0xffffffff, 0xffffffff, 0xffffffff, 0xffffffff, 0xffffffff, 0xffffffff, 0xffffffff, 0xffffffff, 0xffffffff, 0xffffffff, 0xffffffff
    .long 0xffffffff, 0xffffffff, 0xffffffff, 0xffffffff, 0xffffffff, 0xffffffff, 0xffffffff, 0xffffffff, 0xffffffff, 0xffffffff, 0xffffffff, 0xffffffff, 0xffffffff, 0xffffffff, 0xffffffff, 0xffffffff
    .long 0x18e01, 0x8e11, 0x8e21, 0x8e31, 0x8e41, 0x8e51, 0x8e61, 0x8e71, 0x8e81, 0x8e91, 0x8ea1, 0x8eb1, 0x8ec1, 0x8ed1, 0x8ee1, 0x8ef1
    .long 0x8f01, 0x8f11, 0x8f21, 0x8f31, 0x8f41, 0x8f51, 0x8f61, 0x8f71, 0x8f81, 0x8f91, 0x8fa1, 0x8fb1, 0x8fc1, 0x8fd1, 0x8fe1, 0x8ff1
    .long 0xffffffff, 0xffffffff, 0xffffffff, 0xffffffff, 0xffffffff, 0xffffffff, 0xffffffff, 0xffffffff, 0xffffffff, 0xffffffff, 0xffffffff, 0xffffffff, 0xffffffff, 0xffffffff, 0xffffffff, 0xffffffff
    .long 0xffffffff, 0xffffffff, 0xffffffff, 0xffffffff, 0xffffffff, 0xffffffff, 0xffffffff, 0xffffffff, 0xffffffff, 0xffffffff, 0xffffffff, 0xffffffff, 0xffffffff, 0xffffffff, 0xffffffff, 0xffffffff
    .long 0xffffffff, 0xffffffff, 0xffffffff, 0xffffffff, 0xffffffff, 0xffffffff, 0xffffffff, 0xffffffff, 0xffffffff, 0xffffffff, 0xffffffff, 0xffffffff, 0xffffffff, 0xffffffff, 0xffffffff, 0xffffffff
    .long 0x19001, 0x9011, 0x9021, 0x9031, 0x9041, 0x9051, 0x9061, 0x9071, 0x9081, 0x9091, 0x90a1, 0x90b1, 0x90c1, 0x90d1, 0x90e1, 0x90f1
    .long 0x9101, 0x9111, 0x9121, 0x9131, 0x9141, 0x9151, 0x9161, 0x9171, 0x9181, 0x9191, 0x91a1, 0x91b1, 0x91c1, 0x91d1, 0x91e1, 0x91f1
    .long 0xffffffff, 0xffffffff, 0xffffffff, 0xffffffff, 0xffffffff, 0xffffffff, 0xffffffff, 0xffffffff, 0xffffffff, 0xffffffff, 0xffffffff, 0xffffffff, 0xffffffff, 0xffffffff, 0xffffffff, 0xffffffff
    .long 0xffffffff, 0xffffffff, 0xffffffff, 0xffffffff, 0xffffffff, 0xffffffff, 0xffffffff, 0xffffffff, 0xffffffff, 0xffffffff, 0xffffffff, 0xffffffff, 0xffffffff, 0xffffffff, 0xffffffff, 0xffffffff
    .long 0xffffffff, 0xffffffff, 0xffffffff, 0xffffffff, 0xffffffff, 0xffffffff, 0xffffffff, 0xffffffff, 0xffffffff, 0xffffffff, 0xffffffff, 0xffffffff, 0xffffffff, 0xffffffff, 0xffffffff, 0xffffffff
    .long 0x19201, 0x9211, 0x9221, 0x9231, 0x9241, 0x9251, 0x9261, 0x9271, 0x9281, 0x9291, 0x92a1, 0x92b1, 0x92c1, 0x92d1, 0x92e1, 0x92f1
    .long 0x9301, 0x9311, 0x9321, 0x9331, 0x9341, 0x9351, 0x9361, 0x9371, 0x9381, 0x9391, 0x93a1, 0x93b1, 0x93c1, 0x93d1, 0x93e1, 0x93f1
    .long 0xffffffff, 0xffffffff, 0xffffffff, 0xffffffff, 0xffffffff, 0xffffffff, 0xffffffff, 0xffffffff, 0xffffffff, 0xffffffff, 0xffffffff, 0xffffffff, 0xffffffff, 0xffffffff, 0xffffffff, 0xffffffff
    .long 0xffffffff, 0xffffffff, 0xffffffff, 0xffffffff, 0xffffffff, 0xffffffff, 0xffffffff, 0xffffffff, 0xffffffff, 0xffffffff, 0xffffffff, 0xffffffff, 0xffffffff, 0xffffffff, 0xffffffff, 0xffffffff
    .long 0xffffffff, 0xffffffff, 0xffffffff, 0xffffffff, 0xffffffff, 0xffffffff, 0xffffffff, 0xffffffff, 0xffffffff, 0xffffffff, 0xffffffff, 0xffffffff, 0xffffffff, 0xffffffff, 0xffffffff, 0xffffffff
    .long 0x19401, 0x9411, 0x9421, 0x9431, 0x9441, 0x9451, 0x9461, 0x9471, 0x9481, 0x9491, 0x94a1, 0x94b1, 0x94c1, 0x94d1, 0x94e1, 0x94f1
    .long 0x9501, 0x9511, 0x9521, 0x9531, 0x9541, 0x9551, 0x9561, 0x9571, 0x9581, 0x9591, 0x95a1, 0x95b1, 0x95c1, 0x95d1, 0x95e1, 0x95f1
    .long 0xffffffff, 0xffffffff, 0xffffffff, 0xffffffff, 0xffffffff, 0xffffffff, 0xffffffff, 0xffffffff, 0xffffffff, 0xffffffff, 0xffffffff, 0xffffffff, 0xffffffff, 0xffffffff, 0xffffffff, 0xffffffff
    .long 0xffffffff, 0xffffffff, 0xffffffff, 0xffffffff, 0xffffffff, 0xffffffff, 0xffffffff, 0xffffffff, 0xffffffff, 0xffffffff, 0xffffffff, 0xffffffff, 0xffffffff, 0xffffffff, 0xffffffff, 0xffffffff
    .long 0xffffffff, 0xffffffff, 0xffffffff, 0xffffffff, 0xffffffff, 0xffffffff, 0xffffffff, 0xffffffff, 0xffffffff, 0xffffffff, 0xffffffff, 0xffffffff, 0xffffffff, 0xffffffff, 0xffffffff, 0xffffffff
    .long 0x19601, 0x9611, 0x9621, 0x9631, 0x9641, 0x9651, 0x9661, 0x9671, 0x9681, 0x9691, 0x96a1, 0x96b1, 0x96c1, 0x96d1, 0x96e1, 0x96f1
    .long 0x9701, 0x9711, 0x9721, 0x9731, 0x9741, 0x9751, 0x9761, 0x9771, 0x9781, 0x9791, 0x97a1, 0x97b1, 0x97c1, 0x97d1, 0x97e1, 0x97f1
    .long 0xffffffff, 0xffffffff, 0xffffffff, 0xffffffff, 0xffffffff, 0xffffffff, 0xffffffff, 0xffffffff, 0xffffffff, 0xffffffff, 0xffffffff, 0xffffffff, 0xffffffff, 0xffffffff, 0xffffffff, 0xffffffff
    .long 0xffffffff, 0xffffffff, 0xffffffff, 0xffffffff, 0xffffffff, 0xffffffff, 0xffffffff, 0xffffffff, 0xffffffff, 0xffffffff, 0xffffffff, 0xffffffff, 0xffffffff, 0xffffffff, 0xffffffff, 0xffffffff
    .long 0xffffffff, 0xffffffff, 0xffffffff, 0xffffffff, 0xffffffff, 0xffffffff, 0xffffffff, 0xffffffff, 0xffffffff, 0xffffffff, 0xffffffff, 0xffffffff, 0xffffffff, 0xffffffff, 0xffffffff, 0xffffffff
    .long 0x19801, 0x9811, 0x9821, 0x9831, 0x9841, 0x9851, 0x9861, 0x9871, 0x9881, 0x9891, 0x98a1, 0x98b1, 0x98c1, 0x98d1, 0x98e1, 0x98f1
    .long 0x9901, 0x9911, 0x9921, 0x9931, 0x9941, 0x9951, 0x9961, 0x9971, 0x9981, 0x9991, 0x99a1, 0x99b1, 0x99c1, 0x99d1, 0x99e1, 0x99f1
    .long 0xffffffff, 0xffffffff, 0xffffffff, 0xffffffff, 0xffffffff, 0xffffffff, 0xffffffff, 0xffffffff, 0xffffffff, 0xffffffff, 0xffffffff, 0xffffffff, 0xffffffff, 0xffffffff, 0xffffffff, 0xffffffff
    .long 0xffffffff, 0xffffffff, 0xffffffff, 0xffffffff, 0xffffffff, 0xffffffff, 0xffffffff, 0xffffffff, 0xffffffff, 0xffffffff, 0xffffffff, 0xffffffff, 0xffffffff, 0xffffffff, 0xffffffff, 0xffffffff
    .long 0xffffffff, 0xffffffff, 0xffffffff, 0xffffffff, 0xffffffff, 0xffffffff, 0xffffffff, 0xffffffff, 0xffffffff, 0xffffffff, 0xffffffff, 0xffffffff, 0xffffffff, 0xffffffff, 0xffffffff, 0xffffffff
    .long 0x19a01, 0x9a11, 0x9a21, 0x9a31, 0x9a41, 0x9a51, 0x9a61, 0x9a71, 0x9a81, 0x9a91, 0x9aa1, 0x9ab1, 0x9ac1, 0x9ad1, 0x9ae1, 0x9af1
    .long 0x9b01, 0x9b11, 0x9b21, 0x9b31, 0x9b41, 0x9b51, 0x9b61, 0x9b71, 0x9b81, 0x9b91, 0x9ba1, 0x9bb1, 0x9bc1, 0x9bd1, 0x9be1, 0x9bf1
    .long 0xffffffff, 0xffffffff, 0xffffffff, 0xffffffff, 0xffffffff, 0xffffffff, 0xffffffff, 0xffffffff, 0xffffffff, 0xffffffff, 0xffffffff, 0xffffffff, 0xffffffff, 0xffffffff, 0xffffffff, 0xffffffff
    .long 0xffffffff, 0xffffffff, 0xffffffff, 0xffffffff, 0xffffffff, 0xffffffff, 0xffffffff, 0xffffffff, 0xffffffff, 0xffffffff, 0xffffffff, 0xffffffff, 0xffffffff, 0xffffffff, 0xffffffff, 0xffffffff
    .long 0xffffffff, 0xffffffff, 0xffffffff, 0xffffffff, 0xffffffff, 0xffffffff, 0xffffffff, 0xffffffff, 0xffffffff, 0xffffffff, 0xffffffff, 0xffffffff, 0xffffffff, 0xffffffff, 0xffffffff, 0xffffffff
    .long 0x19c01, 0x9c11, 0x9c21, 0x9c31, 0x9c41, 0x9c51, 0x9c61, 0x9c71, 0x9c81, 0x9c91, 0x9ca1, 0x9cb1, 0x9cc1, 0x9cd1, 0x9ce1, 0x9cf1
    .long 0x9d01, 0x9d11, 0x9d21, 0x9d31, 0x9d41, 0x9d51, 0x9d61, 0x9d71, 0x9d81, 0x9d91, 0x9da1, 0x9db1, 0x9dc1, 0x9dd1, 0x9de1, 0x9df1
    .long 0xffffffff, 0xffffffff, 0xffffffff, 0xffffffff, 0xffffffff, 0xffffffff, 0xffffffff, 0xffffffff, 0xffffffff, 0xffffffff, 0xffffffff, 0xffffffff, 0xffffffff, 0xffffffff, 0xffffffff, 0xffffffff
    .long 0xffffffff, 0xffffffff, 0xffffffff, 0xffffffff, 0xffffffff, 0xffffffff, 0xffffffff, 0xffffffff, 0xffffffff, 0xffffffff, 0xffffffff, 0xffffffff, 0xffffffff, 0xffffffff, 0xffffffff, 0xffffffff
    .long 0xffffffff, 0xffffffff, 0xffffffff, 0xffffffff, 0xffffffff, 0xffffffff, 0xffffffff, 0xffffffff, 0xffffffff, 0xffffffff, 0xffffffff, 0xffffffff, 0xffffffff, 0xffffffff, 0xffffffff, 0xffffffff
    .long 0x19e01, 0x9e11, 0x9e21, 0x9e31, 0x9e41, 0x9e51, 0x9e61, 0x9e71, 0x9e81, 0x9e91, 0x9ea1, 0x9eb1, 0x9ec1, 0x9ed1, 0x9ee1, 0x9ef1
    .long 0x9f01, 0x9f11, 0x9f21, 0x9f31, 0x9f41, 0x9f51, 0x9f61, 0x9f71, 0x9f81, 0x9f91, 0x9fa1, 0x9fb1, 0x9fc1, 0x9fd1, 0x9fe1, 0x9ff1
    .long 0xffffffff, 0xffffffff, 0xffffffff, 0xffffffff, 0xffffffff, 0xffffffff, 0xffffffff, 0xffffffff, 0xffffffff, 0xffffffff, 0xffffffff, 0xffffffff, 0xffffffff, 0xffffffff, 0xffffffff, 0xffffffff
    .long 0xffffffff, 0xffffffff, 0xffffffff, 0xffffffff, 0xffffffff, 0xffffffff, 0xffffffff, 0xffffffff, 0xffffffff, 0xffffffff, 0xffffffff, 0xffffffff, 0xffffffff, 0xffffffff, 0xffffffff, 0xffffffff
    .long 0xffffffff, 0xffffffff, 0xffffffff, 0xffffffff, 0xffffffff, 0xffffffff, 0xffffffff, 0xffffffff, 0xffffffff, 0xffffffff, 0xffffffff, 0xffffffff, 0xffffffff, 0xffffffff, 0xffffffff, 0xffffffff
    .long 0x1a001, 0xa011, 0xa021, 0xa031, 0xa041, 0xa051, 0xa061, 0xa071, 0xa081, 0xa091, 0xa0a1, 0xa0b1, 0xa0c1, 0xa0d1, 0xa0e1, 0xa0f1
    .long 0xa101, 0xa111, 0xa121, 0xa131, 0xa141, 0xa151, 0xa161, 0xa171, 0xa181, 0xa191, 0xa1a1, 0xa1b1, 0xa1c1, 0xa1d1, 0xa1e1, 0xa1f1
    .long 0xffffffff, 0xffffffff, 0xffffffff, 0xffffffff, 0xffffffff, 0xffffffff, 0xffffffff, 0xffffffff, 0xffffffff, 0xffffffff, 0xffffffff, 0xffffffff, 0xffffffff, 0xffffffff, 0xffffffff, 0xffffffff
    .long 0xffffffff, 0xffffffff, 0xffffffff, 0xffffffff, 0xffffffff, 0xffffffff, 0xffffffff, 0xffffffff, 0xffffffff, 0xffffffff, 0xffffffff, 0xffffffff, 0xffffffff, 0xffffffff, 0xffffffff, 0xffffffff
    .long 0xffffffff, 0xffffffff, 0xffffffff, 0xffffffff, 0xffffffff, 0xffffffff, 0xffffffff, 0xffffffff, 0xffffffff, 0xffffffff, 0xffffffff, 0xffffffff, 0xffffffff, 0xffffffff, 0xffffffff, 0xffffffff
    .long 0x1a201, 0xa211, 0xa221, 0xa231, 0xa241, 0xa251, 0xa261, 0xa271, 0xa281, 0xa291, 0xa2a1, 0xa2b1, 0xa2c1, 0xa2d1, 0xa2e1, 0xa2f1
    .long 0xa301, 0xa311, 0xa321, 0xa331, 0xa341, 0xa351, 0xa361, 0xa371, 0xa381, 0xa391, 0xa3a1, 0xa3b1, 0xa3c1, 0xa3d1, 0xa3e1, 0xa3f1
    .long 0xffffffff, 0xffffffff, 0xffffffff, 0xffffffff, 0xffffffff, 0xffffffff, 0xffffffff, 0xffffffff, 0xffffffff, 0xffffffff, 0xffffffff, 0xffffffff, 0xffffffff, 0xffffffff, 0xffffffff, 0xffffffff
    .long 0xffffffff, 0xffffffff, 0xffffffff, 0xffffffff, 0xffffffff, 0xffffffff, 0xffffffff, 0xffffffff, 0xffffffff, 0xffffffff, 0xffffffff, 0xffffffff, 0xffffffff, 0xffffffff, 0xffffffff, 0xffffffff
    .long 0xffffffff, 0xffffffff, 0xffffffff, 0xffffffff, 0xffffffff, 0xffffffff, 0xffffffff, 0xffffffff, 0xffffffff, 0xffffffff, 0xffffffff, 0xffffffff, 0xffffffff, 0xffffffff, 0xffffffff, 0xffffffff
    .long 0x1a401, 0xa411, 0xa421, 0xa431, 0xa441, 0xa451, 0xa461, 0xa471, 0xa481, 0xa491, 0xa4a1, 0xa4b1, 0xa4c1, 0xa4d1, 0xa4e1, 0xa4f1
    .long 0xa501, 0xa511, 0xa521, 0xa531, 0xa541, 0xa551, 0xa561, 0xa571, 0xa581, 0xa591, 0xa5a1, 0xa5b1, 0xa5c1, 0xa5d1, 0xa5e1, 0xa5f1
    .long 0xffffffff, 0xffffffff, 0xffffffff, 0xffffffff, 0xffffffff, 0xffffffff, 0xffffffff, 0xffffffff, 0xffffffff, 0xffffffff, 0xffffffff, 0xffffffff, 0xffffffff, 0xffffffff, 0xffffffff, 0xffffffff
    .long 0xffffffff, 0xffffffff, 0xffffffff, 0xffffffff, 0xffffffff, 0xffffffff, 0xffffffff, 0xffffffff, 0xffffffff, 0xffffffff, 0xffffffff, 0xffffffff, 0xffffffff, 0xffffffff, 0xffffffff, 0xffffffff
    .long 0xffffffff, 0xffffffff, 0xffffffff, 0xffffffff, 0xffffffff, 0xffffffff, 0xffffffff, 0xffffffff, 0xffffffff, 0xffffffff, 0xffffffff, 0xffffffff, 0xffffffff, 0xffffffff, 0xffffffff, 0xffffffff
    .long 0x1a601, 0xa611, 0xa621, 0xa631, 0xa641, 0xa651, 0xa661, 0xa671, 0xa681, 0xa691, 0xa6a1, 0xa6b1, 0xa6c1, 0xa6d1, 0xa6e1, 0xa6f1
    .long 0xa701, 0xa711, 0xa721, 0xa731, 0xa741, 0xa751, 0xa761, 0xa771, 0xa781, 0xa791, 0xa7a1, 0xa7b1, 0xa7c1, 0xa7d1, 0xa7e1, 0xa7f1
    .long 0xffffffff, 0xffffffff, 0xffffffff, 0xffffffff, 0xffffffff, 0xffffffff, 0xffffffff, 0xffffffff, 0xffffffff, 0xffffffff, 0xffffffff, 0xffffffff, 0xffffffff, 0xffffffff, 0xffffffff, 0xffffffff
    .long 0xffffffff, 0xffffffff, 0xffffffff, 0xffffffff, 0xffffffff, 0xffffffff, 0xffffffff, 0xffffffff, 0xffffffff, 0xffffffff, 0xffffffff, 0xffffffff, 0xffffffff, 0xffffffff, 0xffffffff, 0xffffffff
    .long 0xffffffff, 0xffffffff, 0xffffffff, 0xffffffff, 0xffffffff, 0xffffffff, 0xffffffff, 0xffffffff, 0xffffffff, 0xffffffff, 0xffffffff, 0xffffffff, 0xffffffff, 0xffffffff, 0xffffffff, 0xffffffff
    .long 0x1a801, 0xa811, 0xa821, 0xa831, 0xa841, 0xa851, 0xa861, 0xa871, 0xa881, 0xa891, 0xa8a1, 0xa8b1, 0xa8c1, 0xa8d1, 0xa8e1, 0xa8f1
    .long 0xa901, 0xa911, 0xa921, 0xa931, 0xa941, 0xa951, 0xa961, 0xa971, 0xa981, 0xa991, 0xa9a1, 0xa9b1, 0xa9c1, 0xa9d1, 0xa9e1, 0xa9f1
    .long 0xffffffff, 0xffffffff, 0xffffffff, 0xffffffff, 0xffffffff, 0xffffffff, 0xffffffff, 0xffffffff, 0xffffffff, 0xffffffff, 0xffffffff, 0xffffffff, 0xffffffff, 0xffffffff, 0xffffffff, 0xffffffff
    .long 0xffffffff, 0xffffffff, 0xffffffff, 0xffffffff, 0xffffffff, 0xffffffff, 0xffffffff, 0xffffffff, 0xffffffff, 0xffffffff, 0xffffffff, 0xffffffff, 0xffffffff, 0xffffffff, 0xffffffff, 0xffffffff
    .long 0xffffffff, 0xffffffff, 0xffffffff, 0xffffffff, 0xffffffff, 0xffffffff, 0xffffffff, 0xffffffff, 0xffffffff, 0xffffffff, 0xffffffff, 0xffffffff, 0xffffffff, 0xffffffff, 0xffffffff, 0xffffffff
    .long 0x1aa01, 0xaa11, 0xaa21, 0xaa31, 0xaa41, 0xaa51, 0xaa61, 0xaa71, 0xaa81, 0xaa91, 0xaaa1, 0xaab1, 0xaac1, 0xaad1, 0xaae1, 0xaaf1
    .long 0xab01, 0xab11, 0xab21, 0xab31, 0xab41, 0xab51, 0xab61, 0xab71, 0xab81, 0xab91, 0xaba1, 0xabb1, 0xabc1, 0xabd1, 0xabe1, 0xabf1
    .long 0xffffffff, 0xffffffff, 0xffffffff, 0xffffffff, 0xffffffff, 0xffffffff, 0xffffffff, 0xffffffff, 0xffffffff, 0xffffffff, 0xffffffff, 0xffffffff, 0xffffffff, 0xffffffff, 0xffffffff, 0xffffffff
    .long 0xffffffff, 0xffffffff, 0xffffffff, 0xffffffff, 0xffffffff, 0xffffffff, 0xffffffff, 0xffffffff, 0xffffffff, 0xffffffff, 0xffffffff, 0xffffffff, 0xffffffff, 0xffffffff, 0xffffffff, 0xffffffff
    .long 0xffffffff, 0xffffffff, 0xffffffff, 0xffffffff, 0xffffffff, 0xffffffff, 0xffffffff, 0xffffffff, 0xffffffff, 0xffffffff, 0xffffffff, 0xffffffff, 0xffffffff, 0xffffffff, 0xffffffff, 0xffffffff
    .long 0x1ac01, 0xac11, 0xac21, 0xac31, 0xac41, 0xac51, 0xac61, 0xac71, 0xac81, 0xac91, 0xaca1, 0xacb1, 0xacc1, 0xacd1, 0xace1, 0xacf1
    .long 0xad01, 0xad11, 0xad21, 0xad31, 0xad41, 0xad51, 0xad61, 0xad71, 0xad81, 0xad91, 0xada1, 0xadb1, 0xadc1, 0xadd1, 0xade1, 0xadf1
    .long 0xffffffff, 0xffffffff, 0xffffffff, 0xffffffff, 0xffffffff, 0xffffffff, 0xffffffff, 0xffffffff, 0xffffffff, 0xffffffff, 0xffffffff, 0xffffffff, 0xffffffff, 0xffffffff, 0xffffffff, 0xffffffff
    .long 0xffffffff, 0xffffffff, 0xffffffff, 0xffffffff, 0xffffffff, 0xffffffff, 0xffffffff, 0xffffffff, 0xffffffff, 0xffffffff, 0xffffffff, 0xffffffff, 0xffffffff, 0xffffffff, 0xffffffff, 0xffffffff
    .long 0xffffffff, 0xffffffff, 0xffffffff, 0xffffffff, 0xffffffff, 0xffffffff, 0xffffffff, 0xffffffff, 0xffffffff, 0xffffffff, 0xffffffff, 0xffffffff, 0xffffffff, 0xffffffff, 0xffffffff, 0xffffffff
    .long 0x1ae01, 0xae11, 0xae21, 0xae31, 0xae41, 0xae51, 0xae61, 0xae71, 0xae81, 0xae91, 0xaea1, 0xaeb1, 0xaec1, 0xaed1, 0xaee1, 0xaef1
    .long 0xaf01, 0xaf11, 0xaf21, 0xaf31, 0xaf41, 0xaf51, 0xaf61, 0xaf71, 0xaf81, 0xaf91, 0xafa1, 0xafb1, 0xafc1, 0xafd1, 0xafe1, 0xaff1
    .long 0xffffffff, 0xffffffff, 0xffffffff, 0xffffffff, 0xffffffff, 0xffffffff, 0xffffffff, 0xffffffff, 0xffffffff, 0xffffffff, 0xffffffff, 0xffffffff, 0xffffffff, 0xffffffff, 0xffffffff, 0xffffffff
    .long 0xffffffff, 0xffffffff, 0xffffffff, 0xffffffff, 0xffffffff, 0xffffffff, 0xffffffff, 0xffffffff, 0xffffffff, 0xffffffff, 0xffffffff, 0xffffffff, 0xffffffff, 0xffffffff, 0xffffffff, 0xffffffff
    .long 0xffffffff, 0xffffffff, 0xffffffff, 0xffffffff, 0xffffffff, 0xffffffff, 0xffffffff, 0xffffffff, 0xffffffff, 0xffffffff, 0xffffffff, 0xffffffff, 0xffffffff, 0xffffffff, 0xffffffff, 0xffffffff
    .long 0x1b001, 0xb011, 0xb021, 0xb031, 0xb041, 0xb051, 0xb061, 0xb071, 0xb081, 0xb091, 0xb0a1, 0xb0b1, 0xb0c1, 0xb0d1, 0xb0e1, 0xb0f1
    .long 0xb101, 0xb111, 0xb121, 0xb131, 0xb141, 0xb151, 0xb161, 0xb171, 0xb181, 0xb191, 0xb1a1, 0xb1b1, 0xb1c1, 0xb1d1, 0xb1e1, 0xb1f1
    .long 0xffffffff, 0xffffffff, 0xffffffff, 0xffffffff, 0xffffffff, 0xffffffff, 0xffffffff, 0xffffffff, 0xffffffff, 0xffffffff, 0xffffffff, 0xffffffff, 0xffffffff, 0xffffffff, 0xffffffff, 0xffffffff
    .long 0xffffffff, 0xffffffff, 0xffffffff, 0xffffffff, 0xffffffff, 0xffffffff, 0xffffffff, 0xffffffff, 0xffffffff, 0xffffffff, 0xffffffff, 0xffffffff, 0xffffffff, 0xffffffff, 0xffffffff, 0xffffffff
    .long 0xffffffff, 0xffffffff, 0xffffffff, 0xffffffff, 0xffffffff, 0xffffffff, 0xffffffff, 0xffffffff, 0xffffffff, 0xffffffff, 0xffffffff, 0xffffffff, 0xffffffff, 0xffffffff, 0xffffffff, 0xffffffff
    .long 0x1b201, 0xb211, 0xb221, 0xb231, 0xb241, 0xb251, 0xb261, 0xb271, 0xb281, 0xb291, 0xb2a1, 0xb2b1, 0xb2c1, 0xb2d1, 0xb2e1, 0xb2f1
    .long 0xb301, 0xb311, 0xb321, 0xb331, 0xb341, 0xb351, 0xb361, 0xb371, 0xb381, 0xb391, 0xb3a1, 0xb3b1, 0xb3c1, 0xb3d1, 0xb3e1, 0xb3f1
    .long 0xffffffff, 0xffffffff, 0xffffffff, 0xffffffff, 0xffffffff, 0xffffffff, 0xffffffff, 0xffffffff, 0xffffffff, 0xffffffff, 0xffffffff, 0xffffffff, 0xffffffff, 0xffffffff, 0xffffffff, 0xffffffff
    .long 0xffffffff, 0xffffffff, 0xffffffff, 0xffffffff, 0xffffffff, 0xffffffff, 0xffffffff, 0xffffffff, 0xffffffff, 0xffffffff, 0xffffffff, 0xffffffff, 0xffffffff, 0xffffffff, 0xffffffff, 0xffffffff
    .long 0xffffffff, 0xffffffff, 0xffffffff, 0xffffffff, 0xffffffff, 0xffffffff, 0xffffffff, 0xffffffff, 0xffffffff, 0xffffffff, 0xffffffff, 0xffffffff, 0xffffffff, 0xffffffff, 0xffffffff, 0xffffffff
    .long 0x1b401, 0xb411, 0xb421, 0xb431, 0xb441, 0xb451, 0xb461, 0xb471, 0xb481, 0xb491, 0xb4a1, 0xb4b1, 0xb4c1, 0xb4d1, 0xb4e1, 0xb4f1
    .long 0xb501, 0xb511, 0xb521, 0xb531, 0xb541, 0xb551, 0xb561, 0xb571, 0xb581, 0xb591, 0xb5a1, 0xb5b1, 0xb5c1, 0xb5d1, 0xb5e1, 0xb5f1
    .long 0xffffffff, 0xffffffff, 0xffffffff, 0xffffffff, 0xffffffff, 0xffffffff, 0xffffffff, 0xffffffff, 0xffffffff, 0xffffffff, 0xffffffff, 0xffffffff, 0xffffffff, 0xffffffff, 0xffffffff, 0xffffffff
    .long 0xffffffff, 0xffffffff, 0xffffffff, 0xffffffff, 0xffffffff, 0xffffffff, 0xffffffff, 0xffffffff, 0xffffffff, 0xffffffff, 0xffffffff, 0xffffffff, 0xffffffff, 0xffffffff, 0xffffffff, 0xffffffff
    .long 0xffffffff, 0xffffffff, 0xffffffff, 0xffffffff, 0xffffffff, 0xffffffff, 0xffffffff, 0xffffffff, 0xffffffff, 0xffffffff, 0xffffffff, 0xffffffff, 0xffffffff, 0xffffffff, 0xffffffff, 0xffffffff
    .long 0x1b601, 0xb611, 0xb621, 0xb631, 0xb641, 0xb651, 0xb661, 0xb671, 0xb681, 0xb691, 0xb6a1, 0xb6b1, 0xb6c1, 0xb6d1, 0xb6e1, 0xb6f1
    .long 0xb701, 0xb711, 0xb721, 0xb731, 0xb741, 0xb751, 0xb761, 0xb771, 0xb781, 0xb791, 0xb7a1, 0xb7b1, 0xb7c1, 0xb7d1, 0xb7e1, 0xb7f1
    .long 0xffffffff, 0xffffffff, 0xffffffff, 0xffffffff, 0xffffffff, 0xffffffff, 0xffffffff, 0xffffffff, 0xffffffff, 0xffffffff, 0xffffffff, 0xffffffff, 0xffffffff, 0xffffffff, 0xffffffff, 0xffffffff
    .long 0xffffffff, 0xffffffff, 0xffffffff, 0xffffffff, 0xffffffff, 0xffffffff, 0xffffffff, 0xffffffff, 0xffffffff, 0xffffffff, 0xffffffff, 0xffffffff, 0xffffffff, 0xffffffff, 0xffffffff, 0xffffffff
    .long 0xffffffff, 0xffffffff, 0xffffffff, 0xffffffff, 0xffffffff, 0xffffffff, 0xffffffff, 0xffffffff, 0xffffffff, 0xffffffff, 0xffffffff, 0xffffffff, 0xffffffff, 0xffffffff, 0xffffffff, 0xffffffff
    .long 0x1b801, 0xb811, 0xb821, 0xb831, 0xb841, 0xb851, 0xb861, 0xb871, 0xb881, 0xb891, 0xb8a1, 0xb8b1, 0xb8c1, 0xb8d1, 0xb8e1, 0xb8f1
    .long 0xb901, 0xb911, 0xb921, 0xb931, 0xb941, 0xb951, 0xb961, 0xb971, 0xb981, 0xb991, 0xb9a1, 0xb9b1, 0xb9c1, 0xb9d1, 0xb9e1, 0xb9f1
    .long 0xffffffff, 0xffffffff, 0xffffffff, 0xffffffff, 0xffffffff, 0xffffffff, 0xffffffff, 0xffffffff, 0xffffffff, 0xffffffff, 0xffffffff, 0xffffffff, 0xffffffff, 0xffffffff, 0xffffffff, 0xffffffff
    .long 0xffffffff, 0xffffffff, 0xffffffff, 0xffffffff, 0xffffffff, 0xffffffff, 0xffffffff, 0xffffffff, 0xffffffff, 0xffffffff, 0xffffffff, 0xffffffff, 0xffffffff, 0xffffffff, 0xffffffff, 0xffffffff
    .long 0xffffffff, 0xffffffff, 0xffffffff, 0xffffffff, 0xffffffff, 0xffffffff, 0xffffffff, 0xffffffff, 0xffffffff, 0xffffffff, 0xffffffff, 0xffffffff, 0xffffffff, 0xffffffff, 0xffffffff, 0xffffffff
    .long 0x1ba01, 0xba11, 0xba21, 0xba31, 0xba41, 0xba51, 0xba61, 0xba71, 0xba81, 0xba91, 0xbaa1, 0xbab1, 0xbac1, 0xbad1, 0xbae1, 0xbaf1
    .long 0xbb01, 0xbb11, 0xbb21, 0xbb31, 0xbb41, 0xbb51, 0xbb61, 0xbb71, 0xbb81, 0xbb91, 0xbba1, 0xbbb1, 0xbbc1, 0xbbd1, 0xbbe1, 0xbbf1
    .long 0xffffffff, 0xffffffff, 0xffffffff, 0xffffffff, 0xffffffff, 0xffffffff, 0xffffffff, 0xffffffff, 0xffffffff, 0xffffffff, 0xffffffff, 0xffffffff, 0xffffffff, 0xffffffff, 0xffffffff, 0xffffffff
    .long 0xffffffff, 0xffffffff, 0xffffffff, 0xffffffff, 0xffffffff, 0xffffffff, 0xffffffff, 0xffffffff, 0xffffffff, 0xffffffff, 0xffffffff, 0xffffffff, 0xffffffff, 0xffffffff, 0xffffffff, 0xffffffff
    .long 0xffffffff, 0xffffffff, 0xffffffff, 0xffffffff, 0xffffffff, 0xffffffff, 0xffffffff, 0xffffffff, 0xffffffff, 0xffffffff, 0xffffffff, 0xffffffff, 0xffffffff, 0xffffffff, 0xffffffff, 0xffffffff
    .long 0x1bc01, 0xbc11, 0xbc21, 0xbc31, 0xbc41, 0xbc51, 0xbc61, 0xbc71, 0xbc81, 0xbc91, 0xbca1, 0xbcb1, 0xbcc1, 0xbcd1, 0xbce1, 0xbcf1
    .long 0xbd01, 0xbd11, 0xbd21, 0xbd31, 0xbd41, 0xbd51, 0xbd61, 0xbd71, 0xbd81, 0xbd91, 0xbda1, 0xbdb1, 0xbdc1, 0xbdd1, 0xbde1, 0xbdf1
    .long 0xffffffff, 0xffffffff, 0xffffffff, 0xffffffff, 0xffffffff, 0xffffffff, 0xffffffff, 0xffffffff, 0xffffffff, 0xffffffff, 0xffffffff, 0xffffffff, 0xffffffff, 0xffffffff, 0xffffffff, 0xffffffff
    .long 0xffffffff, 0xffffffff, 0xffffffff, 0xffffffff, 0xffffffff, 0xffffffff, 0xffffffff, 0xffffffff, 0xffffffff, 0xffffffff, 0xffffffff, 0xffffffff, 0xffffffff, 0xffffffff, 0xffffffff, 0xffffffff
    .long 0xffffffff, 0xffffffff, 0xffffffff, 0xffffffff, 0xffffffff, 0xffffffff, 0xffffffff, 0xffffffff, 0xffffffff, 0xffffffff, 0xffffffff, 0xffffffff, 0xffffffff, 0xffffffff, 0xffffffff, 0xffffffff
    .long 0x1be01, 0xbe11, 0xbe21, 0xbe31, 0xbe41, 0xbe51, 0xbe61, 0xbe71, 0xbe81, 0xbe91, 0xbea1, 0xbeb1, 0xbec1, 0xbed1, 0xbee1, 0xbef1
    .long 0xbf01, 0xbf11, 0xbf21, 0xbf31, 0xbf41, 0xbf51, 0xbf61, 0xbf71, 0xbf81, 0xbf91, 0xbfa1, 0xbfb1, 0xbfc1, 0xbfd1, 0xbfe1, 0xbff1
    .long 0xffffffff, 0xffffffff, 0xffffffff, 0xffffffff, 0xffffffff, 0xffffffff, 0xffffffff, 0xffffffff, 0xffffffff, 0xffffffff, 0xffffffff, 0xffffffff, 0xffffffff, 0xffffffff, 0xffffffff, 0xffffffff
    .long 0xffffffff, 0xffffffff, 0xffffffff, 0xffffffff, 0xffffffff, 0xffffffff, 0xffffffff, 0xffffffff, 0xffffffff, 0xffffffff, 0xffffffff, 0xffffffff, 0xffffffff, 0xffffffff, 0xffffffff, 0xffffffff
    .long 0xffffffff, 0xffffffff, 0xffffffff, 0xffffffff, 0xffffffff, 0xffffffff, 0xffffffff, 0xffffffff, 0xffffffff, 0xffffffff, 0xffffffff, 0xffffffff, 0xffffffff, 0xffffffff, 0xffffffff, 0xffffffff
    .long 0x1c001, 0xc011, 0xc021, 0xc031, 0xc041, 0xc051, 0xc061, 0xc071, 0xc081, 0xc091, 0xc0a1, 0xc0b1, 0xc0c1, 0xc0d1, 0xc0e1, 0xc0f1
    .long 0xc101, 0xc111, 0xc121, 0xc131, 0xc141, 0xc151, 0xc161, 0xc171, 0xc181, 0xc191, 0xc1a1, 0xc1b1, 0xc1c1, 0xc1d1, 0xc1e1, 0xc1f1
    .long 0xffffffff, 0xffffffff, 0xffffffff, 0xffffffff, 0xffffffff, 0xffffffff, 0xffffffff, 0xffffffff, 0xffffffff, 0xffffffff, 0xffffffff, 0xffffffff, 0xffffffff, 0xffffffff, 0xffffffff, 0xffffffff
    .long 0xffffffff, 0xffffffff, 0xffffffff, 0xffffffff, 0xffffffff, 0xffffffff, 0xffffffff, 0xffffffff, 0xffffffff, 0xffffffff, 0xffffffff, 0xffffffff, 0xffffffff, 0xffffffff, 0xffffffff, 0xffffffff
    .long 0xffffffff, 0xffffffff, 0xffffffff, 0xffffffff, 0xffffffff, 0xffffffff, 0xffffffff, 0xffffffff, 0xffffffff, 0xffffffff, 0xffffffff, 0xffffffff, 0xffffffff, 0xffffffff, 0xffffffff, 0xffffffff
    .long 0x1c201, 0xc211, 0xc221, 0xc231, 0xc241, 0xc251, 0xc261, 0xc271, 0xc281, 0xc291, 0xc2a1, 0xc2b1, 0xc2c1, 0xc2d1, 0xc2e1, 0xc2f1
    .long 0xc301, 0xc311, 0xc321, 0xc331, 0xc341, 0xc351, 0xc361, 0xc371, 0xc381, 0xc391, 0xc3a1, 0xc3b1, 0xc3c1, 0xc3d1, 0xc3e1, 0xc3f1
    .long 0xffffffff, 0xffffffff, 0xffffffff, 0xffffffff, 0xffffffff, 0xffffffff, 0xffffffff, 0xffffffff, 0xffffffff, 0xffffffff, 0xffffffff, 0xffffffff, 0xffffffff, 0xffffffff, 0xffffffff, 0xffffffff
    .long 0xffffffff, 0xffffffff, 0xffffffff, 0xffffffff, 0xffffffff, 0xffffffff, 0xffffffff, 0xffffffff, 0xffffffff, 0xffffffff, 0xffffffff, 0xffffffff, 0xffffffff, 0xffffffff, 0xffffffff, 0xffffffff
    .long 0xffffffff, 0xffffffff, 0xffffffff, 0xffffffff, 0xffffffff, 0xffffffff, 0xffffffff, 0xffffffff, 0xffffffff, 0xffffffff, 0xffffffff, 0xffffffff, 0xffffffff, 0xffffffff, 0xffffffff, 0xffffffff
    .long 0x1c401, 0xc411, 0xc421, 0xc431, 0xc441, 0xc451, 0xc461, 0xc471, 0xc481, 0xc491, 0xc4a1, 0xc4b1, 0xc4c1, 0xc4d1, 0xc4e1, 0xc4f1
    .long 0xc501, 0xc511, 0xc521, 0xc531, 0xc541, 0xc551, 0xc561, 0xc571, 0xc581, 0xc591, 0xc5a1, 0xc5b1, 0xc5c1, 0xc5d1, 0xc5e1, 0xc5f1
    .long 0xffffffff, 0xffffffff, 0xffffffff, 0xffffffff, 0xffffffff, 0xffffffff, 0xffffffff, 0xffffffff, 0xffffffff, 0xffffffff, 0xffffffff, 0xffffffff, 0xffffffff, 0xffffffff, 0xffffffff, 0xffffffff
    .long 0xffffffff, 0xffffffff, 0xffffffff, 0xffffffff, 0xffffffff, 0xffffffff, 0xffffffff, 0xffffffff, 0xffffffff, 0xffffffff, 0xffffffff, 0xffffffff, 0xffffffff, 0xffffffff, 0xffffffff, 0xffffffff
    .long 0xffffffff, 0xffffffff, 0xffffffff, 0xffffffff, 0xffffffff, 0xffffffff, 0xffffffff, 0xffffffff, 0xffffffff, 0xffffffff, 0xffffffff, 0xffffffff, 0xffffffff, 0xffffffff, 0xffffffff, 0xffffffff
    .long 0x1c601, 0xc611, 0xc621, 0xc631, 0xc641, 0xc651, 0xc661, 0xc671, 0xc681, 0xc691, 0xc6a1, 0xc6b1, 0xc6c1, 0xc6d1, 0xc6e1, 0xc6f1
    .long 0xc701, 0xc711, 0xc721, 0xc731, 0xc741, 0xc751, 0xc761, 0xc771, 0xc781, 0xc791, 0xc7a1, 0xc7b1, 0xc7c1, 0xc7d1, 0xc7e1, 0xc7f1
    .long 0xffffffff, 0xffffffff, 0xffffffff, 0xffffffff, 0xffffffff, 0xffffffff, 0xffffffff, 0xffffffff, 0xffffffff, 0xffffffff, 0xffffffff, 0xffffffff, 0xffffffff, 0xffffffff, 0xffffffff, 0xffffffff
    .long 0xffffffff, 0xffffffff, 0xffffffff, 0xffffffff, 0xffffffff, 0xffffffff, 0xffffffff, 0xffffffff, 0xffffffff, 0xffffffff, 0xffffffff, 0xffffffff, 0xffffffff, 0xffffffff, 0xffffffff, 0xffffffff
    .long 0xffffffff, 0xffffffff, 0xffffffff, 0xffffffff, 0xffffffff, 0xffffffff, 0xffffffff, 0xffffffff, 0xffffffff, 0xffffffff, 0xffffffff, 0xffffffff, 0xffffffff, 0xffffffff, 0xffffffff, 0xffffffff
    .long 0x1c801, 0xc811, 0xc821, 0xc831, 0xc841, 0xc851, 0xc861, 0xc871, 0xc881, 0xc891, 0xc8a1, 0xc8b1, 0xc8c1, 0xc8d1, 0xc8e1, 0xc8f1
    .long 0xc901, 0xc911, 0xc921, 0xc931, 0xc941, 0xc951, 0xc961, 0xc971, 0xc981, 0xc991, 0xc9a1, 0xc9b1, 0xc9c1, 0xc9d1, 0xc9e1, 0xc9f1
    .long 0xffffffff, 0xffffffff, 0xffffffff, 0xffffffff, 0xffffffff, 0xffffffff, 0xffffffff, 0xffffffff, 0xffffffff, 0xffffffff, 0xffffffff, 0xffffffff, 0xffffffff, 0xffffffff, 0xffffffff, 0xffffffff
    .long 0xffffffff, 0xffffffff, 0xffffffff, 0xffffffff, 0xffffffff, 0xffffffff, 0xffffffff, 0xffffffff, 0xffffffff, 0xffffffff, 0xffffffff, 0xffffffff, 0xffffffff, 0xffffffff, 0xffffffff, 0xffffffff
    .long 0xffffffff, 0xffffffff, 0xffffffff, 0xffffffff, 0xffffffff, 0xffffffff, 0xffffffff, 0xffffffff, 0xffffffff, 0xffffffff, 0xffffffff, 0xffffffff, 0xffffffff, 0xffffffff, 0xffffffff, 0xffffffff
    .long 0x1ca01, 0xca11, 0xca21, 0xca31, 0xca41, 0xca51, 0xca61, 0xca71, 0xca81, 0xca91, 0xcaa1, 0xcab1, 0xcac1, 0xcad1, 0xcae1, 0xcaf1
    .long 0xcb01, 0xcb11, 0xcb21, 0xcb31, 0xcb41, 0xcb51, 0xcb61, 0xcb71, 0xcb81, 0xcb91, 0xcba1, 0xcbb1, 0xcbc1, 0xcbd1, 0xcbe1, 0xcbf1
    .long 0xffffffff, 0xffffffff, 0xffffffff, 0xffffffff, 0xffffffff, 0xffffffff, 0xffffffff, 0xffffffff, 0xffffffff, 0xffffffff, 0xffffffff, 0xffffffff, 0xffffffff, 0xffffffff, 0xffffffff, 0xffffffff
    .long 0xffffffff, 0xffffffff, 0xffffffff, 0xffffffff, 0xffffffff, 0xffffffff, 0xffffffff, 0xffffffff, 0xffffffff, 0xffffffff, 0xffffffff, 0xffffffff, 0xffffffff, 0xffffffff, 0xffffffff, 0xffffffff
    .long 0xffffffff, 0xffffffff, 0xffffffff, 0xffffffff, 0xffffffff, 0xffffffff, 0xffffffff, 0xffffffff, 0xffffffff, 0xffffffff, 0xffffffff, 0xffffffff, 0xffffffff, 0xffffffff, 0xffffffff, 0xffffffff
    .long 0x1cc01, 0xcc11, 0xcc21, 0xcc31, 0xcc41, 0xcc51, 0xcc61, 0xcc71, 0xcc81, 0xcc91, 0xcca1, 0xccb1, 0xccc1, 0xccd1, 0xcce1, 0xccf1
    .long 0xcd01, 0xcd11, 0xcd21, 0xcd31, 0xcd41, 0xcd51, 0xcd61, 0xcd71, 0xcd81, 0xcd91, 0xcda1, 0xcdb1, 0xcdc1, 0xcdd1, 0xcde1, 0xcdf1
    .long 0xffffffff, 0xffffffff, 0xffffffff, 0xffffffff, 0xffffffff, 0xffffffff, 0xffffffff, 0xffffffff, 0xffffffff, 0xffffffff, 0xffffffff, 0xffffffff, 0xffffffff, 0xffffffff, 0xffffffff, 0xffffffff
    .long 0xffffffff, 0xffffffff, 0xffffffff, 0xffffffff, 0xffffffff, 0xffffffff, 0xffffffff, 0xffffffff, 0xffffffff, 0xffffffff, 0xffffffff, 0xffffffff, 0xffffffff, 0xffffffff, 0xffffffff, 0xffffffff
    .long 0xffffffff, 0xffffffff, 0xffffffff, 0xffffffff, 0xffffffff, 0xffffffff, 0xffffffff, 0xffffffff, 0xffffffff, 0xffffffff, 0xffffffff, 0xffffffff, 0xffffffff, 0xffffffff, 0xffffffff, 0xffffffff
    .long 0x1ce01, 0xce11, 0xce21, 0xce31, 0xce41, 0xce51, 0xce61, 0xce71, 0xce81, 0xce91, 0xcea1, 0xceb1, 0xcec1, 0xced1, 0xcee1, 0xcef1
    .long 0xcf01, 0xcf11, 0xcf21, 0xcf31, 0xcf41, 0xcf51, 0xcf61, 0xcf71, 0xcf81, 0xcf91, 0xcfa1, 0xcfb1, 0xcfc1, 0xcfd1, 0xcfe1, 0xcff1
    .long 0xffffffff, 0xffffffff, 0xffffffff, 0xffffffff, 0xffffffff, 0xffffffff, 0xffffffff, 0xffffffff, 0xffffffff, 0xffffffff, 0xffffffff, 0xffffffff, 0xffffffff, 0xffffffff, 0xffffffff, 0xffffffff
    .long 0xffffffff, 0xffffffff, 0xffffffff, 0xffffffff, 0xffffffff, 0xffffffff, 0xffffffff, 0xffffffff, 0xffffffff, 0xffffffff, 0xffffffff, 0xffffffff, 0xffffffff, 0xffffffff, 0xffffffff, 0xffffffff
    .long 0xffffffff, 0xffffffff, 0xffffffff, 0xffffffff, 0xffffffff, 0xffffffff, 0xffffffff, 0xffffffff, 0xffffffff, 0xffffffff, 0xffffffff, 0xffffffff, 0xffffffff, 0xffffffff, 0xffffffff, 0xffffffff
    .long 0x1d001, 0xd011, 0xd021, 0xd031, 0xd041, 0xd051, 0xd061, 0xd071, 0xd081, 0xd091, 0xd0a1, 0xd0b1, 0xd0c1, 0xd0d1, 0xd0e1, 0xd0f1
    .long 0xd101, 0xd111, 0xd121, 0xd131, 0xd141, 0xd151, 0xd161, 0xd171, 0xd181, 0xd191, 0xd1a1, 0xd1b1, 0xd1c1, 0xd1d1, 0xd1e1, 0xd1f1
    .long 0xffffffff, 0xffffffff, 0xffffffff, 0xffffffff, 0xffffffff, 0xffffffff, 0xffffffff, 0xffffffff, 0xffffffff, 0xffffffff, 0xffffffff, 0xffffffff, 0xffffffff, 0xffffffff, 0xffffffff, 0xffffffff
    .long 0xffffffff, 0xffffffff, 0xffffffff, 0xffffffff, 0xffffffff, 0xffffffff, 0xffffffff, 0xffffffff, 0xffffffff, 0xffffffff, 0xffffffff, 0xffffffff, 0xffffffff, 0xffffffff, 0xffffffff, 0xffffffff
    .long 0xffffffff, 0xffffffff, 0xffffffff, 0xffffffff, 0xffffffff, 0xffffffff, 0xffffffff, 0xffffffff, 0xffffffff, 0xffffffff, 0xffffffff, 0xffffffff, 0xffffffff, 0xffffffff, 0xffffffff, 0xffffffff
    .long 0x1d201, 0xd211, 0xd221, 0xd231, 0xd241, 0xd251, 0xd261, 0xd271, 0xd281, 0xd291, 0xd2a1, 0xd2b1, 0xd2c1, 0xd2d1, 0xd2e1, 0xd2f1
    .long 0xd301, 0xd311, 0xd321, 0xd331, 0xd341, 0xd351, 0xd361, 0xd371, 0xd381, 0xd391, 0xd3a1, 0xd3b1, 0xd3c1, 0xd3d1, 0xd3e1, 0xd3f1
    .long 0xffffffff, 0xffffffff, 0xffffffff, 0xffffffff, 0xffffffff, 0xffffffff, 0xffffffff, 0xffffffff, 0xffffffff, 0xffffffff, 0xffffffff, 0xffffffff, 0xffffffff, 0xffffffff, 0xffffffff, 0xffffffff
    .long 0xffffffff, 0xffffffff, 0xffffffff, 0xffffffff, 0xffffffff, 0xffffffff, 0xffffffff, 0xffffffff, 0xffffffff, 0xffffffff, 0xffffffff, 0xffffffff, 0xffffffff, 0xffffffff, 0xffffffff, 0xffffffff
    .long 0xffffffff, 0xffffffff, 0xffffffff, 0xffffffff, 0xffffffff, 0xffffffff, 0xffffffff, 0xffffffff, 0xffffffff, 0xffffffff, 0xffffffff, 0xffffffff, 0xffffffff, 0xffffffff, 0xffffffff, 0xffffffff
    .long 0x1d401, 0xd411, 0xd421, 0xd431, 0xd441, 0xd451, 0xd461, 0xd471, 0xd481, 0xd491, 0xd4a1, 0xd4b1, 0xd4c1, 0xd4d1, 0xd4e1, 0xd4f1
    .long 0xd501, 0xd511, 0xd521, 0xd531, 0xd541, 0xd551, 0xd561, 0xd571, 0xd581, 0xd591, 0xd5a1, 0xd5b1, 0xd5c1, 0xd5d1, 0xd5e1, 0xd5f1
    .long 0xffffffff, 0xffffffff, 0xffffffff, 0xffffffff, 0xffffffff, 0xffffffff, 0xffffffff, 0xffffffff, 0xffffffff, 0xffffffff, 0xffffffff, 0xffffffff, 0xffffffff, 0xffffffff, 0xffffffff, 0xffffffff
    .long 0xffffffff, 0xffffffff, 0xffffffff, 0xffffffff, 0xffffffff, 0xffffffff, 0xffffffff, 0xffffffff, 0xffffffff, 0xffffffff, 0xffffffff, 0xffffffff, 0xffffffff, 0xffffffff, 0xffffffff, 0xffffffff
    .long 0xffffffff, 0xffffffff, 0xffffffff, 0xffffffff, 0xffffffff, 0xffffffff, 0xffffffff, 0xffffffff, 0xffffffff, 0xffffffff, 0xffffffff, 0xffffffff, 0xffffffff, 0xffffffff, 0xffffffff, 0xffffffff
    .long 0x1d601, 0xd611, 0xd621, 0xd631, 0xd641, 0xd651, 0xd661, 0xd671, 0xd681, 0xd691, 0xd6a1, 0xd6b1, 0xd6c1, 0xd6d1, 0xd6e1, 0xd6f1
    .long 0xd701, 0xd711, 0xd721, 0xd731, 0xd741, 0xd751, 0xd761, 0xd771, 0xd781, 0xd791, 0xd7a1, 0xd7b1, 0xd7c1, 0xd7d1, 0xd7e1, 0xd7f1
    .long 0xffffffff, 0xffffffff, 0xffffffff, 0xffffffff, 0xffffffff, 0xffffffff, 0xffffffff, 0xffffffff, 0xffffffff, 0xffffffff, 0xffffffff, 0xffffffff, 0xffffffff, 0xffffffff, 0xffffffff, 0xffffffff
    .long 0xffffffff, 0xffffffff, 0xffffffff, 0xffffffff, 0xffffffff, 0xffffffff, 0xffffffff, 0xffffffff, 0xffffffff, 0xffffffff, 0xffffffff, 0xffffffff, 0xffffffff, 0xffffffff, 0xffffffff, 0xffffffff
    .long 0xffffffff, 0xffffffff, 0xffffffff, 0xffffffff, 0xffffffff, 0xffffffff, 0xffffffff, 0xffffffff, 0xffffffff, 0xffffffff, 0xffffffff, 0xffffffff, 0xffffffff, 0xffffffff, 0xffffffff, 0xffffffff
    .long 0x1d801, 0xd811, 0xd821, 0xd831, 0xd841, 0xd851, 0xd861, 0xd871, 0xd881, 0xd891, 0xd8a1, 0xd8b1, 0xd8c1, 0xd8d1, 0xd8e1, 0xd8f1
    .long 0xd901, 0xd911, 0xd921, 0xd931, 0xd941, 0xd951, 0xd961, 0xd971, 0xd981, 0xd991, 0xd9a1, 0xd9b1, 0xd9c1, 0xd9d1, 0xd9e1, 0xd9f1
    .long 0xffffffff, 0xffffffff, 0xffffffff, 0xffffffff, 0xffffffff, 0xffffffff, 0xffffffff, 0xffffffff, 0xffffffff, 0xffffffff, 0xffffffff, 0xffffffff, 0xffffffff, 0xffffffff, 0xffffffff, 0xffffffff
    .long 0xffffffff, 0xffffffff, 0xffffffff, 0xffffffff, 0xffffffff, 0xffffffff, 0xffffffff, 0xffffffff, 0xffffffff, 0xffffffff, 0xffffffff, 0xffffffff, 0xffffffff, 0xffffffff, 0xffffffff, 0xffffffff
    .long 0xffffffff, 0xffffffff, 0xffffffff, 0xffffffff, 0xffffffff, 0xffffffff, 0xffffffff, 0xffffffff, 0xffffffff, 0xffffffff, 0xffffffff, 0xffffffff, 0xffffffff, 0xffffffff, 0xffffffff, 0xffffffff
    .long 0x1da01, 0xda11, 0xda21, 0xda31, 0xda41, 0xda51, 0xda61, 0xda71, 0xda81, 0xda91, 0xdaa1, 0xdab1, 0xdac1, 0xdad1, 0xdae1, 0xdaf1
    .long 0xdb01, 0xdb11, 0xdb21, 0xdb31, 0xdb41, 0xdb51, 0xdb61, 0xdb71, 0xdb81, 0xdb91, 0xdba1, 0xdbb1, 0xdbc1, 0xdbd1, 0xdbe1, 0xdbf1
    .long 0xffffffff, 0xffffffff, 0xffffffff, 0xffffffff, 0xffffffff, 0xffffffff, 0xffffffff, 0xffffffff, 0xffffffff, 0xffffffff, 0xffffffff, 0xffffffff, 0xffffffff, 0xffffffff, 0xffffffff, 0xffffffff
    .long 0xffffffff, 0xffffffff, 0xffffffff, 0xffffffff, 0xffffffff, 0xffffffff, 0xffffffff, 0xffffffff, 0xffffffff, 0xffffffff, 0xffffffff, 0xffffffff, 0xffffffff, 0xffffffff, 0xffffffff, 0xffffffff
    .long 0xffffffff, 0xffffffff, 0xffffffff, 0xffffffff, 0xffffffff, 0xffffffff, 0xffffffff, 0xffffffff, 0xffffffff, 0xffffffff, 0xffffffff, 0xffffffff, 0xffffffff, 0xffffffff, 0xffffffff, 0xffffffff
    .long 0x1dc01, 0xdc11, 0xdc21, 0xdc31, 0xdc41, 0xdc51, 0xdc61, 0xdc71, 0xdc81, 0xdc91, 0xdca1, 0xdcb1, 0xdcc1, 0xdcd1, 0xdce1, 0xdcf1
    .long 0xdd01, 0xdd11, 0xdd21, 0xdd31, 0xdd41, 0xdd51, 0xdd61, 0xdd71, 0xdd81, 0xdd91, 0xdda1, 0xddb1, 0xddc1, 0xddd1, 0xdde1, 0xddf1
    .long 0xffffffff, 0xffffffff, 0xffffffff, 0xffffffff, 0xffffffff, 0xffffffff, 0xffffffff, 0xffffffff, 0xffffffff, 0xffffffff, 0xffffffff, 0xffffffff, 0xffffffff, 0xffffffff, 0xffffffff, 0xffffffff
    .long 0xffffffff, 0xffffffff, 0xffffffff, 0xffffffff, 0xffffffff, 0xffffffff, 0xffffffff, 0xffffffff, 0xffffffff, 0xffffffff, 0xffffffff, 0xffffffff, 0xffffffff, 0xffffffff, 0xffffffff, 0xffffffff
    .long 0xffffffff, 0xffffffff, 0xffffffff, 0xffffffff, 0xffffffff, 0xffffffff, 0xffffffff, 0xffffffff, 0xffffffff, 0xffffffff, 0xffffffff, 0xffffffff, 0xffffffff, 0xffffffff, 0xffffffff, 0xffffffff
    .long 0x1de01, 0xde11, 0xde21, 0xde31, 0xde41, 0xde51, 0xde61, 0xde71, 0xde81, 0xde91, 0xdea1, 0xdeb1, 0xdec1, 0xded1, 0xdee1, 0xdef1
    .long 0xdf01, 0xdf11, 0xdf21, 0xdf31, 0xdf41, 0xdf51, 0xdf61, 0xdf71, 0xdf81, 0xdf91, 0xdfa1, 0xdfb1, 0xdfc1, 0xdfd1, 0xdfe1, 0xdff1
    .long 0xffffffff, 0xffffffff, 0xffffffff, 0xffffffff, 0xffffffff, 0xffffffff, 0xffffffff, 0xffffffff, 0xffffffff, 0xffffffff, 0xffffffff, 0xffffffff, 0xffffffff, 0xffffffff, 0xffffffff, 0xffffffff
    .long 0xffffffff, 0xffffffff, 0xffffffff, 0xffffffff, 0xffffffff, 0xffffffff, 0xffffffff, 0xffffffff, 0xffffffff, 0xffffffff, 0xffffffff, 0xffffffff, 0xffffffff, 0xffffffff, 0xffffffff, 0xffffffff
    .long 0xffffffff, 0xffffffff, 0xffffffff, 0xffffffff, 0xffffffff, 0xffffffff, 0xffffffff, 0xffffffff, 0xffffffff, 0xffffffff, 0xffffffff, 0xffffffff, 0xffffffff, 0xffffffff, 0xffffffff, 0xffffffff
    .long 0x10003, 0x13, 0x23, 0x33, 0x43, 0x53, 0x63, 0x73, 0x83, 0x93, 0xa3, 0xb3, 0xc3, 0xd3, 0xe3, 0xf3
    .long 0x103, 0x113, 0x123, 0x133, 0x143, 0x153, 0x163, 0x173, 0x183, 0x193, 0x1a3, 0x1b3, 0x1c3, 0x1d3, 0x1e3, 0x1f3
    .long 0x81d3, 0x81f3, 0xffffffff, 0xffffffff, 0xffffffff, 0xffffffff, 0xffffffff, 0xffffffff, 0xffffffff, 0xffffffff, 0xffffffff, 0xffffffff, 0xffffffff, 0xffffffff, 0xffffffff, 0xffffffff
    .long 0xffffffff, 0xffffffff, 0xffffffff, 0xffffffff, 0xffffffff, 0xffffffff, 0xffffffff, 0xffffffff, 0xffffffff, 0xffffffff, 0xffffffff, 0xffffffff, 0xffffffff, 0xffffffff, 0xffffffff, 0xffffffff
    .long 0xffffffff, 0xffffffff, 0xffffffff, 0xffffffff, 0xffffffff, 0xffffffff, 0xffffffff, 0xffffffff, 0xffffffff, 0xffffffff, 0xffffffff, 0xffffffff, 0xffffffff, 0xffffffff, 0xffffffff, 0xffffffff
    .long 0x10203, 0x213, 0x223, 0x233, 0x243, 0x253, 0x263, 0x273, 0x283, 0x293, 0x2a3, 0x2b3, 0x2c3, 0x2d3, 0x2e3, 0x2f3
    .long 0x303, 0x313, 0x323, 0x333, 0x343, 0x353, 0x363, 0x373, 0x383, 0x393, 0x3a3, 0x3b3, 0x3c3, 0x3d3, 0x3e3, 0x3f3
    .long 0x83d3, 0x83f3, 0xffffffff, 0xffffffff, 0xffffffff, 0xffffffff, 0xffffffff, 0xffffffff, 0xffffffff, 0xffffffff, 0xffffffff, 0xffffffff, 0xffffffff, 0xffffffff, 0xffffffff, 0xffffffff
    .long 0xffffffff, 0xffffffff, 0xffffffff, 0xffffffff, 0xffffffff, 0xffffffff, 0xffffffff, 0xffffffff, 0xffffffff, 0xffffffff, 0xffffffff, 0xffffffff, 0xffffffff, 0xffffffff, 0xffffffff, 0xffffffff
    .long 0xffffffff, 0xffffffff, 0xffffffff, 0xffffffff, 0xffffffff, 0xffffffff, 0xffffffff, 0xffffffff, 0xffffffff, 0xffffffff, 0xffffffff, 0xffffffff, 0xffffffff, 0xffffffff, 0xffffffff, 0xffffffff
    .long 0x10403, 0x413, 0x423, 0x433, 0x443, 0x453, 0x463, 0x473, 0x483, 0x493, 0x4a3, 0x4b3, 0x4c3, 0x4d3, 0x4e3, 0x4f3
    .long 0x503, 0x513, 0x523, 0x533, 0x543, 0x553, 0x563, 0x573, 0x583, 0x593, 0x5a3, 0x5b3, 0x5c3, 0x5d3, 0x5e3, 0x5f3
    .long 0x85d3, 0x85f3, 0xffffffff, 0xffffffff, 0xffffffff, 0xffffffff, 0xffffffff, 0xffffffff, 0xffffffff, 0xffffffff, 0xffffffff, 0xffffffff, 0xffffffff, 0xffffffff, 0xffffffff, 0xffffffff
    .long 0xffffffff, 0xffffffff, 0xffffffff, 0xffffffff, 0xffffffff, 0xffffffff, 0xffffffff, 0xffffffff, 0xffffffff, 0xffffffff, 0xffffffff, 0xffffffff, 0xffffffff, 0xffffffff, 0xffffffff, 0xffffffff
    .long 0xffffffff, 0xffffffff, 0xffffffff, 0xffffffff, 0xffffffff, 0xffffffff, 0xffffffff, 0xffffffff, 0xffffffff, 0xffffffff, 0xffffffff, 0xffffffff, 0xffffffff, 0xffffffff, 0xffffffff, 0xffffffff
    .long 0x10603, 0x613, 0x623, 0x633, 0x643, 0x653, 0x663, 0x673, 0x683, 0x693, 0x6a3, 0x6b3, 0x6c3, 0x6d3, 0x6e3, 0x6f3
    .long 0x703, 0x713, 0x723, 0x733, 0x743, 0x753, 0x763, 0x773, 0x783, 0x793, 0x7a3, 0x7b3, 0x7c3, 0x7d3, 0x7e3, 0x7f3
    .long 0x87d3, 0x87f3, 0xffffffff, 0xffffffff, 0xffffffff, 0xffffffff, 0xffffffff, 0xffffffff, 0xffffffff, 0xffffffff, 0xffffffff, 0xffffffff, 0xffffffff, 0xffffffff, 0xffffffff, 0xffffffff
    .long 0xffffffff, 0xffffffff, 0xffffffff, 0xffffffff, 0xffffffff, 0xffffffff, 0xffffffff, 0xffffffff, 0xffffffff, 0xffffffff, 0xffffffff, 0xffffffff, 0xffffffff, 0xffffffff, 0xffffffff, 0xffffffff
    .long 0xffffffff, 0xffffffff, 0xffffffff, 0xffffffff, 0xffffffff, 0xffffffff, 0xffffffff, 0xffffffff, 0xffffffff, 0xffffffff, 0xffffffff, 0xffffffff, 0xffffffff, 0xffffffff, 0xffffffff, 0xffffffff
    .long 0x10803, 0x813, 0x823, 0x833, 0x843, 0x853, 0x863, 0x873, 0x883, 0x893, 0x8a3, 0x8b3, 0x8c3, 0x8d3, 0x8e3, 0x8f3
    .long 0x903, 0x913, 0x923, 0x933, 0x943, 0x953, 0x963, 0x973, 0x983, 0x993, 0x9a3, 0x9b3, 0x9c3, 0x9d3, 0x9e3, 0x9f3
    .long 0x89d3, 0x89f3, 0xffffffff, 0xffffffff, 0xffffffff, 0xffffffff, 0xffffffff, 0xffffffff, 0xffffffff, 0xffffffff, 0xffffffff, 0xffffffff, 0xffffffff, 0xffffffff, 0xffffffff, 0xffffffff
    .long 0xffffffff, 0xffffffff, 0xffffffff, 0xffffffff, 0xffffffff, 0xffffffff, 0xffffffff, 0xffffffff, 0xffffffff, 0xffffffff, 0xffffffff, 0xffffffff, 0xffffffff, 0xffffffff, 0xffffffff, 0xffffffff
    .long 0xffffffff, 0xffffffff, 0xffffffff, 0xffffffff, 0xffffffff, 0xffffffff, 0xffffffff, 0xffffffff, 0xffffffff, 0xffffffff, 0xffffffff, 0xffffffff, 0xffffffff, 0xffffffff, 0xffffffff, 0xffffffff
    .long 0x10a03, 0xa13, 0xa23, 0xa33, 0xa43, 0xa53, 0xa63, 0xa73, 0xa83, 0xa93, 0xaa3, 0xab3, 0xac3, 0xad3, 0xae3, 0xaf3
    .long 0xb03, 0xb13, 0xb23, 0xb33, 0xb43, 0xb53, 0xb63, 0xb73, 0xb83, 0xb93, 0xba3, 0xbb3, 0xbc3, 0xbd3, 0xbe3, 0xbf3
    .long 0x8bd3, 0x8bf3, 0xffffffff, 0xffffffff, 0xffffffff, 0xffffffff, 0xffffffff, 0xffffffff, 0xffffffff, 0xffffffff, 0xffffffff, 0xffffffff, 0xffffffff, 0xffffffff, 0xffffffff, 0xffffffff
    .long 0xffffffff, 0xffffffff, 0xffffffff, 0xffffffff, 0xffffffff, 0xffffffff, 0xffffffff, 0xffffffff, 0xffffffff, 0xffffffff, 0xffffffff, 0xffffffff, 0xffffffff, 0xffffffff, 0xffffffff, 0xffffffff
    .long 0xffffffff, 0xffffffff, 0xffffffff, 0xffffffff, 0xffffffff, 0xffffffff, 0xffffffff, 0xffffffff, 0xffffffff, 0xffffffff, 0xffffffff, 0xffffffff, 0xffffffff, 0xffffffff, 0xffffffff, 0xffffffff
    .long 0x10c03, 0xc13, 0xc23, 0xc33, 0xc43, 0xc53, 0xc63, 0xc73, 0xc83, 0xc93, 0xca3, 0xcb3, 0xcc3, 0xcd3, 0xce3, 0xcf3
    .long 0xd03, 0xd13, 0xd23, 0xd33, 0xd43, 0xd53, 0xd63, 0xd73, 0xd83, 0xd93, 0xda3, 0xdb3, 0xdc3, 0xdd3, 0xde3, 0xdf3
    .long 0x8dd3, 0x8df3, 0xffffffff, 0xffffffff, 0xffffffff, 0xffffffff, 0xffffffff, 0xffffffff, 0xffffffff, 0xffffffff, 0xffffffff, 0xffffffff, 0xffffffff, 0xffffffff, 0xffffffff, 0xffffffff
    .long 0xffffffff, 0xffffffff, 0xffffffff, 0xffffffff, 0xffffffff, 0xffffffff, 0xffffffff, 0xffffffff, 0xffffffff, 0xffffffff, 0xffffffff, 0xffffffff, 0xffffffff, 0xffffffff, 0xffffffff, 0xffffffff
    .long 0xffffffff, 0xffffffff, 0xffffffff, 0xffffffff, 0xffffffff, 0xffffffff, 0xffffffff, 0xffffffff, 0xffffffff, 0xffffffff, 0xffffffff, 0xffffffff, 0xffffffff, 0xffffffff, 0xffffffff, 0xffffffff
    .long 0x10e03, 0xe13, 0xe23, 0xe33, 0xe43, 0xe53, 0xe63, 0xe73, 0xe83, 0xe93, 0xea3, 0xeb3, 0xec3, 0xed3, 0xee3, 0xef3
    .long 0xf03, 0xf13, 0xf23, 0xf33, 0xf43, 0xf53, 0xf63, 0xf73, 0xf83, 0xf93, 0xfa3, 0xfb3, 0xfc3, 0xfd3, 0xfe3, 0xff3
    .long 0x8fd3, 0x8ff3, 0xffffffff, 0xffffffff, 0xffffffff, 0xffffffff, 0xffffffff, 0xffffffff, 0xffffffff, 0xffffffff, 0xffffffff, 0xffffffff, 0xffffffff, 0xffffffff, 0xffffffff, 0xffffffff
    .long 0xffffffff, 0xffffffff, 0xffffffff, 0xffffffff, 0xffffffff, 0xffffffff, 0xffffffff, 0xffffffff, 0xffffffff, 0xffffffff, 0xffffffff, 0xffffffff, 0xffffffff, 0xffffffff, 0xffffffff, 0xffffffff
    .long 0xffffffff, 0xffffffff, 0xffffffff, 0xffffffff, 0xffffffff, 0xffffffff, 0xffffffff, 0xffffffff, 0xffffffff, 0xffffffff, 0xffffffff, 0xffffffff, 0xffffffff, 0xffffffff, 0xffffffff, 0xffffffff
    .long 0x11003, 0x1013, 0x1023, 0x1033, 0x1043, 0x1053, 0x1063, 0x1073, 0x1083, 0x1093, 0x10a3, 0x10b3, 0x10c3, 0x10d3, 0x10e3, 0x10f3
    .long 0x1103, 0x1113, 0x1123, 0x1133, 0x1143, 0x1153, 0x1163, 0x1173, 0x1183, 0x1193, 0x11a3, 0x11b3, 0x11c3, 0x11d3, 0x11e3, 0x11f3
    .long 0x91d3, 0x91f3, 0xffffffff, 0xffffffff, 0xffffffff, 0xffffffff, 0xffffffff, 0xffffffff, 0xffffffff, 0xffffffff, 0xffffffff, 0xffffffff, 0xffffffff, 0xffffffff, 0xffffffff, 0xffffffff
    .long 0xffffffff, 0xffffffff, 0xffffffff, 0xffffffff, 0xffffffff, 0xffffffff, 0xffffffff, 0xffffffff, 0xffffffff, 0xffffffff, 0xffffffff, 0xffffffff, 0xffffffff, 0xffffffff, 0xffffffff, 0xffffffff
    .long 0xffffffff, 0xffffffff, 0xffffffff, 0xffffffff, 0xffffffff, 0xffffffff, 0xffffffff, 0xffffffff, 0xffffffff, 0xffffffff, 0xffffffff, 0xffffffff, 0xffffffff, 0xffffffff, 0xffffffff, 0xffffffff
    .long 0x11203, 0x1213, 0x1223, 0x1233, 0x1243, 0x1253, 0x1263, 0x1273, 0x1283, 0x1293, 0x12a3, 0x12b3, 0x12c3, 0x12d3, 0x12e3, 0x12f3
    .long 0x1303, 0x1313, 0x1323, 0x1333, 0x1343, 0x1353, 0x1363, 0x1373, 0x1383, 0x1393, 0x13a3, 0x13b3, 0x13c3, 0x13d3, 0x13e3, 0x13f3
    .long 0x93d3, 0x93f3, 0xffffffff, 0xffffffff, 0xffffffff, 0xffffffff, 0xffffffff, 0xffffffff, 0xffffffff, 0xffffffff, 0xffffffff, 0xffffffff, 0xffffffff, 0xffffffff, 0xffffffff, 0xffffffff
    .long 0xffffffff, 0xffffffff, 0xffffffff, 0xffffffff, 0xffffffff, 0xffffffff, 0xffffffff, 0xffffffff, 0xffffffff, 0xffffffff, 0xffffffff, 0xffffffff, 0xffffffff, 0xffffffff, 0xffffffff, 0xffffffff
    .long 0xffffffff, 0xffffffff, 0xffffffff, 0xffffffff, 0xffffffff, 0xffffffff, 0xffffffff, 0xffffffff, 0xffffffff, 0xffffffff, 0xffffffff, 0xffffffff, 0xffffffff, 0xffffffff, 0xffffffff, 0xffffffff
    .long 0x11403, 0x1413, 0x1423, 0x1433, 0x1443, 0x1453, 0x1463, 0x1473, 0x1483, 0x1493, 0x14a3, 0x14b3, 0x14c3, 0x14d3, 0x14e3, 0x14f3
    .long 0x1503, 0x1513, 0x1523, 0x1533, 0x1543, 0x1553, 0x1563, 0x1573, 0x1583, 0x1593, 0x15a3, 0x15b3, 0x15c3, 0x15d3, 0x15e3, 0x15f3
    .long 0x95d3, 0x95f3, 0xffffffff, 0xffffffff, 0xffffffff, 0xffffffff, 0xffffffff, 0xffffffff, 0xffffffff, 0xffffffff, 0xffffffff, 0xffffffff, 0xffffffff, 0xffffffff, 0xffffffff, 0xffffffff
    .long 0xffffffff, 0xffffffff, 0xffffffff, 0xffffffff, 0xffffffff, 0xffffffff, 0xffffffff, 0xffffffff, 0xffffffff, 0xffffffff, 0xffffffff, 0xffffffff, 0xffffffff, 0xffffffff, 0xffffffff, 0xffffffff
    .long 0xffffffff, 0xffffffff, 0xffffffff, 0xffffffff, 0xffffffff, 0xffffffff, 0xffffffff, 0xffffffff, 0xffffffff, 0xffffffff, 0xffffffff, 0xffffffff, 0xffffffff, 0xffffffff, 0xffffffff, 0xffffffff
    .long 0x11603, 0x1613, 0x1623, 0x1633, 0x1643, 0x1653, 0x1663, 0x1673, 0x1683, 0x1693, 0x16a3, 0x16b3, 0x16c3, 0x16d3, 0x16e3, 0x16f3
    .long 0x1703, 0x1713, 0x1723, 0x1733, 0x1743, 0x1753, 0x1763, 0x1773, 0x1783, 0x1793, 0x17a3, 0x17b3, 0x17c3, 0x17d3, 0x17e3, 0x17f3
    .long 0x97d3, 0x97f3, 0xffffffff, 0xffffffff, 0xffffffff, 0xffffffff, 0xffffffff, 0xffffffff, 0xffffffff, 0xffffffff, 0xffffffff, 0xffffffff, 0xffffffff, 0xffffffff, 0xffffffff, 0xffffffff
    .long 0xffffffff, 0xffffffff, 0xffffffff, 0xffffffff, 0xffffffff, 0xffffffff, 0xffffffff, 0xffffffff, 0xffffffff, 0xffffffff, 0xffffffff, 0xffffffff, 0xffffffff, 0xffffffff, 0xffffffff, 0xffffffff
    .long 0xffffffff, 0xffffffff, 0xffffffff, 0xffffffff, 0xffffffff, 0xffffffff, 0xffffffff, 0xffffffff, 0xffffffff, 0xffffffff, 0xffffffff, 0xffffffff, 0xffffffff, 0xffffffff, 0xffffffff, 0xffffffff
    .long 0x11803, 0x1813, 0x1823, 0x1833, 0x1843, 0x1853, 0x1863, 0x1873, 0x1883, 0x1893, 0x18a3, 0x18b3, 0x18c3, 0x18d3, 0x18e3, 0x18f3
    .long 0x1903, 0x1913, 0x1923, 0x1933, 0x1943, 0x1953, 0x1963, 0x1973, 0x1983, 0x1993, 0x19a3, 0x19b3, 0x19c3, 0x19d3, 0x19e3, 0x19f3
    .long 0x99d3, 0x99f3, 0xffffffff, 0xffffffff, 0xffffffff, 0xffffffff, 0xffffffff, 0xffffffff, 0xffffffff, 0xffffffff, 0xffffffff, 0xffffffff, 0xffffffff, 0xffffffff, 0xffffffff, 0xffffffff
    .long 0xffffffff, 0xffffffff, 0xffffffff, 0xffffffff, 0xffffffff, 0xffffffff, 0xffffffff, 0xffffffff, 0xffffffff, 0xffffffff, 0xffffffff, 0xffffffff, 0xffffffff, 0xffffffff, 0xffffffff, 0xffffffff
    .long 0xffffffff, 0xffffffff, 0xffffffff, 0xffffffff, 0xffffffff, 0xffffffff, 0xffffffff, 0xffffffff, 0xffffffff, 0xffffffff, 0xffffffff, 0xffffffff, 0xffffffff, 0xffffffff, 0xffffffff, 0xffffffff
    .long 0x11a03, 0x1a13, 0x1a23, 0x1a33, 0x1a43, 0x1a53, 0x1a63, 0x1a73, 0x1a83, 0x1a93, 0x1aa3, 0x1ab3, 0x1ac3, 0x1ad3, 0x1ae3, 0x1af3
    .long 0x1b03, 0x1b13, 0x1b23, 0x1b33, 0x1b43, 0x1b53, 0x1b63, 0x1b73, 0x1b83, 0x1b93, 0x1ba3, 0x1bb3, 0x1bc3, 0x1bd3, 0x1be3, 0x1bf3
    .long 0x9bd3, 0x9bf3, 0xffffffff, 0xffffffff, 0xffffffff, 0xffffffff, 0xffffffff, 0xffffffff, 0xffffffff, 0xffffffff, 0xffffffff, 0xffffffff, 0xffffffff, 0xffffffff, 0xffffffff, 0xffffffff
    .long 0xffffffff, 0xffffffff, 0xffffffff, 0xffffffff, 0xffffffff, 0xffffffff, 0xffffffff, 0xffffffff, 0xffffffff, 0xffffffff, 0xffffffff, 0xffffffff, 0xffffffff, 0xffffffff, 0xffffffff, 0xffffffff
    .long 0xffffffff, 0xffffffff, 0xffffffff, 0xffffffff, 0xffffffff, 0xffffffff, 0xffffffff, 0xffffffff, 0xffffffff, 0xffffffff, 0xffffffff, 0xffffffff, 0xffffffff, 0xffffffff, 0xffffffff, 0xffffffff
    .long 0x11c03, 0x1c13, 0x1c23, 0x1c33, 0x1c43, 0x1c53, 0x1c63, 0x1c73, 0x1c83, 0x1c93, 0x1ca3, 0x1cb3, 0x1cc3, 0x1cd3, 0x1ce3, 0x1cf3
    .long 0x1d03, 0x1d13, 0x1d23, 0x1d33, 0x1d43, 0x1d53, 0x1d63, 0x1d73, 0x1d83, 0x1d93, 0x1da3, 0x1db3, 0x1dc3, 0x1dd3, 0x1de3, 0x1df3
    .long 0x9dd3, 0x9df3, 0xffffffff, 0xffffffff, 0xffffffff, 0xffffffff, 0xffffffff, 0xffffffff, 0xffffffff, 0xffffffff, 0xffffffff, 0xffffffff, 0xffffffff, 0xffffffff, 0xffffffff, 0xffffffff
    .long 0xffffffff, 0xffffffff, 0xffffffff, 0xffffffff, 0xffffffff, 0xffffffff, 0xffffffff, 0xffffffff, 0xffffffff, 0xffffffff, 0xffffffff, 0xffffffff, 0xffffffff, 0xffffffff, 0xffffffff, 0xffffffff
    .long 0xffffffff, 0xffffffff, 0xffffffff, 0xffffffff, 0xffffffff, 0xffffffff, 0xffffffff, 0xffffffff, 0xffffffff, 0xffffffff, 0xffffffff, 0xffffffff, 0xffffffff, 0xffffffff, 0xffffffff, 0xffffffff
    .long 0x11e03, 0x1e13, 0x1e23, 0x1e33, 0x1e43, 0x1e53, 0x1e63, 0x1e73, 0x1e83, 0x1e93, 0x1ea3, 0x1eb3, 0x1ec3, 0x1ed3, 0x1ee3, 0x1ef3
    .long 0x1f03, 0x1f13, 0x1f23, 0x1f33, 0x1f43, 0x1f53, 0x1f63, 0x1f73, 0x1f83, 0x1f93, 0x1fa3, 0x1fb3, 0x1fc3, 0x1fd3, 0x1fe3, 0x1ff3
    .long 0x9fd3, 0x9ff3, 0xffffffff, 0xffffffff, 0xffffffff, 0xffffffff, 0xffffffff, 0xffffffff, 0xffffffff, 0xffffffff, 0xffffffff, 0xffffffff, 0xffffffff, 0xffffffff, 0xffffffff, 0xffffffff
    .long 0xffffffff, 0xffffffff, 0xffffffff, 0xffffffff, 0xffffffff, 0xffffffff, 0xffffffff, 0xffffffff, 0xffffffff, 0xffffffff, 0xffffffff, 0xffffffff, 0xffffffff, 0xffffffff, 0xffffffff, 0xffffffff
    .long 0xffffffff, 0xffffffff, 0xffffffff, 0xffffffff, 0xffffffff, 0xffffffff, 0xffffffff, 0xffffffff, 0xffffffff, 0xffffffff, 0xffffffff, 0xffffffff, 0xffffffff, 0xffffffff, 0xffffffff, 0xffffffff
    .long 0x12003, 0x2013, 0x2023, 0x2033, 0x2043, 0x2053, 0x2063, 0x2073, 0x2083, 0x2093, 0x20a3, 0x20b3, 0x20c3, 0x20d3, 0x20e3, 0x20f3
    .long 0x2103, 0x2113, 0x2123, 0x2133, 0x2143, 0x2153, 0x2163, 0x2173, 0x2183, 0x2193, 0x21a3, 0x21b3, 0x21c3, 0x21d3, 0x21e3, 0x21f3
    .long 0xa1d3, 0xa1f3, 0xffffffff, 0xffffffff, 0xffffffff, 0xffffffff, 0xffffffff, 0xffffffff, 0xffffffff, 0xffffffff, 0xffffffff, 0xffffffff, 0xffffffff, 0xffffffff, 0xffffffff, 0xffffffff
    .long 0xffffffff, 0xffffffff, 0xffffffff, 0xffffffff, 0xffffffff, 0xffffffff, 0xffffffff, 0xffffffff, 0xffffffff, 0xffffffff, 0xffffffff, 0xffffffff, 0xffffffff, 0xffffffff, 0xffffffff, 0xffffffff
    .long 0xffffffff, 0xffffffff, 0xffffffff, 0xffffffff, 0xffffffff, 0xffffffff, 0xffffffff, 0xffffffff, 0xffffffff, 0xffffffff, 0xffffffff, 0xffffffff, 0xffffffff, 0xffffffff, 0xffffffff, 0xffffffff
    .long 0x12203, 0x2213, 0x2223, 0x2233, 0x2243, 0x2253, 0x2263, 0x2273, 0x2283, 0x2293, 0x22a3, 0x22b3, 0x22c3, 0x22d3, 0x22e3, 0x22f3
    .long 0x2303, 0x2313, 0x2323, 0x2333, 0x2343, 0x2353, 0x2363, 0x2373, 0x2383, 0x2393, 0x23a3, 0x23b3, 0x23c3, 0x23d3, 0x23e3, 0x23f3
    .long 0xa3d3, 0xa3f3, 0xffffffff, 0xffffffff, 0xffffffff, 0xffffffff, 0xffffffff, 0xffffffff, 0xffffffff, 0xffffffff, 0xffffffff, 0xffffffff, 0xffffffff, 0xffffffff, 0xffffffff, 0xffffffff
    .long 0xffffffff, 0xffffffff, 0xffffffff, 0xffffffff, 0xffffffff, 0xffffffff, 0xffffffff, 0xffffffff, 0xffffffff, 0xffffffff, 0xffffffff, 0xffffffff, 0xffffffff, 0xffffffff, 0xffffffff, 0xffffffff
    .long 0xffffffff, 0xffffffff, 0xffffffff, 0xffffffff, 0xffffffff, 0xffffffff, 0xffffffff, 0xffffffff, 0xffffffff, 0xffffffff, 0xffffffff, 0xffffffff, 0xffffffff, 0xffffffff, 0xffffffff, 0xffffffff
    .long 0x12403, 0x2413, 0x2423, 0x2433, 0x2443, 0x2453, 0x2463, 0x2473, 0x2483, 0x2493, 0x24a3, 0x24b3, 0x24c3, 0x24d3, 0x24e3, 0x24f3
    .long 0x2503, 0x2513, 0x2523, 0x2533, 0x2543, 0x2553, 0x2563, 0x2573, 0x2583, 0x2593, 0x25a3, 0x25b3, 0x25c3, 0x25d3, 0x25e3, 0x25f3
    .long 0xa5d3, 0xa5f3, 0xffffffff, 0xffffffff, 0xffffffff, 0xffffffff, 0xffffffff, 0xffffffff, 0xffffffff, 0xffffffff, 0xffffffff, 0xffffffff, 0xffffffff, 0xffffffff, 0xffffffff, 0xffffffff
    .long 0xffffffff, 0xffffffff, 0xffffffff, 0xffffffff, 0xffffffff, 0xffffffff, 0xffffffff, 0xffffffff, 0xffffffff, 0xffffffff, 0xffffffff, 0xffffffff, 0xffffffff, 0xffffffff, 0xffffffff, 0xffffffff
    .long 0xffffffff, 0xffffffff, 0xffffffff, 0xffffffff, 0xffffffff, 0xffffffff, 0xffffffff, 0xffffffff, 0xffffffff, 0xffffffff, 0xffffffff, 0xffffffff, 0xffffffff, 0xffffffff, 0xffffffff, 0xffffffff
    .long 0x12603, 0x2613, 0x2623, 0x2633, 0x2643, 0x2653, 0x2663, 0x2673, 0x2683, 0x2693, 0x26a3, 0x26b3, 0x26c3, 0x26d3, 0x26e3, 0x26f3
    .long 0x2703, 0x2713, 0x2723, 0x2733, 0x2743, 0x2753, 0x2763, 0x2773, 0x2783, 0x2793, 0x27a3, 0x27b3, 0x27c3, 0x27d3, 0x27e3, 0x27f3
    .long 0xa7d3, 0xa7f3, 0xffffffff, 0xffffffff, 0xffffffff, 0xffffffff, 0xffffffff, 0xffffffff, 0xffffffff, 0xffffffff, 0xffffffff, 0xffffffff, 0xffffffff, 0xffffffff, 0xffffffff, 0xffffffff
    .long 0xffffffff, 0xffffffff, 0xffffffff, 0xffffffff, 0xffffffff, 0xffffffff, 0xffffffff, 0xffffffff, 0xffffffff, 0xffffffff, 0xffffffff, 0xffffffff, 0xffffffff, 0xffffffff, 0xffffffff, 0xffffffff
    .long 0xffffffff, 0xffffffff, 0xffffffff, 0xffffffff, 0xffffffff, 0xffffffff, 0xffffffff, 0xffffffff, 0xffffffff, 0xffffffff, 0xffffffff, 0xffffffff, 0xffffffff, 0xffffffff, 0xffffffff, 0xffffffff
    .long 0x12803, 0x2813, 0x2823, 0x2833, 0x2843, 0x2853, 0x2863, 0x2873, 0x2883, 0x2893, 0x28a3, 0x28b3, 0x28c3, 0x28d3, 0x28e3, 0x28f3
    .long 0x2903, 0x2913, 0x2923, 0x2933, 0x2943, 0x2953, 0x2963, 0x2973, 0x2983, 0x2993, 0x29a3, 0x29b3, 0x29c3, 0x29d3, 0x29e3, 0x29f3
    .long 0xa9d3, 0xa9f3, 0xffffffff, 0xffffffff, 0xffffffff, 0xffffffff, 0xffffffff, 0xffffffff, 0xffffffff, 0xffffffff, 0xffffffff, 0xffffffff, 0xffffffff, 0xffffffff, 0xffffffff, 0xffffffff
    .long 0xffffffff, 0xffffffff, 0xffffffff, 0xffffffff, 0xffffffff, 0xffffffff, 0xffffffff, 0xffffffff, 0xffffffff, 0xffffffff, 0xffffffff, 0xffffffff, 0xffffffff, 0xffffffff, 0xffffffff, 0xffffffff
    .long 0xffffffff, 0xffffffff, 0xffffffff, 0xffffffff, 0xffffffff, 0xffffffff, 0xffffffff, 0xffffffff, 0xffffffff, 0xffffffff, 0xffffffff, 0xffffffff, 0xffffffff, 0xffffffff, 0xffffffff, 0xffffffff
    .long 0x12a03, 0x2a13, 0x2a23, 0x2a33, 0x2a43, 0x2a53, 0x2a63, 0x2a73, 0x2a83, 0x2a93, 0x2aa3, 0x2ab3, 0x2ac3, 0x2ad3, 0x2ae3, 0x2af3
    .long 0x2b03, 0x2b13, 0x2b23, 0x2b33, 0x2b43, 0x2b53, 0x2b63, 0x2b73, 0x2b83, 0x2b93, 0x2ba3, 0x2bb3, 0x2bc3, 0x2bd3, 0x2be3, 0x2bf3
    .long 0xabd3, 0xabf3, 0xffffffff, 0xffffffff, 0xffffffff, 0xffffffff, 0xffffffff, 0xffffffff, 0xffffffff, 0xffffffff, 0xffffffff, 0xffffffff, 0xffffffff, 0xffffffff, 0xffffffff, 0xffffffff
    .long 0xffffffff, 0xffffffff, 0xffffffff, 0xffffffff, 0xffffffff, 0xffffffff, 0xffffffff, 0xffffffff, 0xffffffff, 0xffffffff, 0xffffffff, 0xffffffff, 0xffffffff, 0xffffffff, 0xffffffff, 0xffffffff
    .long 0xffffffff, 0xffffffff, 0xffffffff, 0xffffffff, 0xffffffff, 0xffffffff, 0xffffffff, 0xffffffff, 0xffffffff, 0xffffffff, 0xffffffff, 0xffffffff, 0xffffffff, 0xffffffff, 0xffffffff, 0xffffffff
    .long 0x12c03, 0x2c13, 0x2c23, 0x2c33, 0x2c43, 0x2c53, 0x2c63, 0x2c73, 0x2c83, 0x2c93, 0x2ca3, 0x2cb3, 0x2cc3, 0x2cd3, 0x2ce3, 0x2cf3
    .long 0x2d03, 0x2d13, 0x2d23, 0x2d33, 0x2d43, 0x2d53, 0x2d63, 0x2d73, 0x2d83, 0x2d93, 0x2da3, 0x2db3, 0x2dc3, 0x2dd3, 0x2de3, 0x2df3
    .long 0xadd3, 0xadf3, 0xffffffff, 0xffffffff, 0xffffffff, 0xffffffff, 0xffffffff, 0xffffffff, 0xffffffff, 0xffffffff, 0xffffffff, 0xffffffff, 0xffffffff, 0xffffffff, 0xffffffff, 0xffffffff
    .long 0xffffffff, 0xffffffff, 0xffffffff, 0xffffffff, 0xffffffff, 0xffffffff, 0xffffffff, 0xffffffff, 0xffffffff, 0xffffffff, 0xffffffff, 0xffffffff, 0xffffffff, 0xffffffff, 0xffffffff, 0xffffffff
    .long 0xffffffff, 0xffffffff, 0xffffffff, 0xffffffff, 0xffffffff, 0xffffffff, 0xffffffff, 0xffffffff, 0xffffffff, 0xffffffff, 0xffffffff, 0xffffffff, 0xffffffff, 0xffffffff, 0xffffffff, 0xffffffff
    .long 0x12e03, 0x2e13, 0x2e23, 0x2e33, 0x2e43, 0x2e53, 0x2e63, 0x2e73, 0x2e83, 0x2e93, 0x2ea3, 0x2eb3, 0x2ec3, 0x2ed3, 0x2ee3, 0x2ef3
    .long 0x2f03, 0x2f13, 0x2f23, 0x2f33, 0x2f43, 0x2f53, 0x2f63, 0x2f73, 0x2f83, 0x2f93, 0x2fa3, 0x2fb3, 0x2fc3, 0x2fd3, 0x2fe3, 0x2ff3
    .long 0xafd3, 0xaff3, 0xffffffff, 0xffffffff, 0xffffffff, 0xffffffff, 0xffffffff, 0xffffffff, 0xffffffff, 0xffffffff, 0xffffffff, 0xffffffff, 0xffffffff, 0xffffffff, 0xffffffff, 0xffffffff
    .long 0xffffffff, 0xffffffff, 0xffffffff, 0xffffffff, 0xffffffff, 0xffffffff, 0xffffffff, 0xffffffff, 0xffffffff, 0xffffffff, 0xffffffff, 0xffffffff, 0xffffffff, 0xffffffff, 0xffffffff, 0xffffffff
    .long 0xffffffff, 0xffffffff, 0xffffffff, 0xffffffff, 0xffffffff, 0xffffffff, 0xffffffff, 0xffffffff, 0xffffffff, 0xffffffff, 0xffffffff, 0xffffffff, 0xffffffff, 0xffffffff, 0xffffffff, 0xffffffff
    .long 0x13003, 0x3013, 0x3023, 0x3033, 0x3043, 0x3053, 0x3063, 0x3073, 0x3083, 0x3093, 0x30a3, 0x30b3, 0x30c3, 0x30d3, 0x30e3, 0x30f3
    .long 0x3103, 0x3113, 0x3123, 0x3133, 0x3143, 0x3153, 0x3163, 0x3173, 0x3183, 0x3193, 0x31a3, 0x31b3, 0x31c3, 0x31d3, 0x31e3, 0x31f3
    .long 0xb1d3, 0xb1f3, 0xffffffff, 0xffffffff, 0xffffffff, 0xffffffff, 0xffffffff, 0xffffffff, 0xffffffff, 0xffffffff, 0xffffffff, 0xffffffff, 0xffffffff, 0xffffffff, 0xffffffff, 0xffffffff
    .long 0xffffffff, 0xffffffff, 0xffffffff, 0xffffffff, 0xffffffff, 0xffffffff, 0xffffffff, 0xffffffff, 0xffffffff, 0xffffffff, 0xffffffff, 0xffffffff, 0xffffffff, 0xffffffff, 0xffffffff, 0xffffffff
    .long 0xffffffff, 0xffffffff, 0xffffffff, 0xffffffff, 0xffffffff, 0xffffffff, 0xffffffff, 0xffffffff, 0xffffffff, 0xffffffff, 0xffffffff, 0xffffffff, 0xffffffff, 0xffffffff, 0xffffffff, 0xffffffff
    .long 0x13203, 0x3213, 0x3223, 0x3233, 0x3243, 0x3253, 0x3263, 0x3273, 0x3283, 0x3293, 0x32a3, 0x32b3, 0x32c3, 0x32d3, 0x32e3, 0x32f3
    .long 0x3303, 0x3313, 0x3323, 0x3333, 0x3343, 0x3353, 0x3363, 0x3373, 0x3383, 0x3393, 0x33a3, 0x33b3, 0x33c3, 0x33d3, 0x33e3, 0x33f3
    .long 0xb3d3, 0xb3f3, 0xffffffff, 0xffffffff, 0xffffffff, 0xffffffff, 0xffffffff, 0xffffffff, 0xffffffff, 0xffffffff, 0xffffffff, 0xffffffff, 0xffffffff, 0xffffffff, 0xffffffff, 0xffffffff
    .long 0xffffffff, 0xffffffff, 0xffffffff, 0xffffffff, 0xffffffff, 0xffffffff, 0xffffffff, 0xffffffff, 0xffffffff, 0xffffffff, 0xffffffff, 0xffffffff, 0xffffffff, 0xffffffff, 0xffffffff, 0xffffffff
    .long 0xffffffff, 0xffffffff, 0xffffffff, 0xffffffff, 0xffffffff, 0xffffffff, 0xffffffff, 0xffffffff, 0xffffffff, 0xffffffff, 0xffffffff, 0xffffffff, 0xffffffff, 0xffffffff, 0xffffffff, 0xffffffff
    .long 0x13403, 0x3413, 0x3423, 0x3433, 0x3443, 0x3453, 0x3463, 0x3473, 0x3483, 0x3493, 0x34a3, 0x34b3, 0x34c3, 0x34d3, 0x34e3, 0x34f3
    .long 0x3503, 0x3513, 0x3523, 0x3533, 0x3543, 0x3553, 0x3563, 0x3573, 0x3583, 0x3593, 0x35a3, 0x35b3, 0x35c3, 0x35d3, 0x35e3, 0x35f3
    .long 0xb5d3, 0xb5f3, 0xffffffff, 0xffffffff, 0xffffffff, 0xffffffff, 0xffffffff, 0xffffffff, 0xffffffff, 0xffffffff, 0xffffffff, 0xffffffff, 0xffffffff, 0xffffffff, 0xffffffff, 0xffffffff
    .long 0xffffffff, 0xffffffff, 0xffffffff, 0xffffffff, 0xffffffff, 0xffffffff, 0xffffffff, 0xffffffff, 0xffffffff, 0xffffffff, 0xffffffff, 0xffffffff, 0xffffffff, 0xffffffff, 0xffffffff, 0xffffffff
    .long 0xffffffff, 0xffffffff, 0xffffffff, 0xffffffff, 0xffffffff, 0xffffffff, 0xffffffff, 0xffffffff, 0xffffffff, 0xffffffff, 0xffffffff, 0xffffffff, 0xffffffff, 0xffffffff, 0xffffffff, 0xffffffff
    .long 0x13603, 0x3613, 0x3623, 0x3633, 0x3643, 0x3653, 0x3663, 0x3673, 0x3683, 0x3693, 0x36a3, 0x36b3, 0x36c3, 0x36d3, 0x36e3, 0x36f3
    .long 0x3703, 0x3713, 0x3723, 0x3733, 0x3743, 0x3753, 0x3763, 0x3773, 0x3783, 0x3793, 0x37a3, 0x37b3, 0x37c3, 0x37d3, 0x37e3, 0x37f3
    .long 0xb7d3, 0xb7f3, 0xffffffff, 0xffffffff, 0xffffffff, 0xffffffff, 0xffffffff, 0xffffffff, 0xffffffff, 0xffffffff, 0xffffffff, 0xffffffff, 0xffffffff, 0xffffffff, 0xffffffff, 0xffffffff
    .long 0xffffffff, 0xffffffff, 0xffffffff, 0xffffffff, 0xffffffff, 0xffffffff, 0xffffffff, 0xffffffff, 0xffffffff, 0xffffffff, 0xffffffff, 0xffffffff, 0xffffffff, 0xffffffff, 0xffffffff, 0xffffffff
    .long 0xffffffff, 0xffffffff, 0xffffffff, 0xffffffff, 0xffffffff, 0xffffffff, 0xffffffff, 0xffffffff, 0xffffffff, 0xffffffff, 0xffffffff, 0xffffffff, 0xffffffff, 0xffffffff, 0xffffffff, 0xffffffff
    .long 0x13803, 0x3813, 0x3823, 0x3833, 0x3843, 0x3853, 0x3863, 0x3873, 0x3883, 0x3893, 0x38a3, 0x38b3, 0x38c3, 0x38d3, 0x38e3, 0x38f3
    .long 0x3903, 0x3913, 0x3923, 0x3933, 0x3943, 0x3953, 0x3963, 0x3973, 0x3983, 0x3993, 0x39a3, 0x39b3, 0x39c3, 0x39d3, 0x39e3, 0x39f3
    .long 0xb9d3, 0xb9f3, 0xffffffff, 0xffffffff, 0xffffffff, 0xffffffff, 0xffffffff, 0xffffffff, 0xffffffff, 0xffffffff, 0xffffffff, 0xffffffff, 0xffffffff, 0xffffffff, 0xffffffff, 0xffffffff
    .long 0xffffffff, 0xffffffff, 0xffffffff, 0xffffffff, 0xffffffff, 0xffffffff, 0xffffffff, 0xffffffff, 0xffffffff, 0xffffffff, 0xffffffff, 0xffffffff, 0xffffffff, 0xffffffff, 0xffffffff, 0xffffffff
    .long 0xffffffff, 0xffffffff, 0xffffffff, 0xffffffff, 0xffffffff, 0xffffffff, 0xffffffff, 0xffffffff, 0xffffffff, 0xffffffff, 0xffffffff, 0xffffffff, 0xffffffff, 0xffffffff, 0xffffffff, 0xffffffff
    .long 0x13a03, 0x3a13, 0x3a23, 0x3a33, 0x3a43, 0x3a53, 0x3a63, 0x3a73, 0x3a83, 0x3a93, 0x3aa3, 0x3ab3, 0x3ac3, 0x3ad3, 0x3ae3, 0x3af3
    .long 0x3b03, 0x3b13, 0x3b23, 0x3b33, 0x3b43, 0x3b53, 0x3b63, 0x3b73, 0x3b83, 0x3b93, 0x3ba3, 0x3bb3, 0x3bc3, 0x3bd3, 0x3be3, 0x3bf3
    .long 0xbbd3, 0xbbf3, 0xffffffff, 0xffffffff, 0xffffffff, 0xffffffff, 0xffffffff, 0xffffffff, 0xffffffff, 0xffffffff, 0xffffffff, 0xffffffff, 0xffffffff, 0xffffffff, 0xffffffff, 0xffffffff
    .long 0xffffffff, 0xffffffff, 0xffffffff, 0xffffffff, 0xffffffff, 0xffffffff, 0xffffffff, 0xffffffff, 0xffffffff, 0xffffffff, 0xffffffff, 0xffffffff, 0xffffffff, 0xffffffff, 0xffffffff, 0xffffffff
    .long 0xffffffff, 0xffffffff, 0xffffffff, 0xffffffff, 0xffffffff, 0xffffffff, 0xffffffff, 0xffffffff, 0xffffffff, 0xffffffff, 0xffffffff, 0xffffffff, 0xffffffff, 0xffffffff, 0xffffffff, 0xffffffff
    .long 0x13c03, 0x3c13, 0x3c23, 0x3c33, 0x3c43, 0x3c53, 0x3c63, 0x3c73, 0x3c83, 0x3c93, 0x3ca3, 0x3cb3, 0x3cc3, 0x3cd3, 0x3ce3, 0x3cf3
    .long 0x3d03, 0x3d13, 0x3d23, 0x3d33, 0x3d43, 0x3d53, 0x3d63, 0x3d73, 0x3d83, 0x3d93, 0x3da3, 0x3db3, 0x3dc3, 0x3dd3, 0x3de3, 0x3df3
    .long 0xbdd3, 0xbdf3, 0xffffffff, 0xffffffff, 0xffffffff, 0xffffffff, 0xffffffff, 0xffffffff, 0xffffffff, 0xffffffff, 0xffffffff, 0xffffffff, 0xffffffff, 0xffffffff, 0xffffffff, 0xffffffff
    .long 0xffffffff, 0xffffffff, 0xffffffff, 0xffffffff, 0xffffffff, 0xffffffff, 0xffffffff, 0xffffffff, 0xffffffff, 0xffffffff, 0xffffffff, 0xffffffff, 0xffffffff, 0xffffffff, 0xffffffff, 0xffffffff
    .long 0xffffffff, 0xffffffff, 0xffffffff, 0xffffffff, 0xffffffff, 0xffffffff, 0xffffffff, 0xffffffff, 0xffffffff, 0xffffffff, 0xffffffff, 0xffffffff, 0xffffffff, 0xffffffff, 0xffffffff, 0xffffffff
    .long 0x13e03, 0x3e13, 0x3e23, 0x3e33, 0x3e43, 0x3e53, 0x3e63, 0x3e73, 0x3e83, 0x3e93, 0x3ea3, 0x3eb3, 0x3ec3, 0x3ed3, 0x3ee3, 0x3ef3
    .long 0x3f03, 0x3f13, 0x3f23, 0x3f33, 0x3f43, 0x3f53, 0x3f63, 0x3f73, 0x3f83, 0x3f93, 0x3fa3, 0x3fb3, 0x3fc3, 0x3fd3, 0x3fe3, 0x3ff3
    .long 0xbfd3, 0xbff3, 0xffffffff, 0xffffffff, 0xffffffff, 0xffffffff, 0xffffffff, 0xffffffff, 0xffffffff, 0xffffffff, 0xffffffff, 0xffffffff, 0xffffffff, 0xffffffff, 0xffffffff, 0xffffffff
    .long 0xffffffff, 0xffffffff, 0xffffffff, 0xffffffff, 0xffffffff, 0xffffffff, 0xffffffff, 0xffffffff, 0xffffffff, 0xffffffff, 0xffffffff, 0xffffffff, 0xffffffff, 0xffffffff, 0xffffffff, 0xffffffff
    .long 0xffffffff, 0xffffffff, 0xffffffff, 0xffffffff, 0xffffffff, 0xffffffff, 0xffffffff, 0xffffffff, 0xffffffff, 0xffffffff, 0xffffffff, 0xffffffff, 0xffffffff, 0xffffffff, 0xffffffff, 0xffffffff
    .long 0x10005, 0x15, 0x25, 0x35, 0x45, 0x55, 0x65, 0x75, 0x85, 0x95, 0xa5, 0xb5, 0xc5, 0xd5, 0xe5, 0xf5
    .long 0x105, 0x115, 0x125, 0x135, 0x145, 0x155, 0x165, 0x175, 0x185, 0x195, 0x1a5, 0x1b5, 0x1c5, 0x1d5, 0x1e5, 0x1f5
    .long 0x81d5, 0x81f5, 0xffffffff, 0xffffffff, 0xffffffff, 0xffffffff, 0xffffffff, 0xffffffff, 0xffffffff, 0xffffffff, 0xffffffff, 0xffffffff, 0xffffffff, 0xffffffff, 0xffffffff, 0xffffffff
    .long 0xffffffff, 0xffffffff, 0xffffffff, 0xffffffff, 0xffffffff, 0xffffffff, 0xffffffff, 0xffffffff, 0xffffffff, 0xffffffff, 0xffffffff, 0xffffffff, 0xffffffff, 0xffffffff, 0xffffffff, 0xffffffff
    .long 0xffffffff, 0xffffffff, 0xffffffff, 0xffffffff, 0xffffffff, 0xffffffff, 0xffffffff, 0xffffffff, 0xffffffff, 0xffffffff, 0xffffffff, 0xffffffff, 0xffffffff, 0xffffffff, 0xffffffff, 0xffffffff
    .long 0x10205, 0x215, 0x225, 0x235, 0x245, 0x255, 0x265, 0x275, 0x285, 0x295, 0x2a5, 0x2b5, 0x2c5, 0x2d5, 0x2e5, 0x2f5
    .long 0x305, 0x315, 0x325, 0x335, 0x345, 0x355, 0x365, 0x375, 0x385, 0x395, 0x3a5, 0x3b5, 0x3c5, 0x3d5, 0x3e5, 0x3f5
    .long 0x83d5, 0x83f5, 0xffffffff, 0xffffffff, 0xffffffff, 0xffffffff, 0xffffffff, 0xffffffff, 0xffffffff, 0xffffffff, 0xffffffff, 0xffffffff, 0xffffffff, 0xffffffff, 0xffffffff, 0xffffffff
    .long 0xffffffff, 0xffffffff, 0xffffffff, 0xffffffff, 0xffffffff, 0xffffffff, 0xffffffff, 0xffffffff, 0xffffffff, 0xffffffff, 0xffffffff, 0xffffffff, 0xffffffff, 0xffffffff, 0xffffffff, 0xffffffff
    .long 0xffffffff, 0xffffffff, 0xffffffff, 0xffffffff, 0xffffffff, 0xffffffff, 0xffffffff, 0xffffffff, 0xffffffff, 0xffffffff, 0xffffffff, 0xffffffff, 0xffffffff, 0xffffffff, 0xffffffff, 0xffffffff
    .long 0x10405, 0x415, 0x425, 0x435, 0x445, 0x455, 0x465, 0x475, 0x485, 0x495, 0x4a5, 0x4b5, 0x4c5, 0x4d5, 0x4e5, 0x4f5
    .long 0x505, 0x515, 0x525, 0x535, 0x545, 0x555, 0x565, 0x575, 0x585, 0x595, 0x5a5, 0x5b5, 0x5c5, 0x5d5, 0x5e5, 0x5f5
    .long 0x85d5, 0x85f5, 0xffffffff, 0xffffffff, 0xffffffff, 0xffffffff, 0xffffffff, 0xffffffff, 0xffffffff, 0xffffffff, 0xffffffff, 0xffffffff, 0xffffffff, 0xffffffff, 0xffffffff, 0xffffffff
    .long 0xffffffff, 0xffffffff, 0xffffffff, 0xffffffff, 0xffffffff, 0xffffffff, 0xffffffff, 0xffffffff, 0xffffffff, 0xffffffff, 0xffffffff, 0xffffffff, 0xffffffff, 0xffffffff, 0xffffffff, 0xffffffff
    .long 0xffffffff, 0xffffffff, 0xffffffff, 0xffffffff, 0xffffffff, 0xffffffff, 0xffffffff, 0xffffffff, 0xffffffff, 0xffffffff, 0xffffffff, 0xffffffff, 0xffffffff, 0xffffffff, 0xffffffff, 0xffffffff
    .long 0x10605, 0x615, 0x625, 0x635, 0x645, 0x655, 0x665, 0x675, 0x685, 0x695, 0x6a5, 0x6b5, 0x6c5, 0x6d5, 0x6e5, 0x6f5
    .long 0x705, 0x715, 0x725, 0x735, 0x745, 0x755, 0x765, 0x775, 0x785, 0x795, 0x7a5, 0x7b5, 0x7c5, 0x7d5, 0x7e5, 0x7f5
    .long 0x87d5, 0x87f5, 0xffffffff, 0xffffffff, 0xffffffff, 0xffffffff, 0xffffffff, 0xffffffff, 0xffffffff, 0xffffffff, 0xffffffff, 0xffffffff, 0xffffffff, 0xffffffff, 0xffffffff, 0xffffffff
    .long 0xffffffff, 0xffffffff, 0xffffffff, 0xffffffff, 0xffffffff, 0xffffffff, 0xffffffff, 0xffffffff, 0xffffffff, 0xffffffff, 0xffffffff, 0xffffffff, 0xffffffff, 0xffffffff, 0xffffffff, 0xffffffff
    .long 0xffffffff, 0xffffffff, 0xffffffff, 0xffffffff, 0xffffffff, 0xffffffff, 0xffffffff, 0xffffffff, 0xffffffff, 0xffffffff, 0xffffffff, 0xffffffff, 0xffffffff, 0xffffffff, 0xffffffff, 0xffffffff
    .long 0x10805, 0x815, 0x825, 0x835, 0x845, 0x855, 0x865, 0x875, 0x885, 0x895, 0x8a5, 0x8b5, 0x8c5, 0x8d5, 0x8e5, 0x8f5
    .long 0x905, 0x915, 0x925, 0x935, 0x945, 0x955, 0x965, 0x975, 0x985, 0x995, 0x9a5, 0x9b5, 0x9c5, 0x9d5, 0x9e5, 0x9f5
    .long 0x89d5, 0x89f5, 0xffffffff, 0xffffffff, 0xffffffff, 0xffffffff, 0xffffffff, 0xffffffff, 0xffffffff, 0xffffffff, 0xffffffff, 0xffffffff, 0xffffffff, 0xffffffff, 0xffffffff, 0xffffffff
    .long 0xffffffff, 0xffffffff, 0xffffffff, 0xffffffff, 0xffffffff, 0xffffffff, 0xffffffff, 0xffffffff, 0xffffffff, 0xffffffff, 0xffffffff, 0xffffffff, 0xffffffff, 0xffffffff, 0xffffffff, 0xffffffff
    .long 0xffffffff, 0xffffffff, 0xffffffff, 0xffffffff, 0xffffffff, 0xffffffff, 0xffffffff, 0xffffffff, 0xffffffff, 0xffffffff, 0xffffffff, 0xffffffff, 0xffffffff, 0xffffffff, 0xffffffff, 0xffffffff
    .long 0x10a05, 0xa15, 0xa25, 0xa35, 0xa45, 0xa55, 0xa65, 0xa75, 0xa85, 0xa95, 0xaa5, 0xab5, 0xac5, 0xad5, 0xae5, 0xaf5
    .long 0xb05, 0xb15, 0xb25, 0xb35, 0xb45, 0xb55, 0xb65, 0xb75, 0xb85, 0xb95, 0xba5, 0xbb5, 0xbc5, 0xbd5, 0xbe5, 0xbf5
    .long 0x8bd5, 0x8bf5, 0xffffffff, 0xffffffff, 0xffffffff, 0xffffffff, 0xffffffff, 0xffffffff, 0xffffffff, 0xffffffff, 0xffffffff, 0xffffffff, 0xffffffff, 0xffffffff, 0xffffffff, 0xffffffff
    .long 0xffffffff, 0xffffffff, 0xffffffff, 0xffffffff, 0xffffffff, 0xffffffff, 0xffffffff, 0xffffffff, 0xffffffff, 0xffffffff, 0xffffffff, 0xffffffff, 0xffffffff, 0xffffffff, 0xffffffff, 0xffffffff
    .long 0xffffffff, 0xffffffff, 0xffffffff, 0xffffffff, 0xffffffff, 0xffffffff, 0xffffffff, 0xffffffff, 0xffffffff, 0xffffffff, 0xffffffff, 0xffffffff, 0xffffffff, 0xffffffff, 0xffffffff, 0xffffffff
    .long 0x10c05, 0xc15, 0xc25, 0xc35, 0xc45, 0xc55, 0xc65, 0xc75, 0xc85, 0xc95, 0xca5, 0xcb5, 0xcc5, 0xcd5, 0xce5, 0xcf5
    .long 0xd05, 0xd15, 0xd25, 0xd35, 0xd45, 0xd55, 0xd65, 0xd75, 0xd85, 0xd95, 0xda5, 0xdb5, 0xdc5, 0xdd5, 0xde5, 0xdf5
    .long 0x8dd5, 0x8df5, 0xffffffff, 0xffffffff, 0xffffffff, 0xffffffff, 0xffffffff, 0xffffffff, 0xffffffff, 0xffffffff, 0xffffffff, 0xffffffff, 0xffffffff, 0xffffffff, 0xffffffff, 0xffffffff
    .long 0xffffffff, 0xffffffff, 0xffffffff, 0xffffffff, 0xffffffff, 0xffffffff, 0xffffffff, 0xffffffff, 0xffffffff, 0xffffffff, 0xffffffff, 0xffffffff, 0xffffffff, 0xffffffff, 0xffffffff, 0xffffffff
    .long 0xffffffff, 0xffffffff, 0xffffffff, 0xffffffff, 0xffffffff, 0xffffffff, 0xffffffff, 0xffffffff, 0xffffffff, 0xffffffff, 0xffffffff, 0xffffffff, 0xffffffff, 0xffffffff, 0xffffffff, 0xffffffff
    .long 0x10e05, 0xe15, 0xe25, 0xe35, 0xe45, 0xe55, 0xe65, 0xe75, 0xe85, 0xe95, 0xea5, 0xeb5, 0xec5, 0xed5, 0xee5, 0xef5
    .long 0xf05, 0xf15, 0xf25, 0xf35, 0xf45, 0xf55, 0xf65, 0xf75, 0xf85, 0xf95, 0xfa5, 0xfb5, 0xfc5, 0xfd5, 0xfe5, 0xff5
    .long 0x8fd5, 0x8ff5, 0xffffffff, 0xffffffff, 0xffffffff, 0xffffffff, 0xffffffff, 0xffffffff, 0xffffffff, 0xffffffff, 0xffffffff, 0xffffffff, 0xffffffff, 0xffffffff, 0xffffffff, 0xffffffff
    .long 0xffffffff, 0xffffffff, 0xffffffff, 0xffffffff, 0xffffffff, 0xffffffff, 0xffffffff, 0xffffffff, 0xffffffff, 0xffffffff, 0xffffffff, 0xffffffff, 0xffffffff, 0xffffffff, 0xffffffff, 0xffffffff
    .long 0xffffffff, 0xffffffff, 0xffffffff, 0xffffffff, 0xffffffff, 0xffffffff, 0xffffffff, 0xffffffff, 0xffffffff, 0xffffffff, 0xffffffff, 0xffffffff, 0xffffffff, 0xffffffff, 0xffffffff, 0xffffffff
    .long 0x11005, 0x1015, 0x1025, 0x1035, 0x1045, 0x1055, 0x1065, 0x1075, 0x1085, 0x1095, 0x10a5, 0x10b5, 0x10c5, 0x10d5, 0x10e5, 0x10f5
    .long 0x1105, 0x1115, 0x1125, 0x1135, 0x1145, 0x1155, 0x1165, 0x1175, 0x1185, 0x1195, 0x11a5, 0x11b5, 0x11c5, 0x11d5, 0x11e5, 0x11f5
    .long 0x91d5, 0x91f5, 0xffffffff, 0xffffffff, 0xffffffff, 0xffffffff, 0xffffffff, 0xffffffff, 0xffffffff, 0xffffffff, 0xffffffff, 0xffffffff, 0xffffffff, 0xffffffff, 0xffffffff, 0xffffffff
    .long 0xffffffff, 0xffffffff, 0xffffffff, 0xffffffff, 0xffffffff, 0xffffffff, 0xffffffff, 0xffffffff, 0xffffffff, 0xffffffff, 0xffffffff, 0xffffffff, 0xffffffff, 0xffffffff, 0xffffffff, 0xffffffff
    .long 0xffffffff, 0xffffffff, 0xffffffff, 0xffffffff, 0xffffffff, 0xffffffff, 0xffffffff, 0xffffffff, 0xffffffff, 0xffffffff, 0xffffffff, 0xffffffff, 0xffffffff, 0xffffffff, 0xffffffff, 0xffffffff
    .long 0x11205, 0x1215, 0x1225, 0x1235, 0x1245, 0x1255, 0x1265, 0x1275, 0x1285, 0x1295, 0x12a5, 0x12b5, 0x12c5, 0x12d5, 0x12e5, 0x12f5
    .long 0x1305, 0x1315, 0x1325, 0x1335, 0x1345, 0x1355, 0x1365, 0x1375, 0x1385, 0x1395, 0x13a5, 0x13b5, 0x13c5, 0x13d5, 0x13e5, 0x13f5
    .long 0x93d5, 0x93f5, 0xffffffff, 0xffffffff, 0xffffffff, 0xffffffff, 0xffffffff, 0xffffffff, 0xffffffff, 0xffffffff, 0xffffffff, 0xffffffff, 0xffffffff, 0xffffffff, 0xffffffff, 0xffffffff
    .long 0xffffffff, 0xffffffff, 0xffffffff, 0xffffffff, 0xffffffff, 0xffffffff, 0xffffffff, 0xffffffff, 0xffffffff, 0xffffffff, 0xffffffff, 0xffffffff, 0xffffffff, 0xffffffff, 0xffffffff, 0xffffffff
    .long 0xffffffff, 0xffffffff, 0xffffffff, 0xffffffff, 0xffffffff, 0xffffffff, 0xffffffff, 0xffffffff, 0xffffffff, 0xffffffff, 0xffffffff, 0xffffffff, 0xffffffff, 0xffffffff, 0xffffffff, 0xffffffff
    .long 0x11405, 0x1415, 0x1425, 0x1435, 0x1445, 0x1455, 0x1465, 0x1475, 0x1485, 0x1495, 0x14a5, 0x14b5, 0x14c5, 0x14d5, 0x14e5, 0x14f5
    .long 0x1505, 0x1515, 0x1525, 0x1535, 0x1545, 0x1555, 0x1565, 0x1575, 0x1585, 0x1595, 0x15a5, 0x15b5, 0x15c5, 0x15d5, 0x15e5, 0x15f5
    .long 0x95d5, 0x95f5, 0xffffffff, 0xffffffff, 0xffffffff, 0xffffffff, 0xffffffff, 0xffffffff, 0xffffffff, 0xffffffff, 0xffffffff, 0xffffffff, 0xffffffff, 0xffffffff, 0xffffffff, 0xffffffff
    .long 0xffffffff, 0xffffffff, 0xffffffff, 0xffffffff, 0xffffffff, 0xffffffff, 0xffffffff, 0xffffffff, 0xffffffff, 0xffffffff, 0xffffffff, 0xffffffff, 0xffffffff, 0xffffffff, 0xffffffff, 0xffffffff
    .long 0xffffffff, 0xffffffff, 0xffffffff, 0xffffffff, 0xffffffff, 0xffffffff, 0xffffffff, 0xffffffff, 0xffffffff, 0xffffffff, 0xffffffff, 0xffffffff, 0xffffffff, 0xffffffff, 0xffffffff, 0xffffffff
    .long 0x11605, 0x1615, 0x1625, 0x1635, 0x1645, 0x1655, 0x1665, 0x1675, 0x1685, 0x1695, 0x16a5, 0x16b5, 0x16c5, 0x16d5, 0x16e5, 0x16f5
    .long 0x1705, 0x1715, 0x1725, 0x1735, 0x1745, 0x1755, 0x1765, 0x1775, 0x1785, 0x1795, 0x17a5, 0x17b5, 0x17c5, 0x17d5, 0x17e5, 0x17f5
    .long 0x97d5, 0x97f5, 0xffffffff, 0xffffffff, 0xffffffff, 0xffffffff, 0xffffffff, 0xffffffff, 0xffffffff, 0xffffffff, 0xffffffff, 0xffffffff, 0xffffffff, 0xffffffff, 0xffffffff, 0xffffffff
    .long 0xffffffff, 0xffffffff, 0xffffffff, 0xffffffff, 0xffffffff, 0xffffffff, 0xffffffff, 0xffffffff, 0xffffffff, 0xffffffff, 0xffffffff, 0xffffffff, 0xffffffff, 0xffffffff, 0xffffffff, 0xffffffff
    .long 0xffffffff, 0xffffffff, 0xffffffff, 0xffffffff, 0xffffffff, 0xffffffff, 0xffffffff, 0xffffffff, 0xffffffff, 0xffffffff, 0xffffffff, 0xffffffff, 0xffffffff, 0xffffffff, 0xffffffff, 0xffffffff
    .long 0x11805, 0x1815, 0x1825, 0x1835, 0x1845, 0x1855, 0x1865, 0x1875, 0x1885, 0x1895, 0x18a5, 0x18b5, 0x18c5, 0x18d5, 0x18e5, 0x18f5
    .long 0x1905, 0x1915, 0x1925, 0x1935, 0x1945, 0x1955, 0x1965, 0x1975, 0x1985, 0x1995, 0x19a5, 0x19b5, 0x19c5, 0x19d5, 0x19e5, 0x19f5
    .long 0x99d5, 0x99f5, 0xffffffff, 0xffffffff, 0xffffffff, 0xffffffff, 0xffffffff, 0xffffffff, 0xffffffff, 0xffffffff, 0xffffffff, 0xffffffff, 0xffffffff, 0xffffffff, 0xffffffff, 0xffffffff
    .long 0xffffffff, 0xffffffff, 0xffffffff, 0xffffffff, 0xffffffff, 0xffffffff, 0xffffffff, 0xffffffff, 0xffffffff, 0xffffffff, 0xffffffff, 0xffffffff, 0xffffffff, 0xffffffff, 0xffffffff, 0xffffffff
    .long 0xffffffff, 0xffffffff, 0xffffffff, 0xffffffff, 0xffffffff, 0xffffffff, 0xffffffff, 0xffffffff, 0xffffffff, 0xffffffff, 0xffffffff, 0xffffffff, 0xffffffff, 0xffffffff, 0xffffffff, 0xffffffff
    .long 0x11a05, 0x1a15, 0x1a25, 0x1a35, 0x1a45, 0x1a55, 0x1a65, 0x1a75, 0x1a85, 0x1a95, 0x1aa5, 0x1ab5, 0x1ac5, 0x1ad5, 0x1ae5, 0x1af5
    .long 0x1b05, 0x1b15, 0x1b25, 0x1b35, 0x1b45, 0x1b55, 0x1b65, 0x1b75, 0x1b85, 0x1b95, 0x1ba5, 0x1bb5, 0x1bc5, 0x1bd5, 0x1be5, 0x1bf5
    .long 0x9bd5, 0x9bf5, 0xffffffff, 0xffffffff, 0xffffffff, 0xffffffff, 0xffffffff, 0xffffffff, 0xffffffff, 0xffffffff, 0xffffffff, 0xffffffff, 0xffffffff, 0xffffffff, 0xffffffff, 0xffffffff
    .long 0xffffffff, 0xffffffff, 0xffffffff, 0xffffffff, 0xffffffff, 0xffffffff, 0xffffffff, 0xffffffff, 0xffffffff, 0xffffffff, 0xffffffff, 0xffffffff, 0xffffffff, 0xffffffff, 0xffffffff, 0xffffffff
    .long 0xffffffff, 0xffffffff, 0xffffffff, 0xffffffff, 0xffffffff, 0xffffffff, 0xffffffff, 0xffffffff, 0xffffffff, 0xffffffff, 0xffffffff, 0xffffffff, 0xffffffff, 0xffffffff, 0xffffffff, 0xffffffff
    .long 0x8, 0x18003, 0x8013, 0x8023, 0x8033, 0x8043, 0x8053, 0x8063, 0x8073, 0x8083, 0x8093, 0x80a3, 0x80b3, 0x80c3, 0x80d3, 0x80e3
    .long 0x80f3, 0x8103, 0x8113, 0x8123, 0x8133, 0x8143, 0x8153, 0x8163, 0x8173, 0x8183, 0x8193, 0x81a3, 0x81b3, 0x81c3, 0x81e3, 0xffffffff
    .long 0xffffffff, 0xffffffff, 0xffffffff, 0xffffffff, 0xffffffff, 0xffffffff, 0xffffffff, 0xffffffff, 0xffffffff, 0xffffffff, 0xffffffff, 0xffffffff, 0xffffffff, 0xffffffff, 0xffffffff, 0xffffffff
    .long 0xffffffff, 0xffffffff, 0xffffffff, 0xffffffff, 0xffffffff, 0xffffffff, 0xffffffff, 0xffffffff, 0xffffffff, 0xffffffff, 0xffffffff, 0xffffffff, 0xffffffff, 0xffffffff, 0xffffffff, 0xffffffff
    .long 0xffffffff, 0xffffffff, 0xffffffff, 0xffffffff, 0xffffffff, 0xffffffff, 0xffffffff, 0xffffffff, 0xffffffff, 0xffffffff, 0xffffffff, 0xffffffff, 0xffffffff, 0xffffffff, 0xffffffff, 0xffffffff
    .long 0x208, 0x18203, 0x8213, 0x8223, 0x8233, 0x8243, 0x8253, 0x8263, 0x8273, 0x8283, 0x8293, 0x82a3, 0x82b3, 0x82c3, 0x82d3, 0x82e3
    .long 0x82f3, 0x8303, 0x8313, 0x8323, 0x8333, 0x8343, 0x8353, 0x8363, 0x8373, 0x8383, 0x8393, 0x83a3, 0x83b3, 0x83c3, 0x83e3, 0xffffffff
    .long 0xffffffff, 0xffffffff, 0xffffffff, 0xffffffff, 0xffffffff, 0xffffffff, 0xffffffff, 0xffffffff, 0xffffffff, 0xffffffff, 0xffffffff, 0xffffffff, 0xffffffff, 0xffffffff, 0xffffffff, 0xffffffff
    .long 0xffffffff, 0xffffffff, 0xffffffff, 0xffffffff, 0xffffffff, 0xffffffff, 0xffffffff, 0xffffffff, 0xffffffff, 0xffffffff, 0xffffffff, 0xffffffff, 0xffffffff, 0xffffffff, 0xffffffff, 0xffffffff
    .long 0xffffffff, 0xffffffff, 0xffffffff, 0xffffffff, 0xffffffff, 0xffffffff, 0xffffffff, 0xffffffff, 0xffffffff, 0xffffffff, 0xffffffff, 0xffffffff, 0xffffffff, 0xffffffff, 0xffffffff, 0xffffffff
    .long 0x408, 0x18403, 0x8413, 0x8423, 0x8433, 0x8443, 0x8453, 0x8463, 0x8473, 0x8483, 0x8493, 0x84a3, 0x84b3, 0x84c3, 0x84d3, 0x84e3
    .long 0x84f3, 0x8503, 0x8513, 0x8523, 0x8533, 0x8543, 0x8553, 0x8563, 0x8573, 0x8583, 0x8593, 0x85a3, 0x85b3, 0x85c3, 0x85e3, 0xffffffff
    .long 0xffffffff, 0xffffffff, 0xffffffff, 0xffffffff, 0xffffffff, 0xffffffff, 0xffffffff, 0xffffffff, 0xffffffff, 0xffffffff, 0xffffffff, 0xffffffff, 0xffffffff, 0xffffffff, 0xffffffff, 0xffffffff
    .long 0xffffffff, 0xffffffff, 0xffffffff, 0xffffffff, 0xffffffff, 0xffffffff, 0xffffffff, 0xffffffff, 0xffffffff, 0xffffffff, 0xffffffff, 0xffffffff, 0xffffffff, 0xffffffff, 0xffffffff, 0xffffffff
    .long 0xffffffff, 0xffffffff, 0xffffffff, 0xffffffff, 0xffffffff, 0xffffffff, 0xffffffff, 0xffffffff, 0xffffffff, 0xffffffff, 0xffffffff, 0xffffffff, 0xffffffff, 0xffffffff, 0xffffffff, 0xffffffff
    .long 0x608, 0x18603, 0x8613, 0x8623, 0x8633, 0x8643, 0x8653, 0x8663, 0x8673, 0x8683, 0x8693, 0x86a3, 0x86b3, 0x86c3, 0x86d3, 0x86e3
    .long 0x86f3, 0x8703, 0x8713, 0x8723, 0x8733, 0x8743, 0x8753, 0x8763, 0x8773, 0x8783, 0x8793, 0x87a3, 0x87b3, 0x87c3, 0x87e3, 0xffffffff
    .long 0xffffffff, 0xffffffff, 0xffffffff, 0xffffffff, 0xffffffff, 0xffffffff, 0xffffffff, 0xffffffff, 0xffffffff, 0xffffffff, 0xffffffff, 0xffffffff, 0xffffffff, 0xffffffff, 0xffffffff, 0xffffffff
    .long 0xffffffff, 0xffffffff, 0xffffffff, 0xffffffff, 0xffffffff, 0xffffffff, 0xffffffff, 0xffffffff, 0xffffffff, 0xffffffff, 0xffffffff, 0xffffffff, 0xffffffff, 0xffffffff, 0xffffffff, 0xffffffff
    .long 0xffffffff, 0xffffffff, 0xffffffff, 0xffffffff, 0xffffffff, 0xffffffff, 0xffffffff, 0xffffffff, 0xffffffff, 0xffffffff, 0xffffffff, 0xffffffff, 0xffffffff, 0xffffffff, 0xffffffff, 0xffffffff
    .long 0x808, 0x18803, 0x8813, 0x8823, 0x8833, 0x8843, 0x8853, 0x8863, 0x8873, 0x8883, 0x8893, 0x88a3, 0x88b3, 0x88c3, 0x88d3, 0x88e3
    .long 0x88f3, 0x8903, 0x8913, 0x8923, 0x8933, 0x8943, 0x8953, 0x8963, 0x8973, 0x8983, 0x8993, 0x89a3, 0x89b3, 0x89c3, 0x89e3, 0xffffffff
    .long 0xffffffff, 0xffffffff, 0xffffffff, 0xffffffff, 0xffffffff, 0xffffffff, 0xffffffff, 0xffffffff, 0xffffffff, 0xffffffff, 0xffffffff, 0xffffffff, 0xffffffff, 0xffffffff, 0xffffffff, 0xffffffff
    .long 0xffffffff, 0xffffffff, 0xffffffff, 0xffffffff, 0xffffffff, 0xffffffff, 0xffffffff, 0xffffffff, 0xffffffff, 0xffffffff, 0xffffffff, 0xffffffff, 0xffffffff, 0xffffffff, 0xffffffff, 0xffffffff
    .long 0xffffffff, 0xffffffff, 0xffffffff, 0xffffffff, 0xffffffff, 0xffffffff, 0xffffffff, 0xffffffff, 0xffffffff, 0xffffffff, 0xffffffff, 0xffffffff, 0xffffffff, 0xffffffff, 0xffffffff, 0xffffffff
    .long 0xa08, 0x18a03, 0x8a13, 0x8a23, 0x8a33, 0x8a43, 0x8a53, 0x8a63, 0x8a73, 0x8a83, 0x8a93, 0x8aa3, 0x8ab3, 0x8ac3, 0x8ad3, 0x8ae3
    .long 0x8af3, 0x8b03, 0x8b13, 0x8b23, 0x8b33, 0x8b43, 0x8b53, 0x8b63, 0x8b73, 0x8b83, 0x8b93, 0x8ba3, 0x8bb3, 0x8bc3, 0x8be3, 0xffffffff
    .long 0xffffffff, 0xffffffff, 0xffffffff, 0xffffffff, 0xffffffff, 0xffffffff, 0xffffffff, 0xffffffff, 0xffffffff, 0xffffffff, 0xffffffff, 0xffffffff, 0xffffffff, 0xffffffff, 0xffffffff, 0xffffffff
    .long 0xffffffff, 0xffffffff, 0xffffffff, 0xffffffff, 0xffffffff, 0xffffffff, 0xffffffff, 0xffffffff, 0xffffffff, 0xffffffff, 0xffffffff, 0xffffffff, 0xffffffff, 0xffffffff, 0xffffffff, 0xffffffff
    .long 0xffffffff, 0xffffffff, 0xffffffff, 0xffffffff, 0xffffffff, 0xffffffff, 0xffffffff, 0xffffffff, 0xffffffff, 0xffffffff, 0xffffffff, 0xffffffff, 0xffffffff, 0xffffffff, 0xffffffff, 0xffffffff
    .long 0xc08, 0x18c03, 0x8c13, 0x8c23, 0x8c33, 0x8c43, 0x8c53, 0x8c63, 0x8c73, 0x8c83, 0x8c93, 0x8ca3, 0x8cb3, 0x8cc3, 0x8cd3, 0x8ce3
    .long 0x8cf3, 0x8d03, 0x8d13, 0x8d23, 0x8d33, 0x8d43, 0x8d53, 0x8d63, 0x8d73, 0x8d83, 0x8d93, 0x8da3, 0x8db3, 0x8dc3, 0x8de3, 0xffffffff
    .long 0xffffffff, 0xffffffff, 0xffffffff, 0xffffffff, 0xffffffff, 0xffffffff, 0xffffffff, 0xffffffff, 0xffffffff, 0xffffffff, 0xffffffff, 0xffffffff, 0xffffffff, 0xffffffff, 0xffffffff, 0xffffffff
    .long 0xffffffff, 0xffffffff, 0xffffffff, 0xffffffff, 0xffffffff, 0xffffffff, 0xffffffff, 0xffffffff, 0xffffffff, 0xffffffff, 0xffffffff, 0xffffffff, 0xffffffff, 0xffffffff, 0xffffffff, 0xffffffff
    .long 0xffffffff, 0xffffffff, 0xffffffff, 0xffffffff, 0xffffffff, 0xffffffff, 0xffffffff, 0xffffffff, 0xffffffff, 0xffffffff, 0xffffffff, 0xffffffff, 0xffffffff, 0xffffffff, 0xffffffff, 0xffffffff
    .long 0xe08, 0x18e03, 0x8e13, 0x8e23, 0x8e33, 0x8e43, 0x8e53, 0x8e63, 0x8e73, 0x8e83, 0x8e93, 0x8ea3, 0x8eb3, 0x8ec3, 0x8ed3, 0x8ee3
    .long 0x8ef3, 0x8f03, 0x8f13, 0x8f23, 0x8f33, 0x8f43, 0x8f53, 0x8f63, 0x8f73, 0x8f83, 0x8f93, 0x8fa3, 0x8fb3, 0x8fc3, 0x8fe3, 0xffffffff
    .long 0xffffffff, 0xffffffff, 0xffffffff, 0xffffffff, 0xffffffff, 0xffffffff, 0xffffffff, 0xffffffff, 0xffffffff, 0xffffffff, 0xffffffff, 0xffffffff, 0xffffffff, 0xffffffff, 0xffffffff, 0xffffffff
    .long 0xffffffff, 0xffffffff, 0xffffffff, 0xffffffff, 0xffffffff, 0xffffffff, 0xffffffff, 0xffffffff, 0xffffffff, 0xffffffff, 0xffffffff, 0xffffffff, 0xffffffff, 0xffffffff, 0xffffffff, 0xffffffff
    .long 0xffffffff, 0xffffffff, 0xffffffff, 0xffffffff, 0xffffffff, 0xffffffff, 0xffffffff, 0xffffffff, 0xffffffff, 0xffffffff, 0xffffffff, 0xffffffff, 0xffffffff, 0xffffffff, 0xffffffff, 0xffffffff
    .long 0x1008, 0x19003, 0x9013, 0x9023, 0x9033, 0x9043, 0x9053, 0x9063, 0x9073, 0x9083, 0x9093, 0x90a3, 0x90b3, 0x90c3, 0x90d3, 0x90e3
    .long 0x90f3, 0x9103, 0x9113, 0x9123, 0x9133, 0x9143, 0x9153, 0x9163, 0x9173, 0x9183, 0x9193, 0x91a3, 0x91b3, 0x91c3, 0x91e3, 0xffffffff
    .long 0xffffffff, 0xffffffff, 0xffffffff, 0xffffffff, 0xffffffff, 0xffffffff, 0xffffffff, 0xffffffff, 0xffffffff, 0xffffffff, 0xffffffff, 0xffffffff, 0xffffffff, 0xffffffff, 0xffffffff, 0xffffffff
    .long 0xffffffff, 0xffffffff, 0xffffffff, 0xffffffff, 0xffffffff, 0xffffffff, 0xffffffff, 0xffffffff, 0xffffffff, 0xffffffff, 0xffffffff, 0xffffffff, 0xffffffff, 0xffffffff, 0xffffffff, 0xffffffff
    .long 0xffffffff, 0xffffffff, 0xffffffff, 0xffffffff, 0xffffffff, 0xffffffff, 0xffffffff, 0xffffffff, 0xffffffff, 0xffffffff, 0xffffffff, 0xffffffff, 0xffffffff, 0xffffffff, 0xffffffff, 0xffffffff
    .long 0x1208, 0x19203, 0x9213, 0x9223, 0x9233, 0x9243, 0x9253, 0x9263, 0x9273, 0x9283, 0x9293, 0x92a3, 0x92b3, 0x92c3, 0x92d3, 0x92e3
    .long 0x92f3, 0x9303, 0x9313, 0x9323, 0x9333, 0x9343, 0x9353, 0x9363, 0x9373, 0x9383, 0x9393, 0x93a3, 0x93b3, 0x93c3, 0x93e3, 0xffffffff
    .long 0xffffffff, 0xffffffff, 0xffffffff, 0xffffffff, 0xffffffff, 0xffffffff, 0xffffffff, 0xffffffff, 0xffffffff, 0xffffffff, 0xffffffff, 0xffffffff, 0xffffffff, 0xffffffff, 0xffffffff, 0xffffffff
    .long 0xffffffff, 0xffffffff, 0xffffffff, 0xffffffff, 0xffffffff, 0xffffffff, 0xffffffff, 0xffffffff, 0xffffffff, 0xffffffff, 0xffffffff, 0xffffffff, 0xffffffff, 0xffffffff, 0xffffffff, 0xffffffff
    .long 0xffffffff, 0xffffffff, 0xffffffff, 0xffffffff, 0xffffffff, 0xffffffff, 0xffffffff, 0xffffffff, 0xffffffff, 0xffffffff, 0xffffffff, 0xffffffff, 0xffffffff, 0xffffffff, 0xffffffff, 0xffffffff
    .long 0x1408, 0x19403, 0x9413, 0x9423, 0x9433, 0x9443, 0x9453, 0x9463, 0x9473, 0x9483, 0x9493, 0x94a3, 0x94b3, 0x94c3, 0x94d3, 0x94e3
    .long 0x94f3, 0x9503, 0x9513, 0x9523, 0x9533, 0x9543, 0x9553, 0x9563, 0x9573, 0x9583, 0x9593, 0x95a3, 0x95b3, 0x95c3, 0x95e3, 0xffffffff
    .long 0xffffffff, 0xffffffff, 0xffffffff, 0xffffffff, 0xffffffff, 0xffffffff, 0xffffffff, 0xffffffff, 0xffffffff, 0xffffffff, 0xffffffff, 0xffffffff, 0xffffffff, 0xffffffff, 0xffffffff, 0xffffffff
    .long 0xffffffff, 0xffffffff, 0xffffffff, 0xffffffff, 0xffffffff, 0xffffffff, 0xffffffff, 0xffffffff, 0xffffffff, 0xffffffff, 0xffffffff, 0xffffffff, 0xffffffff, 0xffffffff, 0xffffffff, 0xffffffff
    .long 0xffffffff, 0xffffffff, 0xffffffff, 0xffffffff, 0xffffffff, 0xffffffff, 0xffffffff, 0xffffffff, 0xffffffff, 0xffffffff, 0xffffffff, 0xffffffff, 0xffffffff, 0xffffffff, 0xffffffff, 0xffffffff
    .long 0x1608, 0x19603, 0x9613, 0x9623, 0x9633, 0x9643, 0x9653, 0x9663, 0x9673, 0x9683, 0x9693, 0x96a3, 0x96b3, 0x96c3, 0x96d3, 0x96e3
    .long 0x96f3, 0x9703, 0x9713, 0x9723, 0x9733, 0x9743, 0x9753, 0x9763, 0x9773, 0x9783, 0x9793, 0x97a3, 0x97b3, 0x97c3, 0x97e3, 0xffffffff
    .long 0xffffffff, 0xffffffff, 0xffffffff, 0xffffffff, 0xffffffff, 0xffffffff, 0xffffffff, 0xffffffff, 0xffffffff, 0xffffffff, 0xffffffff, 0xffffffff, 0xffffffff, 0xffffffff, 0xffffffff, 0xffffffff
    .long 0xffffffff, 0xffffffff, 0xffffffff, 0xffffffff, 0xffffffff, 0xffffffff, 0xffffffff, 0xffffffff, 0xffffffff, 0xffffffff, 0xffffffff, 0xffffffff, 0xffffffff, 0xffffffff, 0xffffffff, 0xffffffff
    .long 0xffffffff, 0xffffffff, 0xffffffff, 0xffffffff, 0xffffffff, 0xffffffff, 0xffffffff, 0xffffffff, 0xffffffff, 0xffffffff, 0xffffffff, 0xffffffff, 0xffffffff, 0xffffffff, 0xffffffff, 0xffffffff
    .long 0x1808, 0x19803, 0x9813, 0x9823, 0x9833, 0x9843, 0x9853, 0x9863, 0x9873, 0x9883, 0x9893, 0x98a3, 0x98b3, 0x98c3, 0x98d3, 0x98e3
    .long 0x98f3, 0x9903, 0x9913, 0x9923, 0x9933, 0x9943, 0x9953, 0x9963, 0x9973, 0x9983, 0x9993, 0x99a3, 0x99b3, 0x99c3, 0x99e3, 0xffffffff
    .long 0xffffffff, 0xffffffff, 0xffffffff, 0xffffffff, 0xffffffff, 0xffffffff, 0xffffffff, 0xffffffff, 0xffffffff, 0xffffffff, 0xffffffff, 0xffffffff, 0xffffffff, 0xffffffff, 0xffffffff, 0xffffffff
    .long 0xffffffff, 0xffffffff, 0xffffffff, 0xffffffff, 0xffffffff, 0xffffffff, 0xffffffff, 0xffffffff, 0xffffffff, 0xffffffff, 0xffffffff, 0xffffffff, 0xffffffff, 0xffffffff, 0xffffffff, 0xffffffff
    .long 0xffffffff, 0xffffffff, 0xffffffff, 0xffffffff, 0xffffffff, 0xffffffff, 0xffffffff, 0xffffffff, 0xffffffff, 0xffffffff, 0xffffffff, 0xffffffff, 0xffffffff, 0xffffffff, 0xffffffff, 0xffffffff
    .long 0x1a08, 0x19a03, 0x9a13, 0x9a23, 0x9a33, 0x9a43, 0x9a53, 0x9a63, 0x9a73, 0x9a83, 0x9a93, 0x9aa3, 0x9ab3, 0x9ac3, 0x9ad3, 0x9ae3
    .long 0x9af3, 0x9b03, 0x9b13, 0x9b23, 0x9b33, 0x9b43, 0x9b53, 0x9b63, 0x9b73, 0x9b83, 0x9b93, 0x9ba3, 0x9bb3, 0x9bc3, 0x9be3, 0xffffffff
    .long 0xffffffff, 0xffffffff, 0xffffffff, 0xffffffff, 0xffffffff, 0xffffffff, 0xffffffff, 0xffffffff, 0xffffffff, 0xffffffff, 0xffffffff, 0xffffffff, 0xffffffff, 0xffffffff, 0xffffffff, 0xffffffff
    .long 0xffffffff, 0xffffffff, 0xffffffff, 0xffffffff, 0xffffffff, 0xffffffff, 0xffffffff, 0xffffffff, 0xffffffff, 0xffffffff, 0xffffffff, 0xffffffff, 0xffffffff, 0xffffffff, 0xffffffff, 0xffffffff
    .long 0xffffffff, 0xffffffff, 0xffffffff, 0xffffffff, 0xffffffff, 0xffffffff, 0xffffffff, 0xffffffff, 0xffffffff, 0xffffffff, 0xffffffff, 0xffffffff, 0xffffffff, 0xffffffff, 0xffffffff, 0xffffffff
    .long 0x1c08, 0x19c03, 0x9c13, 0x9c23, 0x9c33, 0x9c43, 0x9c53, 0x9c63, 0x9c73, 0x9c83, 0x9c93, 0x9ca3, 0x9cb3, 0x9cc3, 0x9cd3, 0x9ce3
    .long 0x9cf3, 0x9d03, 0x9d13, 0x9d23, 0x9d33, 0x9d43, 0x9d53, 0x9d63, 0x9d73, 0x9d83, 0x9d93, 0x9da3, 0x9db3, 0x9dc3, 0x9de3, 0xffffffff
    .long 0xffffffff, 0xffffffff, 0xffffffff, 0xffffffff, 0xffffffff, 0xffffffff, 0xffffffff, 0xffffffff, 0xffffffff, 0xffffffff, 0xffffffff, 0xffffffff, 0xffffffff, 0xffffffff, 0xffffffff, 0xffffffff
    .long 0xffffffff, 0xffffffff, 0xffffffff, 0xffffffff, 0xffffffff, 0xffffffff, 0xffffffff, 0xffffffff, 0xffffffff, 0xffffffff, 0xffffffff, 0xffffffff, 0xffffffff, 0xffffffff, 0xffffffff, 0xffffffff
    .long 0xffffffff, 0xffffffff, 0xffffffff, 0xffffffff, 0xffffffff, 0xffffffff, 0xffffffff, 0xffffffff, 0xffffffff, 0xffffffff, 0xffffffff, 0xffffffff, 0xffffffff, 0xffffffff, 0xffffffff, 0xffffffff
    .long 0x1e08, 0x19e03, 0x9e13, 0x9e23, 0x9e33, 0x9e43, 0x9e53, 0x9e63, 0x9e73, 0x9e83, 0x9e93, 0x9ea3, 0x9eb3, 0x9ec3, 0x9ed3, 0x9ee3
    .long 0x9ef3, 0x9f03, 0x9f13, 0x9f23, 0x9f33, 0x9f43, 0x9f53, 0x9f63, 0x9f73, 0x9f83, 0x9f93, 0x9fa3, 0x9fb3, 0x9fc3, 0x9fe3, 0xffffffff
    .long 0xffffffff, 0xffffffff, 0xffffffff, 0xffffffff, 0xffffffff, 0xffffffff, 0xffffffff, 0xffffffff, 0xffffffff, 0xffffffff, 0xffffffff, 0xffffffff, 0xffffffff, 0xffffffff, 0xffffffff, 0xffffffff
    .long 0xffffffff, 0xffffffff, 0xffffffff, 0xffffffff, 0xffffffff, 0xffffffff, 0xffffffff, 0xffffffff, 0xffffffff, 0xffffffff, 0xffffffff, 0xffffffff, 0xffffffff, 0xffffffff, 0xffffffff, 0xffffffff
    .long 0xffffffff, 0xffffffff, 0xffffffff, 0xffffffff, 0xffffffff, 0xffffffff, 0xffffffff, 0xffffffff, 0xffffffff, 0xffffffff, 0xffffffff, 0xffffffff, 0xffffffff, 0xffffffff, 0xffffffff, 0xffffffff
    .long 0x2008, 0x1a003, 0xa013, 0xa023, 0xa033, 0xa043, 0xa053, 0xa063, 0xa073, 0xa083, 0xa093, 0xa0a3, 0xa0b3, 0xa0c3, 0xa0d3, 0xa0e3
    .long 0xa0f3, 0xa103, 0xa113, 0xa123, 0xa133, 0xa143, 0xa153, 0xa163, 0xa173, 0xa183, 0xa193, 0xa1a3, 0xa1b3, 0xa1c3, 0xa1e3, 0xffffffff
    .long 0xffffffff, 0xffffffff, 0xffffffff, 0xffffffff, 0xffffffff, 0xffffffff, 0xffffffff, 0xffffffff, 0xffffffff, 0xffffffff, 0xffffffff, 0xffffffff, 0xffffffff, 0xffffffff, 0xffffffff, 0xffffffff
    .long 0xffffffff, 0xffffffff, 0xffffffff, 0xffffffff, 0xffffffff, 0xffffffff, 0xffffffff, 0xffffffff, 0xffffffff, 0xffffffff, 0xffffffff, 0xffffffff, 0xffffffff, 0xffffffff, 0xffffffff, 0xffffffff
    .long 0xffffffff, 0xffffffff, 0xffffffff, 0xffffffff, 0xffffffff, 0xffffffff, 0xffffffff, 0xffffffff, 0xffffffff, 0xffffffff, 0xffffffff, 0xffffffff, 0xffffffff, 0xffffffff, 0xffffffff, 0xffffffff
    .long 0x2208, 0x1a203, 0xa213, 0xa223, 0xa233, 0xa243, 0xa253, 0xa263, 0xa273, 0xa283, 0xa293, 0xa2a3, 0xa2b3, 0xa2c3, 0xa2d3, 0xa2e3
    .long 0xa2f3, 0xa303, 0xa313, 0xa323, 0xa333, 0xa343, 0xa353, 0xa363, 0xa373, 0xa383, 0xa393, 0xa3a3, 0xa3b3, 0xa3c3, 0xa3e3, 0xffffffff
    .long 0xffffffff, 0xffffffff, 0xffffffff, 0xffffffff, 0xffffffff, 0xffffffff, 0xffffffff, 0xffffffff, 0xffffffff, 0xffffffff, 0xffffffff, 0xffffffff, 0xffffffff, 0xffffffff, 0xffffffff, 0xffffffff
    .long 0xffffffff, 0xffffffff, 0xffffffff, 0xffffffff, 0xffffffff, 0xffffffff, 0xffffffff, 0xffffffff, 0xffffffff, 0xffffffff, 0xffffffff, 0xffffffff, 0xffffffff, 0xffffffff, 0xffffffff, 0xffffffff
    .long 0xffffffff, 0xffffffff, 0xffffffff, 0xffffffff, 0xffffffff, 0xffffffff, 0xffffffff, 0xffffffff, 0xffffffff, 0xffffffff, 0xffffffff, 0xffffffff, 0xffffffff, 0xffffffff, 0xffffffff, 0xffffffff
    .long 0x2408, 0x1a403, 0xa413, 0xa423, 0xa433, 0xa443, 0xa453, 0xa463, 0xa473, 0xa483, 0xa493, 0xa4a3, 0xa4b3, 0xa4c3, 0xa4d3, 0xa4e3
    .long 0xa4f3, 0xa503, 0xa513, 0xa523, 0xa533, 0xa543, 0xa553, 0xa563, 0xa573, 0xa583, 0xa593, 0xa5a3, 0xa5b3, 0xa5c3, 0xa5e3, 0xffffffff
    .long 0xffffffff, 0xffffffff, 0xffffffff, 0xffffffff, 0xffffffff, 0xffffffff, 0xffffffff, 0xffffffff, 0xffffffff, 0xffffffff, 0xffffffff, 0xffffffff, 0xffffffff, 0xffffffff, 0xffffffff, 0xffffffff
    .long 0xffffffff, 0xffffffff, 0xffffffff, 0xffffffff, 0xffffffff, 0xffffffff, 0xffffffff, 0xffffffff, 0xffffffff, 0xffffffff, 0xffffffff, 0xffffffff, 0xffffffff, 0xffffffff, 0xffffffff, 0xffffffff
    .long 0xffffffff, 0xffffffff, 0xffffffff, 0xffffffff, 0xffffffff, 0xffffffff, 0xffffffff, 0xffffffff, 0xffffffff, 0xffffffff, 0xffffffff, 0xffffffff, 0xffffffff, 0xffffffff, 0xffffffff, 0xffffffff
    .long 0x2608, 0x1a603, 0xa613, 0xa623, 0xa633, 0xa643, 0xa653, 0xa663, 0xa673, 0xa683, 0xa693, 0xa6a3, 0xa6b3, 0xa6c3, 0xa6d3, 0xa6e3
    .long 0xa6f3, 0xa703, 0xa713, 0xa723, 0xa733, 0xa743, 0xa753, 0xa763, 0xa773, 0xa783, 0xa793, 0xa7a3, 0xa7b3, 0xa7c3, 0xa7e3, 0xffffffff
    .long 0xffffffff, 0xffffffff, 0xffffffff, 0xffffffff, 0xffffffff, 0xffffffff, 0xffffffff, 0xffffffff, 0xffffffff, 0xffffffff, 0xffffffff, 0xffffffff, 0xffffffff, 0xffffffff, 0xffffffff, 0xffffffff
    .long 0xffffffff, 0xffffffff, 0xffffffff, 0xffffffff, 0xffffffff, 0xffffffff, 0xffffffff, 0xffffffff, 0xffffffff, 0xffffffff, 0xffffffff, 0xffffffff, 0xffffffff, 0xffffffff, 0xffffffff, 0xffffffff
    .long 0xffffffff, 0xffffffff, 0xffffffff, 0xffffffff, 0xffffffff, 0xffffffff, 0xffffffff, 0xffffffff, 0xffffffff, 0xffffffff, 0xffffffff, 0xffffffff, 0xffffffff, 0xffffffff, 0xffffffff, 0xffffffff
    .long 0x2808, 0x1a803, 0xa813, 0xa823, 0xa833, 0xa843, 0xa853, 0xa863, 0xa873, 0xa883, 0xa893, 0xa8a3, 0xa8b3, 0xa8c3, 0xa8d3, 0xa8e3
    .long 0xa8f3, 0xa903, 0xa913, 0xa923, 0xa933, 0xa943, 0xa953, 0xa963, 0xa973, 0xa983, 0xa993, 0xa9a3, 0xa9b3, 0xa9c3, 0xa9e3, 0xffffffff
    .long 0xffffffff, 0xffffffff, 0xffffffff, 0xffffffff, 0xffffffff, 0xffffffff, 0xffffffff, 0xffffffff, 0xffffffff, 0xffffffff, 0xffffffff, 0xffffffff, 0xffffffff, 0xffffffff, 0xffffffff, 0xffffffff
    .long 0xffffffff, 0xffffffff, 0xffffffff, 0xffffffff, 0xffffffff, 0xffffffff, 0xffffffff, 0xffffffff, 0xffffffff, 0xffffffff, 0xffffffff, 0xffffffff, 0xffffffff, 0xffffffff, 0xffffffff, 0xffffffff
    .long 0xffffffff, 0xffffffff, 0xffffffff, 0xffffffff, 0xffffffff, 0xffffffff, 0xffffffff, 0xffffffff, 0xffffffff, 0xffffffff, 0xffffffff, 0xffffffff, 0xffffffff, 0xffffffff, 0xffffffff, 0xffffffff
    .long 0x2a08, 0x1aa03, 0xaa13, 0xaa23, 0xaa33, 0xaa43, 0xaa53, 0xaa63, 0xaa73, 0xaa83, 0xaa93, 0xaaa3, 0xaab3, 0xaac3, 0xaad3, 0xaae3
    .long 0xaaf3, 0xab03, 0xab13, 0xab23, 0xab33, 0xab43, 0xab53, 0xab63, 0xab73, 0xab83, 0xab93, 0xaba3, 0xabb3, 0xabc3, 0xabe3, 0xffffffff
    .long 0xffffffff, 0xffffffff, 0xffffffff, 0xffffffff, 0xffffffff, 0xffffffff, 0xffffffff, 0xffffffff, 0xffffffff, 0xffffffff, 0xffffffff, 0xffffffff, 0xffffffff, 0xffffffff, 0xffffffff, 0xffffffff
    .long 0xffffffff, 0xffffffff, 0xffffffff, 0xffffffff, 0xffffffff, 0xffffffff, 0xffffffff, 0xffffffff, 0xffffffff, 0xffffffff, 0xffffffff, 0xffffffff, 0xffffffff, 0xffffffff, 0xffffffff, 0xffffffff
    .long 0xffffffff, 0xffffffff, 0xffffffff, 0xffffffff, 0xffffffff, 0xffffffff, 0xffffffff, 0xffffffff, 0xffffffff, 0xffffffff, 0xffffffff, 0xffffffff, 0xffffffff, 0xffffffff, 0xffffffff, 0xffffffff
    .long 0x2c08, 0x1ac03, 0xac13, 0xac23, 0xac33, 0xac43, 0xac53, 0xac63, 0xac73, 0xac83, 0xac93, 0xaca3, 0xacb3, 0xacc3, 0xacd3, 0xace3
    .long 0xacf3, 0xad03, 0xad13, 0xad23, 0xad33, 0xad43, 0xad53, 0xad63, 0xad73, 0xad83, 0xad93, 0xada3, 0xadb3, 0xadc3, 0xade3, 0xffffffff
    .long 0xffffffff, 0xffffffff, 0xffffffff, 0xffffffff, 0xffffffff, 0xffffffff, 0xffffffff, 0xffffffff, 0xffffffff, 0xffffffff, 0xffffffff, 0xffffffff, 0xffffffff, 0xffffffff, 0xffffffff, 0xffffffff
    .long 0xffffffff, 0xffffffff, 0xffffffff, 0xffffffff, 0xffffffff, 0xffffffff, 0xffffffff, 0xffffffff, 0xffffffff, 0xffffffff, 0xffffffff, 0xffffffff, 0xffffffff, 0xffffffff, 0xffffffff, 0xffffffff
    .long 0xffffffff, 0xffffffff, 0xffffffff, 0xffffffff, 0xffffffff, 0xffffffff, 0xffffffff, 0xffffffff, 0xffffffff, 0xffffffff, 0xffffffff, 0xffffffff, 0xffffffff, 0xffffffff, 0xffffffff, 0xffffffff
    .long 0x2e08, 0x1ae03, 0xae13, 0xae23, 0xae33, 0xae43, 0xae53, 0xae63, 0xae73, 0xae83, 0xae93, 0xaea3, 0xaeb3, 0xaec3, 0xaed3, 0xaee3
    .long 0xaef3, 0xaf03, 0xaf13, 0xaf23, 0xaf33, 0xaf43, 0xaf53, 0xaf63, 0xaf73, 0xaf83, 0xaf93, 0xafa3, 0xafb3, 0xafc3, 0xafe3, 0xffffffff
    .long 0xffffffff, 0xffffffff, 0xffffffff, 0xffffffff, 0xffffffff, 0xffffffff, 0xffffffff, 0xffffffff, 0xffffffff, 0xffffffff, 0xffffffff, 0xffffffff, 0xffffffff, 0xffffffff, 0xffffffff, 0xffffffff
    .long 0xffffffff, 0xffffffff, 0xffffffff, 0xffffffff, 0xffffffff, 0xffffffff, 0xffffffff, 0xffffffff, 0xffffffff, 0xffffffff, 0xffffffff, 0xffffffff, 0xffffffff, 0xffffffff, 0xffffffff, 0xffffffff
    .long 0xffffffff, 0xffffffff, 0xffffffff, 0xffffffff, 0xffffffff, 0xffffffff, 0xffffffff, 0xffffffff, 0xffffffff, 0xffffffff, 0xffffffff, 0xffffffff, 0xffffffff, 0xffffffff, 0xffffffff, 0xffffffff
    .long 0x3008, 0x1b003, 0xb013, 0xb023, 0xb033, 0xb043, 0xb053, 0xb063, 0xb073, 0xb083, 0xb093, 0xb0a3, 0xb0b3, 0xb0c3, 0xb0d3, 0xb0e3
    .long 0xb0f3, 0xb103, 0xb113, 0xb123, 0xb133, 0xb143, 0xb153, 0xb163, 0xb173, 0xb183, 0xb193, 0xb1a3, 0xb1b3, 0xb1c3, 0xb1e3, 0xffffffff
    .long 0xffffffff, 0xffffffff, 0xffffffff, 0xffffffff, 0xffffffff, 0xffffffff, 0xffffffff, 0xffffffff, 0xffffffff, 0xffffffff, 0xffffffff, 0xffffffff, 0xffffffff, 0xffffffff, 0xffffffff, 0xffffffff
    .long 0xffffffff, 0xffffffff, 0xffffffff, 0xffffffff, 0xffffffff, 0xffffffff, 0xffffffff, 0xffffffff, 0xffffffff, 0xffffffff, 0xffffffff, 0xffffffff, 0xffffffff, 0xffffffff, 0xffffffff, 0xffffffff
    .long 0xffffffff, 0xffffffff, 0xffffffff, 0xffffffff, 0xffffffff, 0xffffffff, 0xffffffff, 0xffffffff, 0xffffffff, 0xffffffff, 0xffffffff, 0xffffffff, 0xffffffff, 0xffffffff, 0xffffffff, 0xffffffff
    .long 0x3208, 0x1b203, 0xb213, 0xb223, 0xb233, 0xb243, 0xb253, 0xb263, 0xb273, 0xb283, 0xb293, 0xb2a3, 0xb2b3, 0xb2c3, 0xb2d3, 0xb2e3
    .long 0xb2f3, 0xb303, 0xb313, 0xb323, 0xb333, 0xb343, 0xb353, 0xb363, 0xb373, 0xb383, 0xb393, 0xb3a3, 0xb3b3, 0xb3c3, 0xb3e3, 0xffffffff
    .long 0xffffffff, 0xffffffff, 0xffffffff, 0xffffffff, 0xffffffff, 0xffffffff, 0xffffffff, 0xffffffff, 0xffffffff, 0xffffffff, 0xffffffff, 0xffffffff, 0xffffffff, 0xffffffff, 0xffffffff, 0xffffffff
    .long 0xffffffff, 0xffffffff, 0xffffffff, 0xffffffff, 0xffffffff, 0xffffffff, 0xffffffff, 0xffffffff, 0xffffffff, 0xffffffff, 0xffffffff, 0xffffffff, 0xffffffff, 0xffffffff, 0xffffffff, 0xffffffff
    .long 0xffffffff, 0xffffffff, 0xffffffff, 0xffffffff, 0xffffffff, 0xffffffff, 0xffffffff, 0xffffffff, 0xffffffff, 0xffffffff, 0xffffffff, 0xffffffff, 0xffffffff, 0xffffffff, 0xffffffff, 0xffffffff
    .long 0x3408, 0x1b403, 0xb413, 0xb423, 0xb433, 0xb443, 0xb453, 0xb463, 0xb473, 0xb483, 0xb493, 0xb4a3, 0xb4b3, 0xb4c3, 0xb4d3, 0xb4e3
    .long 0xb4f3, 0xb503, 0xb513, 0xb523, 0xb533, 0xb543, 0xb553, 0xb563, 0xb573, 0xb583, 0xb593, 0xb5a3, 0xb5b3, 0xb5c3, 0xb5e3, 0xffffffff
    .long 0xffffffff, 0xffffffff, 0xffffffff, 0xffffffff, 0xffffffff, 0xffffffff, 0xffffffff, 0xffffffff, 0xffffffff, 0xffffffff, 0xffffffff, 0xffffffff, 0xffffffff, 0xffffffff, 0xffffffff, 0xffffffff
    .long 0xffffffff, 0xffffffff, 0xffffffff, 0xffffffff, 0xffffffff, 0xffffffff, 0xffffffff, 0xffffffff, 0xffffffff, 0xffffffff, 0xffffffff, 0xffffffff, 0xffffffff, 0xffffffff, 0xffffffff, 0xffffffff
    .long 0xffffffff, 0xffffffff, 0xffffffff, 0xffffffff, 0xffffffff, 0xffffffff, 0xffffffff, 0xffffffff, 0xffffffff, 0xffffffff, 0xffffffff, 0xffffffff, 0xffffffff, 0xffffffff, 0xffffffff, 0xffffffff
    .long 0x3608, 0x1b603, 0xb613, 0xb623, 0xb633, 0xb643, 0xb653, 0xb663, 0xb673, 0xb683, 0xb693, 0xb6a3, 0xb6b3, 0xb6c3, 0xb6d3, 0xb6e3
    .long 0xb6f3, 0xb703, 0xb713, 0xb723, 0xb733, 0xb743, 0xb753, 0xb763, 0xb773, 0xb783, 0xb793, 0xb7a3, 0xb7b3, 0xb7c3, 0xb7e3, 0xffffffff
    .long 0xffffffff, 0xffffffff, 0xffffffff, 0xffffffff, 0xffffffff, 0xffffffff, 0xffffffff, 0xffffffff, 0xffffffff, 0xffffffff, 0xffffffff, 0xffffffff, 0xffffffff, 0xffffffff, 0xffffffff, 0xffffffff
    .long 0xffffffff, 0xffffffff, 0xffffffff, 0xffffffff, 0xffffffff, 0xffffffff, 0xffffffff, 0xffffffff, 0xffffffff, 0xffffffff, 0xffffffff, 0xffffffff, 0xffffffff, 0xffffffff, 0xffffffff, 0xffffffff
    .long 0xffffffff, 0xffffffff, 0xffffffff, 0xffffffff, 0xffffffff, 0xffffffff, 0xffffffff, 0xffffffff, 0xffffffff, 0xffffffff, 0xffffffff, 0xffffffff, 0xffffffff, 0xffffffff, 0xffffffff, 0xffffffff
    .long 0x3808, 0x1b803, 0xb813, 0xb823, 0xb833, 0xb843, 0xb853, 0xb863, 0xb873, 0xb883, 0xb893, 0xb8a3, 0xb8b3, 0xb8c3, 0xb8d3, 0xb8e3
    .long 0xb8f3, 0xb903, 0xb913, 0xb923, 0xb933, 0xb943, 0xb953, 0xb963, 0xb973, 0xb983, 0xb993, 0xb9a3, 0xb9b3, 0xb9c3, 0xb9e3, 0xffffffff
    .long 0xffffffff, 0xffffffff, 0xffffffff, 0xffffffff, 0xffffffff, 0xffffffff, 0xffffffff, 0xffffffff, 0xffffffff, 0xffffffff, 0xffffffff, 0xffffffff, 0xffffffff, 0xffffffff, 0xffffffff, 0xffffffff
    .long 0xffffffff, 0xffffffff, 0xffffffff, 0xffffffff, 0xffffffff, 0xffffffff, 0xffffffff, 0xffffffff, 0xffffffff, 0xffffffff, 0xffffffff, 0xffffffff, 0xffffffff, 0xffffffff, 0xffffffff, 0xffffffff
    .long 0xffffffff, 0xffffffff, 0xffffffff, 0xffffffff, 0xffffffff, 0xffffffff, 0xffffffff, 0xffffffff, 0xffffffff, 0xffffffff, 0xffffffff, 0xffffffff, 0xffffffff, 0xffffffff, 0xffffffff, 0xffffffff
    .long 0x3a08, 0x1ba03, 0xba13, 0xba23, 0xba33, 0xba43, 0xba53, 0xba63, 0xba73, 0xba83, 0xba93, 0xbaa3, 0xbab3, 0xbac3, 0xbad3, 0xbae3
    .long 0xbaf3, 0xbb03, 0xbb13, 0xbb23, 0xbb33, 0xbb43, 0xbb53, 0xbb63, 0xbb73, 0xbb83, 0xbb93, 0xbba3, 0xbbb3, 0xbbc3, 0xbbe3, 0xffffffff
    .long 0xffffffff, 0xffffffff, 0xffffffff, 0xffffffff, 0xffffffff, 0xffffffff, 0xffffffff, 0xffffffff, 0xffffffff, 0xffffffff, 0xffffffff, 0xffffffff, 0xffffffff, 0xffffffff, 0xffffffff, 0xffffffff
    .long 0xffffffff, 0xffffffff, 0xffffffff, 0xffffffff, 0xffffffff, 0xffffffff, 0xffffffff, 0xffffffff, 0xffffffff, 0xffffffff, 0xffffffff, 0xffffffff, 0xffffffff, 0xffffffff, 0xffffffff, 0xffffffff
    .long 0xffffffff, 0xffffffff, 0xffffffff, 0xffffffff, 0xffffffff, 0xffffffff, 0xffffffff, 0xffffffff, 0xffffffff, 0xffffffff, 0xffffffff, 0xffffffff, 0xffffffff, 0xffffffff, 0xffffffff, 0xffffffff
    .long 0x3c08, 0x1bc03, 0xbc13, 0xbc23, 0xbc33, 0xbc43, 0xbc53, 0xbc63, 0xbc73, 0xbc83, 0xbc93, 0xbca3, 0xbcb3, 0xbcc3, 0xbcd3, 0xbce3
    .long 0xbcf3, 0xbd03, 0xbd13, 0xbd23, 0xbd33, 0xbd43, 0xbd53, 0xbd63, 0xbd73, 0xbd83, 0xbd93, 0xbda3, 0xbdb3, 0xbdc3, 0xbde3, 0xffffffff
    .long 0xffffffff, 0xffffffff, 0xffffffff, 0xffffffff, 0xffffffff, 0xffffffff, 0xffffffff, 0xffffffff, 0xffffffff, 0xffffffff, 0xffffffff, 0xffffffff, 0xffffffff, 0xffffffff, 0xffffffff, 0xffffffff
    .long 0xffffffff, 0xffffffff, 0xffffffff, 0xffffffff, 0xffffffff, 0xffffffff, 0xffffffff, 0xffffffff, 0xffffffff, 0xffffffff, 0xffffffff, 0xffffffff, 0xffffffff, 0xffffffff, 0xffffffff, 0xffffffff
    .long 0xffffffff, 0xffffffff, 0xffffffff, 0xffffffff, 0xffffffff, 0xffffffff, 0xffffffff, 0xffffffff, 0xffffffff, 0xffffffff, 0xffffffff, 0xffffffff, 0xffffffff, 0xffffffff, 0xffffffff, 0xffffffff
    .long 0x3e08, 0x1be03, 0xbe13, 0xbe23, 0xbe33, 0xbe43, 0xbe53, 0xbe63, 0xbe73, 0xbe83, 0xbe93, 0xbea3, 0xbeb3, 0xbec3, 0xbed3, 0xbee3
    .long 0xbef3, 0xbf03, 0xbf13, 0xbf23, 0xbf33, 0xbf43, 0xbf53, 0xbf63, 0xbf73, 0xbf83, 0xbf93, 0xbfa3, 0xbfb3, 0xbfc3, 0xbfe3, 0xffffffff
    .long 0xffffffff, 0xffffffff, 0xffffffff, 0xffffffff, 0xffffffff, 0xffffffff, 0xffffffff, 0xffffffff, 0xffffffff, 0xffffffff, 0xffffffff, 0xffffffff, 0xffffffff, 0xffffffff, 0xffffffff, 0xffffffff
    .long 0xffffffff, 0xffffffff, 0xffffffff, 0xffffffff, 0xffffffff, 0xffffffff, 0xffffffff, 0xffffffff, 0xffffffff, 0xffffffff, 0xffffffff, 0xffffffff, 0xffffffff, 0xffffffff, 0xffffffff, 0xffffffff
    .long 0xffffffff, 0xffffffff, 0xffffffff, 0xffffffff, 0xffffffff, 0xffffffff, 0xffffffff, 0xffffffff, 0xffffffff, 0xffffffff, 0xffffffff, 0xffffffff, 0xffffffff, 0xffffffff, 0xffffffff, 0xffffffff
    .long 0x4008, 0x18005, 0x8015, 0x8025, 0x8035, 0x8045, 0x8055, 0x8065, 0x8075, 0x8085, 0x8095, 0x80a5, 0x80b5, 0x80c5, 0x80d5, 0x80e5
    .long 0x80f5, 0x8105, 0x8115, 0x8125, 0x8135, 0x8145, 0x8155, 0x8165, 0x8175, 0x8185, 0x8195, 0x81a5, 0x81b5, 0x81c5, 0x81e5, 0xffffffff
    .long 0xffffffff, 0xffffffff, 0xffffffff, 0xffffffff, 0xffffffff, 0xffffffff, 0xffffffff, 0xffffffff, 0xffffffff, 0xffffffff, 0xffffffff, 0xffffffff, 0xffffffff, 0xffffffff, 0xffffffff, 0xffffffff
    .long 0xffffffff, 0xffffffff, 0xffffffff, 0xffffffff, 0xffffffff, 0xffffffff, 0xffffffff, 0xffffffff, 0xffffffff, 0xffffffff, 0xffffffff, 0xffffffff, 0xffffffff, 0xffffffff, 0xffffffff, 0xffffffff
    .long 0xffffffff, 0xffffffff, 0xffffffff, 0xffffffff, 0xffffffff, 0xffffffff, 0xffffffff, 0xffffffff, 0xffffffff, 0xffffffff, 0xffffffff, 0xffffffff, 0xffffffff, 0xffffffff, 0xffffffff, 0xffffffff
    .long 0x4208, 0x18205, 0x8215, 0x8225, 0x8235, 0x8245, 0x8255, 0x8265, 0x8275, 0x8285, 0x8295, 0x82a5, 0x82b5, 0x82c5, 0x82d5, 0x82e5
    .long 0x82f5, 0x8305, 0x8315, 0x8325, 0x8335, 0x8345, 0x8355, 0x8365, 0x8375, 0x8385, 0x8395, 0x83a5, 0x83b5, 0x83c5, 0x83e5, 0xffffffff
    .long 0xffffffff, 0xffffffff, 0xffffffff, 0xffffffff, 0xffffffff, 0xffffffff, 0xffffffff, 0xffffffff, 0xffffffff, 0xffffffff, 0xffffffff, 0xffffffff, 0xffffffff, 0xffffffff, 0xffffffff, 0xffffffff
    .long 0xffffffff, 0xffffffff, 0xffffffff, 0xffffffff, 0xffffffff, 0xffffffff, 0xffffffff, 0xffffffff, 0xffffffff, 0xffffffff, 0xffffffff, 0xffffffff, 0xffffffff, 0xffffffff, 0xffffffff, 0xffffffff
    .long 0xffffffff, 0xffffffff, 0xffffffff, 0xffffffff, 0xffffffff, 0xffffffff, 0xffffffff, 0xffffffff, 0xffffffff, 0xffffffff, 0xffffffff, 0xffffffff, 0xffffffff, 0xffffffff, 0xffffffff, 0xffffffff
    .long 0x4408, 0x18405, 0x8415, 0x8425, 0x8435, 0x8445, 0x8455, 0x8465, 0x8475, 0x8485, 0x8495, 0x84a5, 0x84b5, 0x84c5, 0x84d5, 0x84e5
    .long 0x84f5, 0x8505, 0x8515, 0x8525, 0x8535, 0x8545, 0x8555, 0x8565, 0x8575, 0x8585, 0x8595, 0x85a5, 0x85b5, 0x85c5, 0x85e5, 0xffffffff
    .long 0xffffffff, 0xffffffff, 0xffffffff, 0xffffffff, 0xffffffff, 0xffffffff, 0xffffffff, 0xffffffff, 0xffffffff, 0xffffffff, 0xffffffff, 0xffffffff, 0xffffffff, 0xffffffff, 0xffffffff, 0xffffffff
    .long 0xffffffff, 0xffffffff, 0xffffffff, 0xffffffff, 0xffffffff, 0xffffffff, 0xffffffff, 0xffffffff, 0xffffffff, 0xffffffff, 0xffffffff, 0xffffffff, 0xffffffff, 0xffffffff, 0xffffffff, 0xffffffff
    .long 0xffffffff, 0xffffffff, 0xffffffff, 0xffffffff, 0xffffffff, 0xffffffff, 0xffffffff, 0xffffffff, 0xffffffff, 0xffffffff, 0xffffffff, 0xffffffff, 0xffffffff, 0xffffffff, 0xffffffff, 0xffffffff
    .long 0x4608, 0x18605, 0x8615, 0x8625, 0x8635, 0x8645, 0x8655, 0x8665, 0x8675, 0x8685, 0x8695, 0x86a5, 0x86b5, 0x86c5, 0x86d5, 0x86e5
    .long 0x86f5, 0x8705, 0x8715, 0x8725, 0x8735, 0x8745, 0x8755, 0x8765, 0x8775, 0x8785, 0x8795, 0x87a5, 0x87b5, 0x87c5, 0x87e5, 0xffffffff
    .long 0xffffffff, 0xffffffff, 0xffffffff, 0xffffffff, 0xffffffff, 0xffffffff, 0xffffffff, 0xffffffff, 0xffffffff, 0xffffffff, 0xffffffff, 0xffffffff, 0xffffffff, 0xffffffff, 0xffffffff, 0xffffffff
    .long 0xffffffff, 0xffffffff, 0xffffffff, 0xffffffff, 0xffffffff, 0xffffffff, 0xffffffff, 0xffffffff, 0xffffffff, 0xffffffff, 0xffffffff, 0xffffffff, 0xffffffff, 0xffffffff, 0xffffffff, 0xffffffff
    .long 0xffffffff, 0xffffffff, 0xffffffff, 0xffffffff, 0xffffffff, 0xffffffff, 0xffffffff, 0xffffffff, 0xffffffff, 0xffffffff, 0xffffffff, 0xffffffff, 0xffffffff, 0xffffffff, 0xffffffff, 0xffffffff
    .long 0x4808, 0x18805, 0x8815, 0x8825, 0x8835, 0x8845, 0x8855, 0x8865, 0x8875, 0x8885, 0x8895, 0x88a5, 0x88b5, 0x88c5, 0x88d5, 0x88e5
    .long 0x88f5, 0x8905, 0x8915, 0x8925, 0x8935, 0x8945, 0x8955, 0x8965, 0x8975, 0x8985, 0x8995, 0x89a5, 0x89b5, 0x89c5, 0x89e5, 0xffffffff
    .long 0xffffffff, 0xffffffff, 0xffffffff, 0xffffffff, 0xffffffff, 0xffffffff, 0xffffffff, 0xffffffff, 0xffffffff, 0xffffffff, 0xffffffff, 0xffffffff, 0xffffffff, 0xffffffff, 0xffffffff, 0xffffffff
    .long 0xffffffff, 0xffffffff, 0xffffffff, 0xffffffff, 0xffffffff, 0xffffffff, 0xffffffff, 0xffffffff, 0xffffffff, 0xffffffff, 0xffffffff, 0xffffffff, 0xffffffff, 0xffffffff, 0xffffffff, 0xffffffff
    .long 0xffffffff, 0xffffffff, 0xffffffff, 0xffffffff, 0xffffffff, 0xffffffff, 0xffffffff, 0xffffffff, 0xffffffff, 0xffffffff, 0xffffffff, 0xffffffff, 0xffffffff, 0xffffffff, 0xffffffff, 0xffffffff
    .long 0x4a08, 0x18a05, 0x8a15, 0x8a25, 0x8a35, 0x8a45, 0x8a55, 0x8a65, 0x8a75, 0x8a85, 0x8a95, 0x8aa5, 0x8ab5, 0x8ac5, 0x8ad5, 0x8ae5
    .long 0x8af5, 0x8b05, 0x8b15, 0x8b25, 0x8b35, 0x8b45, 0x8b55, 0x8b65, 0x8b75, 0x8b85, 0x8b95, 0x8ba5, 0x8bb5, 0x8bc5, 0x8be5, 0xffffffff
    .long 0xffffffff, 0xffffffff, 0xffffffff, 0xffffffff, 0xffffffff, 0xffffffff, 0xffffffff, 0xffffffff, 0xffffffff, 0xffffffff, 0xffffffff, 0xffffffff, 0xffffffff, 0xffffffff, 0xffffffff, 0xffffffff
    .long 0xffffffff, 0xffffffff, 0xffffffff, 0xffffffff, 0xffffffff, 0xffffffff, 0xffffffff, 0xffffffff, 0xffffffff, 0xffffffff, 0xffffffff, 0xffffffff, 0xffffffff, 0xffffffff, 0xffffffff, 0xffffffff
    .long 0xffffffff, 0xffffffff, 0xffffffff, 0xffffffff, 0xffffffff, 0xffffffff, 0xffffffff, 0xffffffff, 0xffffffff, 0xffffffff, 0xffffffff, 0xffffffff, 0xffffffff, 0xffffffff, 0xffffffff, 0xffffffff
    .long 0x4c08, 0x18c05, 0x8c15, 0x8c25, 0x8c35, 0x8c45, 0x8c55, 0x8c65, 0x8c75, 0x8c85, 0x8c95, 0x8ca5, 0x8cb5, 0x8cc5, 0x8cd5, 0x8ce5
    .long 0x8cf5, 0x8d05, 0x8d15, 0x8d25, 0x8d35, 0x8d45, 0x8d55, 0x8d65, 0x8d75, 0x8d85, 0x8d95, 0x8da5, 0x8db5, 0x8dc5, 0x8de5, 0xffffffff
    .long 0xffffffff, 0xffffffff, 0xffffffff, 0xffffffff, 0xffffffff, 0xffffffff, 0xffffffff, 0xffffffff, 0xffffffff, 0xffffffff, 0xffffffff, 0xffffffff, 0xffffffff, 0xffffffff, 0xffffffff, 0xffffffff
    .long 0xffffffff, 0xffffffff, 0xffffffff, 0xffffffff, 0xffffffff, 0xffffffff, 0xffffffff, 0xffffffff, 0xffffffff, 0xffffffff, 0xffffffff, 0xffffffff, 0xffffffff, 0xffffffff, 0xffffffff, 0xffffffff
    .long 0xffffffff, 0xffffffff, 0xffffffff, 0xffffffff, 0xffffffff, 0xffffffff, 0xffffffff, 0xffffffff, 0xffffffff, 0xffffffff, 0xffffffff, 0xffffffff, 0xffffffff, 0xffffffff, 0xffffffff, 0xffffffff
    .long 0x4e08, 0x18e05, 0x8e15, 0x8e25, 0x8e35, 0x8e45, 0x8e55, 0x8e65, 0x8e75, 0x8e85, 0x8e95, 0x8ea5, 0x8eb5, 0x8ec5, 0x8ed5, 0x8ee5
    .long 0x8ef5, 0x8f05, 0x8f15, 0x8f25, 0x8f35, 0x8f45, 0x8f55, 0x8f65, 0x8f75, 0x8f85, 0x8f95, 0x8fa5, 0x8fb5, 0x8fc5, 0x8fe5, 0xffffffff
    .long 0xffffffff, 0xffffffff, 0xffffffff, 0xffffffff, 0xffffffff, 0xffffffff, 0xffffffff, 0xffffffff, 0xffffffff, 0xffffffff, 0xffffffff, 0xffffffff, 0xffffffff, 0xffffffff, 0xffffffff, 0xffffffff
    .long 0xffffffff, 0xffffffff, 0xffffffff, 0xffffffff, 0xffffffff, 0xffffffff, 0xffffffff, 0xffffffff, 0xffffffff, 0xffffffff, 0xffffffff, 0xffffffff, 0xffffffff, 0xffffffff, 0xffffffff, 0xffffffff
    .long 0xffffffff, 0xffffffff, 0xffffffff, 0xffffffff, 0xffffffff, 0xffffffff, 0xffffffff, 0xffffffff, 0xffffffff, 0xffffffff, 0xffffffff, 0xffffffff, 0xffffffff, 0xffffffff, 0xffffffff, 0xffffffff
    .long 0x5008, 0x19005, 0x9015, 0x9025, 0x9035, 0x9045, 0x9055, 0x9065, 0x9075, 0x9085, 0x9095, 0x90a5, 0x90b5, 0x90c5, 0x90d5, 0x90e5
    .long 0x90f5, 0x9105, 0x9115, 0x9125, 0x9135, 0x9145, 0x9155, 0x9165, 0x9175, 0x9185, 0x9195, 0x91a5, 0x91b5, 0x91c5, 0x91e5, 0xffffffff
    .long 0xffffffff, 0xffffffff, 0xffffffff, 0xffffffff, 0xffffffff, 0xffffffff, 0xffffffff, 0xffffffff, 0xffffffff, 0xffffffff, 0xffffffff, 0xffffffff, 0xffffffff, 0xffffffff, 0xffffffff, 0xffffffff
    .long 0xffffffff, 0xffffffff, 0xffffffff, 0xffffffff, 0xffffffff, 0xffffffff, 0xffffffff, 0xffffffff, 0xffffffff, 0xffffffff, 0xffffffff, 0xffffffff, 0xffffffff, 0xffffffff, 0xffffffff, 0xffffffff
    .long 0xffffffff, 0xffffffff, 0xffffffff, 0xffffffff, 0xffffffff, 0xffffffff, 0xffffffff, 0xffffffff, 0xffffffff, 0xffffffff, 0xffffffff, 0xffffffff, 0xffffffff, 0xffffffff, 0xffffffff, 0xffffffff
    .long 0x5208, 0x19205, 0x9215, 0x9225, 0x9235, 0x9245, 0x9255, 0x9265, 0x9275, 0x9285, 0x9295, 0x92a5, 0x92b5, 0x92c5, 0x92d5, 0x92e5
    .long 0x92f5, 0x9305, 0x9315, 0x9325, 0x9335, 0x9345, 0x9355, 0x9365, 0x9375, 0x9385, 0x9395, 0x93a5, 0x93b5, 0x93c5, 0x93e5, 0xffffffff
    .long 0xffffffff, 0xffffffff, 0xffffffff, 0xffffffff, 0xffffffff, 0xffffffff, 0xffffffff, 0xffffffff, 0xffffffff, 0xffffffff, 0xffffffff, 0xffffffff, 0xffffffff, 0xffffffff, 0xffffffff, 0xffffffff
    .long 0xffffffff, 0xffffffff, 0xffffffff, 0xffffffff, 0xffffffff, 0xffffffff, 0xffffffff, 0xffffffff, 0xffffffff, 0xffffffff, 0xffffffff, 0xffffffff, 0xffffffff, 0xffffffff, 0xffffffff, 0xffffffff
    .long 0xffffffff, 0xffffffff, 0xffffffff, 0xffffffff, 0xffffffff, 0xffffffff, 0xffffffff, 0xffffffff, 0xffffffff, 0xffffffff, 0xffffffff, 0xffffffff, 0xffffffff, 0xffffffff, 0xffffffff, 0xffffffff
    .long 0x5408, 0x19405, 0x9415, 0x9425, 0x9435, 0x9445, 0x9455, 0x9465, 0x9475, 0x9485, 0x9495, 0x94a5, 0x94b5, 0x94c5, 0x94d5, 0x94e5
    .long 0x94f5, 0x9505, 0x9515, 0x9525, 0x9535, 0x9545, 0x9555, 0x9565, 0x9575, 0x9585, 0x9595, 0x95a5, 0x95b5, 0x95c5, 0x95e5, 0xffffffff
    .long 0xffffffff, 0xffffffff, 0xffffffff, 0xffffffff, 0xffffffff, 0xffffffff, 0xffffffff, 0xffffffff, 0xffffffff, 0xffffffff, 0xffffffff, 0xffffffff, 0xffffffff, 0xffffffff, 0xffffffff, 0xffffffff
    .long 0xffffffff, 0xffffffff, 0xffffffff, 0xffffffff, 0xffffffff, 0xffffffff, 0xffffffff, 0xffffffff, 0xffffffff, 0xffffffff, 0xffffffff, 0xffffffff, 0xffffffff, 0xffffffff, 0xffffffff, 0xffffffff
    .long 0xffffffff, 0xffffffff, 0xffffffff, 0xffffffff, 0xffffffff, 0xffffffff, 0xffffffff, 0xffffffff, 0xffffffff, 0xffffffff, 0xffffffff, 0xffffffff, 0xffffffff, 0xffffffff, 0xffffffff, 0xffffffff
    .long 0x5608, 0x19605, 0x9615, 0x9625, 0x9635, 0x9645, 0x9655, 0x9665, 0x9675, 0x9685, 0x9695, 0x96a5, 0x96b5, 0x96c5, 0x96d5, 0x96e5
    .long 0x96f5, 0x9705, 0x9715, 0x9725, 0x9735, 0x9745, 0x9755, 0x9765, 0x9775, 0x9785, 0x9795, 0x97a5, 0x97b5, 0x97c5, 0x97e5, 0xffffffff
    .long 0xffffffff, 0xffffffff, 0xffffffff, 0xffffffff, 0xffffffff, 0xffffffff, 0xffffffff, 0xffffffff, 0xffffffff, 0xffffffff, 0xffffffff, 0xffffffff, 0xffffffff, 0xffffffff, 0xffffffff, 0xffffffff
    .long 0xffffffff, 0xffffffff, 0xffffffff, 0xffffffff, 0xffffffff, 0xffffffff, 0xffffffff, 0xffffffff, 0xffffffff, 0xffffffff, 0xffffffff, 0xffffffff, 0xffffffff, 0xffffffff, 0xffffffff, 0xffffffff
    .long 0xffffffff, 0xffffffff, 0xffffffff, 0xffffffff, 0xffffffff, 0xffffffff, 0xffffffff, 0xffffffff, 0xffffffff, 0xffffffff, 0xffffffff, 0xffffffff, 0xffffffff, 0xffffffff, 0xffffffff, 0xffffffff
    .long 0x5808, 0x19805, 0x9815, 0x9825, 0x9835, 0x9845, 0x9855, 0x9865, 0x9875, 0x9885, 0x9895, 0x98a5, 0x98b5, 0x98c5, 0x98d5, 0x98e5
    .long 0x98f5, 0x9905, 0x9915, 0x9925, 0x9935, 0x9945, 0x9955, 0x9965, 0x9975, 0x9985, 0x9995, 0x99a5, 0x99b5, 0x99c5, 0x99e5, 0xffffffff
    .long 0xffffffff, 0xffffffff, 0xffffffff, 0xffffffff, 0xffffffff, 0xffffffff, 0xffffffff, 0xffffffff, 0xffffffff, 0xffffffff, 0xffffffff, 0xffffffff, 0xffffffff, 0xffffffff, 0xffffffff, 0xffffffff
    .long 0xffffffff, 0xffffffff, 0xffffffff, 0xffffffff, 0xffffffff, 0xffffffff, 0xffffffff, 0xffffffff, 0xffffffff, 0xffffffff, 0xffffffff, 0xffffffff, 0xffffffff, 0xffffffff, 0xffffffff, 0xffffffff
    .long 0xffffffff, 0xffffffff, 0xffffffff, 0xffffffff, 0xffffffff, 0xffffffff, 0xffffffff, 0xffffffff, 0xffffffff, 0xffffffff, 0xffffffff, 0xffffffff, 0xffffffff, 0xffffffff, 0xffffffff, 0xffffffff
    .long 0x5a08, 0x19a05, 0x9a15, 0x9a25, 0x9a35, 0x9a45, 0x9a55, 0x9a65, 0x9a75, 0x9a85, 0x9a95, 0x9aa5, 0x9ab5, 0x9ac5, 0x9ad5, 0x9ae5
    .long 0x9af5, 0x9b05, 0x9b15, 0x9b25, 0x9b35, 0x9b45, 0x9b55, 0x9b65, 0x9b75, 0x9b85, 0x9b95, 0x9ba5, 0x9bb5, 0x9bc5, 0x9be5, 0xffffffff
    .long 0xffffffff, 0xffffffff, 0xffffffff, 0xffffffff, 0xffffffff, 0xffffffff, 0xffffffff, 0xffffffff, 0xffffffff, 0xffffffff, 0xffffffff, 0xffffffff, 0xffffffff, 0xffffffff, 0xffffffff, 0xffffffff
    .long 0xffffffff, 0xffffffff, 0xffffffff, 0xffffffff, 0xffffffff, 0xffffffff, 0xffffffff, 0xffffffff, 0xffffffff, 0xffffffff, 0xffffffff, 0xffffffff, 0xffffffff, 0xffffffff, 0xffffffff, 0xffffffff
    .long 0xffffffff, 0xffffffff, 0xffffffff, 0xffffffff, 0xffffffff, 0xffffffff, 0xffffffff, 0xffffffff, 0xffffffff, 0xffffffff, 0xffffffff, 0xffffffff, 0xffffffff, 0xffffffff, 0xffffffff, 0xffffffff
    .long 0x10006, 0x16, 0x26, 0x36, 0x46, 0x56, 0x66, 0x76, 0x86, 0x96, 0xa6, 0xb6, 0xc6, 0xd6, 0x8006, 0xe6
    .long 0x8016, 0xf6, 0x8026, 0x8036, 0x106, 0x8046, 0x116, 0x8056, 0x126, 0x8066, 0x8076, 0x136, 0x8086, 0x146, 0x8096, 0x156
    .long 0x80a6, 0x80b6, 0x166, 0x80c6, 0x176, 0x80d6, 0x186, 0x80e6, 0x80f6, 0x196, 0x8106, 0x1a6, 0x8116, 0x1b6, 0x8126, 0x8136
    .long 0x1c6, 0x8146, 0x1d6, 0x8156, 0x1e6, 0x8166, 0x8176, 0x1f6, 0x8186, 0x8196, 0x81a6, 0x81b6, 0x81c6, 0x81d6, 0x81e6, 0x81f6
    .long 0xffffffff, 0xffffffff, 0xffffffff, 0xffffffff, 0xffffffff, 0xffffffff, 0xffffffff, 0xffffffff, 0xffffffff, 0xffffffff, 0xffffffff, 0xffffffff, 0xffffffff, 0xffffffff, 0xffffffff, 0xffffffff
    .long 0x12006, 0x2016, 0x2026, 0x2036, 0x2046, 0x2056, 0x2066, 0x2076, 0x2086, 0x2096, 0x20a6, 0x20b6, 0x20c6, 0x20d6, 0xa006, 0x20e6
    .long 0xa016, 0x20f6, 0xa026, 0xa036, 0x2106, 0xa046, 0x2116, 0xa056, 0x2126, 0xa066, 0xa076, 0x2136, 0xa086, 0x2146, 0xa096, 0x2156
    .long 0xa0a6, 0xa0b6, 0x2166, 0xa0c6, 0x2176, 0xa0d6, 0x2186, 0xa0e6, 0xa0f6, 0x2196, 0xa106, 0x21a6, 0xa116, 0x21b6, 0xa126, 0xa136
    .long 0x21c6, 0xa146, 0x21d6, 0xa156, 0x21e6, 0xa166, 0xa176, 0x21f6, 0xa186, 0xa196, 0xa1a6, 0xa1b6, 0xa1c6, 0xa1d6, 0xa1e6, 0xa1f6
    .long 0xffffffff, 0xffffffff, 0xffffffff, 0xffffffff, 0xffffffff, 0xffffffff, 0xffffffff, 0xffffffff, 0xffffffff, 0xffffffff, 0xffffffff, 0xffffffff, 0xffffffff, 0xffffffff, 0xffffffff, 0xffffffff
    .long 0x10206, 0x216, 0x226, 0x236, 0x246, 0x256, 0x266, 0x276, 0x286, 0x296, 0x2a6, 0x2b6, 0x2c6, 0x2d6, 0x8206, 0x2e6
    .long 0x8216, 0x2f6, 0x8226, 0x8236, 0x306, 0x8246, 0x316, 0x8256, 0x326, 0x8266, 0x8276, 0x336, 0x8286, 0x346, 0x8296, 0x356
    .long 0x82a6, 0x82b6, 0x366, 0x82c6, 0x376, 0x82d6, 0x386, 0x82e6, 0x82f6, 0x396, 0x8306, 0x3a6, 0x8316, 0x3b6, 0x8326, 0x8336
    .long 0x3c6, 0x8346, 0x3d6, 0x8356, 0x3e6, 0x8366, 0x8376, 0x3f6, 0x8386, 0x8396, 0x83a6, 0x83b6, 0x83c6, 0x83d6, 0x83e6, 0x83f6
    .long 0xffffffff, 0xffffffff, 0xffffffff, 0xffffffff, 0xffffffff, 0xffffffff, 0xffffffff, 0xffffffff, 0xffffffff, 0xffffffff, 0xffffffff, 0xffffffff, 0xffffffff, 0xffffffff, 0xffffffff, 0xffffffff
    .long 0x12206, 0x2216, 0x2226, 0x2236, 0x2246, 0x2256, 0x2266, 0x2276, 0x2286, 0x2296, 0x22a6, 0x22b6, 0x22c6, 0x22d6, 0xa206, 0x22e6
    .long 0xa216, 0x22f6, 0xa226, 0xa236, 0x2306, 0xa246, 0x2316, 0xa256, 0x2326, 0xa266, 0xa276, 0x2336, 0xa286, 0x2346, 0xa296, 0x2356
    .long 0xa2a6, 0xa2b6, 0x2366, 0xa2c6, 0x2376, 0xa2d6, 0x2386, 0xa2e6, 0xa2f6, 0x2396, 0xa306, 0x23a6, 0xa316, 0x23b6, 0xa326, 0xa336
    .long 0x23c6, 0xa346, 0x23d6, 0xa356, 0x23e6, 0xa366, 0xa376, 0x23f6, 0xa386, 0xa396, 0xa3a6, 0xa3b6, 0xa3c6, 0xa3d6, 0xa3e6, 0xa3f6
    .long 0xffffffff, 0xffffffff, 0xffffffff, 0xffffffff, 0xffffffff, 0xffffffff, 0xffffffff, 0xffffffff, 0xffffffff, 0xffffffff, 0xffffffff, 0xffffffff, 0xffffffff, 0xffffffff, 0xffffffff, 0xffffffff
    .long 0x10406, 0x416, 0x426, 0x436, 0x446, 0x456, 0x466, 0x476, 0x486, 0x496, 0x4a6, 0x4b6, 0x4c6, 0x4d6, 0x8406, 0x4e6
    .long 0x8416, 0x4f6, 0x8426, 0x8436, 0x506, 0x8446, 0x516, 0x8456, 0x526, 0x8466, 0x8476, 0x536, 0x8486, 0x546, 0x8496, 0x556
    .long 0x84a6, 0x84b6, 0x566, 0x84c6, 0x576, 0x84d6, 0x586, 0x84e6, 0x84f6, 0x596, 0x8506, 0x5a6, 0x8516, 0x5b6, 0x8526, 0x8536
    .long 0x5c6, 0x8546, 0x5d6, 0x8556, 0x5e6, 0x8566, 0x8576, 0x5f6, 0x8586, 0x8596, 0x85a6, 0x85b6, 0x85c6, 0x85d6, 0x85e6, 0x85f6
    .long 0xffffffff, 0xffffffff, 0xffffffff, 0xffffffff, 0xffffffff, 0xffffffff, 0xffffffff, 0xffffffff, 0xffffffff, 0xffffffff, 0xffffffff, 0xffffffff, 0xffffffff, 0xffffffff, 0xffffffff, 0xffffffff
    .long 0x12406, 0x2416, 0x2426, 0x2436, 0x2446, 0x2456, 0x2466, 0x2476, 0x2486, 0x2496, 0x24a6, 0x24b6, 0x24c6, 0x24d6, 0xa406, 0x24e6
    .long 0xa416, 0x24f6, 0xa426, 0xa436, 0x2506, 0xa446, 0x2516, 0xa456, 0x2526, 0xa466, 0xa476, 0x2536, 0xa486, 0x2546, 0xa496, 0x2556
    .long 0xa4a6, 0xa4b6, 0x2566, 0xa4c6, 0x2576, 0xa4d6, 0x2586, 0xa4e6, 0xa4f6, 0x2596, 0xa506, 0x25a6, 0xa516, 0x25b6, 0xa526, 0xa536
    .long 0x25c6, 0xa546, 0x25d6, 0xa556, 0x25e6, 0xa566, 0xa576, 0x25f6, 0xa586, 0xa596, 0xa5a6, 0xa5b6, 0xa5c6, 0xa5d6, 0xa5e6, 0xa5f6
    .long 0xffffffff, 0xffffffff, 0xffffffff, 0xffffffff, 0xffffffff, 0xffffffff, 0xffffffff, 0xffffffff, 0xffffffff, 0xffffffff, 0xffffffff, 0xffffffff, 0xffffffff, 0xffffffff, 0xffffffff, 0xffffffff
    .long 0x10606, 0x616, 0x626, 0x636, 0x646, 0x656, 0x666, 0x676, 0x686, 0x696, 0x6a6, 0x6b6, 0x6c6, 0x6d6, 0x8606, 0x6e6
    .long 0x8616, 0x6f6, 0x8626, 0x8636, 0x706, 0x8646, 0x716, 0x8656, 0x726, 0x8666, 0x8676, 0x736, 0x8686, 0x746, 0x8696, 0x756
    .long 0x86a6, 0x86b6, 0x766, 0x86c6, 0x776, 0x86d6, 0x786, 0x86e6, 0x86f6, 0x796, 0x8706, 0x7a6, 0x8716, 0x7b6, 0x8726, 0x8736
    .long 0x7c6, 0x8746, 0x7d6, 0x8756, 0x7e6, 0x8766, 0x8776, 0x7f6, 0x8786, 0x8796, 0x87a6, 0x87b6, 0x87c6, 0x87d6, 0x87e6, 0x87f6
    .long 0xffffffff, 0xffffffff, 0xffffffff, 0xffffffff, 0xffffffff, 0xffffffff, 0xffffffff, 0xffffffff, 0xffffffff, 0xffffffff, 0xffffffff, 0xffffffff, 0xffffffff, 0xffffffff, 0xffffffff, 0xffffffff
    .long 0x12606, 0x2616, 0x2626, 0x2636, 0x2646, 0x2656, 0x2666, 0x2676, 0x2686, 0x2696, 0x26a6, 0x26b6, 0x26c6, 0x26d6, 0xa606, 0x26e6
    .long 0xa616, 0x26f6, 0xa626, 0xa636, 0x2706, 0xa646, 0x2716, 0xa656, 0x2726, 0xa666, 0xa676, 0x2736, 0xa686, 0x2746, 0xa696, 0x2756
    .long 0xa6a6, 0xa6b6, 0x2766, 0xa6c6, 0x2776, 0xa6d6, 0x2786, 0xa6e6, 0xa6f6, 0x2796, 0xa706, 0x27a6, 0xa716, 0x27b6, 0xa726, 0xa736
    .long 0x27c6, 0xa746, 0x27d6, 0xa756, 0x27e6, 0xa766, 0xa776, 0x27f6, 0xa786, 0xa796, 0xa7a6, 0xa7b6, 0xa7c6, 0xa7d6, 0xa7e6, 0xa7f6
    .long 0xffffffff, 0xffffffff, 0xffffffff, 0xffffffff, 0xffffffff, 0xffffffff, 0xffffffff, 0xffffffff, 0xffffffff, 0xffffffff, 0xffffffff, 0xffffffff, 0xffffffff, 0xffffffff, 0xffffffff, 0xffffffff
    .long 0x10806, 0x816, 0x826, 0x836, 0x846, 0x856, 0x866, 0x876, 0x886, 0x896, 0x8a6, 0x8b6, 0x8c6, 0x8d6, 0x8806, 0x8e6
    .long 0x8816, 0x8f6, 0x8826, 0x8836, 0x906, 0x8846, 0x916, 0x8856, 0x926, 0x8866, 0x8876, 0x936, 0x8886, 0x946, 0x8896, 0x956
    .long 0x88a6, 0x88b6, 0x966, 0x88c6, 0x976, 0x88d6, 0x986, 0x88e6, 0x88f6, 0x996, 0x8906, 0x9a6, 0x8916, 0x9b6, 0x8926, 0x8936
    .long 0x9c6, 0x8946, 0x9d6, 0x8956, 0x9e6, 0x8966, 0x8976, 0x9f6, 0x8986, 0x8996, 0x89a6, 0x89b6, 0x89c6, 0x89d6, 0x89e6, 0x89f6
    .long 0xffffffff, 0xffffffff, 0xffffffff, 0xffffffff, 0xffffffff, 0xffffffff, 0xffffffff, 0xffffffff, 0xffffffff, 0xffffffff, 0xffffffff, 0xffffffff, 0xffffffff, 0xffffffff, 0xffffffff, 0xffffffff
    .long 0x12806, 0x2816, 0x2826, 0x2836, 0x2846, 0x2856, 0x2866, 0x2876, 0x2886, 0x2896, 0x28a6, 0x28b6, 0x28c6, 0x28d6, 0xa806, 0x28e6
    .long 0xa816, 0x28f6, 0xa826, 0xa836, 0x2906, 0xa846, 0x2916, 0xa856, 0x2926, 0xa866, 0xa876, 0x2936, 0xa886, 0x2946, 0xa896, 0x2956
    .long 0xa8a6, 0xa8b6, 0x2966, 0xa8c6, 0x2976, 0xa8d6, 0x2986, 0xa8e6, 0xa8f6, 0x2996, 0xa906, 0x29a6, 0xa916, 0x29b6, 0xa926, 0xa936
    .long 0x29c6, 0xa946, 0x29d6, 0xa956, 0x29e6, 0xa966, 0xa976, 0x29f6, 0xa986, 0xa996, 0xa9a6, 0xa9b6, 0xa9c6, 0xa9d6, 0xa9e6, 0xa9f6
    .long 0xffffffff, 0xffffffff, 0xffffffff, 0xffffffff, 0xffffffff, 0xffffffff, 0xffffffff, 0xffffffff, 0xffffffff, 0xffffffff, 0xffffffff, 0xffffffff, 0xffffffff, 0xffffffff, 0xffffffff, 0xffffffff
    .long 0x10a06, 0xa16, 0xa26, 0xa36, 0xa46, 0xa56, 0xa66, 0xa76, 0xa86, 0xa96, 0xaa6, 0xab6, 0xac6, 0xad6, 0x8a06, 0xae6
    .long 0x8a16, 0xaf6, 0x8a26, 0x8a36, 0xb06, 0x8a46, 0xb16, 0x8a56, 0xb26, 0x8a66, 0x8a76, 0xb36, 0x8a86, 0xb46, 0x8a96, 0xb56
    .long 0x8aa6, 0x8ab6, 0xb66, 0x8ac6, 0xb76, 0x8ad6, 0xb86, 0x8ae6, 0x8af6, 0xb96, 0x8b06, 0xba6, 0x8b16, 0xbb6, 0x8b26, 0x8b36
    .long 0xbc6, 0x8b46, 0xbd6, 0x8b56, 0xbe6, 0x8b66, 0x8b76, 0xbf6, 0x8b86, 0x8b96, 0x8ba6, 0x8bb6, 0x8bc6, 0x8bd6, 0x8be6, 0x8bf6
    .long 0xffffffff, 0xffffffff, 0xffffffff, 0xffffffff, 0xffffffff, 0xffffffff, 0xffffffff, 0xffffffff, 0xffffffff, 0xffffffff, 0xffffffff, 0xffffffff, 0xffffffff, 0xffffffff, 0xffffffff, 0xffffffff
    .long 0x12a06, 0x2a16, 0x2a26, 0x2a36, 0x2a46, 0x2a56, 0x2a66, 0x2a76, 0x2a86, 0x2a96, 0x2aa6, 0x2ab6, 0x2ac6, 0x2ad6, 0xaa06, 0x2ae6
    .long 0xaa16, 0x2af6, 0xaa26, 0xaa36, 0x2b06, 0xaa46, 0x2b16, 0xaa56, 0x2b26, 0xaa66, 0xaa76, 0x2b36, 0xaa86, 0x2b46, 0xaa96, 0x2b56
    .long 0xaaa6, 0xaab6, 0x2b66, 0xaac6, 0x2b76, 0xaad6, 0x2b86, 0xaae6, 0xaaf6, 0x2b96, 0xab06, 0x2ba6, 0xab16, 0x2bb6, 0xab26, 0xab36
    .long 0x2bc6, 0xab46, 0x2bd6, 0xab56, 0x2be6, 0xab66, 0xab76, 0x2bf6, 0xab86, 0xab96, 0xaba6, 0xabb6, 0xabc6, 0xabd6, 0xabe6, 0xabf6
    .long 0xffffffff, 0xffffffff, 0xffffffff, 0xffffffff, 0xffffffff, 0xffffffff, 0xffffffff, 0xffffffff, 0xffffffff, 0xffffffff, 0xffffffff, 0xffffffff, 0xffffffff, 0xffffffff, 0xffffffff, 0xffffffff
    .long 0x10c06, 0xc16, 0xc26, 0xc36, 0xc46, 0xc56, 0xc66, 0xc76, 0xc86, 0xc96, 0xca6, 0xcb6, 0xcc6, 0xcd6, 0x8c06, 0xce6
    .long 0x8c16, 0xcf6, 0x8c26, 0x8c36, 0xd06, 0x8c46, 0xd16, 0x8c56, 0xd26, 0x8c66, 0x8c76, 0xd36, 0x8c86, 0xd46, 0x8c96, 0xd56
    .long 0x8ca6, 0x8cb6, 0xd66, 0x8cc6, 0xd76, 0x8cd6, 0xd86, 0x8ce6, 0x8cf6, 0xd96, 0x8d06, 0xda6, 0x8d16, 0xdb6, 0x8d26, 0x8d36
    .long 0xdc6, 0x8d46, 0xdd6, 0x8d56, 0xde6, 0x8d66, 0x8d76, 0xdf6, 0x8d86, 0x8d96, 0x8da6, 0x8db6, 0x8dc6, 0x8dd6, 0x8de6, 0x8df6
    .long 0xffffffff, 0xffffffff, 0xffffffff, 0xffffffff, 0xffffffff, 0xffffffff, 0xffffffff, 0xffffffff, 0xffffffff, 0xffffffff, 0xffffffff, 0xffffffff, 0xffffffff, 0xffffffff, 0xffffffff, 0xffffffff
    .long 0x12c06, 0x2c16, 0x2c26, 0x2c36, 0x2c46, 0x2c56, 0x2c66, 0x2c76, 0x2c86, 0x2c96, 0x2ca6, 0x2cb6, 0x2cc6, 0x2cd6, 0xac06, 0x2ce6
    .long 0xac16, 0x2cf6, 0xac26, 0xac36, 0x2d06, 0xac46, 0x2d16, 0xac56, 0x2d26, 0xac66, 0xac76, 0x2d36, 0xac86, 0x2d46, 0xac96, 0x2d56
    .long 0xaca6, 0xacb6, 0x2d66, 0xacc6, 0x2d76, 0xacd6, 0x2d86, 0xace6, 0xacf6, 0x2d96, 0xad06, 0x2da6, 0xad16, 0x2db6, 0xad26, 0xad36
    .long 0x2dc6, 0xad46, 0x2dd6, 0xad56, 0x2de6, 0xad66, 0xad76, 0x2df6, 0xad86, 0xad96, 0xada6, 0xadb6, 0xadc6, 0xadd6, 0xade6, 0xadf6
    .long 0xffffffff, 0xffffffff, 0xffffffff, 0xffffffff, 0xffffffff, 0xffffffff, 0xffffffff, 0xffffffff, 0xffffffff, 0xffffffff, 0xffffffff, 0xffffffff, 0xffffffff, 0xffffffff, 0xffffffff, 0xffffffff
    .long 0x10e06, 0xe16, 0xe26, 0xe36, 0xe46, 0xe56, 0xe66, 0xe76, 0xe86, 0xe96, 0xea6, 0xeb6, 0xec6, 0xed6, 0x8e06, 0xee6
    .long 0x8e16, 0xef6, 0x8e26, 0x8e36, 0xf06, 0x8e46, 0xf16, 0x8e56, 0xf26, 0x8e66, 0x8e76, 0xf36, 0x8e86, 0xf46, 0x8e96, 0xf56
    .long 0x8ea6, 0x8eb6, 0xf66, 0x8ec6, 0xf76, 0x8ed6, 0xf86, 0x8ee6, 0x8ef6, 0xf96, 0x8f06, 0xfa6, 0x8f16, 0xfb6, 0x8f26, 0x8f36
    .long 0xfc6, 0x8f46, 0xfd6, 0x8f56, 0xfe6, 0x8f66, 0x8f76, 0xff6, 0x8f86, 0x8f96, 0x8fa6, 0x8fb6, 0x8fc6, 0x8fd6, 0x8fe6, 0x8ff6
    .long 0xffffffff, 0xffffffff, 0xffffffff, 0xffffffff, 0xffffffff, 0xffffffff, 0xffffffff, 0xffffffff, 0xffffffff, 0xffffffff, 0xffffffff, 0xffffffff, 0xffffffff, 0xffffffff, 0xffffffff, 0xffffffff
    .long 0x12e06, 0x2e16, 0x2e26, 0x2e36, 0x2e46, 0x2e56, 0x2e66, 0x2e76, 0x2e86, 0x2e96, 0x2ea6, 0x2eb6, 0x2ec6, 0x2ed6, 0xae06, 0x2ee6
    .long 0xae16, 0x2ef6, 0xae26, 0xae36, 0x2f06, 0xae46, 0x2f16, 0xae56, 0x2f26, 0xae66, 0xae76, 0x2f36, 0xae86, 0x2f46, 0xae96, 0x2f56
    .long 0xaea6, 0xaeb6, 0x2f66, 0xaec6, 0x2f76, 0xaed6, 0x2f86, 0xaee6, 0xaef6, 0x2f96, 0xaf06, 0x2fa6, 0xaf16, 0x2fb6, 0xaf26, 0xaf36
    .long 0x2fc6, 0xaf46, 0x2fd6, 0xaf56, 0x2fe6, 0xaf66, 0xaf76, 0x2ff6, 0xaf86, 0xaf96, 0xafa6, 0xafb6, 0xafc6, 0xafd6, 0xafe6, 0xaff6
    .long 0xffffffff, 0xffffffff, 0xffffffff, 0xffffffff, 0xffffffff, 0xffffffff, 0xffffffff, 0xffffffff, 0xffffffff, 0xffffffff, 0xffffffff, 0xffffffff, 0xffffffff, 0xffffffff, 0xffffffff, 0xffffffff
    .long 0x11006, 0x1016, 0x1026, 0x1036, 0x1046, 0x1056, 0x1066, 0x1076, 0x1086, 0x1096, 0x10a6, 0x10b6, 0x10c6, 0x10d6, 0x9006, 0x10e6
    .long 0x9016, 0x10f6, 0x9026, 0x9036, 0x1106, 0x9046, 0x1116, 0x9056, 0x1126, 0x9066, 0x9076, 0x1136, 0x9086, 0x1146, 0x9096, 0x1156
    .long 0x90a6, 0x90b6, 0x1166, 0x90c6, 0x1176, 0x90d6, 0x1186, 0x90e6, 0x90f6, 0x1196, 0x9106, 0x11a6, 0x9116, 0x11b6, 0x9126, 0x9136
    .long 0x11c6, 0x9146, 0x11d6, 0x9156, 0x11e6, 0x9166, 0x9176, 0x11f6, 0x9186, 0x9196, 0x91a6, 0x91b6, 0x91c6, 0x91d6, 0x91e6, 0x91f6
    .long 0xffffffff, 0xffffffff, 0xffffffff, 0xffffffff, 0xffffffff, 0xffffffff, 0xffffffff, 0xffffffff, 0xffffffff, 0xffffffff, 0xffffffff, 0xffffffff, 0xffffffff, 0xffffffff, 0xffffffff, 0xffffffff
    .long 0x13006, 0x3016, 0x3026, 0x3036, 0x3046, 0x3056, 0x3066, 0x3076, 0x3086, 0x3096, 0x30a6, 0x30b6, 0x30c6, 0x30d6, 0xb006, 0x30e6
    .long 0xb016, 0x30f6, 0xb026, 0xb036, 0x3106, 0xb046, 0x3116, 0xb056, 0x3126, 0xb066, 0xb076, 0x3136, 0xb086, 0x3146, 0xb096, 0x3156
    .long 0xb0a6, 0xb0b6, 0x3166, 0xb0c6, 0x3176, 0xb0d6, 0x3186, 0xb0e6, 0xb0f6, 0x3196, 0xb106, 0x31a6, 0xb116, 0x31b6, 0xb126, 0xb136
    .long 0x31c6, 0xb146, 0x31d6, 0xb156, 0x31e6, 0xb166, 0xb176, 0x31f6, 0xb186, 0xb196, 0xb1a6, 0xb1b6, 0xb1c6, 0xb1d6, 0xb1e6, 0xb1f6
    .long 0xffffffff, 0xffffffff, 0xffffffff, 0xffffffff, 0xffffffff, 0xffffffff, 0xffffffff, 0xffffffff, 0xffffffff, 0xffffffff, 0xffffffff, 0xffffffff, 0xffffffff, 0xffffffff, 0xffffffff, 0xffffffff
    .long 0x11206, 0x1216, 0x1226, 0x1236, 0x1246, 0x1256, 0x1266, 0x1276, 0x1286, 0x1296, 0x12a6, 0x12b6, 0x12c6, 0x12d6, 0x9206, 0x12e6
    .long 0x9216, 0x12f6, 0x9226, 0x9236, 0x1306, 0x9246, 0x1316, 0x9256, 0x1326, 0x9266, 0x9276, 0x1336, 0x9286, 0x1346, 0x9296, 0x1356
    .long 0x92a6, 0x92b6, 0x1366, 0x92c6, 0x1376, 0x92d6, 0x1386, 0x92e6, 0x92f6, 0x1396, 0x9306, 0x13a6, 0x9316, 0x13b6, 0x9326, 0x9336
    .long 0x13c6, 0x9346, 0x13d6, 0x9356, 0x13e6, 0x9366, 0x9376, 0x13f6, 0x9386, 0x9396, 0x93a6, 0x93b6, 0x93c6, 0x93d6, 0x93e6, 0x93f6
    .long 0xffffffff, 0xffffffff, 0xffffffff, 0xffffffff, 0xffffffff, 0xffffffff, 0xffffffff, 0xffffffff, 0xffffffff, 0xffffffff, 0xffffffff, 0xffffffff, 0xffffffff, 0xffffffff, 0xffffffff, 0xffffffff
    .long 0x13206, 0x3216, 0x3226, 0x3236, 0x3246, 0x3256, 0x3266, 0x3276, 0x3286, 0x3296, 0x32a6, 0x32b6, 0x32c6, 0x32d6, 0xb206, 0x32e6
    .long 0xb216, 0x32f6, 0xb226, 0xb236, 0x3306, 0xb246, 0x3316, 0xb256, 0x3326, 0xb266, 0xb276, 0x3336, 0xb286, 0x3346, 0xb296, 0x3356
    .long 0xb2a6, 0xb2b6, 0x3366, 0xb2c6, 0x3376, 0xb2d6, 0x3386, 0xb2e6, 0xb2f6, 0x3396, 0xb306, 0x33a6, 0xb316, 0x33b6, 0xb326, 0xb336
    .long 0x33c6, 0xb346, 0x33d6, 0xb356, 0x33e6, 0xb366, 0xb376, 0x33f6, 0xb386, 0xb396, 0xb3a6, 0xb3b6, 0xb3c6, 0xb3d6, 0xb3e6, 0xb3f6
    .long 0xffffffff, 0xffffffff, 0xffffffff, 0xffffffff, 0xffffffff, 0xffffffff, 0xffffffff, 0xffffffff, 0xffffffff, 0xffffffff, 0xffffffff, 0xffffffff, 0xffffffff, 0xffffffff, 0xffffffff, 0xffffffff
    .long 0x11406, 0x1416, 0x1426, 0x1436, 0x1446, 0x1456, 0x1466, 0x1476, 0x1486, 0x1496, 0x14a6, 0x14b6, 0x14c6, 0x14d6, 0x9406, 0x14e6
    .long 0x9416, 0x14f6, 0x9426, 0x9436, 0x1506, 0x9446, 0x1516, 0x9456, 0x1526, 0x9466, 0x9476, 0x1536, 0x9486, 0x1546, 0x9496, 0x1556
    .long 0x94a6, 0x94b6, 0x1566, 0x94c6, 0x1576, 0x94d6, 0x1586, 0x94e6, 0x94f6, 0x1596, 0x9506, 0x15a6, 0x9516, 0x15b6, 0x9526, 0x9536
    .long 0x15c6, 0x9546, 0x15d6, 0x9556, 0x15e6, 0x9566, 0x9576, 0x15f6, 0x9586, 0x9596, 0x95a6, 0x95b6, 0x95c6, 0x95d6, 0x95e6, 0x95f6
    .long 0xffffffff, 0xffffffff, 0xffffffff, 0xffffffff, 0xffffffff, 0xffffffff, 0xffffffff, 0xffffffff, 0xffffffff, 0xffffffff, 0xffffffff, 0xffffffff, 0xffffffff, 0xffffffff, 0xffffffff, 0xffffffff
    .long 0x13406, 0x3416, 0x3426, 0x3436, 0x3446, 0x3456, 0x3466, 0x3476, 0x3486, 0x3496, 0x34a6, 0x34b6, 0x34c6, 0x34d6, 0xb406, 0x34e6
    .long 0xb416, 0x34f6, 0xb426, 0xb436, 0x3506, 0xb446, 0x3516, 0xb456, 0x3526, 0xb466, 0xb476, 0x3536, 0xb486, 0x3546, 0xb496, 0x3556
    .long 0xb4a6, 0xb4b6, 0x3566, 0xb4c6, 0x3576, 0xb4d6, 0x3586, 0xb4e6, 0xb4f6, 0x3596, 0xb506, 0x35a6, 0xb516, 0x35b6, 0xb526, 0xb536
    .long 0x35c6, 0xb546, 0x35d6, 0xb556, 0x35e6, 0xb566, 0xb576, 0x35f6, 0xb586, 0xb596, 0xb5a6, 0xb5b6, 0xb5c6, 0xb5d6, 0xb5e6, 0xb5f6
    .long 0xffffffff, 0xffffffff, 0xffffffff, 0xffffffff, 0xffffffff, 0xffffffff, 0xffffffff, 0xffffffff, 0xffffffff, 0xffffffff, 0xffffffff, 0xffffffff, 0xffffffff, 0xffffffff, 0xffffffff, 0xffffffff
    .long 0x11606, 0x1616, 0x1626, 0x1636, 0x1646, 0x1656, 0x1666, 0x1676, 0x1686, 0x1696, 0x16a6, 0x16b6, 0x16c6, 0x16d6, 0x9606, 0x16e6
    .long 0x9616, 0x16f6, 0x9626, 0x9636, 0x1706, 0x9646, 0x1716, 0x9656, 0x1726, 0x9666, 0x9676, 0x1736, 0x9686, 0x1746, 0x9696, 0x1756
    .long 0x96a6, 0x96b6, 0x1766, 0x96c6, 0x1776, 0x96d6, 0x1786, 0x96e6, 0x96f6, 0x1796, 0x9706, 0x17a6, 0x9716, 0x17b6, 0x9726, 0x9736
    .long 0x17c6, 0x9746, 0x17d6, 0x9756, 0x17e6, 0x9766, 0x9776, 0x17f6, 0x9786, 0x9796, 0x97a6, 0x97b6, 0x97c6, 0x97d6, 0x97e6, 0x97f6
    .long 0xffffffff, 0xffffffff, 0xffffffff, 0xffffffff, 0xffffffff, 0xffffffff, 0xffffffff, 0xffffffff, 0xffffffff, 0xffffffff, 0xffffffff, 0xffffffff, 0xffffffff, 0xffffffff, 0xffffffff, 0xffffffff
    .long 0x13606, 0x3616, 0x3626, 0x3636, 0x3646, 0x3656, 0x3666, 0x3676, 0x3686, 0x3696, 0x36a6, 0x36b6, 0x36c6, 0x36d6, 0xb606, 0x36e6
    .long 0xb616, 0x36f6, 0xb626, 0xb636, 0x3706, 0xb646, 0x3716, 0xb656, 0x3726, 0xb666, 0xb676, 0x3736, 0xb686, 0x3746, 0xb696, 0x3756
    .long 0xb6a6, 0xb6b6, 0x3766, 0xb6c6, 0x3776, 0xb6d6, 0x3786, 0xb6e6, 0xb6f6, 0x3796, 0xb706, 0x37a6, 0xb716, 0x37b6, 0xb726, 0xb736
    .long 0x37c6, 0xb746, 0x37d6, 0xb756, 0x37e6, 0xb766, 0xb776, 0x37f6, 0xb786, 0xb796, 0xb7a6, 0xb7b6, 0xb7c6, 0xb7d6, 0xb7e6, 0xb7f6
    .long 0xffffffff, 0xffffffff, 0xffffffff, 0xffffffff, 0xffffffff, 0xffffffff, 0xffffffff, 0xffffffff, 0xffffffff, 0xffffffff, 0xffffffff, 0xffffffff, 0xffffffff, 0xffffffff, 0xffffffff, 0xffffffff
    .long 0x11806, 0x1816, 0x1826, 0x1836, 0x1846, 0x1856, 0x1866, 0x1876, 0x1886, 0x1896, 0x18a6, 0x18b6, 0x18c6, 0x18d6, 0x9806, 0x18e6
    .long 0x9816, 0x18f6, 0x9826, 0x9836, 0x1906, 0x9846, 0x1916, 0x9856, 0x1926, 0x9866, 0x9876, 0x1936, 0x9886, 0x1946, 0x9896, 0x1956
    .long 0x98a6, 0x98b6, 0x1966, 0x98c6, 0x1976, 0x98d6, 0x1986, 0x98e6, 0x98f6, 0x1996, 0x9906, 0x19a6, 0x9916, 0x19b6, 0x9926, 0x9936
    .long 0x19c6, 0x9946, 0x19d6, 0x9956, 0x19e6, 0x9966, 0x9976, 0x19f6, 0x9986, 0x9996, 0x99a6, 0x99b6, 0x99c6, 0x99d6, 0x99e6, 0x99f6
    .long 0xffffffff, 0xffffffff, 0xffffffff, 0xffffffff, 0xffffffff, 0xffffffff, 0xffffffff, 0xffffffff, 0xffffffff, 0xffffffff, 0xffffffff, 0xffffffff, 0xffffffff, 0xffffffff, 0xffffffff, 0xffffffff
    .long 0x13806, 0x3816, 0x3826, 0x3836, 0x3846, 0x3856, 0x3866, 0x3876, 0x3886, 0x3896, 0x38a6, 0x38b6, 0x38c6, 0x38d6, 0xb806, 0x38e6
    .long 0xb816, 0x38f6, 0xb826, 0xb836, 0x3906, 0xb846, 0x3916, 0xb856, 0x3926, 0xb866, 0xb876, 0x3936, 0xb886, 0x3946, 0xb896, 0x3956
    .long 0xb8a6, 0xb8b6, 0x3966, 0xb8c6, 0x3976, 0xb8d6, 0x3986, 0xb8e6, 0xb8f6, 0x3996, 0xb906, 0x39a6, 0xb916, 0x39b6, 0xb926, 0xb936
    .long 0x39c6, 0xb946, 0x39d6, 0xb956, 0x39e6, 0xb966, 0xb976, 0x39f6, 0xb986, 0xb996, 0xb9a6, 0xb9b6, 0xb9c6, 0xb9d6, 0xb9e6, 0xb9f6
    .long 0xffffffff, 0xffffffff, 0xffffffff, 0xffffffff, 0xffffffff, 0xffffffff, 0xffffffff, 0xffffffff, 0xffffffff, 0xffffffff, 0xffffffff, 0xffffffff, 0xffffffff, 0xffffffff, 0xffffffff, 0xffffffff
    .long 0x11a06, 0x1a16, 0x1a26, 0x1a36, 0x1a46, 0x1a56, 0x1a66, 0x1a76, 0x1a86, 0x1a96, 0x1aa6, 0x1ab6, 0x1ac6, 0x1ad6, 0x9a06, 0x1ae6
    .long 0x9a16, 0x1af6, 0x9a26, 0x9a36, 0x1b06, 0x9a46, 0x1b16, 0x9a56, 0x1b26, 0x9a66, 0x9a76, 0x1b36, 0x9a86, 0x1b46, 0x9a96, 0x1b56
    .long 0x9aa6, 0x9ab6, 0x1b66, 0x9ac6, 0x1b76, 0x9ad6, 0x1b86, 0x9ae6, 0x9af6, 0x1b96, 0x9b06, 0x1ba6, 0x9b16, 0x1bb6, 0x9b26, 0x9b36
    .long 0x1bc6, 0x9b46, 0x1bd6, 0x9b56, 0x1be6, 0x9b66, 0x9b76, 0x1bf6, 0x9b86, 0x9b96, 0x9ba6, 0x9bb6, 0x9bc6, 0x9bd6, 0x9be6, 0x9bf6
    .long 0xffffffff, 0xffffffff, 0xffffffff, 0xffffffff, 0xffffffff, 0xffffffff, 0xffffffff, 0xffffffff, 0xffffffff, 0xffffffff, 0xffffffff, 0xffffffff, 0xffffffff, 0xffffffff, 0xffffffff, 0xffffffff
    .long 0x13a06, 0x3a16, 0x3a26, 0x3a36, 0x3a46, 0x3a56, 0x3a66, 0x3a76, 0x3a86, 0x3a96, 0x3aa6, 0x3ab6, 0x3ac6, 0x3ad6, 0xba06, 0x3ae6
    .long 0xba16, 0x3af6, 0xba26, 0xba36, 0x3b06, 0xba46, 0x3b16, 0xba56, 0x3b26, 0xba66, 0xba76, 0x3b36, 0xba86, 0x3b46, 0xba96, 0x3b56
    .long 0xbaa6, 0xbab6, 0x3b66, 0xbac6, 0x3b76, 0xbad6, 0x3b86, 0xbae6, 0xbaf6, 0x3b96, 0xbb06, 0x3ba6, 0xbb16, 0x3bb6, 0xbb26, 0xbb36
    .long 0x3bc6, 0xbb46, 0x3bd6, 0xbb56, 0x3be6, 0xbb66, 0xbb76, 0x3bf6, 0xbb86, 0xbb96, 0xbba6, 0xbbb6, 0xbbc6, 0xbbd6, 0xbbe6, 0xbbf6
    .long 0xffffffff, 0xffffffff, 0xffffffff, 0xffffffff, 0xffffffff, 0xffffffff, 0xffffffff, 0xffffffff, 0xffffffff, 0xffffffff, 0xffffffff, 0xffffffff, 0xffffffff, 0xffffffff, 0xffffffff, 0xffffffff
    .long 0x11c06, 0x1c16, 0x1c26, 0x1c36, 0x1c46, 0x1c56, 0x1c66, 0x1c76, 0x1c86, 0x1c96, 0x1ca6, 0x1cb6, 0x1cc6, 0x1cd6, 0x9c06, 0x1ce6
    .long 0x9c16, 0x1cf6, 0x9c26, 0x9c36, 0x1d06, 0x9c46, 0x1d16, 0x9c56, 0x1d26, 0x9c66, 0x9c76, 0x1d36, 0x9c86, 0x1d46, 0x9c96, 0x1d56
    .long 0x9ca6, 0x9cb6, 0x1d66, 0x9cc6, 0x1d76, 0x9cd6, 0x1d86, 0x9ce6, 0x9cf6, 0x1d96, 0x9d06, 0x1da6, 0x9d16, 0x1db6, 0x9d26, 0x9d36
    .long 0x1dc6, 0x9d46, 0x1dd6, 0x9d56, 0x1de6, 0x9d66, 0x9d76, 0x1df6, 0x9d86, 0x9d96, 0x9da6, 0x9db6, 0x9dc6, 0x9dd6, 0x9de6, 0x9df6
    .long 0xffffffff, 0xffffffff, 0xffffffff, 0xffffffff, 0xffffffff, 0xffffffff, 0xffffffff, 0xffffffff, 0xffffffff, 0xffffffff, 0xffffffff, 0xffffffff, 0xffffffff, 0xffffffff, 0xffffffff, 0xffffffff
    .long 0x13c06, 0x3c16, 0x3c26, 0x3c36, 0x3c46, 0x3c56, 0x3c66, 0x3c76, 0x3c86, 0x3c96, 0x3ca6, 0x3cb6, 0x3cc6, 0x3cd6, 0xbc06, 0x3ce6
    .long 0xbc16, 0x3cf6, 0xbc26, 0xbc36, 0x3d06, 0xbc46, 0x3d16, 0xbc56, 0x3d26, 0xbc66, 0xbc76, 0x3d36, 0xbc86, 0x3d46, 0xbc96, 0x3d56
    .long 0xbca6, 0xbcb6, 0x3d66, 0xbcc6, 0x3d76, 0xbcd6, 0x3d86, 0xbce6, 0xbcf6, 0x3d96, 0xbd06, 0x3da6, 0xbd16, 0x3db6, 0xbd26, 0xbd36
    .long 0x3dc6, 0xbd46, 0x3dd6, 0xbd56, 0x3de6, 0xbd66, 0xbd76, 0x3df6, 0xbd86, 0xbd96, 0xbda6, 0xbdb6, 0xbdc6, 0xbdd6, 0xbde6, 0xbdf6
    .long 0xffffffff, 0xffffffff, 0xffffffff, 0xffffffff, 0xffffffff, 0xffffffff, 0xffffffff, 0xffffffff, 0xffffffff, 0xffffffff, 0xffffffff, 0xffffffff, 0xffffffff, 0xffffffff, 0xffffffff, 0xffffffff
    .long 0x11e06, 0x1e16, 0x1e26, 0x1e36, 0x1e46, 0x1e56, 0x1e66, 0x1e76, 0x1e86, 0x1e96, 0x1ea6, 0x1eb6, 0x1ec6, 0x1ed6, 0x9e06, 0x1ee6
    .long 0x9e16, 0x1ef6, 0x9e26, 0x9e36, 0x1f06, 0x9e46, 0x1f16, 0x9e56, 0x1f26, 0x9e66, 0x9e76, 0x1f36, 0x9e86, 0x1f46, 0x9e96, 0x1f56
    .long 0x9ea6, 0x9eb6, 0x1f66, 0x9ec6, 0x1f76, 0x9ed6, 0x1f86, 0x9ee6, 0x9ef6, 0x1f96, 0x9f06, 0x1fa6, 0x9f16, 0x1fb6, 0x9f26, 0x9f36
    .long 0x1fc6, 0x9f46, 0x1fd6, 0x9f56, 0x1fe6, 0x9f66, 0x9f76, 0x1ff6, 0x9f86, 0x9f96, 0x9fa6, 0x9fb6, 0x9fc6, 0x9fd6, 0x9fe6, 0x9ff6
    .long 0xffffffff, 0xffffffff, 0xffffffff, 0xffffffff, 0xffffffff, 0xffffffff, 0xffffffff, 0xffffffff, 0xffffffff, 0xffffffff, 0xffffffff, 0xffffffff, 0xffffffff, 0xffffffff, 0xffffffff, 0xffffffff
    .long 0x13e06, 0x3e16, 0x3e26, 0x3e36, 0x3e46, 0x3e56, 0x3e66, 0x3e76, 0x3e86, 0x3e96, 0x3ea6, 0x3eb6, 0x3ec6, 0x3ed6, 0xbe06, 0x3ee6
    .long 0xbe16, 0x3ef6, 0xbe26, 0xbe36, 0x3f06, 0xbe46, 0x3f16, 0xbe56, 0x3f26, 0xbe66, 0xbe76, 0x3f36, 0xbe86, 0x3f46, 0xbe96, 0x3f56
    .long 0xbea6, 0xbeb6, 0x3f66, 0xbec6, 0x3f76, 0xbed6, 0x3f86, 0xbee6, 0xbef6, 0x3f96, 0xbf06, 0x3fa6, 0xbf16, 0x3fb6, 0xbf26, 0xbf36
    .long 0x3fc6, 0xbf46, 0x3fd6, 0xbf56, 0x3fe6, 0xbf66, 0xbf76, 0x3ff6, 0xbf86, 0xbf96, 0xbfa6, 0xbfb6, 0xbfc6, 0xbfd6, 0xbfe6, 0xbff6
    .long 0xffffffff, 0xffffffff, 0xffffffff, 0xffffffff, 0xffffffff, 0xffffffff, 0xffffffff, 0xffffffff, 0xffffffff, 0xffffffff, 0xffffffff, 0xffffffff, 0xffffffff, 0xffffffff, 0xffffffff, 0xffffffff
    .long 0x10002, 0x12, 0x22, 0x32, 0x42, 0x52, 0x62, 0x72, 0x82, 0x92, 0xa2, 0xb2, 0xc2, 0xd2, 0xe2, 0xf2
    .long 0x102, 0x112, 0x122, 0x132, 0x142, 0x152, 0x162, 0x172, 0x182, 0x192, 0x1a2, 0x1b2, 0x1c2, 0x1d2, 0x1e2, 0x1f2
    .long 0x81d2, 0x8de2, 0xffffffff, 0xffffffff, 0xffffffff, 0xffffffff, 0xffffffff, 0xffffffff, 0xffffffff, 0xffffffff, 0xffffffff, 0xffffffff, 0xffffffff, 0xffffffff, 0xffffffff, 0xffffffff
    .long 0xffffffff, 0xffffffff, 0xffffffff, 0xffffffff, 0xffffffff, 0xffffffff, 0xffffffff, 0xffffffff, 0xffffffff, 0xffffffff, 0xffffffff, 0xffffffff, 0xffffffff, 0xffffffff, 0xffffffff, 0xffffffff
    .long 0xffffffff, 0xffffffff, 0xffffffff, 0xffffffff, 0xffffffff, 0xffffffff, 0xffffffff, 0xffffffff, 0xffffffff, 0xffffffff, 0xffffffff, 0xffffffff, 0xffffffff, 0xffffffff, 0xffffffff, 0xffffffff
    .long 0x10202, 0x212, 0x222, 0x232, 0x242, 0x252, 0x262, 0x272, 0x282, 0x292, 0x2a2, 0x2b2, 0x2c2, 0x2d2, 0x2e2, 0x2f2
    .long 0x302, 0x312, 0x322, 0x332, 0x342, 0x352, 0x362, 0x372, 0x382, 0x392, 0x3a2, 0x3b2, 0x3c2, 0x3d2, 0x3e2, 0x3f2
    .long 0x87d2, 0x83f2, 0xffffffff, 0xffffffff, 0xffffffff, 0xffffffff, 0xffffffff, 0xffffffff, 0xffffffff, 0xffffffff, 0xffffffff, 0xffffffff, 0xffffffff, 0xffffffff, 0xffffffff, 0xffffffff
    .long 0xffffffff, 0xffffffff, 0xffffffff, 0xffffffff, 0xffffffff, 0xffffffff, 0xffffffff, 0xffffffff, 0xffffffff, 0xffffffff, 0xffffffff, 0xffffffff, 0xffffffff, 0xffffffff, 0xffffffff, 0xffffffff
    .long 0xffffffff, 0xffffffff, 0xffffffff, 0xffffffff, 0xffffffff, 0xffffffff, 0xffffffff, 0xffffffff, 0xffffffff, 0xffffffff, 0xffffffff, 0xffffffff, 0xffffffff, 0xffffffff, 0xffffffff, 0xffffffff
    .long 0x10402, 0x412, 0x422, 0x432, 0x442, 0x452, 0x462, 0x472, 0x482, 0x492, 0x4a2, 0x4b2, 0x4c2, 0x4d2, 0x4e2, 0x4f2
    .long 0x502, 0x512, 0x522, 0x532, 0x542, 0x552, 0x562, 0x572, 0x582, 0x592, 0x5a2, 0x5b2, 0x5c2, 0x5d2, 0x5e2, 0x5f2
    .long 0x8dd2, 0x89f2, 0xffffffff, 0xffffffff, 0xffffffff, 0xffffffff, 0xffffffff, 0xffffffff, 0xffffffff, 0xffffffff, 0xffffffff, 0xffffffff, 0xffffffff, 0xffffffff, 0xffffffff, 0xffffffff
    .long 0xffffffff, 0xffffffff, 0xffffffff, 0xffffffff, 0xffffffff, 0xffffffff, 0xffffffff, 0xffffffff, 0xffffffff, 0xffffffff, 0xffffffff, 0xffffffff, 0xffffffff, 0xffffffff, 0xffffffff, 0xffffffff
    .long 0xffffffff, 0xffffffff, 0xffffffff, 0xffffffff, 0xffffffff, 0xffffffff, 0xffffffff, 0xffffffff, 0xffffffff, 0xffffffff, 0xffffffff, 0xffffffff, 0xffffffff, 0xffffffff, 0xffffffff, 0xffffffff
    .long 0x10602, 0x612, 0x622, 0x632, 0x642, 0x652, 0x662, 0x672, 0x682, 0x692, 0x6a2, 0x6b2, 0x6c2, 0x6d2, 0x6e2, 0x6f2
    .long 0x702, 0x712, 0x722, 0x732, 0x742, 0x752, 0x762, 0x772, 0x782, 0x792, 0x7a2, 0x7b2, 0x7c2, 0x7d2, 0x7e2, 0x7f2
    .long 0x83e2, 0x8ff2, 0xffffffff, 0xffffffff, 0xffffffff, 0xffffffff, 0xffffffff, 0xffffffff, 0xffffffff, 0xffffffff, 0xffffffff, 0xffffffff, 0xffffffff, 0xffffffff, 0xffffffff, 0xffffffff
    .long 0xffffffff, 0xffffffff, 0xffffffff, 0xffffffff, 0xffffffff, 0xffffffff, 0xffffffff, 0xffffffff, 0xffffffff, 0xffffffff, 0xffffffff, 0xffffffff, 0xffffffff, 0xffffffff, 0xffffffff, 0xffffffff
    .long 0xffffffff, 0xffffffff, 0xffffffff, 0xffffffff, 0xffffffff, 0xffffffff, 0xffffffff, 0xffffffff, 0xffffffff, 0xffffffff, 0xffffffff, 0xffffffff, 0xffffffff, 0xffffffff, 0xffffffff, 0xffffffff
    .long 0x10802, 0x812, 0x822, 0x832, 0x842, 0x852, 0x862, 0x872, 0x882, 0x892, 0x8a2, 0x8b2, 0x8c2, 0x8d2, 0x8e2, 0x8f2
    .long 0x902, 0x912, 0x922, 0x932, 0x942, 0x952, 0x962, 0x972, 0x982, 0x992, 0x9a2, 0x9b2, 0x9c2, 0x9d2, 0x9e2, 0x9f2
    .long 0x89e2, 0xffffffff, 0xffffffff, 0xffffffff, 0xffffffff, 0xffffffff, 0xffffffff, 0xffffffff, 0xffffffff, 0xffffffff, 0xffffffff, 0xffffffff, 0xffffffff, 0xffffffff, 0xffffffff, 0xffffffff
    .long 0xffffffff, 0xffffffff, 0xffffffff, 0xffffffff, 0xffffffff, 0xffffffff, 0xffffffff, 0xffffffff, 0xffffffff, 0xffffffff, 0xffffffff, 0xffffffff, 0xffffffff, 0xffffffff, 0xffffffff, 0xffffffff
    .long 0xffffffff, 0xffffffff, 0xffffffff, 0xffffffff, 0xffffffff, 0xffffffff, 0xffffffff, 0xffffffff, 0xffffffff, 0xffffffff, 0xffffffff, 0xffffffff, 0xffffffff, 0xffffffff, 0xffffffff, 0xffffffff
    .long 0x10a02, 0xa12, 0xa22, 0xa32, 0xa42, 0xa52, 0xa62, 0xa72, 0xa82, 0xa92, 0xaa2, 0xab2, 0xac2, 0xad2, 0xae2, 0xaf2
    .long 0xb02, 0xb12, 0xb22, 0xb32, 0xb42, 0xb52, 0xb62, 0xb72, 0xb82, 0xb92, 0xba2, 0xbb2, 0xbc2, 0xbd2, 0xbe2, 0xbf2
    .long 0x83d2, 0x8fe2, 0xffffffff, 0xffffffff, 0xffffffff, 0xffffffff, 0xffffffff, 0xffffffff, 0xffffffff, 0xffffffff, 0xffffffff, 0xffffffff, 0xffffffff, 0xffffffff, 0xffffffff, 0xffffffff
    .long 0xffffffff, 0xffffffff, 0xffffffff, 0xffffffff, 0xffffffff, 0xffffffff, 0xffffffff, 0xffffffff, 0xffffffff, 0xffffffff, 0xffffffff, 0xffffffff, 0xffffffff, 0xffffffff, 0xffffffff, 0xffffffff
    .long 0xffffffff, 0xffffffff, 0xffffffff, 0xffffffff, 0xffffffff, 0xffffffff, 0xffffffff, 0xffffffff, 0xffffffff, 0xffffffff, 0xffffffff, 0xffffffff, 0xffffffff, 0xffffffff, 0xffffffff, 0xffffffff
    .long 0x10c02, 0xc12, 0xc22, 0xc32, 0xc42, 0xc52, 0xc62, 0xc72, 0xc82, 0xc92, 0xca2, 0xcb2, 0xcc2, 0xcd2, 0xce2, 0xcf2
    .long 0xd02, 0xd12, 0xd22, 0xd32, 0xd42, 0xd52, 0xd62, 0xd72, 0xd82, 0xd92, 0xda2, 0xdb2, 0xdc2, 0xdd2, 0xde2, 0xdf2
    .long 0x89d2, 0x85f2, 0xffffffff, 0xffffffff, 0xffffffff, 0xffffffff, 0xffffffff, 0xffffffff, 0xffffffff, 0xffffffff, 0xffffffff, 0xffffffff, 0xffffffff, 0xffffffff, 0xffffffff, 0xffffffff
    .long 0xffffffff, 0xffffffff, 0xffffffff, 0xffffffff, 0xffffffff, 0xffffffff, 0xffffffff, 0xffffffff, 0xffffffff, 0xffffffff, 0xffffffff, 0xffffffff, 0xffffffff, 0xffffffff, 0xffffffff, 0xffffffff
    .long 0xffffffff, 0xffffffff, 0xffffffff, 0xffffffff, 0xffffffff, 0xffffffff, 0xffffffff, 0xffffffff, 0xffffffff, 0xffffffff, 0xffffffff, 0xffffffff, 0xffffffff, 0xffffffff, 0xffffffff, 0xffffffff
    .long 0x10e02, 0xe12, 0xe22, 0xe32, 0xe42, 0xe52, 0xe62, 0xe72, 0xe82, 0xe92, 0xea2, 0xeb2, 0xec2, 0xed2, 0xee2, 0xef2
    .long 0xf02, 0xf12, 0xf22, 0xf32, 0xf42, 0xf52, 0xf62, 0xf72, 0xf82, 0xf92, 0xfa2, 0xfb2, 0xfc2, 0xfd2, 0xfe2, 0xff2
    .long 0x8fd2, 0x8bf2, 0xffffffff, 0xffffffff, 0xffffffff, 0xffffffff, 0xffffffff, 0xffffffff, 0xffffffff, 0xffffffff, 0xffffffff, 0xffffffff, 0xffffffff, 0xffffffff, 0xffffffff, 0xffffffff
    .long 0xffffffff, 0xffffffff, 0xffffffff, 0xffffffff, 0xffffffff, 0xffffffff, 0xffffffff, 0xffffffff, 0xffffffff, 0xffffffff, 0xffffffff, 0xffffffff, 0xffffffff, 0xffffffff, 0xffffffff, 0xffffffff
    .long 0xffffffff, 0xffffffff, 0xffffffff, 0xffffffff, 0xffffffff, 0xffffffff, 0xffffffff, 0xffffffff, 0xffffffff, 0xffffffff, 0xffffffff, 0xffffffff, 0xffffffff, 0xffffffff, 0xffffffff, 0xffffffff
    .long 0x18002, 0x8c02, 0x8812, 0x8422, 0x8032, 0x8c32, 0x8842, 0x8452, 0x8062, 0x8c62, 0x8872, 0x8482, 0x8092, 0x8c92, 0x88a2, 0x84b2
    .long 0x80c2, 0x8cc2, 0x88d2, 0x84e2, 0x80f2, 0x8cf2, 0x8902, 0x8512, 0x8122, 0x8d22, 0x8932, 0x8542, 0x8152, 0x8d52, 0x8962, 0x8572
    .long 0x8182, 0x8d82, 0x8992, 0x85a2, 0x81b2, 0x8db2, 0x89c2, 0x85e2, 0xffffffff, 0xffffffff, 0xffffffff, 0xffffffff, 0xffffffff, 0xffffffff, 0xffffffff, 0xffffffff
    .long 0xffffffff, 0xffffffff, 0xffffffff, 0xffffffff, 0xffffffff, 0xffffffff, 0xffffffff, 0xffffffff, 0xffffffff, 0xffffffff, 0xffffffff, 0xffffffff, 0xffffffff, 0xffffffff, 0xffffffff, 0xffffffff
    .long 0xffffffff, 0xffffffff, 0xffffffff, 0xffffffff, 0xffffffff, 0xffffffff, 0xffffffff, 0xffffffff, 0xffffffff, 0xffffffff, 0xffffffff, 0xffffffff, 0xffffffff, 0xffffffff, 0xffffffff, 0xffffffff
    .long 0x18202, 0x8e02, 0x8a12, 0x8622, 0x8232, 0x8e32, 0x8a42, 0x8652, 0x8262, 0x8e62, 0x8a72, 0x8682, 0x8292, 0x8e92, 0x8aa2, 0x86b2
    .long 0x82c2, 0x8ec2, 0x8ad2, 0x86e2, 0x82f2, 0x8ef2, 0x8b02, 0x8712, 0x8322, 0x8f22, 0x8b32, 0x8742, 0x8352, 0x8f52, 0x8b62, 0x8772
    .long 0x8382, 0x8f82, 0x8b92, 0x87a2, 0x83b2, 0x8fb2, 0x8bc2, 0x8be2, 0xffffffff, 0xffffffff, 0xffffffff, 0xffffffff, 0xffffffff, 0xffffffff, 0xffffffff, 0xffffffff
    .long 0xffffffff, 0xffffffff, 0xffffffff, 0xffffffff, 0xffffffff, 0xffffffff, 0xffffffff, 0xffffffff, 0xffffffff, 0xffffffff, 0xffffffff, 0xffffffff, 0xffffffff, 0xffffffff, 0xffffffff, 0xffffffff
    .long 0xffffffff, 0xffffffff, 0xffffffff, 0xffffffff, 0xffffffff, 0xffffffff, 0xffffffff, 0xffffffff, 0xffffffff, 0xffffffff, 0xffffffff, 0xffffffff, 0xffffffff, 0xffffffff, 0xffffffff, 0xffffffff
    .long 0x18402, 0x8012, 0x8c12, 0x8822, 0x8432, 0x8042, 0x8c42, 0x8852, 0x8462, 0x8072, 0x8c72, 0x8882, 0x8492, 0x80a2, 0x8ca2, 0x88b2
    .long 0x84c2, 0x80d2, 0x8cd2, 0x88e2, 0x84f2, 0x8102, 0x8d02, 0x8912, 0x8522, 0x8132, 0x8d32, 0x8942, 0x8552, 0x8162, 0x8d62, 0x8972
    .long 0x8582, 0x8192, 0x8d92, 0x89a2, 0x85b2, 0x81c2, 0x8dc2, 0x85d2, 0x81f2, 0xffffffff, 0xffffffff, 0xffffffff, 0xffffffff, 0xffffffff, 0xffffffff, 0xffffffff
    .long 0xffffffff, 0xffffffff, 0xffffffff, 0xffffffff, 0xffffffff, 0xffffffff, 0xffffffff, 0xffffffff, 0xffffffff, 0xffffffff, 0xffffffff, 0xffffffff, 0xffffffff, 0xffffffff, 0xffffffff, 0xffffffff
    .long 0xffffffff, 0xffffffff, 0xffffffff, 0xffffffff, 0xffffffff, 0xffffffff, 0xffffffff, 0xffffffff, 0xffffffff, 0xffffffff, 0xffffffff, 0xffffffff, 0xffffffff, 0xffffffff, 0xffffffff, 0xffffffff
    .long 0x18602, 0x8212, 0x8e12, 0x8a22, 0x8632, 0x8242, 0x8e42, 0x8a52, 0x8662, 0x8272, 0x8e72, 0x8a82, 0x8692, 0x82a2, 0x8ea2, 0x8ab2
    .long 0x86c2, 0x82d2, 0x8ed2, 0x8ae2, 0x86f2, 0x8302, 0x8f02, 0x8b12, 0x8722, 0x8332, 0x8f32, 0x8b42, 0x8752, 0x8362, 0x8f62, 0x8b72
    .long 0x8782, 0x8392, 0x8f92, 0x8ba2, 0x87b2, 0x83c2, 0x8fc2, 0x8bd2, 0x87f2, 0xffffffff, 0xffffffff, 0xffffffff, 0xffffffff, 0xffffffff, 0xffffffff, 0xffffffff
    .long 0xffffffff, 0xffffffff, 0xffffffff, 0xffffffff, 0xffffffff, 0xffffffff, 0xffffffff, 0xffffffff, 0xffffffff, 0xffffffff, 0xffffffff, 0xffffffff, 0xffffffff, 0xffffffff, 0xffffffff, 0xffffffff
    .long 0xffffffff, 0xffffffff, 0xffffffff, 0xffffffff, 0xffffffff, 0xffffffff, 0xffffffff, 0xffffffff, 0xffffffff, 0xffffffff, 0xffffffff, 0xffffffff, 0xffffffff, 0xffffffff, 0xffffffff, 0xffffffff
    .long 0x18802, 0x8412, 0x8022, 0x8c22, 0x8832, 0x8442, 0x8052, 0x8c52, 0x8862, 0x8472, 0x8082, 0x8c82, 0x8892, 0x84a2, 0x80b2, 0x8cb2
    .long 0x88c2, 0x84d2, 0x80e2, 0x8ce2, 0x88f2, 0x8502, 0x8112, 0x8d12, 0x8922, 0x8532, 0x8142, 0x8d42, 0x8952, 0x8562, 0x8172, 0x8d72
    .long 0x8982, 0x8592, 0x81a2, 0x8da2, 0x89b2, 0x85c2, 0x81e2, 0x8df2, 0xffffffff, 0xffffffff, 0xffffffff, 0xffffffff, 0xffffffff, 0xffffffff, 0xffffffff, 0xffffffff
    .long 0xffffffff, 0xffffffff, 0xffffffff, 0xffffffff, 0xffffffff, 0xffffffff, 0xffffffff, 0xffffffff, 0xffffffff, 0xffffffff, 0xffffffff, 0xffffffff, 0xffffffff, 0xffffffff, 0xffffffff, 0xffffffff
    .long 0xffffffff, 0xffffffff, 0xffffffff, 0xffffffff, 0xffffffff, 0xffffffff, 0xffffffff, 0xffffffff, 0xffffffff, 0xffffffff, 0xffffffff, 0xffffffff, 0xffffffff, 0xffffffff, 0xffffffff, 0xffffffff
    .long 0x18a02, 0x8612, 0x8222, 0x8e22, 0x8a32, 0x8642, 0x8252, 0x8e52, 0x8a62, 0x8672, 0x8282, 0x8e82, 0x8a92, 0x86a2, 0x82b2, 0x8eb2
    .long 0x8ac2, 0x86d2, 0x82e2, 0x8ee2, 0x8af2, 0x8702, 0x8312, 0x8f12, 0x8b22, 0x8732, 0x8342, 0x8f42, 0x8b52, 0x8762, 0x8372, 0x8f72
    .long 0x8b82, 0x8792, 0x83a2, 0x8fa2, 0x8bb2, 0x87c2, 0x87e2, 0xffffffff, 0xffffffff, 0xffffffff, 0xffffffff, 0xffffffff, 0xffffffff, 0xffffffff, 0xffffffff, 0xffffffff
    .long 0xffffffff, 0xffffffff, 0xffffffff, 0xffffffff, 0xffffffff, 0xffffffff, 0xffffffff, 0xffffffff, 0xffffffff, 0xffffffff, 0xffffffff, 0xffffffff, 0xffffffff, 0xffffffff, 0xffffffff, 0xffffffff
    .long 0xffffffff, 0xffffffff, 0xffffffff, 0xffffffff, 0xffffffff, 0xffffffff, 0xffffffff, 0xffffffff, 0xffffffff, 0xffffffff, 0xffffffff, 0xffffffff, 0xffffffff, 0xffffffff, 0xffffffff, 0xffffffff
    .long 0x10004, 0x14, 0x24, 0x34, 0x44, 0x54, 0x64, 0x74, 0x84, 0x94, 0xa4, 0xb4, 0xc4, 0xd4, 0xe4, 0xf4
    .long 0x104, 0x114, 0x124, 0x134, 0x144, 0x154, 0x164, 0x174, 0x184, 0x194, 0x1a4, 0x1b4, 0x1c4, 0x1d4, 0x1e4, 0x1f4
    .long 0xffffffff, 0xffffffff, 0xffffffff, 0xffffffff, 0xffffffff, 0xffffffff, 0xffffffff, 0xffffffff, 0xffffffff, 0xffffffff, 0xffffffff, 0xffffffff, 0xffffffff, 0xffffffff, 0xffffffff, 0xffffffff
    .long 0xffffffff, 0xffffffff, 0xffffffff, 0xffffffff, 0xffffffff, 0xffffffff, 0xffffffff, 0xffffffff, 0xffffffff, 0xffffffff, 0xffffffff, 0xffffffff, 0xffffffff, 0xffffffff, 0xffffffff, 0xffffffff
    .long 0xffffffff, 0xffffffff, 0xffffffff, 0xffffffff, 0xffffffff, 0xffffffff, 0xffffffff, 0xffffffff, 0xffffffff, 0xffffffff, 0xffffffff, 0xffffffff, 0xffffffff, 0xffffffff, 0xffffffff, 0xffffffff
    .long 0x10204, 0x214, 0x224, 0x234, 0x244, 0x254, 0x264, 0x274, 0x284, 0x294, 0x2a4, 0x2b4, 0x2c4, 0x2d4, 0x2e4, 0x2f4
    .long 0x304, 0x314, 0x324, 0x334, 0x344, 0x354, 0x364, 0x374, 0x384, 0x394, 0x3a4, 0x3b4, 0x3c4, 0x3d4, 0x3e4, 0x3f4
    .long 0xffffffff, 0xffffffff, 0xffffffff, 0xffffffff, 0xffffffff, 0xffffffff, 0xffffffff, 0xffffffff, 0xffffffff, 0xffffffff, 0xffffffff, 0xffffffff, 0xffffffff, 0xffffffff, 0xffffffff, 0xffffffff
    .long 0xffffffff, 0xffffffff, 0xffffffff, 0xffffffff, 0xffffffff, 0xffffffff, 0xffffffff, 0xffffffff, 0xffffffff, 0xffffffff, 0xffffffff, 0xffffffff, 0xffffffff, 0xffffffff, 0xffffffff, 0xffffffff
    .long 0xffffffff, 0xffffffff, 0xffffffff, 0xffffffff, 0xffffffff, 0xffffffff, 0xffffffff, 0xffffffff, 0xffffffff, 0xffffffff, 0xffffffff, 0xffffffff, 0xffffffff, 0xffffffff, 0xffffffff, 0xffffffff
    .long 0x18000, 0x8010, 0x8020, 0x8030, 0x8040, 0x8050, 0x8060, 0x8070, 0x8080, 0x8090, 0x80a0, 0x80b0, 0x80c0, 0x80d0, 0x80e0, 0x80f0
    .long 0x8100, 0x8110, 0x8120, 0x8130, 0x8140, 0x8150, 0x8160, 0x8170, 0x8180, 0x8190, 0x81a0, 0x81b0, 0x81c0, 0x81d0, 0x81e0, 0x81f0
    .long 0xffffffff, 0xffffffff, 0xffffffff, 0xffffffff, 0xffffffff, 0xffffffff, 0xffffffff, 0xffffffff, 0xffffffff, 0xffffffff, 0xffffffff, 0xffffffff, 0xffffffff, 0xffffffff, 0xffffffff, 0xffffffff
    .long 0xffffffff, 0xffffffff, 0xffffffff, 0xffffffff, 0xffffffff, 0xffffffff, 0xffffffff, 0xffffffff, 0xffffffff, 0xffffffff, 0xffffffff, 0xffffffff, 0xffffffff, 0xffffffff, 0xffffffff, 0xffffffff
    .long 0xffffffff, 0xffffffff, 0xffffffff, 0xffffffff, 0xffffffff, 0xffffffff, 0xffffffff, 0xffffffff, 0xffffffff, 0xffffffff, 0xffffffff, 0xffffffff, 0xffffffff, 0xffffffff, 0xffffffff, 0xffffffff
    .long 0x18200, 0x8210, 0x8220, 0x8230, 0x8240, 0x8250, 0x8260, 0x8270, 0x8280, 0x8290, 0x82a0, 0x82b0, 0x82c0, 0x82d0, 0x82e0, 0x82f0
    .long 0x8300, 0x8310, 0x8320, 0x8330, 0x8340, 0x8350, 0x8360, 0x8370, 0x8380, 0x8390, 0x83a0, 0x83b0, 0x83c0, 0x83d0, 0x83e0, 0x83f0
    .long 0xffffffff, 0xffffffff, 0xffffffff, 0xffffffff, 0xffffffff, 0xffffffff, 0xffffffff, 0xffffffff, 0xffffffff, 0xffffffff, 0xffffffff, 0xffffffff, 0xffffffff, 0xffffffff, 0xffffffff, 0xffffffff
    .long 0xffffffff, 0xffffffff, 0xffffffff, 0xffffffff, 0xffffffff, 0xffffffff, 0xffffffff, 0xffffffff, 0xffffffff, 0xffffffff, 0xffffffff, 0xffffffff, 0xffffffff, 0xffffffff, 0xffffffff, 0xffffffff
    .long 0xffffffff, 0xffffffff, 0xffffffff, 0xffffffff, 0xffffffff, 0xffffffff, 0xffffffff, 0xffffffff, 0xffffffff, 0xffffffff, 0xffffffff, 0xffffffff, 0xffffffff, 0xffffffff, 0xffffffff, 0xffffffff
    .long 0x5c08, 0x18004, 0x8014, 0x8024, 0x8034, 0x8044, 0x8054, 0x8064, 0x8074, 0x8084, 0x8094, 0x80a4, 0x80b4, 0x80c4, 0x80d4, 0x80e4
    .long 0x80f4, 0x8104, 0x8114, 0x8124, 0x8134, 0x8144, 0x8154, 0x8164, 0x8174, 0x8184, 0x8194, 0x81a4, 0x81b4, 0x81c4, 0x81d4, 0x81e4
    .long 0x81f4, 0xffffffff, 0xffffffff, 0xffffffff, 0xffffffff, 0xffffffff, 0xffffffff, 0xffffffff, 0xffffffff, 0xffffffff, 0xffffffff, 0xffffffff, 0xffffffff, 0xffffffff, 0xffffffff, 0xffffffff
    .long 0xffffffff, 0xffffffff, 0xffffffff, 0xffffffff, 0xffffffff, 0xffffffff, 0xffffffff, 0xffffffff, 0xffffffff, 0xffffffff, 0xffffffff, 0xffffffff, 0xffffffff, 0xffffffff, 0xffffffff, 0xffffffff
    .long 0xffffffff, 0xffffffff, 0xffffffff, 0xffffffff, 0xffffffff, 0xffffffff, 0xffffffff, 0xffffffff, 0xffffffff, 0xffffffff, 0xffffffff, 0xffffffff, 0xffffffff, 0xffffffff, 0xffffffff, 0xffffffff
    .long 0x5e08, 0x18204, 0x8214, 0x8224, 0x8234, 0x8244, 0x8254, 0x8264, 0x8274, 0x8284, 0x8294, 0x82a4, 0x82b4, 0x82c4, 0x82d4, 0x82e4
    .long 0x82f4, 0x8304, 0x8314, 0x8324, 0x8334, 0x8344, 0x8354, 0x8364, 0x8374, 0x8384, 0x8394, 0x83a4, 0x83b4, 0x83c4, 0x83d4, 0x83e4
    .long 0x83f4, 0xffffffff, 0xffffffff, 0xffffffff, 0xffffffff, 0xffffffff, 0xffffffff, 0xffffffff, 0xffffffff, 0xffffffff, 0xffffffff, 0xffffffff, 0xffffffff, 0xffffffff, 0xffffffff, 0xffffffff
    .long 0xffffffff, 0xffffffff, 0xffffffff, 0xffffffff, 0xffffffff, 0xffffffff, 0xffffffff, 0xffffffff, 0xffffffff, 0xffffffff, 0xffffffff, 0xffffffff, 0xffffffff, 0xffffffff, 0xffffffff, 0xffffffff
    .long 0xffffffff, 0xffffffff, 0xffffffff, 0xffffffff, 0xffffffff, 0xffffffff, 0xffffffff, 0xffffffff, 0xffffffff, 0xffffffff, 0xffffffff, 0xffffffff, 0xffffffff, 0xffffffff, 0xffffffff, 0xffffffff

.section .rodata,"a"
.p2align 6
.amdhsa_kernel prep_kernel
  .amdhsa_next_free_vgpr 80
  .amdhsa_next_free_sgpr 102
  .amdhsa_accum_offset 80
  .amdhsa_group_segment_fixed_size 0
  .amdhsa_kernarg_size 112
  .amdhsa_user_sgpr_count 2
  .amdhsa_user_sgpr_kernarg_segment_ptr 1
  .amdhsa_system_sgpr_workgroup_id_x 1
.end_amdhsa_kernel

.p2align 6
.amdhsa_kernel mega_kernel
  .amdhsa_next_free_vgpr 512
  .amdhsa_next_free_sgpr 102
  .amdhsa_accum_offset 256
  .amdhsa_group_segment_fixed_size 0
  .amdhsa_kernarg_size 112
  .amdhsa_user_sgpr_count 2
  .amdhsa_user_sgpr_kernarg_segment_ptr 1
  .amdhsa_system_sgpr_workgroup_id_x 1
.end_amdhsa_kernel
```
